```python
import torch

def _softmax(x, axis=-1):
    return torch.softmax(x, dim=axis)
def _gelu(x):
    return torch.nn.functional.gelu(x, approximate="tanh")
def _silu(x):
    return torch.nn.functional.silu(x)
def _sigmoid(x):
    return torch.sigmoid(x)
def _layernorm(x, axis=-1, eps=1e-5):
    m = x.mean(dim=axis, keepdim=True)
    v = x.var(dim=axis, keepdim=True, unbiased=False)
    return (x - m) / torch.sqrt(v + eps)
def _scatter_add(tgt, idx, src, axis=0):
    return tgt.clone().index_add_(axis, idx, src)
def _segment_sum(src, seg, n):
    out = torch.zeros((n,) + src.shape[1:], dtype=src.dtype)
    return out.index_add_(0, seg, src)
def _pad(x, pw):
    flat = tuple(v for pair in reversed(pw) for v in pair)
    return torch.nn.functional.pad(x, flat)

kernel_name = 'parallel_sum__linear_kernel_hedgehog__dense_activation_gelu__prompt'

def setup_inputs():

    _w = (lambda a: (lambda t: t.to(torch.bfloat16) if t.is_floating_point() else t)(torch.as_tensor(a)))
    def _A_setup():
        B, S, D, H = 1, 2048, 1024, 32
        Dh = D // H
        return {
            "x": _w((lambda *s: torch.randn(*s, dtype=torch.bfloat16) * 0.05)(B, S, D)),
            "wqkv": _w((lambda *s: torch.randn(*s, dtype=torch.bfloat16) * 0.2)(D, 3 * D)),
            "w_phi": _w((lambda *s: torch.randn(*s, dtype=torch.bfloat16) * 0.2)(H, Dh, Dh) * (Dh ** -0.5)),
            "wo": _w((lambda *s: torch.randn(*s, dtype=torch.bfloat16) * 0.05)(D, D)),
        }
    _A_in = _A_setup()

    def _B_setup():
        B, S, D, F = 1, 2048, 1024, 3584
        return {
            "x": _w((lambda *s: torch.randn(*s, dtype=torch.bfloat16) * 0.05)(B, S, D)),
            "w1": _w((lambda *s: torch.randn(*s, dtype=torch.bfloat16) * 0.8)(D, F) * (D ** -0.5)),
            "b1": _w((lambda *s: torch.randn(*s, dtype=torch.bfloat16) * 0.8)(F) * 0.01),
            "w2": _w((lambda *s: torch.randn(*s, dtype=torch.bfloat16) * 0.2)(F, D) * (F ** -0.5)),
            "b2": _w((lambda *s: torch.randn(*s, dtype=torch.bfloat16) * 0.2)(D) * 0.01),
        }
    _B_in = _B_setup()

    return {
        "A_x": _A_in["x"],
        "A_wqkv": _A_in["wqkv"],
        "A_w_phi": _A_in["w_phi"],
        "A_wo": _A_in["wo"],
        "B_x": _B_in["x"],
        "B_w1": _B_in["w1"],
        "B_b1": _B_in["b1"],
        "B_w2": _B_in["w2"],
        "B_b2": _B_in["b2"],
    }

def reference(A_x, A_wqkv, A_w_phi, A_wo, B_x, B_w1, B_b1, B_w2, B_b2):
    def _A_ref(x, wqkv, w_phi, wo):
        B, S, D = x.shape
        H = 32; Dh = D // H
        qkv = (lambda x, *d: x.permute(*d))((x @ wqkv).reshape(B, S, 3, H, Dh), 2, 0, 3, 1, 4)
        q, k, v = qkv[0], qkv[1], qkv[2]
        pq = torch.einsum("bhsd,hdf->bhsf", q, w_phi)
        pk = torch.einsum("bhsd,hdf->bhsf", k, w_phi)
        phi_q = torch.concatenate([_softmax(pq, axis=-1), _softmax(-pq, axis=-1)], axis=-1)
        phi_k = torch.concatenate([_softmax(pk, axis=-1), _softmax(-pk, axis=-1)], axis=-1)
        kv = torch.einsum("bhsf,bhsd->bhfd", phi_k, v)
        z  = torch.einsum("bhsf->bhf", phi_k)
        num = torch.einsum("bhqf,bhfd->bhqd", phi_q, kv)
        den = torch.einsum("bhqf,bhf->bhq", phi_q, z)[..., None] + 1e-6
        o = num / den
        return (lambda x, *d: x.permute(*d))(o, 0, 2, 1, 3).reshape(B, S, D) @ wo

    def _B_ref(x, w1, b1, w2, b2):
        h = torch.einsum("bsd,df->bsf", x, w1) + b1
        h = _gelu(h)
        return torch.einsum("bsf,fd->bsd", h, w2) + b2

    x = A_x
    xn = _layernorm(x, axis=-1)
    return x + _A_ref(xn, A_wqkv, A_w_phi, A_wo) + _B_ref(xn, B_w1, B_b1, B_w2, B_b2)
```

```asm
; @launch kernel=ln_kernel grid=(512,1,1) block=(256,1,1) lds=0
; @launch kernel=gemm1_kernel grid=(256,1,1) block=(512,1,1) lds=163840
.amdgcn_target "amdgcn-amd-amdhsa--gfx950"
.text
.globl ln_kernel
.p2align 8
.type ln_kernel,@function
ln_kernel:
    s_cmp_ge_u32 s2, 512
    s_cbranch_scc1 ln_done
    s_load_dwordx2 s[4:5], s[0:1], 0
    s_load_dwordx2 s[6:7], s[0:1], 88
    s_load_dwordx2 s[24:25], s[0:1], 8
    s_load_dwordx2 s[26:27], s[0:1], 40
    v_lshrrev_b32 v1, 6, v0
    v_and_b32 v2, 63, v0
    s_lshl_b32 s3, s2, 2
    v_add_u32 v1, s3, v1
    v_lshlrev_b32 v3, 10, v1
    v_lshl_add_u32 v3, v2, 4, v3
    v_lshlrev_b32 v1, 11, v1
    v_lshl_add_u32 v1, v2, 4, v1
    s_waitcnt lgkmcnt(0)
    s_mov_b32 s8, s4
    s_mov_b32 s9, s5
    s_and_b32 s9, s9, 0xffff
    s_mov_b32 s10, 0x400000
    s_mov_b32 s11, 0x00020000
    s_mov_b32 s12, s6
    s_mov_b32 s13, s7
    s_and_b32 s13, s13, 0xffff
    s_mov_b32 s14, 0x400000
    s_mov_b32 s15, 0x00020000
    buffer_load_dwordx4 v[4:7], v1, s[8:11], 0 offen
    buffer_load_dwordx4 v[8:11], v1, s[8:11], 0 offen offset:1024
    s_add_u32 s36, s6, 0x2a00000
    s_addc_u32 s37, s7, 0
    s_and_b32 s37, s37, 0xffff
    s_mov_b32 s38, 0x300000
    s_mov_b32 s39, 0x00020000
    s_cmp_ge_u32 s2, 256
    s_cbranch_scc1 ln_noz
    v_mov_b32 v61, 0
    v_lshlrev_b32 v60, 7, v0
    s_lshl_b32 s17, s2, 9
    v_cmp_gt_u32 vcc, 4, v0
    s_nop 1
    s_and_saveexec_b64 s[18:19], vcc
    buffer_store_dword v61, v60, s[36:39], s17 offen
    s_mov_b64 exec, s[18:19]
    s_lshl_b32 s17, s2, 2
    s_add_u32 s17, s17, 0x100000
    s_and_b32 s20, s2, 31
    s_lshl_b32 s20, s20, 7
    s_add_u32 s20, s20, 0x200000
    v_cmp_eq_u32 vcc, 0, v0
    s_nop 1
    s_and_saveexec_b64 s[18:19], vcc
    buffer_store_dword v61, v61, s[36:39], s17 offen
    buffer_store_dword v61, v61, s[36:39], s20 offen
    s_mov_b64 exec, s[18:19]
ln_noz:
    s_mov_b32 s16, 0xffff0000
    s_waitcnt vmcnt(0)
    v_lshlrev_b32 v16, 16, v4
    v_and_b32 v17, s16, v4
    v_lshlrev_b32 v18, 16, v5
    v_and_b32 v19, s16, v5
    v_lshlrev_b32 v20, 16, v6
    v_and_b32 v21, s16, v6
    v_lshlrev_b32 v22, 16, v7
    v_and_b32 v23, s16, v7
    v_lshlrev_b32 v24, 16, v8
    v_and_b32 v25, s16, v8
    v_lshlrev_b32 v26, 16, v9
    v_and_b32 v27, s16, v9
    v_lshlrev_b32 v28, 16, v10
    v_and_b32 v29, s16, v10
    v_lshlrev_b32 v30, 16, v11
    v_and_b32 v31, s16, v11
    v_add_f32 v32, v16, v17
    v_add_f32 v33, v18, v19
    v_add_f32 v34, v20, v21
    v_add_f32 v35, v22, v23
    v_add_f32 v36, v24, v25
    v_add_f32 v37, v26, v27
    v_add_f32 v38, v28, v29
    v_add_f32 v39, v30, v31
    v_add_f32 v32, v32, v33
    v_add_f32 v33, v34, v35
    v_add_f32 v34, v36, v37
    v_add_f32 v35, v38, v39
    v_add_f32 v32, v32, v33
    v_add_f32 v34, v34, v35
    v_add_f32 v32, v32, v34
    s_nop 1
    v_add_f32_dpp v33, v32, v32 row_ror:8 row_mask:0xf bank_mask:0xf
    s_nop 1
    v_add_f32_dpp v32, v33, v33 row_ror:4 row_mask:0xf bank_mask:0xf
    s_nop 1
    v_add_f32_dpp v33, v32, v32 row_ror:2 row_mask:0xf bank_mask:0xf
    s_nop 1
    v_add_f32_dpp v32, v33, v33 row_ror:1 row_mask:0xf bank_mask:0xf
    v_mov_b32 v34, v32
    s_nop 1
    v_permlane32_swap_b32 v32, v34
    v_add_f32 v32, v32, v34
    v_mov_b32 v34, v32
    s_nop 1
    v_permlane16_swap_b32 v32, v34
    v_add_f32 v32, v32, v34
    v_mul_f32 v40, 0x3a800000, v32
    v_sub_f32 v44, v16, v40
    v_sub_f32 v45, v17, v40
    v_sub_f32 v46, v18, v40
    v_sub_f32 v47, v19, v40
    v_sub_f32 v48, v20, v40
    v_sub_f32 v49, v21, v40
    v_sub_f32 v50, v22, v40
    v_sub_f32 v51, v23, v40
    v_sub_f32 v52, v24, v40
    v_sub_f32 v53, v25, v40
    v_sub_f32 v54, v26, v40
    v_sub_f32 v55, v27, v40
    v_sub_f32 v56, v28, v40
    v_sub_f32 v57, v29, v40
    v_sub_f32 v58, v30, v40
    v_sub_f32 v59, v31, v40
    v_mul_f32 v32, v44, v44
    v_mul_f32 v33, v45, v45
    v_fmac_f32 v32, v46, v46
    v_fmac_f32 v33, v47, v47
    v_fmac_f32 v32, v48, v48
    v_fmac_f32 v33, v49, v49
    v_fmac_f32 v32, v50, v50
    v_fmac_f32 v33, v51, v51
    v_fmac_f32 v32, v52, v52
    v_fmac_f32 v33, v53, v53
    v_fmac_f32 v32, v54, v54
    v_fmac_f32 v33, v55, v55
    v_fmac_f32 v32, v56, v56
    v_fmac_f32 v33, v57, v57
    v_fmac_f32 v32, v58, v58
    v_fmac_f32 v33, v59, v59
    v_add_f32 v32, v32, v33
    s_nop 1
    v_add_f32_dpp v33, v32, v32 row_ror:8 row_mask:0xf bank_mask:0xf
    s_nop 1
    v_add_f32_dpp v32, v33, v33 row_ror:4 row_mask:0xf bank_mask:0xf
    s_nop 1
    v_add_f32_dpp v33, v32, v32 row_ror:2 row_mask:0xf bank_mask:0xf
    s_nop 1
    v_add_f32_dpp v32, v33, v33 row_ror:1 row_mask:0xf bank_mask:0xf
    v_mov_b32 v34, v32
    s_nop 1
    v_permlane32_swap_b32 v32, v34
    v_add_f32 v32, v32, v34
    v_mov_b32 v34, v32
    s_nop 1
    v_permlane16_swap_b32 v32, v34
    v_add_f32 v32, v32, v34
    v_mul_f32 v41, 0x3a800000, v32
    v_cvt_pk_bf16_f32 v40, v40, v40
    v_lshlrev_b32 v40, 16, v40
    v_cvt_pk_bf16_f32 v41, v41, v41
    v_lshlrev_b32 v41, 16, v41
    v_add_f32 v41, 0x3727c5ac, v41
    v_cvt_pk_bf16_f32 v41, v41, v41
    v_lshlrev_b32 v41, 16, v41
    v_sqrt_f32 v41, v41
    s_nop 0
    v_cvt_pk_bf16_f32 v41, v41, v41
    v_lshlrev_b32 v41, 16, v41
    v_rcp_f32 v42, v41
    v_sub_f32 v16, v16, v40
    v_sub_f32 v17, v17, v40
    v_cvt_pk_bf16_f32 v44, v16, v17
    v_lshlrev_b32 v16, 16, v44
    v_and_b32 v17, s16, v44
    v_sub_f32 v18, v18, v40
    v_sub_f32 v19, v19, v40
    v_cvt_pk_bf16_f32 v46, v18, v19
    v_lshlrev_b32 v18, 16, v46
    v_and_b32 v19, s16, v46
    v_sub_f32 v20, v20, v40
    v_sub_f32 v21, v21, v40
    v_cvt_pk_bf16_f32 v48, v20, v21
    v_lshlrev_b32 v20, 16, v48
    v_and_b32 v21, s16, v48
    v_sub_f32 v22, v22, v40
    v_sub_f32 v23, v23, v40
    v_cvt_pk_bf16_f32 v50, v22, v23
    v_lshlrev_b32 v22, 16, v50
    v_and_b32 v23, s16, v50
    v_sub_f32 v24, v24, v40
    v_sub_f32 v25, v25, v40
    v_cvt_pk_bf16_f32 v52, v24, v25
    v_lshlrev_b32 v24, 16, v52
    v_and_b32 v25, s16, v52
    v_sub_f32 v26, v26, v40
    v_sub_f32 v27, v27, v40
    v_cvt_pk_bf16_f32 v54, v26, v27
    v_lshlrev_b32 v26, 16, v54
    v_and_b32 v27, s16, v54
    v_sub_f32 v28, v28, v40
    v_sub_f32 v29, v29, v40
    v_cvt_pk_bf16_f32 v56, v28, v29
    v_lshlrev_b32 v28, 16, v56
    v_and_b32 v29, s16, v56
    v_sub_f32 v30, v30, v40
    v_sub_f32 v31, v31, v40
    v_cvt_pk_bf16_f32 v58, v30, v31
    v_lshlrev_b32 v30, 16, v58
    v_and_b32 v31, s16, v58
    v_mul_f32 v44, v16, v42
    v_mul_f32 v45, v17, v42
    v_mul_f32 v46, v18, v42
    v_mul_f32 v47, v19, v42
    v_mul_f32 v48, v20, v42
    v_mul_f32 v49, v21, v42
    v_mul_f32 v50, v22, v42
    v_mul_f32 v51, v23, v42
    v_mul_f32 v52, v24, v42
    v_mul_f32 v53, v25, v42
    v_mul_f32 v54, v26, v42
    v_mul_f32 v55, v27, v42
    v_mul_f32 v56, v28, v42
    v_mul_f32 v57, v29, v42
    v_mul_f32 v58, v30, v42
    v_mul_f32 v59, v31, v42
    v_fma_f32 v16, -v44, v41, v16
    v_fma_f32 v17, -v45, v41, v17
    v_fma_f32 v18, -v46, v41, v18
    v_fma_f32 v19, -v47, v41, v19
    v_fma_f32 v20, -v48, v41, v20
    v_fma_f32 v21, -v49, v41, v21
    v_fma_f32 v22, -v50, v41, v22
    v_fma_f32 v23, -v51, v41, v23
    v_fma_f32 v24, -v52, v41, v24
    v_fma_f32 v25, -v53, v41, v25
    v_fma_f32 v26, -v54, v41, v26
    v_fma_f32 v27, -v55, v41, v27
    v_fma_f32 v28, -v56, v41, v28
    v_fma_f32 v29, -v57, v41, v29
    v_fma_f32 v30, -v58, v41, v30
    v_fma_f32 v31, -v59, v41, v31
    v_fmac_f32 v44, v16, v42
    v_fmac_f32 v45, v17, v42
    v_fmac_f32 v46, v18, v42
    v_fmac_f32 v47, v19, v42
    v_fmac_f32 v48, v20, v42
    v_fmac_f32 v49, v21, v42
    v_fmac_f32 v50, v22, v42
    v_fmac_f32 v51, v23, v42
    v_fmac_f32 v52, v24, v42
    v_fmac_f32 v53, v25, v42
    v_fmac_f32 v54, v26, v42
    v_fmac_f32 v55, v27, v42
    v_fmac_f32 v56, v28, v42
    v_fmac_f32 v57, v29, v42
    v_fmac_f32 v58, v30, v42
    v_fmac_f32 v59, v31, v42
    v_cvt_pk_bf16_f32 v4, v44, v45
    v_cvt_pk_bf16_f32 v5, v46, v47
    v_cvt_pk_bf16_f32 v6, v48, v49
    v_cvt_pk_bf16_f32 v7, v50, v51
    v_cvt_pk_bf16_f32 v8, v52, v53
    v_cvt_pk_bf16_f32 v9, v54, v55
    v_cvt_pk_bf16_f32 v10, v56, v57
    v_cvt_pk_bf16_f32 v11, v58, v59
    buffer_store_dwordx4 v[4:7], v1, s[12:15], 0 offen
    buffer_store_dwordx4 v[8:11], v1, s[12:15], 0 offen offset:1024
ln_done:
    s_endpgm
.globl gemm1_kernel
.p2align 8
.type gemm1_kernel,@function
gemm1_kernel:
    s_cmp_ge_u32 s2, 256
    s_cbranch_scc1 g1_exit
    s_load_dwordx2 s[4:5], s[0:1], 88
    s_load_dwordx2 s[6:7], s[0:1], 8
    s_load_dwordx2 s[56:57], s[0:1], 16
    s_load_dwordx2 s[58:59], s[0:1], 40
    s_load_dwordx2 s[60:61], s[0:1], 48
    s_load_dwordx2 s[72:73], s[0:1], 24
    s_load_dwordx2 s[74:75], s[0:1], 56
    v_lshrrev_b32 v1, 6, v0
    v_and_b32 v14, 63, v0
    s_nop 0
    v_readfirstlane_b32 s20, v1
    v_lshrrev_b32 v15, 4, v14
    v_and_b32 v16, 15, v14
    s_nop 1
    s_lshr_b32 s21, s20, 1
    s_and_b32 s22, s20, 1
    s_and_b32 s26, s2, 7
    s_lshr_b32 s27, s2, 3
    s_and_b32 s24, s26, 1
    s_lshl_b32 s24, s24, 2
    s_and_b32 s28, s27, 3
    s_add_u32 s24, s24, s28
    s_lshr_b32 s25, s26, 1
    s_lshl_b32 s25, s25, 2
    s_bfe_u32 s28, s27, 0x20002
    s_add_u32 s25, s25, s28
    s_lshr_b32 s28, s27, 4
    s_lshl_b32 s28, s28, 4
    s_add_u32 s25, s25, s28
    s_lshl_b32 s28, s21, 13
    v_and_b32 v17, 7, v14
    v_xor_b32 v17, v17, v15
    v_lshlrev_b32 v17, 4, v17
    v_lshl_add_u32 v17, v16, 7, v17
    v_add_u32 v17, s28, v17
    v_xor_b32 v18, 64, v17
    v_add_u32 v2, 0x0, v17
    v_add_u32 v3, 0x0, v18
    v_add_u32 v4, 0x8000, v17
    v_add_u32 v5, 0x8000, v18
    v_add_u32 v6, 0x10000, v17
    v_add_u32 v7, 0x10000, v18
    v_lshrrev_b32 v17, 3, v14
    v_and_b32 v18, 7, v14
    v_xor_b32 v18, v18, v17
    s_lshl_b32 s28, s24, 8
    s_lshl_b32 s29, s20, 5
    s_add_u32 s28, s28, s29
    v_add_u32 v17, s28, v17
    v_lshlrev_b32 v17, 11, v17
    v_lshl_add_u32 v11, v18, 4, v17
    v_lshlrev_b32 v31, 4, v14
    s_lshl_b32 s30, s20, 12
    s_lshl_b32 s31, s20, 10
    s_and_b32 s77, s31, 0xc00
    s_cmp_ge_u32 s25, 16
    s_cbranch_scc1 g1_w1
    v_lshrrev_b32 v17, 2, v16
    v_lshl_add_u32 v18, v15, 3, v17
    v_lshrrev_b32 v19, 1, v17
    v_and_b32 v20, 1, v15
    v_lshl_or_b32 v19, v20, 1, v19
    v_and_b32 v21, 3, v14
    v_lshlrev_b32 v21, 3, v21
    v_lshl_add_u32 v22, v18, 7, v21
    v_add_u32 v22, 0x18000, v22
    s_lshl_b32 s28, s22, 1
    s_add_u32 s28, s28, 0
    v_xor_b32 v23, s28, v19
    v_lshl_add_u32 v8, v23, 5, v22
    s_lshl_b32 s28, s22, 1
    s_add_u32 s28, s28, 1
    v_xor_b32 v23, s28, v19
    v_lshl_add_u32 v9, v23, 5, v22
    v_lshrrev_b32 v17, 3, v14
    v_bfe_u32 v18, v14, 4, 1
    s_and_b32 s28, s20, 1
    s_lshl_b32 s28, s28, 1
    v_or_b32 v18, s28, v18
    v_bfe_u32 v19, v14, 1, 2
    v_xor_b32 v19, v19, v18
    v_and_b32 v20, 1, v14
    v_lshlrev_b32 v20, 4, v20
    v_lshl_add_u32 v20, v19, 5, v20
    s_and_b32 s28, s20, 3
    s_lshl_b32 s28, s28, 3
    v_add_u32 v17, s28, v17
    s_mov_b32 s29, 6144
    v_mul_lo_u32 v17, v17, s29
    v_add_u32 v17, v17, v20
    s_lshr_b32 s28, s20, 2
    s_mul_i32 s28, s28, 2048
    s_lshl_b32 s32, s25, 7
    s_add_u32 s28, s28, s32
    v_add_u32 v12, s28, v17
    v_add_u32 v13, 0x1000, v12
    s_waitcnt lgkmcnt(0)
    s_mov_b32 s8, s4
    s_mov_b32 s9, s5
    s_and_b32 s9, s9, 0xffff
    s_mov_b32 s10, 0x400000
    s_mov_b32 s11, 0x00020000
    s_mov_b32 s12, s6
    s_mov_b32 s13, s7
    s_and_b32 s13, s13, 0xffff
    s_mov_b32 s14, 0x600000
    s_mov_b32 s15, 0x00020000
    s_add_u32 m0, s30, 0x0
    s_mov_b32 s28, 0x0
    buffer_load_dwordx4 v11, s[8:11], s28 offen lds
    s_add_u32 m0, s30, 0x400
    s_mov_b32 s28, 0x4000
    buffer_load_dwordx4 v11, s[8:11], s28 offen lds
    s_add_u32 m0, s30, 0x800
    s_mov_b32 s28, 0x8000
    buffer_load_dwordx4 v11, s[8:11], s28 offen lds
    s_add_u32 m0, s30, 0xc00
    s_mov_b32 s28, 0xc000
    buffer_load_dwordx4 v11, s[8:11], s28 offen lds
    s_add_u32 m0, s31, 0x18000
    s_mov_b32 s28, 0x0
    buffer_load_dwordx4 v12, s[12:15], s28 offen lds
    s_cmp_ge_u32 s20, 4
    s_cbranch_scc1 g1qkv_sk0
    s_add_u32 m0, s31, 0x1a000
    s_mov_b32 s28, 0x0
    s_nop 0
    buffer_load_dwordx4 v13, s[12:15], s28 offen lds
g1qkv_sk0:
    s_mov_b32 s40, s56
    s_mov_b32 s41, s57
    s_and_b32 s41, s41, 0xffff
    s_mov_b32 s42, 0x10000
    s_mov_b32 s43, 0x00020000
    s_lshl_b32 s33, s25, 1
    s_add_u32 s33, s33, s22
    s_lshl_b32 s28, s33, 11
    v_lshlrev_b32 v17, 8, v15
    v_lshl_add_u32 v17, v16, 1, v17
    buffer_load_ushort v224, v17, s[40:43], s28 offen offset:0
    buffer_load_ushort v225, v17, s[40:43], s28 offen offset:64
    buffer_load_ushort v226, v17, s[40:43], s28 offen offset:128
    buffer_load_ushort v227, v17, s[40:43], s28 offen offset:192
    buffer_load_ushort v228, v17, s[40:43], s28 offen offset:1024
    buffer_load_ushort v229, v17, s[40:43], s28 offen offset:1088
    buffer_load_ushort v230, v17, s[40:43], s28 offen offset:1152
    buffer_load_ushort v231, v17, s[40:43], s28 offen offset:1216
    buffer_load_ushort v232, v17, s[40:43], s28 offen offset:32
    buffer_load_ushort v233, v17, s[40:43], s28 offen offset:96
    buffer_load_ushort v234, v17, s[40:43], s28 offen offset:160
    buffer_load_ushort v235, v17, s[40:43], s28 offen offset:224
    buffer_load_ushort v236, v17, s[40:43], s28 offen offset:1056
    buffer_load_ushort v237, v17, s[40:43], s28 offen offset:1120
    buffer_load_ushort v238, v17, s[40:43], s28 offen offset:1184
    buffer_load_ushort v239, v17, s[40:43], s28 offen offset:1248
    s_add_u32 m0, s31, 0x1b800
    s_mov_b32 s28, 0x30000
    buffer_load_dwordx4 v12, s[12:15], s28 offen lds
    s_cmp_ge_u32 s20, 4
    s_cbranch_scc1 g1qkv_sk1
    s_add_u32 m0, s31, 0x1d800
    s_mov_b32 s28, 0x30000
    s_nop 0
    buffer_load_dwordx4 v13, s[12:15], s28 offen lds
g1qkv_sk1:
    s_add_u32 m0, s30, 0x8000
    s_mov_b32 s28, 0x80
    buffer_load_dwordx4 v11, s[8:11], s28 offen lds
    s_add_u32 m0, s30, 0x8400
    s_mov_b32 s28, 0x4080
    buffer_load_dwordx4 v11, s[8:11], s28 offen lds
    s_add_u32 m0, s30, 0x8800
    s_mov_b32 s28, 0x8080
    buffer_load_dwordx4 v11, s[8:11], s28 offen lds
    s_add_u32 m0, s30, 0x8c00
    s_mov_b32 s28, 0xc080
    buffer_load_dwordx4 v11, s[8:11], s28 offen lds
    s_add_u32 m0, s31, 0x1f000
    s_mov_b32 s28, 0x60000
    buffer_load_dwordx4 v12, s[12:15], s28 offen lds
    s_cmp_ge_u32 s20, 4
    s_cbranch_scc1 g1qkv_sk2
    s_add_u32 m0, s31, 0x21000
    s_mov_b32 s28, 0x60000
    s_nop 0
    buffer_load_dwordx4 v13, s[12:15], s28 offen lds
g1qkv_sk2:
    s_add_u32 m0, s31, 0x22800
    s_mov_b32 s28, 0x90000
    buffer_load_dwordx4 v12, s[12:15], s28 offen lds
    s_cmp_ge_u32 s20, 4
    s_cbranch_scc1 g1qkv_sk3
    s_add_u32 m0, s31, 0x24800
    s_mov_b32 s28, 0x90000
    s_nop 0
    buffer_load_dwordx4 v13, s[12:15], s28 offen lds
g1qkv_sk3:
    s_add_u32 m0, s30, 0x10000
    s_mov_b32 s28, 0x100
    buffer_load_dwordx4 v11, s[8:11], s28 offen lds
    s_add_u32 m0, s30, 0x10400
    s_mov_b32 s28, 0x4100
    buffer_load_dwordx4 v11, s[8:11], s28 offen lds
    s_add_u32 m0, s30, 0x10800
    s_mov_b32 s28, 0x8100
    buffer_load_dwordx4 v11, s[8:11], s28 offen lds
    s_add_u32 m0, s30, 0x10c00
    s_mov_b32 s28, 0xc100
    buffer_load_dwordx4 v11, s[8:11], s28 offen lds
    s_add_u32 s36, s4, 0x1600000
    s_addc_u32 s37, s5, 0
    s_and_b32 s37, s37, 0xffff
    s_mov_b32 s38, 0x800000
    s_mov_b32 s39, 0x00020000
    s_add_u32 s44, s4, 0x1e00000
    s_addc_u32 s45, s5, 0
    s_and_b32 s45, s45, 0xffff
    s_mov_b32 s46, 0x210000
    s_mov_b32 s47, 0x00020000
    s_mov_b32 s64, s72
    s_mov_b32 s65, s73
    s_and_b32 s65, s65, 0xffff
    s_mov_b32 s66, 0x200000
    s_mov_b32 s67, 0x00020000
    s_mov_b32 s68, s74
    s_mov_b32 s69, s75
    s_and_b32 s69, s69, 0xffff
    s_mov_b32 s70, 0x700000
    s_mov_b32 s71, 0x00020000
    s_add_u32 s92, s4, 0x2a00000
    s_addc_u32 s93, s5, 0
    s_and_b32 s93, s93, 0xffff
    s_mov_b32 s94, 0x300000
    s_mov_b32 s95, 0x00020000
    s_lshl_b32 s28, s2, 3
    s_add_u32 s28, s28, s20
    s_cmp_lt_u32 s28, 1024
    s_cselect_b32 s88, s6, s58
    s_cselect_b32 s89, s7, s59
    s_mov_b32 s90, 0x700000
    s_cselect_b32 s90, 0x600000, s90
    s_cselect_b32 s29, 0xc0000, 0
    s_cselect_b32 s91, 0, 0xe0000
    s_add_u32 s29, s29, s91
    s_and_b32 s89, s89, 0xffff
    s_mov_b32 s91, 0x00020000
    s_and_b32 s28, s28, 1023
    s_lshl_b32 s28, s28, 10
    s_add_u32 s28, s28, s29
    v_add_u32 v30, s28, v31
    v_mov_b32 v128, 0
    v_mov_b32 v129, 0
    v_mov_b32 v130, 0
    v_mov_b32 v131, 0
    v_mov_b32 v132, 0
    v_mov_b32 v133, 0
    v_mov_b32 v134, 0
    v_mov_b32 v135, 0
    v_mov_b32 v136, 0
    v_mov_b32 v137, 0
    v_mov_b32 v138, 0
    v_mov_b32 v139, 0
    v_mov_b32 v140, 0
    v_mov_b32 v141, 0
    v_mov_b32 v142, 0
    v_mov_b32 v143, 0
    v_mov_b32 v144, 0
    v_mov_b32 v145, 0
    v_mov_b32 v146, 0
    v_mov_b32 v147, 0
    v_mov_b32 v148, 0
    v_mov_b32 v149, 0
    v_mov_b32 v150, 0
    v_mov_b32 v151, 0
    v_mov_b32 v152, 0
    v_mov_b32 v153, 0
    v_mov_b32 v154, 0
    v_mov_b32 v155, 0
    v_mov_b32 v156, 0
    v_mov_b32 v157, 0
    v_mov_b32 v158, 0
    v_mov_b32 v159, 0
    v_mov_b32 v160, 0
    v_mov_b32 v161, 0
    v_mov_b32 v162, 0
    v_mov_b32 v163, 0
    v_mov_b32 v164, 0
    v_mov_b32 v165, 0
    v_mov_b32 v166, 0
    v_mov_b32 v167, 0
    v_mov_b32 v168, 0
    v_mov_b32 v169, 0
    v_mov_b32 v170, 0
    v_mov_b32 v171, 0
    v_mov_b32 v172, 0
    v_mov_b32 v173, 0
    v_mov_b32 v174, 0
    v_mov_b32 v175, 0
    v_mov_b32 v176, 0
    v_mov_b32 v177, 0
    v_mov_b32 v178, 0
    v_mov_b32 v179, 0
    v_mov_b32 v180, 0
    v_mov_b32 v181, 0
    v_mov_b32 v182, 0
    v_mov_b32 v183, 0
    v_mov_b32 v184, 0
    v_mov_b32 v185, 0
    v_mov_b32 v186, 0
    v_mov_b32 v187, 0
    v_mov_b32 v188, 0
    v_mov_b32 v189, 0
    v_mov_b32 v190, 0
    v_mov_b32 v191, 0
    v_mov_b32 v192, 0
    v_mov_b32 v193, 0
    v_mov_b32 v194, 0
    v_mov_b32 v195, 0
    v_mov_b32 v196, 0
    v_mov_b32 v197, 0
    v_mov_b32 v198, 0
    v_mov_b32 v199, 0
    v_mov_b32 v200, 0
    v_mov_b32 v201, 0
    v_mov_b32 v202, 0
    v_mov_b32 v203, 0
    v_mov_b32 v204, 0
    v_mov_b32 v205, 0
    v_mov_b32 v206, 0
    v_mov_b32 v207, 0
    v_mov_b32 v208, 0
    v_mov_b32 v209, 0
    v_mov_b32 v210, 0
    v_mov_b32 v211, 0
    v_mov_b32 v212, 0
    v_mov_b32 v213, 0
    v_mov_b32 v214, 0
    v_mov_b32 v215, 0
    v_mov_b32 v216, 0
    v_mov_b32 v217, 0
    v_mov_b32 v218, 0
    v_mov_b32 v219, 0
    v_mov_b32 v220, 0
    v_mov_b32 v221, 0
    v_mov_b32 v222, 0
    v_mov_b32 v223, 0
    s_waitcnt vmcnt(11)
    s_barrier
    ds_read_b128 v[32:35], v2 offset:0
    ds_read_b128 v[36:39], v2 offset:2048
    ds_read_b128 v[40:43], v2 offset:4096
    ds_read_b128 v[44:47], v2 offset:6144
    ds_read_b64_tr_b16 v[48:49], v8 offset:0
    ds_read_b64_tr_b16 v[50:51], v8 offset:512
    ds_read_b64_tr_b16 v[52:53], v9 offset:0
    ds_read_b64_tr_b16 v[54:55], v9 offset:512
    ds_read_b64_tr_b16 v[56:57], v8 offset:4096
    ds_read_b64_tr_b16 v[58:59], v8 offset:4608
    ds_read_b64_tr_b16 v[60:61], v9 offset:4096
    ds_read_b64_tr_b16 v[62:63], v9 offset:4608
    ds_read_b64_tr_b16 v[64:65], v8 offset:8192
    ds_read_b64_tr_b16 v[66:67], v8 offset:8704
    ds_read_b64_tr_b16 v[68:69], v9 offset:8192
    ds_read_b64_tr_b16 v[70:71], v9 offset:8704
    s_waitcnt lgkmcnt(0)
    s_waitcnt vmcnt(10)
    s_barrier
    v_mfma_f32_16x16x32_bf16 v[128:131], v[48:51], v[32:35], v[128:131]
    ds_read_b128 v[76:79], v3 offset:0
    v_mfma_f32_16x16x32_bf16 v[132:135], v[48:51], v[36:39], v[132:135]
    s_add_u32 m0, s31, 0x18000
    s_mov_b32 s28, 0xc0000
    buffer_load_dwordx4 v12, s[12:15], s28 offen lds
    v_mfma_f32_16x16x32_bf16 v[136:139], v[48:51], v[40:43], v[136:139]
    ds_read_b128 v[80:83], v3 offset:2048
    v_mfma_f32_16x16x32_bf16 v[140:143], v[48:51], v[44:47], v[140:143]
    ds_read_b128 v[84:87], v3 offset:4096
    v_mfma_f32_16x16x32_bf16 v[144:147], v[52:55], v[32:35], v[144:147]
    ds_read_b128 v[88:91], v3 offset:6144
    v_mfma_f32_16x16x32_bf16 v[148:151], v[52:55], v[36:39], v[148:151]
    s_cmp_ge_u32 s20, 4
    s_cbranch_scc1 g1qkv_sk4
    s_add_u32 m0, s31, 0x1a000
    s_mov_b32 s28, 0xc0000
    s_nop 0
    buffer_load_dwordx4 v13, s[12:15], s28 offen lds
g1qkv_sk4:
    v_mfma_f32_16x16x32_bf16 v[152:155], v[52:55], v[40:43], v[152:155]
    ds_read_b64_tr_b16 v[92:93], v8 offset:14336
    v_mfma_f32_16x16x32_bf16 v[156:159], v[52:55], v[44:47], v[156:159]
    ds_read_b64_tr_b16 v[94:95], v8 offset:14848
    v_mfma_f32_16x16x32_bf16 v[160:163], v[56:59], v[32:35], v[160:163]
    ds_read_b64_tr_b16 v[96:97], v9 offset:14336
    v_mfma_f32_16x16x32_bf16 v[164:167], v[56:59], v[36:39], v[164:167]
    s_add_u32 m0, s77, 0x26000
    s_mov_b32 s28, 0x0
    buffer_load_dwordx4 v30, s[88:91], s28 offen lds
    v_mfma_f32_16x16x32_bf16 v[168:171], v[56:59], v[40:43], v[168:171]
    ds_read_b64_tr_b16 v[98:99], v9 offset:14848
    v_mfma_f32_16x16x32_bf16 v[172:175], v[56:59], v[44:47], v[172:175]
    ds_read_b64_tr_b16 v[100:101], v8 offset:18432
    v_mfma_f32_16x16x32_bf16 v[176:179], v[60:63], v[32:35], v[176:179]
    ds_read_b64_tr_b16 v[102:103], v8 offset:18944
    v_mfma_f32_16x16x32_bf16 v[180:183], v[60:63], v[36:39], v[180:183]
    ds_read_b64_tr_b16 v[104:105], v9 offset:18432
    v_mfma_f32_16x16x32_bf16 v[184:187], v[60:63], v[40:43], v[184:187]
    ds_read_b64_tr_b16 v[106:107], v9 offset:18944
    v_mfma_f32_16x16x32_bf16 v[188:191], v[60:63], v[44:47], v[188:191]
    ds_read_b64_tr_b16 v[108:109], v8 offset:22528
    v_mfma_f32_16x16x32_bf16 v[192:195], v[32:35], v[64:67], v[192:195]
    ds_read_b64_tr_b16 v[110:111], v8 offset:23040
    v_mfma_f32_16x16x32_bf16 v[196:199], v[36:39], v[64:67], v[196:199]
    ds_read_b64_tr_b16 v[112:113], v9 offset:22528
    v_mfma_f32_16x16x32_bf16 v[200:203], v[40:43], v[64:67], v[200:203]
    ds_read_b64_tr_b16 v[114:115], v9 offset:23040
    v_mfma_f32_16x16x32_bf16 v[204:207], v[44:47], v[64:67], v[204:207]
    v_mfma_f32_16x16x32_bf16 v[208:211], v[32:35], v[68:71], v[208:211]
    v_mfma_f32_16x16x32_bf16 v[212:215], v[36:39], v[68:71], v[212:215]
    v_mfma_f32_16x16x32_bf16 v[216:219], v[40:43], v[68:71], v[216:219]
    v_mfma_f32_16x16x32_bf16 v[220:223], v[44:47], v[68:71], v[220:223]
    s_waitcnt lgkmcnt(0)
    s_waitcnt vmcnt(6)
    s_barrier
    v_mfma_f32_16x16x32_bf16 v[128:131], v[92:95], v[76:79], v[128:131]
    ds_read_b128 v[32:35], v4 offset:0
    v_mfma_f32_16x16x32_bf16 v[132:135], v[92:95], v[80:83], v[132:135]
    s_add_u32 m0, s31, 0x1b800
    s_mov_b32 s28, 0xf0000
    buffer_load_dwordx4 v12, s[12:15], s28 offen lds
    v_mfma_f32_16x16x32_bf16 v[136:139], v[92:95], v[84:87], v[136:139]
    ds_read_b128 v[36:39], v4 offset:2048
    v_mfma_f32_16x16x32_bf16 v[140:143], v[92:95], v[88:91], v[140:143]
    ds_read_b128 v[40:43], v4 offset:4096
    v_mfma_f32_16x16x32_bf16 v[144:147], v[96:99], v[76:79], v[144:147]
    ds_read_b128 v[44:47], v4 offset:6144
    v_mfma_f32_16x16x32_bf16 v[148:151], v[96:99], v[80:83], v[148:151]
    s_cmp_ge_u32 s20, 4
    s_cbranch_scc1 g1qkv_sk5
    s_add_u32 m0, s31, 0x1d800
    s_mov_b32 s28, 0xf0000
    s_nop 0
    buffer_load_dwordx4 v13, s[12:15], s28 offen lds
g1qkv_sk5:
    v_mfma_f32_16x16x32_bf16 v[152:155], v[96:99], v[84:87], v[152:155]
    ds_read_b64_tr_b16 v[48:49], v8 offset:28672
    v_mfma_f32_16x16x32_bf16 v[156:159], v[96:99], v[88:91], v[156:159]
    ds_read_b64_tr_b16 v[50:51], v8 offset:29184
    v_mfma_f32_16x16x32_bf16 v[160:163], v[100:103], v[76:79], v[160:163]
    ds_read_b64_tr_b16 v[52:53], v9 offset:28672
    v_mfma_f32_16x16x32_bf16 v[164:167], v[100:103], v[80:83], v[164:167]
    s_add_u32 m0, s30, 0x0
    s_mov_b32 s28, 0x180
    buffer_load_dwordx4 v11, s[8:11], s28 offen lds
    v_mfma_f32_16x16x32_bf16 v[168:171], v[100:103], v[84:87], v[168:171]
    ds_read_b64_tr_b16 v[54:55], v9 offset:29184
    v_mfma_f32_16x16x32_bf16 v[172:175], v[100:103], v[88:91], v[172:175]
    ds_read_b64_tr_b16 v[56:57], v8 offset:32768
    v_mfma_f32_16x16x32_bf16 v[176:179], v[104:107], v[76:79], v[176:179]
    ds_read_b64_tr_b16 v[58:59], v8 offset:33280
    v_mfma_f32_16x16x32_bf16 v[180:183], v[104:107], v[80:83], v[180:183]
    s_add_u32 m0, s30, 0x400
    s_mov_b32 s28, 0x4180
    buffer_load_dwordx4 v11, s[8:11], s28 offen lds
    v_mfma_f32_16x16x32_bf16 v[184:187], v[104:107], v[84:87], v[184:187]
    ds_read_b64_tr_b16 v[60:61], v9 offset:32768
    v_mfma_f32_16x16x32_bf16 v[188:191], v[104:107], v[88:91], v[188:191]
    ds_read_b64_tr_b16 v[62:63], v9 offset:33280
    v_mfma_f32_16x16x32_bf16 v[192:195], v[76:79], v[108:111], v[192:195]
    ds_read_b64_tr_b16 v[64:65], v8 offset:36864
    v_mfma_f32_16x16x32_bf16 v[196:199], v[80:83], v[108:111], v[196:199]
    s_add_u32 m0, s30, 0x800
    s_mov_b32 s28, 0x8180
    buffer_load_dwordx4 v11, s[8:11], s28 offen lds
    v_mfma_f32_16x16x32_bf16 v[200:203], v[84:87], v[108:111], v[200:203]
    ds_read_b64_tr_b16 v[66:67], v8 offset:37376
    v_mfma_f32_16x16x32_bf16 v[204:207], v[88:91], v[108:111], v[204:207]
    ds_read_b64_tr_b16 v[68:69], v9 offset:36864
    v_mfma_f32_16x16x32_bf16 v[208:211], v[76:79], v[112:115], v[208:211]
    ds_read_b64_tr_b16 v[70:71], v9 offset:37376
    v_mfma_f32_16x16x32_bf16 v[212:215], v[80:83], v[112:115], v[212:215]
    s_add_u32 m0, s30, 0xc00
    s_mov_b32 s28, 0xc180
    buffer_load_dwordx4 v11, s[8:11], s28 offen lds
    v_mfma_f32_16x16x32_bf16 v[216:219], v[84:87], v[112:115], v[216:219]
    s_add_u32 m0, s77, 0x26000
    s_mov_b32 s28, 0x100000
    buffer_load_dwordx4 v30, s[88:91], s28 offen lds
    v_mfma_f32_16x16x32_bf16 v[220:223], v[88:91], v[112:115], v[220:223]
    s_waitcnt lgkmcnt(0)
    s_waitcnt vmcnt(10)
    s_barrier
    v_mfma_f32_16x16x32_bf16 v[128:131], v[48:51], v[32:35], v[128:131]
    ds_read_b128 v[76:79], v5 offset:0
    v_mfma_f32_16x16x32_bf16 v[132:135], v[48:51], v[36:39], v[132:135]
    s_add_u32 m0, s31, 0x1f000
    s_mov_b32 s28, 0x120000
    buffer_load_dwordx4 v12, s[12:15], s28 offen lds
    v_mfma_f32_16x16x32_bf16 v[136:139], v[48:51], v[40:43], v[136:139]
    ds_read_b128 v[80:83], v5 offset:2048
    v_mfma_f32_16x16x32_bf16 v[140:143], v[48:51], v[44:47], v[140:143]
    ds_read_b128 v[84:87], v5 offset:4096
    v_mfma_f32_16x16x32_bf16 v[144:147], v[52:55], v[32:35], v[144:147]
    ds_read_b128 v[88:91], v5 offset:6144
    v_mfma_f32_16x16x32_bf16 v[148:151], v[52:55], v[36:39], v[148:151]
    s_cmp_ge_u32 s20, 4
    s_cbranch_scc1 g1qkv_sk6
    s_add_u32 m0, s31, 0x21000
    s_mov_b32 s28, 0x120000
    s_nop 0
    buffer_load_dwordx4 v13, s[12:15], s28 offen lds
g1qkv_sk6:
    v_mfma_f32_16x16x32_bf16 v[152:155], v[52:55], v[40:43], v[152:155]
    ds_read_b64_tr_b16 v[92:93], v8 offset:43008
    v_mfma_f32_16x16x32_bf16 v[156:159], v[52:55], v[44:47], v[156:159]
    ds_read_b64_tr_b16 v[94:95], v8 offset:43520
    v_mfma_f32_16x16x32_bf16 v[160:163], v[56:59], v[32:35], v[160:163]
    ds_read_b64_tr_b16 v[96:97], v9 offset:43008
    v_mfma_f32_16x16x32_bf16 v[164:167], v[56:59], v[36:39], v[164:167]
    ds_read_b64_tr_b16 v[98:99], v9 offset:43520
    v_mfma_f32_16x16x32_bf16 v[168:171], v[56:59], v[40:43], v[168:171]
    ds_read_b64_tr_b16 v[100:101], v8 offset:47104
    v_mfma_f32_16x16x32_bf16 v[172:175], v[56:59], v[44:47], v[172:175]
    ds_read_b64_tr_b16 v[102:103], v8 offset:47616
    v_mfma_f32_16x16x32_bf16 v[176:179], v[60:63], v[32:35], v[176:179]
    ds_read_b64_tr_b16 v[104:105], v9 offset:47104
    v_mfma_f32_16x16x32_bf16 v[180:183], v[60:63], v[36:39], v[180:183]
    ds_read_b64_tr_b16 v[106:107], v9 offset:47616
    v_mfma_f32_16x16x32_bf16 v[184:187], v[60:63], v[40:43], v[184:187]
    ds_read_b64_tr_b16 v[108:109], v8 offset:51200
    v_mfma_f32_16x16x32_bf16 v[188:191], v[60:63], v[44:47], v[188:191]
    ds_read_b64_tr_b16 v[110:111], v8 offset:51712
    v_mfma_f32_16x16x32_bf16 v[192:195], v[32:35], v[64:67], v[192:195]
    ds_read_b64_tr_b16 v[112:113], v9 offset:51200
    v_mfma_f32_16x16x32_bf16 v[196:199], v[36:39], v[64:67], v[196:199]
    ds_read_b64_tr_b16 v[114:115], v9 offset:51712
    v_mfma_f32_16x16x32_bf16 v[200:203], v[40:43], v[64:67], v[200:203]
    v_mfma_f32_16x16x32_bf16 v[204:207], v[44:47], v[64:67], v[204:207]
    v_mfma_f32_16x16x32_bf16 v[208:211], v[32:35], v[68:71], v[208:211]
    v_mfma_f32_16x16x32_bf16 v[212:215], v[36:39], v[68:71], v[212:215]
    v_mfma_f32_16x16x32_bf16 v[216:219], v[40:43], v[68:71], v[216:219]
    v_mfma_f32_16x16x32_bf16 v[220:223], v[44:47], v[68:71], v[220:223]
    s_waitcnt lgkmcnt(0)
    s_waitcnt vmcnt(6)
    s_barrier
    v_mfma_f32_16x16x32_bf16 v[128:131], v[92:95], v[76:79], v[128:131]
    ds_read_b128 v[32:35], v6 offset:0
    v_mfma_f32_16x16x32_bf16 v[132:135], v[92:95], v[80:83], v[132:135]
    s_add_u32 m0, s31, 0x22800
    s_mov_b32 s28, 0x150000
    buffer_load_dwordx4 v12, s[12:15], s28 offen lds
    v_mfma_f32_16x16x32_bf16 v[136:139], v[92:95], v[84:87], v[136:139]
    ds_read_b128 v[36:39], v6 offset:2048
    v_mfma_f32_16x16x32_bf16 v[140:143], v[92:95], v[88:91], v[140:143]
    ds_read_b128 v[40:43], v6 offset:4096
    v_mfma_f32_16x16x32_bf16 v[144:147], v[96:99], v[76:79], v[144:147]
    ds_read_b128 v[44:47], v6 offset:6144
    v_mfma_f32_16x16x32_bf16 v[148:151], v[96:99], v[80:83], v[148:151]
    s_cmp_ge_u32 s20, 4
    s_cbranch_scc1 g1qkv_sk7
    s_add_u32 m0, s31, 0x24800
    s_mov_b32 s28, 0x150000
    s_nop 0
    buffer_load_dwordx4 v13, s[12:15], s28 offen lds
g1qkv_sk7:
    v_mfma_f32_16x16x32_bf16 v[152:155], v[96:99], v[84:87], v[152:155]
    ds_read_b64_tr_b16 v[48:49], v8 offset:0
    v_mfma_f32_16x16x32_bf16 v[156:159], v[96:99], v[88:91], v[156:159]
    ds_read_b64_tr_b16 v[50:51], v8 offset:512
    v_mfma_f32_16x16x32_bf16 v[160:163], v[100:103], v[76:79], v[160:163]
    ds_read_b64_tr_b16 v[52:53], v9 offset:0
    v_mfma_f32_16x16x32_bf16 v[164:167], v[100:103], v[80:83], v[164:167]
    s_add_u32 m0, s30, 0x8000
    s_mov_b32 s28, 0x200
    buffer_load_dwordx4 v11, s[8:11], s28 offen lds
    v_mfma_f32_16x16x32_bf16 v[168:171], v[100:103], v[84:87], v[168:171]
    ds_read_b64_tr_b16 v[54:55], v9 offset:512
    v_mfma_f32_16x16x32_bf16 v[172:175], v[100:103], v[88:91], v[172:175]
    ds_read_b64_tr_b16 v[56:57], v8 offset:4096
    v_mfma_f32_16x16x32_bf16 v[176:179], v[104:107], v[76:79], v[176:179]
    ds_read_b64_tr_b16 v[58:59], v8 offset:4608
    v_mfma_f32_16x16x32_bf16 v[180:183], v[104:107], v[80:83], v[180:183]
    s_add_u32 m0, s30, 0x8400
    s_mov_b32 s28, 0x4200
    buffer_load_dwordx4 v11, s[8:11], s28 offen lds
    v_mfma_f32_16x16x32_bf16 v[184:187], v[104:107], v[84:87], v[184:187]
    ds_read_b64_tr_b16 v[60:61], v9 offset:4096
    v_mfma_f32_16x16x32_bf16 v[188:191], v[104:107], v[88:91], v[188:191]
    ds_read_b64_tr_b16 v[62:63], v9 offset:4608
    v_mfma_f32_16x16x32_bf16 v[192:195], v[76:79], v[108:111], v[192:195]
    ds_read_b64_tr_b16 v[64:65], v8 offset:8192
    v_mfma_f32_16x16x32_bf16 v[196:199], v[80:83], v[108:111], v[196:199]
    s_add_u32 m0, s30, 0x8800
    s_mov_b32 s28, 0x8200
    buffer_load_dwordx4 v11, s[8:11], s28 offen lds
    v_mfma_f32_16x16x32_bf16 v[200:203], v[84:87], v[108:111], v[200:203]
    ds_read_b64_tr_b16 v[66:67], v8 offset:8704
    v_mfma_f32_16x16x32_bf16 v[204:207], v[88:91], v[108:111], v[204:207]
    ds_read_b64_tr_b16 v[68:69], v9 offset:8192
    v_mfma_f32_16x16x32_bf16 v[208:211], v[76:79], v[112:115], v[208:211]
    ds_read_b64_tr_b16 v[70:71], v9 offset:8704
    v_mfma_f32_16x16x32_bf16 v[212:215], v[80:83], v[112:115], v[212:215]
    s_add_u32 m0, s30, 0x8c00
    s_mov_b32 s28, 0xc200
    buffer_load_dwordx4 v11, s[8:11], s28 offen lds
    v_mfma_f32_16x16x32_bf16 v[216:219], v[84:87], v[112:115], v[216:219]
    v_mfma_f32_16x16x32_bf16 v[220:223], v[88:91], v[112:115], v[220:223]
    s_waitcnt lgkmcnt(0)
    s_waitcnt vmcnt(10)
    s_barrier
    v_mfma_f32_16x16x32_bf16 v[128:131], v[48:51], v[32:35], v[128:131]
    ds_read_b128 v[76:79], v7 offset:0
    v_mfma_f32_16x16x32_bf16 v[132:135], v[48:51], v[36:39], v[132:135]
    s_add_u32 m0, s31, 0x18000
    s_mov_b32 s28, 0x180000
    buffer_load_dwordx4 v12, s[12:15], s28 offen lds
    v_mfma_f32_16x16x32_bf16 v[136:139], v[48:51], v[40:43], v[136:139]
    ds_read_b128 v[80:83], v7 offset:2048
    v_mfma_f32_16x16x32_bf16 v[140:143], v[48:51], v[44:47], v[140:143]
    ds_read_b128 v[84:87], v7 offset:4096
    v_mfma_f32_16x16x32_bf16 v[144:147], v[52:55], v[32:35], v[144:147]
    ds_read_b128 v[88:91], v7 offset:6144
    v_mfma_f32_16x16x32_bf16 v[148:151], v[52:55], v[36:39], v[148:151]
    s_cmp_ge_u32 s20, 4
    s_cbranch_scc1 g1qkv_sk8
    s_add_u32 m0, s31, 0x1a000
    s_mov_b32 s28, 0x180000
    s_nop 0
    buffer_load_dwordx4 v13, s[12:15], s28 offen lds
g1qkv_sk8:
    v_mfma_f32_16x16x32_bf16 v[152:155], v[52:55], v[40:43], v[152:155]
    ds_read_b64_tr_b16 v[92:93], v8 offset:14336
    v_mfma_f32_16x16x32_bf16 v[156:159], v[52:55], v[44:47], v[156:159]
    ds_read_b64_tr_b16 v[94:95], v8 offset:14848
    v_mfma_f32_16x16x32_bf16 v[160:163], v[56:59], v[32:35], v[160:163]
    ds_read_b64_tr_b16 v[96:97], v9 offset:14336
    v_mfma_f32_16x16x32_bf16 v[164:167], v[56:59], v[36:39], v[164:167]
    s_add_u32 m0, s77, 0x26000
    s_mov_b32 s28, 0x200000
    buffer_load_dwordx4 v30, s[88:91], s28 offen lds
    v_mfma_f32_16x16x32_bf16 v[168:171], v[56:59], v[40:43], v[168:171]
    ds_read_b64_tr_b16 v[98:99], v9 offset:14848
    v_mfma_f32_16x16x32_bf16 v[172:175], v[56:59], v[44:47], v[172:175]
    ds_read_b64_tr_b16 v[100:101], v8 offset:18432
    v_mfma_f32_16x16x32_bf16 v[176:179], v[60:63], v[32:35], v[176:179]
    ds_read_b64_tr_b16 v[102:103], v8 offset:18944
    v_mfma_f32_16x16x32_bf16 v[180:183], v[60:63], v[36:39], v[180:183]
    ds_read_b64_tr_b16 v[104:105], v9 offset:18432
    v_mfma_f32_16x16x32_bf16 v[184:187], v[60:63], v[40:43], v[184:187]
    ds_read_b64_tr_b16 v[106:107], v9 offset:18944
    v_mfma_f32_16x16x32_bf16 v[188:191], v[60:63], v[44:47], v[188:191]
    ds_read_b64_tr_b16 v[108:109], v8 offset:22528
    v_mfma_f32_16x16x32_bf16 v[192:195], v[32:35], v[64:67], v[192:195]
    ds_read_b64_tr_b16 v[110:111], v8 offset:23040
    v_mfma_f32_16x16x32_bf16 v[196:199], v[36:39], v[64:67], v[196:199]
    ds_read_b64_tr_b16 v[112:113], v9 offset:22528
    v_mfma_f32_16x16x32_bf16 v[200:203], v[40:43], v[64:67], v[200:203]
    ds_read_b64_tr_b16 v[114:115], v9 offset:23040
    v_mfma_f32_16x16x32_bf16 v[204:207], v[44:47], v[64:67], v[204:207]
    v_mfma_f32_16x16x32_bf16 v[208:211], v[32:35], v[68:71], v[208:211]
    v_mfma_f32_16x16x32_bf16 v[212:215], v[36:39], v[68:71], v[212:215]
    v_mfma_f32_16x16x32_bf16 v[216:219], v[40:43], v[68:71], v[216:219]
    v_mfma_f32_16x16x32_bf16 v[220:223], v[44:47], v[68:71], v[220:223]
    s_waitcnt lgkmcnt(0)
    s_waitcnt vmcnt(6)
    s_barrier
    v_mfma_f32_16x16x32_bf16 v[128:131], v[92:95], v[76:79], v[128:131]
    ds_read_b128 v[32:35], v2 offset:0
    v_mfma_f32_16x16x32_bf16 v[132:135], v[92:95], v[80:83], v[132:135]
    s_add_u32 m0, s31, 0x1b800
    s_mov_b32 s28, 0x1b0000
    buffer_load_dwordx4 v12, s[12:15], s28 offen lds
    v_mfma_f32_16x16x32_bf16 v[136:139], v[92:95], v[84:87], v[136:139]
    ds_read_b128 v[36:39], v2 offset:2048
    v_mfma_f32_16x16x32_bf16 v[140:143], v[92:95], v[88:91], v[140:143]
    ds_read_b128 v[40:43], v2 offset:4096
    v_mfma_f32_16x16x32_bf16 v[144:147], v[96:99], v[76:79], v[144:147]
    ds_read_b128 v[44:47], v2 offset:6144
    v_mfma_f32_16x16x32_bf16 v[148:151], v[96:99], v[80:83], v[148:151]
    s_cmp_ge_u32 s20, 4
    s_cbranch_scc1 g1qkv_sk9
    s_add_u32 m0, s31, 0x1d800
    s_mov_b32 s28, 0x1b0000
    s_nop 0
    buffer_load_dwordx4 v13, s[12:15], s28 offen lds
g1qkv_sk9:
    v_mfma_f32_16x16x32_bf16 v[152:155], v[96:99], v[84:87], v[152:155]
    ds_read_b64_tr_b16 v[48:49], v8 offset:28672
    v_mfma_f32_16x16x32_bf16 v[156:159], v[96:99], v[88:91], v[156:159]
    ds_read_b64_tr_b16 v[50:51], v8 offset:29184
    v_mfma_f32_16x16x32_bf16 v[160:163], v[100:103], v[76:79], v[160:163]
    ds_read_b64_tr_b16 v[52:53], v9 offset:28672
    v_mfma_f32_16x16x32_bf16 v[164:167], v[100:103], v[80:83], v[164:167]
    s_add_u32 m0, s30, 0x10000
    s_mov_b32 s28, 0x280
    buffer_load_dwordx4 v11, s[8:11], s28 offen lds
    v_mfma_f32_16x16x32_bf16 v[168:171], v[100:103], v[84:87], v[168:171]
    ds_read_b64_tr_b16 v[54:55], v9 offset:29184
    v_mfma_f32_16x16x32_bf16 v[172:175], v[100:103], v[88:91], v[172:175]
    ds_read_b64_tr_b16 v[56:57], v8 offset:32768
    v_mfma_f32_16x16x32_bf16 v[176:179], v[104:107], v[76:79], v[176:179]
    ds_read_b64_tr_b16 v[58:59], v8 offset:33280
    v_mfma_f32_16x16x32_bf16 v[180:183], v[104:107], v[80:83], v[180:183]
    s_add_u32 m0, s30, 0x10400
    s_mov_b32 s28, 0x4280
    buffer_load_dwordx4 v11, s[8:11], s28 offen lds
    v_mfma_f32_16x16x32_bf16 v[184:187], v[104:107], v[84:87], v[184:187]
    ds_read_b64_tr_b16 v[60:61], v9 offset:32768
    v_mfma_f32_16x16x32_bf16 v[188:191], v[104:107], v[88:91], v[188:191]
    ds_read_b64_tr_b16 v[62:63], v9 offset:33280
    v_mfma_f32_16x16x32_bf16 v[192:195], v[76:79], v[108:111], v[192:195]
    ds_read_b64_tr_b16 v[64:65], v8 offset:36864
    v_mfma_f32_16x16x32_bf16 v[196:199], v[80:83], v[108:111], v[196:199]
    s_add_u32 m0, s30, 0x10800
    s_mov_b32 s28, 0x8280
    buffer_load_dwordx4 v11, s[8:11], s28 offen lds
    v_mfma_f32_16x16x32_bf16 v[200:203], v[84:87], v[108:111], v[200:203]
    ds_read_b64_tr_b16 v[66:67], v8 offset:37376
    v_mfma_f32_16x16x32_bf16 v[204:207], v[88:91], v[108:111], v[204:207]
    ds_read_b64_tr_b16 v[68:69], v9 offset:36864
    v_mfma_f32_16x16x32_bf16 v[208:211], v[76:79], v[112:115], v[208:211]
    ds_read_b64_tr_b16 v[70:71], v9 offset:37376
    v_mfma_f32_16x16x32_bf16 v[212:215], v[80:83], v[112:115], v[212:215]
    s_add_u32 m0, s30, 0x10c00
    s_mov_b32 s28, 0xc280
    buffer_load_dwordx4 v11, s[8:11], s28 offen lds
    v_mfma_f32_16x16x32_bf16 v[216:219], v[84:87], v[112:115], v[216:219]
    v_mfma_f32_16x16x32_bf16 v[220:223], v[88:91], v[112:115], v[220:223]
    s_waitcnt lgkmcnt(0)
    s_waitcnt vmcnt(10)
    s_barrier
    v_mfma_f32_16x16x32_bf16 v[128:131], v[48:51], v[32:35], v[128:131]
    ds_read_b128 v[76:79], v3 offset:0
    v_mfma_f32_16x16x32_bf16 v[132:135], v[48:51], v[36:39], v[132:135]
    s_add_u32 m0, s31, 0x1f000
    s_mov_b32 s28, 0x1e0000
    buffer_load_dwordx4 v12, s[12:15], s28 offen lds
    v_mfma_f32_16x16x32_bf16 v[136:139], v[48:51], v[40:43], v[136:139]
    ds_read_b128 v[80:83], v3 offset:2048
    v_mfma_f32_16x16x32_bf16 v[140:143], v[48:51], v[44:47], v[140:143]
    ds_read_b128 v[84:87], v3 offset:4096
    v_mfma_f32_16x16x32_bf16 v[144:147], v[52:55], v[32:35], v[144:147]
    ds_read_b128 v[88:91], v3 offset:6144
    v_mfma_f32_16x16x32_bf16 v[148:151], v[52:55], v[36:39], v[148:151]
    s_cmp_ge_u32 s20, 4
    s_cbranch_scc1 g1qkv_sk10
    s_add_u32 m0, s31, 0x21000
    s_mov_b32 s28, 0x1e0000
    s_nop 0
    buffer_load_dwordx4 v13, s[12:15], s28 offen lds
g1qkv_sk10:
    v_mfma_f32_16x16x32_bf16 v[152:155], v[52:55], v[40:43], v[152:155]
    ds_read_b64_tr_b16 v[92:93], v8 offset:43008
    v_mfma_f32_16x16x32_bf16 v[156:159], v[52:55], v[44:47], v[156:159]
    ds_read_b64_tr_b16 v[94:95], v8 offset:43520
    v_mfma_f32_16x16x32_bf16 v[160:163], v[56:59], v[32:35], v[160:163]
    ds_read_b64_tr_b16 v[96:97], v9 offset:43008
    v_mfma_f32_16x16x32_bf16 v[164:167], v[56:59], v[36:39], v[164:167]
    ds_read_b64_tr_b16 v[98:99], v9 offset:43520
    v_mfma_f32_16x16x32_bf16 v[168:171], v[56:59], v[40:43], v[168:171]
    ds_read_b64_tr_b16 v[100:101], v8 offset:47104
    v_mfma_f32_16x16x32_bf16 v[172:175], v[56:59], v[44:47], v[172:175]
    ds_read_b64_tr_b16 v[102:103], v8 offset:47616
    v_mfma_f32_16x16x32_bf16 v[176:179], v[60:63], v[32:35], v[176:179]
    ds_read_b64_tr_b16 v[104:105], v9 offset:47104
    v_mfma_f32_16x16x32_bf16 v[180:183], v[60:63], v[36:39], v[180:183]
    ds_read_b64_tr_b16 v[106:107], v9 offset:47616
    v_mfma_f32_16x16x32_bf16 v[184:187], v[60:63], v[40:43], v[184:187]
    ds_read_b64_tr_b16 v[108:109], v8 offset:51200
    v_mfma_f32_16x16x32_bf16 v[188:191], v[60:63], v[44:47], v[188:191]
    ds_read_b64_tr_b16 v[110:111], v8 offset:51712
    v_mfma_f32_16x16x32_bf16 v[192:195], v[32:35], v[64:67], v[192:195]
    ds_read_b64_tr_b16 v[112:113], v9 offset:51200
    v_mfma_f32_16x16x32_bf16 v[196:199], v[36:39], v[64:67], v[196:199]
    ds_read_b64_tr_b16 v[114:115], v9 offset:51712
    v_mfma_f32_16x16x32_bf16 v[200:203], v[40:43], v[64:67], v[200:203]
    v_mfma_f32_16x16x32_bf16 v[204:207], v[44:47], v[64:67], v[204:207]
    v_mfma_f32_16x16x32_bf16 v[208:211], v[32:35], v[68:71], v[208:211]
    v_mfma_f32_16x16x32_bf16 v[212:215], v[36:39], v[68:71], v[212:215]
    v_mfma_f32_16x16x32_bf16 v[216:219], v[40:43], v[68:71], v[216:219]
    v_mfma_f32_16x16x32_bf16 v[220:223], v[44:47], v[68:71], v[220:223]
    s_waitcnt lgkmcnt(0)
    s_waitcnt vmcnt(6)
    s_barrier
    v_mfma_f32_16x16x32_bf16 v[128:131], v[92:95], v[76:79], v[128:131]
    ds_read_b128 v[32:35], v4 offset:0
    v_mfma_f32_16x16x32_bf16 v[132:135], v[92:95], v[80:83], v[132:135]
    s_add_u32 m0, s31, 0x22800
    s_mov_b32 s28, 0x210000
    buffer_load_dwordx4 v12, s[12:15], s28 offen lds
    v_mfma_f32_16x16x32_bf16 v[136:139], v[92:95], v[84:87], v[136:139]
    ds_read_b128 v[36:39], v4 offset:2048
    v_mfma_f32_16x16x32_bf16 v[140:143], v[92:95], v[88:91], v[140:143]
    ds_read_b128 v[40:43], v4 offset:4096
    v_mfma_f32_16x16x32_bf16 v[144:147], v[96:99], v[76:79], v[144:147]
    ds_read_b128 v[44:47], v4 offset:6144
    v_mfma_f32_16x16x32_bf16 v[148:151], v[96:99], v[80:83], v[148:151]
    s_cmp_ge_u32 s20, 4
    s_cbranch_scc1 g1qkv_sk11
    s_add_u32 m0, s31, 0x24800
    s_mov_b32 s28, 0x210000
    s_nop 0
    buffer_load_dwordx4 v13, s[12:15], s28 offen lds
g1qkv_sk11:
    v_mfma_f32_16x16x32_bf16 v[152:155], v[96:99], v[84:87], v[152:155]
    ds_read_b64_tr_b16 v[48:49], v8 offset:0
    v_mfma_f32_16x16x32_bf16 v[156:159], v[96:99], v[88:91], v[156:159]
    ds_read_b64_tr_b16 v[50:51], v8 offset:512
    v_mfma_f32_16x16x32_bf16 v[160:163], v[100:103], v[76:79], v[160:163]
    ds_read_b64_tr_b16 v[52:53], v9 offset:0
    v_mfma_f32_16x16x32_bf16 v[164:167], v[100:103], v[80:83], v[164:167]
    s_add_u32 m0, s30, 0x0
    s_mov_b32 s28, 0x300
    buffer_load_dwordx4 v11, s[8:11], s28 offen lds
    v_mfma_f32_16x16x32_bf16 v[168:171], v[100:103], v[84:87], v[168:171]
    ds_read_b64_tr_b16 v[54:55], v9 offset:512
    v_mfma_f32_16x16x32_bf16 v[172:175], v[100:103], v[88:91], v[172:175]
    ds_read_b64_tr_b16 v[56:57], v8 offset:4096
    v_mfma_f32_16x16x32_bf16 v[176:179], v[104:107], v[76:79], v[176:179]
    ds_read_b64_tr_b16 v[58:59], v8 offset:4608
    v_mfma_f32_16x16x32_bf16 v[180:183], v[104:107], v[80:83], v[180:183]
    s_add_u32 m0, s30, 0x400
    s_mov_b32 s28, 0x4300
    buffer_load_dwordx4 v11, s[8:11], s28 offen lds
    v_mfma_f32_16x16x32_bf16 v[184:187], v[104:107], v[84:87], v[184:187]
    ds_read_b64_tr_b16 v[60:61], v9 offset:4096
    v_mfma_f32_16x16x32_bf16 v[188:191], v[104:107], v[88:91], v[188:191]
    ds_read_b64_tr_b16 v[62:63], v9 offset:4608
    v_mfma_f32_16x16x32_bf16 v[192:195], v[76:79], v[108:111], v[192:195]
    ds_read_b64_tr_b16 v[64:65], v8 offset:8192
    v_mfma_f32_16x16x32_bf16 v[196:199], v[80:83], v[108:111], v[196:199]
    s_add_u32 m0, s30, 0x800
    s_mov_b32 s28, 0x8300
    buffer_load_dwordx4 v11, s[8:11], s28 offen lds
    v_mfma_f32_16x16x32_bf16 v[200:203], v[84:87], v[108:111], v[200:203]
    ds_read_b64_tr_b16 v[66:67], v8 offset:8704
    v_mfma_f32_16x16x32_bf16 v[204:207], v[88:91], v[108:111], v[204:207]
    ds_read_b64_tr_b16 v[68:69], v9 offset:8192
    v_mfma_f32_16x16x32_bf16 v[208:211], v[76:79], v[112:115], v[208:211]
    ds_read_b64_tr_b16 v[70:71], v9 offset:8704
    v_mfma_f32_16x16x32_bf16 v[212:215], v[80:83], v[112:115], v[212:215]
    s_add_u32 m0, s30, 0xc00
    s_mov_b32 s28, 0xc300
    buffer_load_dwordx4 v11, s[8:11], s28 offen lds
    v_mfma_f32_16x16x32_bf16 v[216:219], v[84:87], v[112:115], v[216:219]
    v_mfma_f32_16x16x32_bf16 v[220:223], v[88:91], v[112:115], v[220:223]
    s_waitcnt lgkmcnt(0)
    s_waitcnt vmcnt(10)
    s_barrier
    v_mfma_f32_16x16x32_bf16 v[128:131], v[48:51], v[32:35], v[128:131]
    ds_read_b128 v[76:79], v5 offset:0
    v_mfma_f32_16x16x32_bf16 v[132:135], v[48:51], v[36:39], v[132:135]
    s_add_u32 m0, s31, 0x18000
    s_mov_b32 s28, 0x240000
    buffer_load_dwordx4 v12, s[12:15], s28 offen lds
    v_mfma_f32_16x16x32_bf16 v[136:139], v[48:51], v[40:43], v[136:139]
    ds_read_b128 v[80:83], v5 offset:2048
    v_mfma_f32_16x16x32_bf16 v[140:143], v[48:51], v[44:47], v[140:143]
    ds_read_b128 v[84:87], v5 offset:4096
    v_mfma_f32_16x16x32_bf16 v[144:147], v[52:55], v[32:35], v[144:147]
    ds_read_b128 v[88:91], v5 offset:6144
    v_mfma_f32_16x16x32_bf16 v[148:151], v[52:55], v[36:39], v[148:151]
    s_cmp_ge_u32 s20, 4
    s_cbranch_scc1 g1qkv_sk12
    s_add_u32 m0, s31, 0x1a000
    s_mov_b32 s28, 0x240000
    s_nop 0
    buffer_load_dwordx4 v13, s[12:15], s28 offen lds
g1qkv_sk12:
    v_mfma_f32_16x16x32_bf16 v[152:155], v[52:55], v[40:43], v[152:155]
    ds_read_b64_tr_b16 v[92:93], v8 offset:14336
    v_mfma_f32_16x16x32_bf16 v[156:159], v[52:55], v[44:47], v[156:159]
    ds_read_b64_tr_b16 v[94:95], v8 offset:14848
    v_mfma_f32_16x16x32_bf16 v[160:163], v[56:59], v[32:35], v[160:163]
    ds_read_b64_tr_b16 v[96:97], v9 offset:14336
    v_mfma_f32_16x16x32_bf16 v[164:167], v[56:59], v[36:39], v[164:167]
    ds_read_b64_tr_b16 v[98:99], v9 offset:14848
    v_mfma_f32_16x16x32_bf16 v[168:171], v[56:59], v[40:43], v[168:171]
    ds_read_b64_tr_b16 v[100:101], v8 offset:18432
    v_mfma_f32_16x16x32_bf16 v[172:175], v[56:59], v[44:47], v[172:175]
    ds_read_b64_tr_b16 v[102:103], v8 offset:18944
    v_mfma_f32_16x16x32_bf16 v[176:179], v[60:63], v[32:35], v[176:179]
    ds_read_b64_tr_b16 v[104:105], v9 offset:18432
    v_mfma_f32_16x16x32_bf16 v[180:183], v[60:63], v[36:39], v[180:183]
    ds_read_b64_tr_b16 v[106:107], v9 offset:18944
    v_mfma_f32_16x16x32_bf16 v[184:187], v[60:63], v[40:43], v[184:187]
    ds_read_b64_tr_b16 v[108:109], v8 offset:22528
    v_mfma_f32_16x16x32_bf16 v[188:191], v[60:63], v[44:47], v[188:191]
    ds_read_b64_tr_b16 v[110:111], v8 offset:23040
    v_mfma_f32_16x16x32_bf16 v[192:195], v[32:35], v[64:67], v[192:195]
    ds_read_b64_tr_b16 v[112:113], v9 offset:22528
    v_mfma_f32_16x16x32_bf16 v[196:199], v[36:39], v[64:67], v[196:199]
    ds_read_b64_tr_b16 v[114:115], v9 offset:23040
    v_mfma_f32_16x16x32_bf16 v[200:203], v[40:43], v[64:67], v[200:203]
    v_mfma_f32_16x16x32_bf16 v[204:207], v[44:47], v[64:67], v[204:207]
    v_mfma_f32_16x16x32_bf16 v[208:211], v[32:35], v[68:71], v[208:211]
    v_mfma_f32_16x16x32_bf16 v[212:215], v[36:39], v[68:71], v[212:215]
    v_mfma_f32_16x16x32_bf16 v[216:219], v[40:43], v[68:71], v[216:219]
    v_mfma_f32_16x16x32_bf16 v[220:223], v[44:47], v[68:71], v[220:223]
    s_waitcnt lgkmcnt(0)
    s_waitcnt vmcnt(6)
    s_barrier
    v_mfma_f32_16x16x32_bf16 v[128:131], v[92:95], v[76:79], v[128:131]
    ds_read_b128 v[32:35], v6 offset:0
    v_mfma_f32_16x16x32_bf16 v[132:135], v[92:95], v[80:83], v[132:135]
    s_add_u32 m0, s31, 0x1b800
    s_mov_b32 s28, 0x270000
    buffer_load_dwordx4 v12, s[12:15], s28 offen lds
    v_mfma_f32_16x16x32_bf16 v[136:139], v[92:95], v[84:87], v[136:139]
    ds_read_b128 v[36:39], v6 offset:2048
    v_mfma_f32_16x16x32_bf16 v[140:143], v[92:95], v[88:91], v[140:143]
    ds_read_b128 v[40:43], v6 offset:4096
    v_mfma_f32_16x16x32_bf16 v[144:147], v[96:99], v[76:79], v[144:147]
    ds_read_b128 v[44:47], v6 offset:6144
    v_mfma_f32_16x16x32_bf16 v[148:151], v[96:99], v[80:83], v[148:151]
    s_cmp_ge_u32 s20, 4
    s_cbranch_scc1 g1qkv_sk13
    s_add_u32 m0, s31, 0x1d800
    s_mov_b32 s28, 0x270000
    s_nop 0
    buffer_load_dwordx4 v13, s[12:15], s28 offen lds
g1qkv_sk13:
    v_mfma_f32_16x16x32_bf16 v[152:155], v[96:99], v[84:87], v[152:155]
    ds_read_b64_tr_b16 v[48:49], v8 offset:28672
    v_mfma_f32_16x16x32_bf16 v[156:159], v[96:99], v[88:91], v[156:159]
    ds_read_b64_tr_b16 v[50:51], v8 offset:29184
    v_mfma_f32_16x16x32_bf16 v[160:163], v[100:103], v[76:79], v[160:163]
    ds_read_b64_tr_b16 v[52:53], v9 offset:28672
    v_mfma_f32_16x16x32_bf16 v[164:167], v[100:103], v[80:83], v[164:167]
    s_add_u32 m0, s30, 0x8000
    s_mov_b32 s28, 0x380
    buffer_load_dwordx4 v11, s[8:11], s28 offen lds
    v_mfma_f32_16x16x32_bf16 v[168:171], v[100:103], v[84:87], v[168:171]
    ds_read_b64_tr_b16 v[54:55], v9 offset:29184
    v_mfma_f32_16x16x32_bf16 v[172:175], v[100:103], v[88:91], v[172:175]
    ds_read_b64_tr_b16 v[56:57], v8 offset:32768
    v_mfma_f32_16x16x32_bf16 v[176:179], v[104:107], v[76:79], v[176:179]
    ds_read_b64_tr_b16 v[58:59], v8 offset:33280
    v_mfma_f32_16x16x32_bf16 v[180:183], v[104:107], v[80:83], v[180:183]
    s_add_u32 m0, s30, 0x8400
    s_mov_b32 s28, 0x4380
    buffer_load_dwordx4 v11, s[8:11], s28 offen lds
    v_mfma_f32_16x16x32_bf16 v[184:187], v[104:107], v[84:87], v[184:187]
    ds_read_b64_tr_b16 v[60:61], v9 offset:32768
    v_mfma_f32_16x16x32_bf16 v[188:191], v[104:107], v[88:91], v[188:191]
    ds_read_b64_tr_b16 v[62:63], v9 offset:33280
    v_mfma_f32_16x16x32_bf16 v[192:195], v[76:79], v[108:111], v[192:195]
    ds_read_b64_tr_b16 v[64:65], v8 offset:36864
    v_mfma_f32_16x16x32_bf16 v[196:199], v[80:83], v[108:111], v[196:199]
    s_add_u32 m0, s30, 0x8800
    s_mov_b32 s28, 0x8380
    buffer_load_dwordx4 v11, s[8:11], s28 offen lds
    v_mfma_f32_16x16x32_bf16 v[200:203], v[84:87], v[108:111], v[200:203]
    ds_read_b64_tr_b16 v[66:67], v8 offset:37376
    v_mfma_f32_16x16x32_bf16 v[204:207], v[88:91], v[108:111], v[204:207]
    ds_read_b64_tr_b16 v[68:69], v9 offset:36864
    v_mfma_f32_16x16x32_bf16 v[208:211], v[76:79], v[112:115], v[208:211]
    ds_read_b64_tr_b16 v[70:71], v9 offset:37376
    v_mfma_f32_16x16x32_bf16 v[212:215], v[80:83], v[112:115], v[212:215]
    s_add_u32 m0, s30, 0x8c00
    s_mov_b32 s28, 0xc380
    buffer_load_dwordx4 v11, s[8:11], s28 offen lds
    v_mfma_f32_16x16x32_bf16 v[216:219], v[84:87], v[112:115], v[216:219]
    s_add_u32 m0, s77, 0x26000
    s_mov_b32 s28, 0x300000
    buffer_load_dwordx4 v30, s[88:91], s28 offen lds
    v_mfma_f32_16x16x32_bf16 v[220:223], v[88:91], v[112:115], v[220:223]
    s_waitcnt lgkmcnt(0)
    s_waitcnt vmcnt(10)
    s_barrier
    v_mfma_f32_16x16x32_bf16 v[128:131], v[48:51], v[32:35], v[128:131]
    ds_read_b128 v[76:79], v7 offset:0
    v_mfma_f32_16x16x32_bf16 v[132:135], v[48:51], v[36:39], v[132:135]
    s_add_u32 m0, s31, 0x1f000
    s_mov_b32 s28, 0x2a0000
    buffer_load_dwordx4 v12, s[12:15], s28 offen lds
    v_mfma_f32_16x16x32_bf16 v[136:139], v[48:51], v[40:43], v[136:139]
    ds_read_b128 v[80:83], v7 offset:2048
    v_mfma_f32_16x16x32_bf16 v[140:143], v[48:51], v[44:47], v[140:143]
    ds_read_b128 v[84:87], v7 offset:4096
    v_mfma_f32_16x16x32_bf16 v[144:147], v[52:55], v[32:35], v[144:147]
    ds_read_b128 v[88:91], v7 offset:6144
    v_mfma_f32_16x16x32_bf16 v[148:151], v[52:55], v[36:39], v[148:151]
    s_cmp_ge_u32 s20, 4
    s_cbranch_scc1 g1qkv_sk14
    s_add_u32 m0, s31, 0x21000
    s_mov_b32 s28, 0x2a0000
    s_nop 0
    buffer_load_dwordx4 v13, s[12:15], s28 offen lds
g1qkv_sk14:
    v_mfma_f32_16x16x32_bf16 v[152:155], v[52:55], v[40:43], v[152:155]
    ds_read_b64_tr_b16 v[92:93], v8 offset:43008
    v_mfma_f32_16x16x32_bf16 v[156:159], v[52:55], v[44:47], v[156:159]
    ds_read_b64_tr_b16 v[94:95], v8 offset:43520
    v_mfma_f32_16x16x32_bf16 v[160:163], v[56:59], v[32:35], v[160:163]
    ds_read_b64_tr_b16 v[96:97], v9 offset:43008
    v_mfma_f32_16x16x32_bf16 v[164:167], v[56:59], v[36:39], v[164:167]
    ds_read_b64_tr_b16 v[98:99], v9 offset:43520
    v_mfma_f32_16x16x32_bf16 v[168:171], v[56:59], v[40:43], v[168:171]
    ds_read_b64_tr_b16 v[100:101], v8 offset:47104
    v_mfma_f32_16x16x32_bf16 v[172:175], v[56:59], v[44:47], v[172:175]
    ds_read_b64_tr_b16 v[102:103], v8 offset:47616
    v_mfma_f32_16x16x32_bf16 v[176:179], v[60:63], v[32:35], v[176:179]
    ds_read_b64_tr_b16 v[104:105], v9 offset:47104
    v_mfma_f32_16x16x32_bf16 v[180:183], v[60:63], v[36:39], v[180:183]
    ds_read_b64_tr_b16 v[106:107], v9 offset:47616
    v_mfma_f32_16x16x32_bf16 v[184:187], v[60:63], v[40:43], v[184:187]
    ds_read_b64_tr_b16 v[108:109], v8 offset:51200
    v_mfma_f32_16x16x32_bf16 v[188:191], v[60:63], v[44:47], v[188:191]
    ds_read_b64_tr_b16 v[110:111], v8 offset:51712
    v_mfma_f32_16x16x32_bf16 v[192:195], v[32:35], v[64:67], v[192:195]
    ds_read_b64_tr_b16 v[112:113], v9 offset:51200
    v_mfma_f32_16x16x32_bf16 v[196:199], v[36:39], v[64:67], v[196:199]
    ds_read_b64_tr_b16 v[114:115], v9 offset:51712
    v_mfma_f32_16x16x32_bf16 v[200:203], v[40:43], v[64:67], v[200:203]
    v_mfma_f32_16x16x32_bf16 v[204:207], v[44:47], v[64:67], v[204:207]
    v_mfma_f32_16x16x32_bf16 v[208:211], v[32:35], v[68:71], v[208:211]
    v_mfma_f32_16x16x32_bf16 v[212:215], v[36:39], v[68:71], v[212:215]
    v_mfma_f32_16x16x32_bf16 v[216:219], v[40:43], v[68:71], v[216:219]
    v_mfma_f32_16x16x32_bf16 v[220:223], v[44:47], v[68:71], v[220:223]
    s_waitcnt lgkmcnt(0)
    s_waitcnt vmcnt(6)
    s_barrier
    v_mfma_f32_16x16x32_bf16 v[128:131], v[92:95], v[76:79], v[128:131]
    ds_read_b128 v[32:35], v2 offset:0
    v_mfma_f32_16x16x32_bf16 v[132:135], v[92:95], v[80:83], v[132:135]
    s_add_u32 m0, s31, 0x22800
    s_mov_b32 s28, 0x2d0000
    buffer_load_dwordx4 v12, s[12:15], s28 offen lds
    v_mfma_f32_16x16x32_bf16 v[136:139], v[92:95], v[84:87], v[136:139]
    ds_read_b128 v[36:39], v2 offset:2048
    v_mfma_f32_16x16x32_bf16 v[140:143], v[92:95], v[88:91], v[140:143]
    ds_read_b128 v[40:43], v2 offset:4096
    v_mfma_f32_16x16x32_bf16 v[144:147], v[96:99], v[76:79], v[144:147]
    ds_read_b128 v[44:47], v2 offset:6144
    v_mfma_f32_16x16x32_bf16 v[148:151], v[96:99], v[80:83], v[148:151]
    s_cmp_ge_u32 s20, 4
    s_cbranch_scc1 g1qkv_sk15
    s_add_u32 m0, s31, 0x24800
    s_mov_b32 s28, 0x2d0000
    s_nop 0
    buffer_load_dwordx4 v13, s[12:15], s28 offen lds
g1qkv_sk15:
    v_mfma_f32_16x16x32_bf16 v[152:155], v[96:99], v[84:87], v[152:155]
    ds_read_b64_tr_b16 v[48:49], v8 offset:0
    v_mfma_f32_16x16x32_bf16 v[156:159], v[96:99], v[88:91], v[156:159]
    ds_read_b64_tr_b16 v[50:51], v8 offset:512
    v_mfma_f32_16x16x32_bf16 v[160:163], v[100:103], v[76:79], v[160:163]
    ds_read_b64_tr_b16 v[52:53], v9 offset:0
    v_mfma_f32_16x16x32_bf16 v[164:167], v[100:103], v[80:83], v[164:167]
    s_add_u32 m0, s30, 0x10000
    s_mov_b32 s28, 0x400
    buffer_load_dwordx4 v11, s[8:11], s28 offen lds
    v_mfma_f32_16x16x32_bf16 v[168:171], v[100:103], v[84:87], v[168:171]
    ds_read_b64_tr_b16 v[54:55], v9 offset:512
    v_mfma_f32_16x16x32_bf16 v[172:175], v[100:103], v[88:91], v[172:175]
    ds_read_b64_tr_b16 v[56:57], v8 offset:4096
    v_mfma_f32_16x16x32_bf16 v[176:179], v[104:107], v[76:79], v[176:179]
    ds_read_b64_tr_b16 v[58:59], v8 offset:4608
    v_mfma_f32_16x16x32_bf16 v[180:183], v[104:107], v[80:83], v[180:183]
    s_add_u32 m0, s30, 0x10400
    s_mov_b32 s28, 0x4400
    buffer_load_dwordx4 v11, s[8:11], s28 offen lds
    v_mfma_f32_16x16x32_bf16 v[184:187], v[104:107], v[84:87], v[184:187]
    ds_read_b64_tr_b16 v[60:61], v9 offset:4096
    v_mfma_f32_16x16x32_bf16 v[188:191], v[104:107], v[88:91], v[188:191]
    ds_read_b64_tr_b16 v[62:63], v9 offset:4608
    v_mfma_f32_16x16x32_bf16 v[192:195], v[76:79], v[108:111], v[192:195]
    ds_read_b64_tr_b16 v[64:65], v8 offset:8192
    v_mfma_f32_16x16x32_bf16 v[196:199], v[80:83], v[108:111], v[196:199]
    s_add_u32 m0, s30, 0x10800
    s_mov_b32 s28, 0x8400
    buffer_load_dwordx4 v11, s[8:11], s28 offen lds
    v_mfma_f32_16x16x32_bf16 v[200:203], v[84:87], v[108:111], v[200:203]
    ds_read_b64_tr_b16 v[66:67], v8 offset:8704
    v_mfma_f32_16x16x32_bf16 v[204:207], v[88:91], v[108:111], v[204:207]
    ds_read_b64_tr_b16 v[68:69], v9 offset:8192
    v_mfma_f32_16x16x32_bf16 v[208:211], v[76:79], v[112:115], v[208:211]
    ds_read_b64_tr_b16 v[70:71], v9 offset:8704
    v_mfma_f32_16x16x32_bf16 v[212:215], v[80:83], v[112:115], v[212:215]
    s_add_u32 m0, s30, 0x10c00
    s_mov_b32 s28, 0xc400
    buffer_load_dwordx4 v11, s[8:11], s28 offen lds
    v_mfma_f32_16x16x32_bf16 v[216:219], v[84:87], v[112:115], v[216:219]
    v_mfma_f32_16x16x32_bf16 v[220:223], v[88:91], v[112:115], v[220:223]
    s_waitcnt lgkmcnt(0)
    s_waitcnt vmcnt(10)
    s_barrier
    v_mfma_f32_16x16x32_bf16 v[128:131], v[48:51], v[32:35], v[128:131]
    ds_read_b128 v[76:79], v3 offset:0
    v_mfma_f32_16x16x32_bf16 v[132:135], v[48:51], v[36:39], v[132:135]
    s_add_u32 m0, s31, 0x18000
    s_mov_b32 s28, 0x300000
    buffer_load_dwordx4 v12, s[12:15], s28 offen lds
    v_mfma_f32_16x16x32_bf16 v[136:139], v[48:51], v[40:43], v[136:139]
    ds_read_b128 v[80:83], v3 offset:2048
    v_mfma_f32_16x16x32_bf16 v[140:143], v[48:51], v[44:47], v[140:143]
    ds_read_b128 v[84:87], v3 offset:4096
    v_mfma_f32_16x16x32_bf16 v[144:147], v[52:55], v[32:35], v[144:147]
    ds_read_b128 v[88:91], v3 offset:6144
    v_mfma_f32_16x16x32_bf16 v[148:151], v[52:55], v[36:39], v[148:151]
    s_cmp_ge_u32 s20, 4
    s_cbranch_scc1 g1qkv_sk16
    s_add_u32 m0, s31, 0x1a000
    s_mov_b32 s28, 0x300000
    s_nop 0
    buffer_load_dwordx4 v13, s[12:15], s28 offen lds
g1qkv_sk16:
    v_mfma_f32_16x16x32_bf16 v[152:155], v[52:55], v[40:43], v[152:155]
    ds_read_b64_tr_b16 v[92:93], v8 offset:14336
    v_mfma_f32_16x16x32_bf16 v[156:159], v[52:55], v[44:47], v[156:159]
    ds_read_b64_tr_b16 v[94:95], v8 offset:14848
    v_mfma_f32_16x16x32_bf16 v[160:163], v[56:59], v[32:35], v[160:163]
    ds_read_b64_tr_b16 v[96:97], v9 offset:14336
    v_mfma_f32_16x16x32_bf16 v[164:167], v[56:59], v[36:39], v[164:167]
    ds_read_b64_tr_b16 v[98:99], v9 offset:14848
    v_mfma_f32_16x16x32_bf16 v[168:171], v[56:59], v[40:43], v[168:171]
    ds_read_b64_tr_b16 v[100:101], v8 offset:18432
    v_mfma_f32_16x16x32_bf16 v[172:175], v[56:59], v[44:47], v[172:175]
    ds_read_b64_tr_b16 v[102:103], v8 offset:18944
    v_mfma_f32_16x16x32_bf16 v[176:179], v[60:63], v[32:35], v[176:179]
    ds_read_b64_tr_b16 v[104:105], v9 offset:18432
    v_mfma_f32_16x16x32_bf16 v[180:183], v[60:63], v[36:39], v[180:183]
    ds_read_b64_tr_b16 v[106:107], v9 offset:18944
    v_mfma_f32_16x16x32_bf16 v[184:187], v[60:63], v[40:43], v[184:187]
    ds_read_b64_tr_b16 v[108:109], v8 offset:22528
    v_mfma_f32_16x16x32_bf16 v[188:191], v[60:63], v[44:47], v[188:191]
    ds_read_b64_tr_b16 v[110:111], v8 offset:23040
    v_mfma_f32_16x16x32_bf16 v[192:195], v[32:35], v[64:67], v[192:195]
    ds_read_b64_tr_b16 v[112:113], v9 offset:22528
    v_mfma_f32_16x16x32_bf16 v[196:199], v[36:39], v[64:67], v[196:199]
    ds_read_b64_tr_b16 v[114:115], v9 offset:23040
    v_mfma_f32_16x16x32_bf16 v[200:203], v[40:43], v[64:67], v[200:203]
    v_mfma_f32_16x16x32_bf16 v[204:207], v[44:47], v[64:67], v[204:207]
    v_mfma_f32_16x16x32_bf16 v[208:211], v[32:35], v[68:71], v[208:211]
    v_mfma_f32_16x16x32_bf16 v[212:215], v[36:39], v[68:71], v[212:215]
    v_mfma_f32_16x16x32_bf16 v[216:219], v[40:43], v[68:71], v[216:219]
    v_mfma_f32_16x16x32_bf16 v[220:223], v[44:47], v[68:71], v[220:223]
    s_waitcnt lgkmcnt(0)
    s_waitcnt vmcnt(6)
    s_barrier
    v_mfma_f32_16x16x32_bf16 v[128:131], v[92:95], v[76:79], v[128:131]
    ds_read_b128 v[32:35], v4 offset:0
    v_mfma_f32_16x16x32_bf16 v[132:135], v[92:95], v[80:83], v[132:135]
    s_add_u32 m0, s31, 0x1b800
    s_mov_b32 s28, 0x330000
    buffer_load_dwordx4 v12, s[12:15], s28 offen lds
    v_mfma_f32_16x16x32_bf16 v[136:139], v[92:95], v[84:87], v[136:139]
    ds_read_b128 v[36:39], v4 offset:2048
    v_mfma_f32_16x16x32_bf16 v[140:143], v[92:95], v[88:91], v[140:143]
    ds_read_b128 v[40:43], v4 offset:4096
    v_mfma_f32_16x16x32_bf16 v[144:147], v[96:99], v[76:79], v[144:147]
    ds_read_b128 v[44:47], v4 offset:6144
    v_mfma_f32_16x16x32_bf16 v[148:151], v[96:99], v[80:83], v[148:151]
    s_cmp_ge_u32 s20, 4
    s_cbranch_scc1 g1qkv_sk17
    s_add_u32 m0, s31, 0x1d800
    s_mov_b32 s28, 0x330000
    s_nop 0
    buffer_load_dwordx4 v13, s[12:15], s28 offen lds
g1qkv_sk17:
    v_mfma_f32_16x16x32_bf16 v[152:155], v[96:99], v[84:87], v[152:155]
    ds_read_b64_tr_b16 v[48:49], v8 offset:28672
    v_mfma_f32_16x16x32_bf16 v[156:159], v[96:99], v[88:91], v[156:159]
    ds_read_b64_tr_b16 v[50:51], v8 offset:29184
    v_mfma_f32_16x16x32_bf16 v[160:163], v[100:103], v[76:79], v[160:163]
    ds_read_b64_tr_b16 v[52:53], v9 offset:28672
    v_mfma_f32_16x16x32_bf16 v[164:167], v[100:103], v[80:83], v[164:167]
    s_add_u32 m0, s30, 0x0
    s_mov_b32 s28, 0x480
    buffer_load_dwordx4 v11, s[8:11], s28 offen lds
    v_mfma_f32_16x16x32_bf16 v[168:171], v[100:103], v[84:87], v[168:171]
    ds_read_b64_tr_b16 v[54:55], v9 offset:29184
    v_mfma_f32_16x16x32_bf16 v[172:175], v[100:103], v[88:91], v[172:175]
    ds_read_b64_tr_b16 v[56:57], v8 offset:32768
    v_mfma_f32_16x16x32_bf16 v[176:179], v[104:107], v[76:79], v[176:179]
    ds_read_b64_tr_b16 v[58:59], v8 offset:33280
    v_mfma_f32_16x16x32_bf16 v[180:183], v[104:107], v[80:83], v[180:183]
    s_add_u32 m0, s30, 0x400
    s_mov_b32 s28, 0x4480
    buffer_load_dwordx4 v11, s[8:11], s28 offen lds
    v_mfma_f32_16x16x32_bf16 v[184:187], v[104:107], v[84:87], v[184:187]
    ds_read_b64_tr_b16 v[60:61], v9 offset:32768
    v_mfma_f32_16x16x32_bf16 v[188:191], v[104:107], v[88:91], v[188:191]
    ds_read_b64_tr_b16 v[62:63], v9 offset:33280
    v_mfma_f32_16x16x32_bf16 v[192:195], v[76:79], v[108:111], v[192:195]
    ds_read_b64_tr_b16 v[64:65], v8 offset:36864
    v_mfma_f32_16x16x32_bf16 v[196:199], v[80:83], v[108:111], v[196:199]
    s_add_u32 m0, s30, 0x800
    s_mov_b32 s28, 0x8480
    buffer_load_dwordx4 v11, s[8:11], s28 offen lds
    v_mfma_f32_16x16x32_bf16 v[200:203], v[84:87], v[108:111], v[200:203]
    ds_read_b64_tr_b16 v[66:67], v8 offset:37376
    v_mfma_f32_16x16x32_bf16 v[204:207], v[88:91], v[108:111], v[204:207]
    ds_read_b64_tr_b16 v[68:69], v9 offset:36864
    v_mfma_f32_16x16x32_bf16 v[208:211], v[76:79], v[112:115], v[208:211]
    ds_read_b64_tr_b16 v[70:71], v9 offset:37376
    v_mfma_f32_16x16x32_bf16 v[212:215], v[80:83], v[112:115], v[212:215]
    s_add_u32 m0, s30, 0xc00
    s_mov_b32 s28, 0xc480
    buffer_load_dwordx4 v11, s[8:11], s28 offen lds
    v_mfma_f32_16x16x32_bf16 v[216:219], v[84:87], v[112:115], v[216:219]
    v_mfma_f32_16x16x32_bf16 v[220:223], v[88:91], v[112:115], v[220:223]
    s_waitcnt lgkmcnt(0)
    s_waitcnt vmcnt(10)
    s_barrier
    v_mfma_f32_16x16x32_bf16 v[128:131], v[48:51], v[32:35], v[128:131]
    ds_read_b128 v[76:79], v5 offset:0
    v_mfma_f32_16x16x32_bf16 v[132:135], v[48:51], v[36:39], v[132:135]
    s_add_u32 m0, s31, 0x1f000
    s_mov_b32 s28, 0x360000
    buffer_load_dwordx4 v12, s[12:15], s28 offen lds
    v_mfma_f32_16x16x32_bf16 v[136:139], v[48:51], v[40:43], v[136:139]
    ds_read_b128 v[80:83], v5 offset:2048
    v_mfma_f32_16x16x32_bf16 v[140:143], v[48:51], v[44:47], v[140:143]
    ds_read_b128 v[84:87], v5 offset:4096
    v_mfma_f32_16x16x32_bf16 v[144:147], v[52:55], v[32:35], v[144:147]
    ds_read_b128 v[88:91], v5 offset:6144
    v_mfma_f32_16x16x32_bf16 v[148:151], v[52:55], v[36:39], v[148:151]
    s_cmp_ge_u32 s20, 4
    s_cbranch_scc1 g1qkv_sk18
    s_add_u32 m0, s31, 0x21000
    s_mov_b32 s28, 0x360000
    s_nop 0
    buffer_load_dwordx4 v13, s[12:15], s28 offen lds
g1qkv_sk18:
    v_mfma_f32_16x16x32_bf16 v[152:155], v[52:55], v[40:43], v[152:155]
    ds_read_b64_tr_b16 v[92:93], v8 offset:43008
    v_mfma_f32_16x16x32_bf16 v[156:159], v[52:55], v[44:47], v[156:159]
    ds_read_b64_tr_b16 v[94:95], v8 offset:43520
    v_mfma_f32_16x16x32_bf16 v[160:163], v[56:59], v[32:35], v[160:163]
    ds_read_b64_tr_b16 v[96:97], v9 offset:43008
    v_mfma_f32_16x16x32_bf16 v[164:167], v[56:59], v[36:39], v[164:167]
    s_add_u32 m0, s77, 0x26000
    s_mov_b32 s28, 0x400000
    buffer_load_dwordx4 v30, s[88:91], s28 offen lds
    v_mfma_f32_16x16x32_bf16 v[168:171], v[56:59], v[40:43], v[168:171]
    ds_read_b64_tr_b16 v[98:99], v9 offset:43520
    v_mfma_f32_16x16x32_bf16 v[172:175], v[56:59], v[44:47], v[172:175]
    ds_read_b64_tr_b16 v[100:101], v8 offset:47104
    v_mfma_f32_16x16x32_bf16 v[176:179], v[60:63], v[32:35], v[176:179]
    ds_read_b64_tr_b16 v[102:103], v8 offset:47616
    v_mfma_f32_16x16x32_bf16 v[180:183], v[60:63], v[36:39], v[180:183]
    ds_read_b64_tr_b16 v[104:105], v9 offset:47104
    v_mfma_f32_16x16x32_bf16 v[184:187], v[60:63], v[40:43], v[184:187]
    ds_read_b64_tr_b16 v[106:107], v9 offset:47616
    v_mfma_f32_16x16x32_bf16 v[188:191], v[60:63], v[44:47], v[188:191]
    ds_read_b64_tr_b16 v[108:109], v8 offset:51200
    v_mfma_f32_16x16x32_bf16 v[192:195], v[32:35], v[64:67], v[192:195]
    ds_read_b64_tr_b16 v[110:111], v8 offset:51712
    v_mfma_f32_16x16x32_bf16 v[196:199], v[36:39], v[64:67], v[196:199]
    ds_read_b64_tr_b16 v[112:113], v9 offset:51200
    v_mfma_f32_16x16x32_bf16 v[200:203], v[40:43], v[64:67], v[200:203]
    ds_read_b64_tr_b16 v[114:115], v9 offset:51712
    v_mfma_f32_16x16x32_bf16 v[204:207], v[44:47], v[64:67], v[204:207]
    v_mfma_f32_16x16x32_bf16 v[208:211], v[32:35], v[68:71], v[208:211]
    v_mfma_f32_16x16x32_bf16 v[212:215], v[36:39], v[68:71], v[212:215]
    v_mfma_f32_16x16x32_bf16 v[216:219], v[40:43], v[68:71], v[216:219]
    v_mfma_f32_16x16x32_bf16 v[220:223], v[44:47], v[68:71], v[220:223]
    s_waitcnt lgkmcnt(0)
    s_waitcnt vmcnt(6)
    s_barrier
    v_mfma_f32_16x16x32_bf16 v[128:131], v[92:95], v[76:79], v[128:131]
    ds_read_b128 v[32:35], v6 offset:0
    v_mfma_f32_16x16x32_bf16 v[132:135], v[92:95], v[80:83], v[132:135]
    s_add_u32 m0, s31, 0x22800
    s_mov_b32 s28, 0x390000
    buffer_load_dwordx4 v12, s[12:15], s28 offen lds
    v_mfma_f32_16x16x32_bf16 v[136:139], v[92:95], v[84:87], v[136:139]
    ds_read_b128 v[36:39], v6 offset:2048
    v_mfma_f32_16x16x32_bf16 v[140:143], v[92:95], v[88:91], v[140:143]
    ds_read_b128 v[40:43], v6 offset:4096
    v_mfma_f32_16x16x32_bf16 v[144:147], v[96:99], v[76:79], v[144:147]
    ds_read_b128 v[44:47], v6 offset:6144
    v_mfma_f32_16x16x32_bf16 v[148:151], v[96:99], v[80:83], v[148:151]
    s_cmp_ge_u32 s20, 4
    s_cbranch_scc1 g1qkv_sk19
    s_add_u32 m0, s31, 0x24800
    s_mov_b32 s28, 0x390000
    s_nop 0
    buffer_load_dwordx4 v13, s[12:15], s28 offen lds
g1qkv_sk19:
    v_mfma_f32_16x16x32_bf16 v[152:155], v[96:99], v[84:87], v[152:155]
    ds_read_b64_tr_b16 v[48:49], v8 offset:0
    v_mfma_f32_16x16x32_bf16 v[156:159], v[96:99], v[88:91], v[156:159]
    ds_read_b64_tr_b16 v[50:51], v8 offset:512
    v_mfma_f32_16x16x32_bf16 v[160:163], v[100:103], v[76:79], v[160:163]
    ds_read_b64_tr_b16 v[52:53], v9 offset:0
    v_mfma_f32_16x16x32_bf16 v[164:167], v[100:103], v[80:83], v[164:167]
    s_add_u32 m0, s30, 0x8000
    s_mov_b32 s28, 0x500
    buffer_load_dwordx4 v11, s[8:11], s28 offen lds
    v_mfma_f32_16x16x32_bf16 v[168:171], v[100:103], v[84:87], v[168:171]
    ds_read_b64_tr_b16 v[54:55], v9 offset:512
    v_mfma_f32_16x16x32_bf16 v[172:175], v[100:103], v[88:91], v[172:175]
    ds_read_b64_tr_b16 v[56:57], v8 offset:4096
    v_mfma_f32_16x16x32_bf16 v[176:179], v[104:107], v[76:79], v[176:179]
    ds_read_b64_tr_b16 v[58:59], v8 offset:4608
    v_mfma_f32_16x16x32_bf16 v[180:183], v[104:107], v[80:83], v[180:183]
    s_add_u32 m0, s30, 0x8400
    s_mov_b32 s28, 0x4500
    buffer_load_dwordx4 v11, s[8:11], s28 offen lds
    v_mfma_f32_16x16x32_bf16 v[184:187], v[104:107], v[84:87], v[184:187]
    ds_read_b64_tr_b16 v[60:61], v9 offset:4096
    v_mfma_f32_16x16x32_bf16 v[188:191], v[104:107], v[88:91], v[188:191]
    ds_read_b64_tr_b16 v[62:63], v9 offset:4608
    v_mfma_f32_16x16x32_bf16 v[192:195], v[76:79], v[108:111], v[192:195]
    ds_read_b64_tr_b16 v[64:65], v8 offset:8192
    v_mfma_f32_16x16x32_bf16 v[196:199], v[80:83], v[108:111], v[196:199]
    s_add_u32 m0, s30, 0x8800
    s_mov_b32 s28, 0x8500
    buffer_load_dwordx4 v11, s[8:11], s28 offen lds
    v_mfma_f32_16x16x32_bf16 v[200:203], v[84:87], v[108:111], v[200:203]
    ds_read_b64_tr_b16 v[66:67], v8 offset:8704
    v_mfma_f32_16x16x32_bf16 v[204:207], v[88:91], v[108:111], v[204:207]
    ds_read_b64_tr_b16 v[68:69], v9 offset:8192
    v_mfma_f32_16x16x32_bf16 v[208:211], v[76:79], v[112:115], v[208:211]
    ds_read_b64_tr_b16 v[70:71], v9 offset:8704
    v_mfma_f32_16x16x32_bf16 v[212:215], v[80:83], v[112:115], v[212:215]
    s_add_u32 m0, s30, 0x8c00
    s_mov_b32 s28, 0xc500
    buffer_load_dwordx4 v11, s[8:11], s28 offen lds
    v_mfma_f32_16x16x32_bf16 v[216:219], v[84:87], v[112:115], v[216:219]
    v_mfma_f32_16x16x32_bf16 v[220:223], v[88:91], v[112:115], v[220:223]
    s_waitcnt lgkmcnt(0)
    s_waitcnt vmcnt(10)
    s_barrier
    v_mfma_f32_16x16x32_bf16 v[128:131], v[48:51], v[32:35], v[128:131]
    ds_read_b128 v[76:79], v7 offset:0
    v_mfma_f32_16x16x32_bf16 v[132:135], v[48:51], v[36:39], v[132:135]
    s_add_u32 m0, s31, 0x18000
    s_mov_b32 s28, 0x3c0000
    buffer_load_dwordx4 v12, s[12:15], s28 offen lds
    v_mfma_f32_16x16x32_bf16 v[136:139], v[48:51], v[40:43], v[136:139]
    ds_read_b128 v[80:83], v7 offset:2048
    v_mfma_f32_16x16x32_bf16 v[140:143], v[48:51], v[44:47], v[140:143]
    ds_read_b128 v[84:87], v7 offset:4096
    v_mfma_f32_16x16x32_bf16 v[144:147], v[52:55], v[32:35], v[144:147]
    ds_read_b128 v[88:91], v7 offset:6144
    v_mfma_f32_16x16x32_bf16 v[148:151], v[52:55], v[36:39], v[148:151]
    s_cmp_ge_u32 s20, 4
    s_cbranch_scc1 g1qkv_sk20
    s_add_u32 m0, s31, 0x1a000
    s_mov_b32 s28, 0x3c0000
    s_nop 0
    buffer_load_dwordx4 v13, s[12:15], s28 offen lds
g1qkv_sk20:
    v_mfma_f32_16x16x32_bf16 v[152:155], v[52:55], v[40:43], v[152:155]
    ds_read_b64_tr_b16 v[92:93], v8 offset:14336
    v_mfma_f32_16x16x32_bf16 v[156:159], v[52:55], v[44:47], v[156:159]
    ds_read_b64_tr_b16 v[94:95], v8 offset:14848
    v_mfma_f32_16x16x32_bf16 v[160:163], v[56:59], v[32:35], v[160:163]
    ds_read_b64_tr_b16 v[96:97], v9 offset:14336
    v_mfma_f32_16x16x32_bf16 v[164:167], v[56:59], v[36:39], v[164:167]
    ds_read_b64_tr_b16 v[98:99], v9 offset:14848
    v_mfma_f32_16x16x32_bf16 v[168:171], v[56:59], v[40:43], v[168:171]
    ds_read_b64_tr_b16 v[100:101], v8 offset:18432
    v_mfma_f32_16x16x32_bf16 v[172:175], v[56:59], v[44:47], v[172:175]
    ds_read_b64_tr_b16 v[102:103], v8 offset:18944
    v_mfma_f32_16x16x32_bf16 v[176:179], v[60:63], v[32:35], v[176:179]
    ds_read_b64_tr_b16 v[104:105], v9 offset:18432
    v_mfma_f32_16x16x32_bf16 v[180:183], v[60:63], v[36:39], v[180:183]
    ds_read_b64_tr_b16 v[106:107], v9 offset:18944
    v_mfma_f32_16x16x32_bf16 v[184:187], v[60:63], v[40:43], v[184:187]
    ds_read_b64_tr_b16 v[108:109], v8 offset:22528
    v_mfma_f32_16x16x32_bf16 v[188:191], v[60:63], v[44:47], v[188:191]
    ds_read_b64_tr_b16 v[110:111], v8 offset:23040
    v_mfma_f32_16x16x32_bf16 v[192:195], v[32:35], v[64:67], v[192:195]
    ds_read_b64_tr_b16 v[112:113], v9 offset:22528
    v_mfma_f32_16x16x32_bf16 v[196:199], v[36:39], v[64:67], v[196:199]
    ds_read_b64_tr_b16 v[114:115], v9 offset:23040
    v_mfma_f32_16x16x32_bf16 v[200:203], v[40:43], v[64:67], v[200:203]
    v_mfma_f32_16x16x32_bf16 v[204:207], v[44:47], v[64:67], v[204:207]
    v_mfma_f32_16x16x32_bf16 v[208:211], v[32:35], v[68:71], v[208:211]
    v_mfma_f32_16x16x32_bf16 v[212:215], v[36:39], v[68:71], v[212:215]
    v_mfma_f32_16x16x32_bf16 v[216:219], v[40:43], v[68:71], v[216:219]
    v_mfma_f32_16x16x32_bf16 v[220:223], v[44:47], v[68:71], v[220:223]
    s_waitcnt lgkmcnt(0)
    s_waitcnt vmcnt(6)
    s_barrier
    v_mfma_f32_16x16x32_bf16 v[128:131], v[92:95], v[76:79], v[128:131]
    ds_read_b128 v[32:35], v2 offset:0
    v_mfma_f32_16x16x32_bf16 v[132:135], v[92:95], v[80:83], v[132:135]
    s_add_u32 m0, s31, 0x1b800
    s_mov_b32 s28, 0x3f0000
    buffer_load_dwordx4 v12, s[12:15], s28 offen lds
    v_mfma_f32_16x16x32_bf16 v[136:139], v[92:95], v[84:87], v[136:139]
    ds_read_b128 v[36:39], v2 offset:2048
    v_mfma_f32_16x16x32_bf16 v[140:143], v[92:95], v[88:91], v[140:143]
    ds_read_b128 v[40:43], v2 offset:4096
    v_mfma_f32_16x16x32_bf16 v[144:147], v[96:99], v[76:79], v[144:147]
    ds_read_b128 v[44:47], v2 offset:6144
    v_mfma_f32_16x16x32_bf16 v[148:151], v[96:99], v[80:83], v[148:151]
    s_cmp_ge_u32 s20, 4
    s_cbranch_scc1 g1qkv_sk21
    s_add_u32 m0, s31, 0x1d800
    s_mov_b32 s28, 0x3f0000
    s_nop 0
    buffer_load_dwordx4 v13, s[12:15], s28 offen lds
g1qkv_sk21:
    v_mfma_f32_16x16x32_bf16 v[152:155], v[96:99], v[84:87], v[152:155]
    ds_read_b64_tr_b16 v[48:49], v8 offset:28672
    v_mfma_f32_16x16x32_bf16 v[156:159], v[96:99], v[88:91], v[156:159]
    ds_read_b64_tr_b16 v[50:51], v8 offset:29184
    v_mfma_f32_16x16x32_bf16 v[160:163], v[100:103], v[76:79], v[160:163]
    ds_read_b64_tr_b16 v[52:53], v9 offset:28672
    v_mfma_f32_16x16x32_bf16 v[164:167], v[100:103], v[80:83], v[164:167]
    s_add_u32 m0, s30, 0x10000
    s_mov_b32 s28, 0x580
    buffer_load_dwordx4 v11, s[8:11], s28 offen lds
    v_mfma_f32_16x16x32_bf16 v[168:171], v[100:103], v[84:87], v[168:171]
    ds_read_b64_tr_b16 v[54:55], v9 offset:29184
    v_mfma_f32_16x16x32_bf16 v[172:175], v[100:103], v[88:91], v[172:175]
    ds_read_b64_tr_b16 v[56:57], v8 offset:32768
    v_mfma_f32_16x16x32_bf16 v[176:179], v[104:107], v[76:79], v[176:179]
    ds_read_b64_tr_b16 v[58:59], v8 offset:33280
    v_mfma_f32_16x16x32_bf16 v[180:183], v[104:107], v[80:83], v[180:183]
    s_add_u32 m0, s30, 0x10400
    s_mov_b32 s28, 0x4580
    buffer_load_dwordx4 v11, s[8:11], s28 offen lds
    v_mfma_f32_16x16x32_bf16 v[184:187], v[104:107], v[84:87], v[184:187]
    ds_read_b64_tr_b16 v[60:61], v9 offset:32768
    v_mfma_f32_16x16x32_bf16 v[188:191], v[104:107], v[88:91], v[188:191]
    ds_read_b64_tr_b16 v[62:63], v9 offset:33280
    v_mfma_f32_16x16x32_bf16 v[192:195], v[76:79], v[108:111], v[192:195]
    ds_read_b64_tr_b16 v[64:65], v8 offset:36864
    v_mfma_f32_16x16x32_bf16 v[196:199], v[80:83], v[108:111], v[196:199]
    s_add_u32 m0, s30, 0x10800
    s_mov_b32 s28, 0x8580
    buffer_load_dwordx4 v11, s[8:11], s28 offen lds
    v_mfma_f32_16x16x32_bf16 v[200:203], v[84:87], v[108:111], v[200:203]
    ds_read_b64_tr_b16 v[66:67], v8 offset:37376
    v_mfma_f32_16x16x32_bf16 v[204:207], v[88:91], v[108:111], v[204:207]
    ds_read_b64_tr_b16 v[68:69], v9 offset:36864
    v_mfma_f32_16x16x32_bf16 v[208:211], v[76:79], v[112:115], v[208:211]
    ds_read_b64_tr_b16 v[70:71], v9 offset:37376
    v_mfma_f32_16x16x32_bf16 v[212:215], v[80:83], v[112:115], v[212:215]
    s_add_u32 m0, s30, 0x10c00
    s_mov_b32 s28, 0xc580
    buffer_load_dwordx4 v11, s[8:11], s28 offen lds
    v_mfma_f32_16x16x32_bf16 v[216:219], v[84:87], v[112:115], v[216:219]
    v_mfma_f32_16x16x32_bf16 v[220:223], v[88:91], v[112:115], v[220:223]
    s_waitcnt lgkmcnt(0)
    s_waitcnt vmcnt(10)
    s_barrier
    v_mfma_f32_16x16x32_bf16 v[128:131], v[48:51], v[32:35], v[128:131]
    ds_read_b128 v[76:79], v3 offset:0
    v_mfma_f32_16x16x32_bf16 v[132:135], v[48:51], v[36:39], v[132:135]
    s_add_u32 m0, s31, 0x1f000
    s_mov_b32 s28, 0x420000
    buffer_load_dwordx4 v12, s[12:15], s28 offen lds
    v_mfma_f32_16x16x32_bf16 v[136:139], v[48:51], v[40:43], v[136:139]
    ds_read_b128 v[80:83], v3 offset:2048
    v_mfma_f32_16x16x32_bf16 v[140:143], v[48:51], v[44:47], v[140:143]
    ds_read_b128 v[84:87], v3 offset:4096
    v_mfma_f32_16x16x32_bf16 v[144:147], v[52:55], v[32:35], v[144:147]
    ds_read_b128 v[88:91], v3 offset:6144
    v_mfma_f32_16x16x32_bf16 v[148:151], v[52:55], v[36:39], v[148:151]
    s_cmp_ge_u32 s20, 4
    s_cbranch_scc1 g1qkv_sk22
    s_add_u32 m0, s31, 0x21000
    s_mov_b32 s28, 0x420000
    s_nop 0
    buffer_load_dwordx4 v13, s[12:15], s28 offen lds
g1qkv_sk22:
    v_mfma_f32_16x16x32_bf16 v[152:155], v[52:55], v[40:43], v[152:155]
    ds_read_b64_tr_b16 v[92:93], v8 offset:43008
    v_mfma_f32_16x16x32_bf16 v[156:159], v[52:55], v[44:47], v[156:159]
    ds_read_b64_tr_b16 v[94:95], v8 offset:43520
    v_mfma_f32_16x16x32_bf16 v[160:163], v[56:59], v[32:35], v[160:163]
    ds_read_b64_tr_b16 v[96:97], v9 offset:43008
    v_mfma_f32_16x16x32_bf16 v[164:167], v[56:59], v[36:39], v[164:167]
    ds_read_b64_tr_b16 v[98:99], v9 offset:43520
    v_mfma_f32_16x16x32_bf16 v[168:171], v[56:59], v[40:43], v[168:171]
    ds_read_b64_tr_b16 v[100:101], v8 offset:47104
    v_mfma_f32_16x16x32_bf16 v[172:175], v[56:59], v[44:47], v[172:175]
    ds_read_b64_tr_b16 v[102:103], v8 offset:47616
    v_mfma_f32_16x16x32_bf16 v[176:179], v[60:63], v[32:35], v[176:179]
    ds_read_b64_tr_b16 v[104:105], v9 offset:47104
    v_mfma_f32_16x16x32_bf16 v[180:183], v[60:63], v[36:39], v[180:183]
    ds_read_b64_tr_b16 v[106:107], v9 offset:47616
    v_mfma_f32_16x16x32_bf16 v[184:187], v[60:63], v[40:43], v[184:187]
    ds_read_b64_tr_b16 v[108:109], v8 offset:51200
    v_mfma_f32_16x16x32_bf16 v[188:191], v[60:63], v[44:47], v[188:191]
    ds_read_b64_tr_b16 v[110:111], v8 offset:51712
    v_mfma_f32_16x16x32_bf16 v[192:195], v[32:35], v[64:67], v[192:195]
    ds_read_b64_tr_b16 v[112:113], v9 offset:51200
    v_mfma_f32_16x16x32_bf16 v[196:199], v[36:39], v[64:67], v[196:199]
    ds_read_b64_tr_b16 v[114:115], v9 offset:51712
    v_mfma_f32_16x16x32_bf16 v[200:203], v[40:43], v[64:67], v[200:203]
    v_mfma_f32_16x16x32_bf16 v[204:207], v[44:47], v[64:67], v[204:207]
    v_mfma_f32_16x16x32_bf16 v[208:211], v[32:35], v[68:71], v[208:211]
    v_mfma_f32_16x16x32_bf16 v[212:215], v[36:39], v[68:71], v[212:215]
    v_mfma_f32_16x16x32_bf16 v[216:219], v[40:43], v[68:71], v[216:219]
    v_mfma_f32_16x16x32_bf16 v[220:223], v[44:47], v[68:71], v[220:223]
    s_waitcnt lgkmcnt(0)
    s_waitcnt vmcnt(6)
    s_barrier
    v_mfma_f32_16x16x32_bf16 v[128:131], v[92:95], v[76:79], v[128:131]
    ds_read_b128 v[32:35], v4 offset:0
    v_mfma_f32_16x16x32_bf16 v[132:135], v[92:95], v[80:83], v[132:135]
    s_add_u32 m0, s31, 0x22800
    s_mov_b32 s28, 0x450000
    buffer_load_dwordx4 v12, s[12:15], s28 offen lds
    v_mfma_f32_16x16x32_bf16 v[136:139], v[92:95], v[84:87], v[136:139]
    ds_read_b128 v[36:39], v4 offset:2048
    v_mfma_f32_16x16x32_bf16 v[140:143], v[92:95], v[88:91], v[140:143]
    ds_read_b128 v[40:43], v4 offset:4096
    v_mfma_f32_16x16x32_bf16 v[144:147], v[96:99], v[76:79], v[144:147]
    ds_read_b128 v[44:47], v4 offset:6144
    v_mfma_f32_16x16x32_bf16 v[148:151], v[96:99], v[80:83], v[148:151]
    s_cmp_ge_u32 s20, 4
    s_cbranch_scc1 g1qkv_sk23
    s_add_u32 m0, s31, 0x24800
    s_mov_b32 s28, 0x450000
    s_nop 0
    buffer_load_dwordx4 v13, s[12:15], s28 offen lds
g1qkv_sk23:
    v_mfma_f32_16x16x32_bf16 v[152:155], v[96:99], v[84:87], v[152:155]
    ds_read_b64_tr_b16 v[48:49], v8 offset:0
    v_mfma_f32_16x16x32_bf16 v[156:159], v[96:99], v[88:91], v[156:159]
    ds_read_b64_tr_b16 v[50:51], v8 offset:512
    v_mfma_f32_16x16x32_bf16 v[160:163], v[100:103], v[76:79], v[160:163]
    ds_read_b64_tr_b16 v[52:53], v9 offset:0
    v_mfma_f32_16x16x32_bf16 v[164:167], v[100:103], v[80:83], v[164:167]
    s_add_u32 m0, s30, 0x0
    s_mov_b32 s28, 0x600
    buffer_load_dwordx4 v11, s[8:11], s28 offen lds
    v_mfma_f32_16x16x32_bf16 v[168:171], v[100:103], v[84:87], v[168:171]
    ds_read_b64_tr_b16 v[54:55], v9 offset:512
    v_mfma_f32_16x16x32_bf16 v[172:175], v[100:103], v[88:91], v[172:175]
    ds_read_b64_tr_b16 v[56:57], v8 offset:4096
    v_mfma_f32_16x16x32_bf16 v[176:179], v[104:107], v[76:79], v[176:179]
    ds_read_b64_tr_b16 v[58:59], v8 offset:4608
    v_mfma_f32_16x16x32_bf16 v[180:183], v[104:107], v[80:83], v[180:183]
    s_add_u32 m0, s30, 0x400
    s_mov_b32 s28, 0x4600
    buffer_load_dwordx4 v11, s[8:11], s28 offen lds
    v_mfma_f32_16x16x32_bf16 v[184:187], v[104:107], v[84:87], v[184:187]
    ds_read_b64_tr_b16 v[60:61], v9 offset:4096
    v_mfma_f32_16x16x32_bf16 v[188:191], v[104:107], v[88:91], v[188:191]
    ds_read_b64_tr_b16 v[62:63], v9 offset:4608
    v_mfma_f32_16x16x32_bf16 v[192:195], v[76:79], v[108:111], v[192:195]
    ds_read_b64_tr_b16 v[64:65], v8 offset:8192
    v_mfma_f32_16x16x32_bf16 v[196:199], v[80:83], v[108:111], v[196:199]
    s_add_u32 m0, s30, 0x800
    s_mov_b32 s28, 0x8600
    buffer_load_dwordx4 v11, s[8:11], s28 offen lds
    v_mfma_f32_16x16x32_bf16 v[200:203], v[84:87], v[108:111], v[200:203]
    ds_read_b64_tr_b16 v[66:67], v8 offset:8704
    v_mfma_f32_16x16x32_bf16 v[204:207], v[88:91], v[108:111], v[204:207]
    ds_read_b64_tr_b16 v[68:69], v9 offset:8192
    v_mfma_f32_16x16x32_bf16 v[208:211], v[76:79], v[112:115], v[208:211]
    ds_read_b64_tr_b16 v[70:71], v9 offset:8704
    v_mfma_f32_16x16x32_bf16 v[212:215], v[80:83], v[112:115], v[212:215]
    s_add_u32 m0, s30, 0xc00
    s_mov_b32 s28, 0xc600
    buffer_load_dwordx4 v11, s[8:11], s28 offen lds
    v_mfma_f32_16x16x32_bf16 v[216:219], v[84:87], v[112:115], v[216:219]
    s_add_u32 m0, s77, 0x26000
    s_mov_b32 s28, 0x500000
    buffer_load_dwordx4 v30, s[88:91], s28 offen lds
    v_mfma_f32_16x16x32_bf16 v[220:223], v[88:91], v[112:115], v[220:223]
    s_waitcnt lgkmcnt(0)
    s_waitcnt vmcnt(10)
    s_barrier
    v_mfma_f32_16x16x32_bf16 v[128:131], v[48:51], v[32:35], v[128:131]
    ds_read_b128 v[76:79], v5 offset:0
    v_mfma_f32_16x16x32_bf16 v[132:135], v[48:51], v[36:39], v[132:135]
    s_add_u32 m0, s31, 0x18000
    s_mov_b32 s28, 0x480000
    buffer_load_dwordx4 v12, s[12:15], s28 offen lds
    v_mfma_f32_16x16x32_bf16 v[136:139], v[48:51], v[40:43], v[136:139]
    ds_read_b128 v[80:83], v5 offset:2048
    v_mfma_f32_16x16x32_bf16 v[140:143], v[48:51], v[44:47], v[140:143]
    ds_read_b128 v[84:87], v5 offset:4096
    v_mfma_f32_16x16x32_bf16 v[144:147], v[52:55], v[32:35], v[144:147]
    ds_read_b128 v[88:91], v5 offset:6144
    v_mfma_f32_16x16x32_bf16 v[148:151], v[52:55], v[36:39], v[148:151]
    s_cmp_ge_u32 s20, 4
    s_cbranch_scc1 g1qkv_sk24
    s_add_u32 m0, s31, 0x1a000
    s_mov_b32 s28, 0x480000
    s_nop 0
    buffer_load_dwordx4 v13, s[12:15], s28 offen lds
g1qkv_sk24:
    v_mfma_f32_16x16x32_bf16 v[152:155], v[52:55], v[40:43], v[152:155]
    ds_read_b64_tr_b16 v[92:93], v8 offset:14336
    v_mfma_f32_16x16x32_bf16 v[156:159], v[52:55], v[44:47], v[156:159]
    ds_read_b64_tr_b16 v[94:95], v8 offset:14848
    v_mfma_f32_16x16x32_bf16 v[160:163], v[56:59], v[32:35], v[160:163]
    ds_read_b64_tr_b16 v[96:97], v9 offset:14336
    v_mfma_f32_16x16x32_bf16 v[164:167], v[56:59], v[36:39], v[164:167]
    ds_read_b64_tr_b16 v[98:99], v9 offset:14848
    v_mfma_f32_16x16x32_bf16 v[168:171], v[56:59], v[40:43], v[168:171]
    ds_read_b64_tr_b16 v[100:101], v8 offset:18432
    v_mfma_f32_16x16x32_bf16 v[172:175], v[56:59], v[44:47], v[172:175]
    ds_read_b64_tr_b16 v[102:103], v8 offset:18944
    v_mfma_f32_16x16x32_bf16 v[176:179], v[60:63], v[32:35], v[176:179]
    ds_read_b64_tr_b16 v[104:105], v9 offset:18432
    v_mfma_f32_16x16x32_bf16 v[180:183], v[60:63], v[36:39], v[180:183]
    ds_read_b64_tr_b16 v[106:107], v9 offset:18944
    v_mfma_f32_16x16x32_bf16 v[184:187], v[60:63], v[40:43], v[184:187]
    ds_read_b64_tr_b16 v[108:109], v8 offset:22528
    v_mfma_f32_16x16x32_bf16 v[188:191], v[60:63], v[44:47], v[188:191]
    ds_read_b64_tr_b16 v[110:111], v8 offset:23040
    v_mfma_f32_16x16x32_bf16 v[192:195], v[32:35], v[64:67], v[192:195]
    ds_read_b64_tr_b16 v[112:113], v9 offset:22528
    v_mfma_f32_16x16x32_bf16 v[196:199], v[36:39], v[64:67], v[196:199]
    ds_read_b64_tr_b16 v[114:115], v9 offset:23040
    v_mfma_f32_16x16x32_bf16 v[200:203], v[40:43], v[64:67], v[200:203]
    v_mfma_f32_16x16x32_bf16 v[204:207], v[44:47], v[64:67], v[204:207]
    v_mfma_f32_16x16x32_bf16 v[208:211], v[32:35], v[68:71], v[208:211]
    v_mfma_f32_16x16x32_bf16 v[212:215], v[36:39], v[68:71], v[212:215]
    v_mfma_f32_16x16x32_bf16 v[216:219], v[40:43], v[68:71], v[216:219]
    v_mfma_f32_16x16x32_bf16 v[220:223], v[44:47], v[68:71], v[220:223]
    s_waitcnt lgkmcnt(0)
    s_waitcnt vmcnt(6)
    s_barrier
    v_mfma_f32_16x16x32_bf16 v[128:131], v[92:95], v[76:79], v[128:131]
    ds_read_b128 v[32:35], v6 offset:0
    v_mfma_f32_16x16x32_bf16 v[132:135], v[92:95], v[80:83], v[132:135]
    s_add_u32 m0, s31, 0x1b800
    s_mov_b32 s28, 0x4b0000
    buffer_load_dwordx4 v12, s[12:15], s28 offen lds
    v_mfma_f32_16x16x32_bf16 v[136:139], v[92:95], v[84:87], v[136:139]
    ds_read_b128 v[36:39], v6 offset:2048
    v_mfma_f32_16x16x32_bf16 v[140:143], v[92:95], v[88:91], v[140:143]
    ds_read_b128 v[40:43], v6 offset:4096
    v_mfma_f32_16x16x32_bf16 v[144:147], v[96:99], v[76:79], v[144:147]
    ds_read_b128 v[44:47], v6 offset:6144
    v_mfma_f32_16x16x32_bf16 v[148:151], v[96:99], v[80:83], v[148:151]
    s_cmp_ge_u32 s20, 4
    s_cbranch_scc1 g1qkv_sk25
    s_add_u32 m0, s31, 0x1d800
    s_mov_b32 s28, 0x4b0000
    s_nop 0
    buffer_load_dwordx4 v13, s[12:15], s28 offen lds
g1qkv_sk25:
    v_mfma_f32_16x16x32_bf16 v[152:155], v[96:99], v[84:87], v[152:155]
    ds_read_b64_tr_b16 v[48:49], v8 offset:28672
    v_mfma_f32_16x16x32_bf16 v[156:159], v[96:99], v[88:91], v[156:159]
    ds_read_b64_tr_b16 v[50:51], v8 offset:29184
    v_mfma_f32_16x16x32_bf16 v[160:163], v[100:103], v[76:79], v[160:163]
    ds_read_b64_tr_b16 v[52:53], v9 offset:28672
    v_mfma_f32_16x16x32_bf16 v[164:167], v[100:103], v[80:83], v[164:167]
    s_add_u32 m0, s30, 0x8000
    s_mov_b32 s28, 0x680
    buffer_load_dwordx4 v11, s[8:11], s28 offen lds
    v_mfma_f32_16x16x32_bf16 v[168:171], v[100:103], v[84:87], v[168:171]
    ds_read_b64_tr_b16 v[54:55], v9 offset:29184
    v_mfma_f32_16x16x32_bf16 v[172:175], v[100:103], v[88:91], v[172:175]
    ds_read_b64_tr_b16 v[56:57], v8 offset:32768
    v_mfma_f32_16x16x32_bf16 v[176:179], v[104:107], v[76:79], v[176:179]
    ds_read_b64_tr_b16 v[58:59], v8 offset:33280
    v_mfma_f32_16x16x32_bf16 v[180:183], v[104:107], v[80:83], v[180:183]
    s_add_u32 m0, s30, 0x8400
    s_mov_b32 s28, 0x4680
    buffer_load_dwordx4 v11, s[8:11], s28 offen lds
    v_mfma_f32_16x16x32_bf16 v[184:187], v[104:107], v[84:87], v[184:187]
    ds_read_b64_tr_b16 v[60:61], v9 offset:32768
    v_mfma_f32_16x16x32_bf16 v[188:191], v[104:107], v[88:91], v[188:191]
    ds_read_b64_tr_b16 v[62:63], v9 offset:33280
    v_mfma_f32_16x16x32_bf16 v[192:195], v[76:79], v[108:111], v[192:195]
    ds_read_b64_tr_b16 v[64:65], v8 offset:36864
    v_mfma_f32_16x16x32_bf16 v[196:199], v[80:83], v[108:111], v[196:199]
    s_add_u32 m0, s30, 0x8800
    s_mov_b32 s28, 0x8680
    buffer_load_dwordx4 v11, s[8:11], s28 offen lds
    v_mfma_f32_16x16x32_bf16 v[200:203], v[84:87], v[108:111], v[200:203]
    ds_read_b64_tr_b16 v[66:67], v8 offset:37376
    v_mfma_f32_16x16x32_bf16 v[204:207], v[88:91], v[108:111], v[204:207]
    ds_read_b64_tr_b16 v[68:69], v9 offset:36864
    v_mfma_f32_16x16x32_bf16 v[208:211], v[76:79], v[112:115], v[208:211]
    ds_read_b64_tr_b16 v[70:71], v9 offset:37376
    v_mfma_f32_16x16x32_bf16 v[212:215], v[80:83], v[112:115], v[212:215]
    s_add_u32 m0, s30, 0x8c00
    s_mov_b32 s28, 0xc680
    buffer_load_dwordx4 v11, s[8:11], s28 offen lds
    v_mfma_f32_16x16x32_bf16 v[216:219], v[84:87], v[112:115], v[216:219]
    v_mfma_f32_16x16x32_bf16 v[220:223], v[88:91], v[112:115], v[220:223]
    s_waitcnt lgkmcnt(0)
    s_waitcnt vmcnt(10)
    s_barrier
    v_mfma_f32_16x16x32_bf16 v[128:131], v[48:51], v[32:35], v[128:131]
    ds_read_b128 v[76:79], v7 offset:0
    v_mfma_f32_16x16x32_bf16 v[132:135], v[48:51], v[36:39], v[132:135]
    s_add_u32 m0, s31, 0x1f000
    s_mov_b32 s28, 0x4e0000
    buffer_load_dwordx4 v12, s[12:15], s28 offen lds
    v_mfma_f32_16x16x32_bf16 v[136:139], v[48:51], v[40:43], v[136:139]
    ds_read_b128 v[80:83], v7 offset:2048
    v_mfma_f32_16x16x32_bf16 v[140:143], v[48:51], v[44:47], v[140:143]
    ds_read_b128 v[84:87], v7 offset:4096
    v_mfma_f32_16x16x32_bf16 v[144:147], v[52:55], v[32:35], v[144:147]
    ds_read_b128 v[88:91], v7 offset:6144
    v_mfma_f32_16x16x32_bf16 v[148:151], v[52:55], v[36:39], v[148:151]
    s_cmp_ge_u32 s20, 4
    s_cbranch_scc1 g1qkv_sk26
    s_add_u32 m0, s31, 0x21000
    s_mov_b32 s28, 0x4e0000
    s_nop 0
    buffer_load_dwordx4 v13, s[12:15], s28 offen lds
g1qkv_sk26:
    v_mfma_f32_16x16x32_bf16 v[152:155], v[52:55], v[40:43], v[152:155]
    ds_read_b64_tr_b16 v[92:93], v8 offset:43008
    v_mfma_f32_16x16x32_bf16 v[156:159], v[52:55], v[44:47], v[156:159]
    ds_read_b64_tr_b16 v[94:95], v8 offset:43520
    v_mfma_f32_16x16x32_bf16 v[160:163], v[56:59], v[32:35], v[160:163]
    ds_read_b64_tr_b16 v[96:97], v9 offset:43008
    v_mfma_f32_16x16x32_bf16 v[164:167], v[56:59], v[36:39], v[164:167]
    ds_read_b64_tr_b16 v[98:99], v9 offset:43520
    v_mfma_f32_16x16x32_bf16 v[168:171], v[56:59], v[40:43], v[168:171]
    ds_read_b64_tr_b16 v[100:101], v8 offset:47104
    v_mfma_f32_16x16x32_bf16 v[172:175], v[56:59], v[44:47], v[172:175]
    ds_read_b64_tr_b16 v[102:103], v8 offset:47616
    v_mfma_f32_16x16x32_bf16 v[176:179], v[60:63], v[32:35], v[176:179]
    ds_read_b64_tr_b16 v[104:105], v9 offset:47104
    v_mfma_f32_16x16x32_bf16 v[180:183], v[60:63], v[36:39], v[180:183]
    ds_read_b64_tr_b16 v[106:107], v9 offset:47616
    v_mfma_f32_16x16x32_bf16 v[184:187], v[60:63], v[40:43], v[184:187]
    ds_read_b64_tr_b16 v[108:109], v8 offset:51200
    v_mfma_f32_16x16x32_bf16 v[188:191], v[60:63], v[44:47], v[188:191]
    ds_read_b64_tr_b16 v[110:111], v8 offset:51712
    v_mfma_f32_16x16x32_bf16 v[192:195], v[32:35], v[64:67], v[192:195]
    ds_read_b64_tr_b16 v[112:113], v9 offset:51200
    v_mfma_f32_16x16x32_bf16 v[196:199], v[36:39], v[64:67], v[196:199]
    ds_read_b64_tr_b16 v[114:115], v9 offset:51712
    v_mfma_f32_16x16x32_bf16 v[200:203], v[40:43], v[64:67], v[200:203]
    v_mfma_f32_16x16x32_bf16 v[204:207], v[44:47], v[64:67], v[204:207]
    v_mfma_f32_16x16x32_bf16 v[208:211], v[32:35], v[68:71], v[208:211]
    v_mfma_f32_16x16x32_bf16 v[212:215], v[36:39], v[68:71], v[212:215]
    v_mfma_f32_16x16x32_bf16 v[216:219], v[40:43], v[68:71], v[216:219]
    v_mfma_f32_16x16x32_bf16 v[220:223], v[44:47], v[68:71], v[220:223]
    s_waitcnt lgkmcnt(0)
    s_waitcnt vmcnt(6)
    s_barrier
    v_mfma_f32_16x16x32_bf16 v[128:131], v[92:95], v[76:79], v[128:131]
    ds_read_b128 v[32:35], v2 offset:0
    v_mfma_f32_16x16x32_bf16 v[132:135], v[92:95], v[80:83], v[132:135]
    s_add_u32 m0, s31, 0x22800
    s_mov_b32 s28, 0x510000
    buffer_load_dwordx4 v12, s[12:15], s28 offen lds
    v_mfma_f32_16x16x32_bf16 v[136:139], v[92:95], v[84:87], v[136:139]
    ds_read_b128 v[36:39], v2 offset:2048
    v_mfma_f32_16x16x32_bf16 v[140:143], v[92:95], v[88:91], v[140:143]
    ds_read_b128 v[40:43], v2 offset:4096
    v_mfma_f32_16x16x32_bf16 v[144:147], v[96:99], v[76:79], v[144:147]
    ds_read_b128 v[44:47], v2 offset:6144
    v_mfma_f32_16x16x32_bf16 v[148:151], v[96:99], v[80:83], v[148:151]
    s_cmp_ge_u32 s20, 4
    s_cbranch_scc1 g1qkv_sk27
    s_add_u32 m0, s31, 0x24800
    s_mov_b32 s28, 0x510000
    s_nop 0
    buffer_load_dwordx4 v13, s[12:15], s28 offen lds
g1qkv_sk27:
    v_mfma_f32_16x16x32_bf16 v[152:155], v[96:99], v[84:87], v[152:155]
    ds_read_b64_tr_b16 v[48:49], v8 offset:0
    v_mfma_f32_16x16x32_bf16 v[156:159], v[96:99], v[88:91], v[156:159]
    ds_read_b64_tr_b16 v[50:51], v8 offset:512
    v_mfma_f32_16x16x32_bf16 v[160:163], v[100:103], v[76:79], v[160:163]
    ds_read_b64_tr_b16 v[52:53], v9 offset:0
    v_mfma_f32_16x16x32_bf16 v[164:167], v[100:103], v[80:83], v[164:167]
    s_add_u32 m0, s30, 0x10000
    s_mov_b32 s28, 0x700
    buffer_load_dwordx4 v11, s[8:11], s28 offen lds
    v_mfma_f32_16x16x32_bf16 v[168:171], v[100:103], v[84:87], v[168:171]
    ds_read_b64_tr_b16 v[54:55], v9 offset:512
    v_mfma_f32_16x16x32_bf16 v[172:175], v[100:103], v[88:91], v[172:175]
    ds_read_b64_tr_b16 v[56:57], v8 offset:4096
    v_mfma_f32_16x16x32_bf16 v[176:179], v[104:107], v[76:79], v[176:179]
    ds_read_b64_tr_b16 v[58:59], v8 offset:4608
    v_mfma_f32_16x16x32_bf16 v[180:183], v[104:107], v[80:83], v[180:183]
    s_add_u32 m0, s30, 0x10400
    s_mov_b32 s28, 0x4700
    buffer_load_dwordx4 v11, s[8:11], s28 offen lds
    v_mfma_f32_16x16x32_bf16 v[184:187], v[104:107], v[84:87], v[184:187]
    ds_read_b64_tr_b16 v[60:61], v9 offset:4096
    v_mfma_f32_16x16x32_bf16 v[188:191], v[104:107], v[88:91], v[188:191]
    ds_read_b64_tr_b16 v[62:63], v9 offset:4608
    v_mfma_f32_16x16x32_bf16 v[192:195], v[76:79], v[108:111], v[192:195]
    ds_read_b64_tr_b16 v[64:65], v8 offset:8192
    v_mfma_f32_16x16x32_bf16 v[196:199], v[80:83], v[108:111], v[196:199]
    s_add_u32 m0, s30, 0x10800
    s_mov_b32 s28, 0x8700
    buffer_load_dwordx4 v11, s[8:11], s28 offen lds
    v_mfma_f32_16x16x32_bf16 v[200:203], v[84:87], v[108:111], v[200:203]
    ds_read_b64_tr_b16 v[66:67], v8 offset:8704
    v_mfma_f32_16x16x32_bf16 v[204:207], v[88:91], v[108:111], v[204:207]
    ds_read_b64_tr_b16 v[68:69], v9 offset:8192
    v_mfma_f32_16x16x32_bf16 v[208:211], v[76:79], v[112:115], v[208:211]
    ds_read_b64_tr_b16 v[70:71], v9 offset:8704
    v_mfma_f32_16x16x32_bf16 v[212:215], v[80:83], v[112:115], v[212:215]
    s_add_u32 m0, s30, 0x10c00
    s_mov_b32 s28, 0xc700
    buffer_load_dwordx4 v11, s[8:11], s28 offen lds
    v_mfma_f32_16x16x32_bf16 v[216:219], v[84:87], v[112:115], v[216:219]
    v_mfma_f32_16x16x32_bf16 v[220:223], v[88:91], v[112:115], v[220:223]
    s_waitcnt lgkmcnt(0)
    s_waitcnt vmcnt(10)
    s_barrier
    v_mfma_f32_16x16x32_bf16 v[128:131], v[48:51], v[32:35], v[128:131]
    ds_read_b128 v[76:79], v3 offset:0
    v_mfma_f32_16x16x32_bf16 v[132:135], v[48:51], v[36:39], v[132:135]
    s_add_u32 m0, s31, 0x18000
    s_mov_b32 s28, 0x540000
    buffer_load_dwordx4 v12, s[12:15], s28 offen lds
    v_mfma_f32_16x16x32_bf16 v[136:139], v[48:51], v[40:43], v[136:139]
    ds_read_b128 v[80:83], v3 offset:2048
    v_mfma_f32_16x16x32_bf16 v[140:143], v[48:51], v[44:47], v[140:143]
    ds_read_b128 v[84:87], v3 offset:4096
    v_mfma_f32_16x16x32_bf16 v[144:147], v[52:55], v[32:35], v[144:147]
    ds_read_b128 v[88:91], v3 offset:6144
    v_mfma_f32_16x16x32_bf16 v[148:151], v[52:55], v[36:39], v[148:151]
    s_cmp_ge_u32 s20, 4
    s_cbranch_scc1 g1qkv_sk28
    s_add_u32 m0, s31, 0x1a000
    s_mov_b32 s28, 0x540000
    s_nop 0
    buffer_load_dwordx4 v13, s[12:15], s28 offen lds
g1qkv_sk28:
    v_mfma_f32_16x16x32_bf16 v[152:155], v[52:55], v[40:43], v[152:155]
    ds_read_b64_tr_b16 v[92:93], v8 offset:14336
    v_mfma_f32_16x16x32_bf16 v[156:159], v[52:55], v[44:47], v[156:159]
    ds_read_b64_tr_b16 v[94:95], v8 offset:14848
    v_mfma_f32_16x16x32_bf16 v[160:163], v[56:59], v[32:35], v[160:163]
    ds_read_b64_tr_b16 v[96:97], v9 offset:14336
    v_mfma_f32_16x16x32_bf16 v[164:167], v[56:59], v[36:39], v[164:167]
    ds_read_b64_tr_b16 v[98:99], v9 offset:14848
    v_mfma_f32_16x16x32_bf16 v[168:171], v[56:59], v[40:43], v[168:171]
    ds_read_b64_tr_b16 v[100:101], v8 offset:18432
    v_mfma_f32_16x16x32_bf16 v[172:175], v[56:59], v[44:47], v[172:175]
    ds_read_b64_tr_b16 v[102:103], v8 offset:18944
    v_mfma_f32_16x16x32_bf16 v[176:179], v[60:63], v[32:35], v[176:179]
    ds_read_b64_tr_b16 v[104:105], v9 offset:18432
    v_mfma_f32_16x16x32_bf16 v[180:183], v[60:63], v[36:39], v[180:183]
    ds_read_b64_tr_b16 v[106:107], v9 offset:18944
    v_mfma_f32_16x16x32_bf16 v[184:187], v[60:63], v[40:43], v[184:187]
    ds_read_b64_tr_b16 v[108:109], v8 offset:22528
    v_mfma_f32_16x16x32_bf16 v[188:191], v[60:63], v[44:47], v[188:191]
    ds_read_b64_tr_b16 v[110:111], v8 offset:23040
    v_mfma_f32_16x16x32_bf16 v[192:195], v[32:35], v[64:67], v[192:195]
    ds_read_b64_tr_b16 v[112:113], v9 offset:22528
    v_mfma_f32_16x16x32_bf16 v[196:199], v[36:39], v[64:67], v[196:199]
    ds_read_b64_tr_b16 v[114:115], v9 offset:23040
    v_mfma_f32_16x16x32_bf16 v[200:203], v[40:43], v[64:67], v[200:203]
    v_mfma_f32_16x16x32_bf16 v[204:207], v[44:47], v[64:67], v[204:207]
    v_mfma_f32_16x16x32_bf16 v[208:211], v[32:35], v[68:71], v[208:211]
    v_mfma_f32_16x16x32_bf16 v[212:215], v[36:39], v[68:71], v[212:215]
    v_mfma_f32_16x16x32_bf16 v[216:219], v[40:43], v[68:71], v[216:219]
    v_mfma_f32_16x16x32_bf16 v[220:223], v[44:47], v[68:71], v[220:223]
    s_waitcnt lgkmcnt(0)
    s_waitcnt vmcnt(6)
    s_barrier
    v_mfma_f32_16x16x32_bf16 v[128:131], v[92:95], v[76:79], v[128:131]
    ds_read_b128 v[32:35], v4 offset:0
    v_mfma_f32_16x16x32_bf16 v[132:135], v[92:95], v[80:83], v[132:135]
    s_add_u32 m0, s31, 0x1b800
    s_mov_b32 s28, 0x570000
    buffer_load_dwordx4 v12, s[12:15], s28 offen lds
    v_mfma_f32_16x16x32_bf16 v[136:139], v[92:95], v[84:87], v[136:139]
    ds_read_b128 v[36:39], v4 offset:2048
    v_mfma_f32_16x16x32_bf16 v[140:143], v[92:95], v[88:91], v[140:143]
    ds_read_b128 v[40:43], v4 offset:4096
    v_mfma_f32_16x16x32_bf16 v[144:147], v[96:99], v[76:79], v[144:147]
    ds_read_b128 v[44:47], v4 offset:6144
    v_mfma_f32_16x16x32_bf16 v[148:151], v[96:99], v[80:83], v[148:151]
    s_cmp_ge_u32 s20, 4
    s_cbranch_scc1 g1qkv_sk29
    s_add_u32 m0, s31, 0x1d800
    s_mov_b32 s28, 0x570000
    s_nop 0
    buffer_load_dwordx4 v13, s[12:15], s28 offen lds
g1qkv_sk29:
    v_mfma_f32_16x16x32_bf16 v[152:155], v[96:99], v[84:87], v[152:155]
    ds_read_b64_tr_b16 v[48:49], v8 offset:28672
    v_mfma_f32_16x16x32_bf16 v[156:159], v[96:99], v[88:91], v[156:159]
    ds_read_b64_tr_b16 v[50:51], v8 offset:29184
    v_mfma_f32_16x16x32_bf16 v[160:163], v[100:103], v[76:79], v[160:163]
    ds_read_b64_tr_b16 v[52:53], v9 offset:28672
    v_mfma_f32_16x16x32_bf16 v[164:167], v[100:103], v[80:83], v[164:167]
    s_add_u32 m0, s30, 0x0
    s_mov_b32 s28, 0x780
    buffer_load_dwordx4 v11, s[8:11], s28 offen lds
    v_mfma_f32_16x16x32_bf16 v[168:171], v[100:103], v[84:87], v[168:171]
    ds_read_b64_tr_b16 v[54:55], v9 offset:29184
    v_mfma_f32_16x16x32_bf16 v[172:175], v[100:103], v[88:91], v[172:175]
    ds_read_b64_tr_b16 v[56:57], v8 offset:32768
    v_mfma_f32_16x16x32_bf16 v[176:179], v[104:107], v[76:79], v[176:179]
    ds_read_b64_tr_b16 v[58:59], v8 offset:33280
    v_mfma_f32_16x16x32_bf16 v[180:183], v[104:107], v[80:83], v[180:183]
    s_add_u32 m0, s30, 0x400
    s_mov_b32 s28, 0x4780
    buffer_load_dwordx4 v11, s[8:11], s28 offen lds
    v_mfma_f32_16x16x32_bf16 v[184:187], v[104:107], v[84:87], v[184:187]
    ds_read_b64_tr_b16 v[60:61], v9 offset:32768
    v_mfma_f32_16x16x32_bf16 v[188:191], v[104:107], v[88:91], v[188:191]
    ds_read_b64_tr_b16 v[62:63], v9 offset:33280
    v_mfma_f32_16x16x32_bf16 v[192:195], v[76:79], v[108:111], v[192:195]
    ds_read_b64_tr_b16 v[64:65], v8 offset:36864
    v_mfma_f32_16x16x32_bf16 v[196:199], v[80:83], v[108:111], v[196:199]
    s_add_u32 m0, s30, 0x800
    s_mov_b32 s28, 0x8780
    buffer_load_dwordx4 v11, s[8:11], s28 offen lds
    v_mfma_f32_16x16x32_bf16 v[200:203], v[84:87], v[108:111], v[200:203]
    ds_read_b64_tr_b16 v[66:67], v8 offset:37376
    v_mfma_f32_16x16x32_bf16 v[204:207], v[88:91], v[108:111], v[204:207]
    ds_read_b64_tr_b16 v[68:69], v9 offset:36864
    v_mfma_f32_16x16x32_bf16 v[208:211], v[76:79], v[112:115], v[208:211]
    ds_read_b64_tr_b16 v[70:71], v9 offset:37376
    v_mfma_f32_16x16x32_bf16 v[212:215], v[80:83], v[112:115], v[212:215]
    s_add_u32 m0, s30, 0xc00
    s_mov_b32 s28, 0xc780
    buffer_load_dwordx4 v11, s[8:11], s28 offen lds
    v_mfma_f32_16x16x32_bf16 v[216:219], v[84:87], v[112:115], v[216:219]
    v_mfma_f32_16x16x32_bf16 v[220:223], v[88:91], v[112:115], v[220:223]
    s_waitcnt lgkmcnt(0)
    s_waitcnt vmcnt(10)
    s_barrier
    v_mfma_f32_16x16x32_bf16 v[128:131], v[48:51], v[32:35], v[128:131]
    ds_read_b128 v[76:79], v5 offset:0
    v_mfma_f32_16x16x32_bf16 v[132:135], v[48:51], v[36:39], v[132:135]
    s_add_u32 m0, s31, 0x1f000
    s_mov_b32 s28, 0x5a0000
    buffer_load_dwordx4 v12, s[12:15], s28 offen lds
    v_mfma_f32_16x16x32_bf16 v[136:139], v[48:51], v[40:43], v[136:139]
    ds_read_b128 v[80:83], v5 offset:2048
    v_mfma_f32_16x16x32_bf16 v[140:143], v[48:51], v[44:47], v[140:143]
    ds_read_b128 v[84:87], v5 offset:4096
    v_mfma_f32_16x16x32_bf16 v[144:147], v[52:55], v[32:35], v[144:147]
    ds_read_b128 v[88:91], v5 offset:6144
    v_mfma_f32_16x16x32_bf16 v[148:151], v[52:55], v[36:39], v[148:151]
    s_cmp_ge_u32 s20, 4
    s_cbranch_scc1 g1qkv_sk30
    s_add_u32 m0, s31, 0x21000
    s_mov_b32 s28, 0x5a0000
    s_nop 0
    buffer_load_dwordx4 v13, s[12:15], s28 offen lds
g1qkv_sk30:
    v_mfma_f32_16x16x32_bf16 v[152:155], v[52:55], v[40:43], v[152:155]
    ds_read_b64_tr_b16 v[92:93], v8 offset:43008
    v_mfma_f32_16x16x32_bf16 v[156:159], v[52:55], v[44:47], v[156:159]
    ds_read_b64_tr_b16 v[94:95], v8 offset:43520
    v_mfma_f32_16x16x32_bf16 v[160:163], v[56:59], v[32:35], v[160:163]
    ds_read_b64_tr_b16 v[96:97], v9 offset:43008
    v_mfma_f32_16x16x32_bf16 v[164:167], v[56:59], v[36:39], v[164:167]
    ds_read_b64_tr_b16 v[98:99], v9 offset:43520
    v_mfma_f32_16x16x32_bf16 v[168:171], v[56:59], v[40:43], v[168:171]
    ds_read_b64_tr_b16 v[100:101], v8 offset:47104
    v_mfma_f32_16x16x32_bf16 v[172:175], v[56:59], v[44:47], v[172:175]
    ds_read_b64_tr_b16 v[102:103], v8 offset:47616
    v_mfma_f32_16x16x32_bf16 v[176:179], v[60:63], v[32:35], v[176:179]
    ds_read_b64_tr_b16 v[104:105], v9 offset:47104
    v_mfma_f32_16x16x32_bf16 v[180:183], v[60:63], v[36:39], v[180:183]
    ds_read_b64_tr_b16 v[106:107], v9 offset:47616
    v_mfma_f32_16x16x32_bf16 v[184:187], v[60:63], v[40:43], v[184:187]
    ds_read_b64_tr_b16 v[108:109], v8 offset:51200
    v_mfma_f32_16x16x32_bf16 v[188:191], v[60:63], v[44:47], v[188:191]
    ds_read_b64_tr_b16 v[110:111], v8 offset:51712
    v_mfma_f32_16x16x32_bf16 v[192:195], v[32:35], v[64:67], v[192:195]
    ds_read_b64_tr_b16 v[112:113], v9 offset:51200
    v_mfma_f32_16x16x32_bf16 v[196:199], v[36:39], v[64:67], v[196:199]
    ds_read_b64_tr_b16 v[114:115], v9 offset:51712
    v_mfma_f32_16x16x32_bf16 v[200:203], v[40:43], v[64:67], v[200:203]
    v_mfma_f32_16x16x32_bf16 v[204:207], v[44:47], v[64:67], v[204:207]
    v_mfma_f32_16x16x32_bf16 v[208:211], v[32:35], v[68:71], v[208:211]
    v_mfma_f32_16x16x32_bf16 v[212:215], v[36:39], v[68:71], v[212:215]
    v_mfma_f32_16x16x32_bf16 v[216:219], v[40:43], v[68:71], v[216:219]
    v_mfma_f32_16x16x32_bf16 v[220:223], v[44:47], v[68:71], v[220:223]
    s_waitcnt lgkmcnt(0)
    s_waitcnt vmcnt(6)
    s_barrier
    v_mfma_f32_16x16x32_bf16 v[128:131], v[92:95], v[76:79], v[128:131]
    ds_read_b128 v[32:35], v6 offset:0
    v_mfma_f32_16x16x32_bf16 v[132:135], v[92:95], v[80:83], v[132:135]
    s_add_u32 m0, s31, 0x22800
    s_mov_b32 s28, 0x5d0000
    buffer_load_dwordx4 v12, s[12:15], s28 offen lds
    v_mfma_f32_16x16x32_bf16 v[136:139], v[92:95], v[84:87], v[136:139]
    ds_read_b128 v[36:39], v6 offset:2048
    v_mfma_f32_16x16x32_bf16 v[140:143], v[92:95], v[88:91], v[140:143]
    ds_read_b128 v[40:43], v6 offset:4096
    v_mfma_f32_16x16x32_bf16 v[144:147], v[96:99], v[76:79], v[144:147]
    ds_read_b128 v[44:47], v6 offset:6144
    v_mfma_f32_16x16x32_bf16 v[148:151], v[96:99], v[80:83], v[148:151]
    s_cmp_ge_u32 s20, 4
    s_cbranch_scc1 g1qkv_sk31
    s_add_u32 m0, s31, 0x24800
    s_mov_b32 s28, 0x5d0000
    s_nop 0
    buffer_load_dwordx4 v13, s[12:15], s28 offen lds
g1qkv_sk31:
    v_mfma_f32_16x16x32_bf16 v[152:155], v[96:99], v[84:87], v[152:155]
    ds_read_b64_tr_b16 v[48:49], v8 offset:0
    v_mfma_f32_16x16x32_bf16 v[156:159], v[96:99], v[88:91], v[156:159]
    ds_read_b64_tr_b16 v[50:51], v8 offset:512
    v_mfma_f32_16x16x32_bf16 v[160:163], v[100:103], v[76:79], v[160:163]
    ds_read_b64_tr_b16 v[52:53], v9 offset:0
    v_mfma_f32_16x16x32_bf16 v[164:167], v[100:103], v[80:83], v[164:167]
    ds_read_b64_tr_b16 v[54:55], v9 offset:512
    v_mfma_f32_16x16x32_bf16 v[168:171], v[100:103], v[84:87], v[168:171]
    ds_read_b64_tr_b16 v[56:57], v8 offset:4096
    v_mfma_f32_16x16x32_bf16 v[172:175], v[100:103], v[88:91], v[172:175]
    ds_read_b64_tr_b16 v[58:59], v8 offset:4608
    v_mfma_f32_16x16x32_bf16 v[176:179], v[104:107], v[76:79], v[176:179]
    ds_read_b64_tr_b16 v[60:61], v9 offset:4096
    v_mfma_f32_16x16x32_bf16 v[180:183], v[104:107], v[80:83], v[180:183]
    ds_read_b64_tr_b16 v[62:63], v9 offset:4608
    v_mfma_f32_16x16x32_bf16 v[184:187], v[104:107], v[84:87], v[184:187]
    ds_read_b64_tr_b16 v[64:65], v8 offset:8192
    v_mfma_f32_16x16x32_bf16 v[188:191], v[104:107], v[88:91], v[188:191]
    ds_read_b64_tr_b16 v[66:67], v8 offset:8704
    v_mfma_f32_16x16x32_bf16 v[192:195], v[76:79], v[108:111], v[192:195]
    ds_read_b64_tr_b16 v[68:69], v9 offset:8192
    v_mfma_f32_16x16x32_bf16 v[196:199], v[80:83], v[108:111], v[196:199]
    ds_read_b64_tr_b16 v[70:71], v9 offset:8704
    v_mfma_f32_16x16x32_bf16 v[200:203], v[84:87], v[108:111], v[200:203]
    v_mfma_f32_16x16x32_bf16 v[204:207], v[88:91], v[108:111], v[204:207]
    v_mfma_f32_16x16x32_bf16 v[208:211], v[76:79], v[112:115], v[208:211]
    v_mfma_f32_16x16x32_bf16 v[212:215], v[80:83], v[112:115], v[212:215]
    v_mfma_f32_16x16x32_bf16 v[216:219], v[84:87], v[112:115], v[216:219]
    v_mfma_f32_16x16x32_bf16 v[220:223], v[88:91], v[112:115], v[220:223]
    s_waitcnt lgkmcnt(0)
    s_waitcnt vmcnt(6)
    s_barrier
    v_mfma_f32_16x16x32_bf16 v[128:131], v[48:51], v[32:35], v[128:131]
    ds_read_b128 v[76:79], v7 offset:0
    v_mfma_f32_16x16x32_bf16 v[132:135], v[48:51], v[36:39], v[132:135]
    s_add_u32 m0, s77, 0x26000
    s_lshl_b32 s28, s2, 13
    s_add_u32 s28, s28, s31
    buffer_load_dwordx4 v31, s[64:67], s28 offen lds
    s_mul_i32 s76, s2, 28672
    s_mul_i32 s29, s20, 3584
    s_add_u32 s76, s76, s29
    v_mfma_f32_16x16x32_bf16 v[136:139], v[48:51], v[40:43], v[136:139]
    ds_read_b128 v[80:83], v7 offset:2048
    v_mfma_f32_16x16x32_bf16 v[140:143], v[48:51], v[44:47], v[140:143]
    ds_read_b128 v[84:87], v7 offset:4096
    v_mfma_f32_16x16x32_bf16 v[144:147], v[52:55], v[32:35], v[144:147]
    ds_read_b128 v[88:91], v7 offset:6144
    v_mfma_f32_16x16x32_bf16 v[148:151], v[52:55], v[36:39], v[148:151]
    buffer_load_dwordx4 v31, s[68:71], s76 offen lds
    s_add_u32 s76, s76, 1024
    v_mfma_f32_16x16x32_bf16 v[152:155], v[52:55], v[40:43], v[152:155]
    ds_read_b64_tr_b16 v[92:93], v8 offset:14336
    v_mfma_f32_16x16x32_bf16 v[156:159], v[52:55], v[44:47], v[156:159]
    ds_read_b64_tr_b16 v[94:95], v8 offset:14848
    v_mfma_f32_16x16x32_bf16 v[160:163], v[56:59], v[32:35], v[160:163]
    ds_read_b64_tr_b16 v[96:97], v9 offset:14336
    v_mfma_f32_16x16x32_bf16 v[164:167], v[56:59], v[36:39], v[164:167]
    buffer_load_dwordx4 v31, s[68:71], s76 offen lds
    s_add_u32 s76, s76, 1024
    v_mfma_f32_16x16x32_bf16 v[168:171], v[56:59], v[40:43], v[168:171]
    ds_read_b64_tr_b16 v[98:99], v9 offset:14848
    v_mfma_f32_16x16x32_bf16 v[172:175], v[56:59], v[44:47], v[172:175]
    ds_read_b64_tr_b16 v[100:101], v8 offset:18432
    v_mfma_f32_16x16x32_bf16 v[176:179], v[60:63], v[32:35], v[176:179]
    ds_read_b64_tr_b16 v[102:103], v8 offset:18944
    v_mfma_f32_16x16x32_bf16 v[180:183], v[60:63], v[36:39], v[180:183]
    buffer_load_dwordx4 v31, s[68:71], s76 offen lds
    s_add_u32 s76, s76, 1024
    v_mfma_f32_16x16x32_bf16 v[184:187], v[60:63], v[40:43], v[184:187]
    ds_read_b64_tr_b16 v[104:105], v9 offset:18432
    v_mfma_f32_16x16x32_bf16 v[188:191], v[60:63], v[44:47], v[188:191]
    ds_read_b64_tr_b16 v[106:107], v9 offset:18944
    v_mfma_f32_16x16x32_bf16 v[192:195], v[32:35], v[64:67], v[192:195]
    ds_read_b64_tr_b16 v[108:109], v8 offset:22528
    v_mfma_f32_16x16x32_bf16 v[196:199], v[36:39], v[64:67], v[196:199]
    buffer_load_dwordx4 v31, s[68:71], s76 offen lds
    s_add_u32 s76, s76, 1024
    v_mfma_f32_16x16x32_bf16 v[200:203], v[40:43], v[64:67], v[200:203]
    ds_read_b64_tr_b16 v[110:111], v8 offset:23040
    v_mfma_f32_16x16x32_bf16 v[204:207], v[44:47], v[64:67], v[204:207]
    ds_read_b64_tr_b16 v[112:113], v9 offset:22528
    v_mfma_f32_16x16x32_bf16 v[208:211], v[32:35], v[68:71], v[208:211]
    ds_read_b64_tr_b16 v[114:115], v9 offset:23040
    v_mfma_f32_16x16x32_bf16 v[212:215], v[36:39], v[68:71], v[212:215]
    v_mfma_f32_16x16x32_bf16 v[216:219], v[40:43], v[68:71], v[216:219]
    v_mfma_f32_16x16x32_bf16 v[220:223], v[44:47], v[68:71], v[220:223]
    s_waitcnt lgkmcnt(0)
    s_waitcnt vmcnt(1)
    s_barrier
    v_mfma_f32_16x16x32_bf16 v[128:131], v[92:95], v[76:79], v[128:131]
    ds_read_b128 v[32:35], v2 offset:0
    v_mfma_f32_16x16x32_bf16 v[132:135], v[92:95], v[80:83], v[132:135]
    ds_read_b128 v[36:39], v2 offset:2048
    v_mfma_f32_16x16x32_bf16 v[136:139], v[92:95], v[84:87], v[136:139]
    ds_read_b128 v[40:43], v2 offset:4096
    v_mfma_f32_16x16x32_bf16 v[140:143], v[92:95], v[88:91], v[140:143]
    ds_read_b128 v[44:47], v2 offset:6144
    v_mfma_f32_16x16x32_bf16 v[144:147], v[96:99], v[76:79], v[144:147]
    ds_read_b64_tr_b16 v[48:49], v8 offset:28672
    v_mfma_f32_16x16x32_bf16 v[148:151], v[96:99], v[80:83], v[148:151]
    ds_read_b64_tr_b16 v[50:51], v8 offset:29184
    v_mfma_f32_16x16x32_bf16 v[152:155], v[96:99], v[84:87], v[152:155]
    ds_read_b64_tr_b16 v[52:53], v9 offset:28672
    v_mfma_f32_16x16x32_bf16 v[156:159], v[96:99], v[88:91], v[156:159]
    ds_read_b64_tr_b16 v[54:55], v9 offset:29184
    v_mfma_f32_16x16x32_bf16 v[160:163], v[100:103], v[76:79], v[160:163]
    ds_read_b64_tr_b16 v[56:57], v8 offset:32768
    v_mfma_f32_16x16x32_bf16 v[164:167], v[100:103], v[80:83], v[164:167]
    ds_read_b64_tr_b16 v[58:59], v8 offset:33280
    v_mfma_f32_16x16x32_bf16 v[168:171], v[100:103], v[84:87], v[168:171]
    ds_read_b64_tr_b16 v[60:61], v9 offset:32768
    v_mfma_f32_16x16x32_bf16 v[172:175], v[100:103], v[88:91], v[172:175]
    ds_read_b64_tr_b16 v[62:63], v9 offset:33280
    v_mfma_f32_16x16x32_bf16 v[176:179], v[104:107], v[76:79], v[176:179]
    ds_read_b64_tr_b16 v[64:65], v8 offset:36864
    v_mfma_f32_16x16x32_bf16 v[180:183], v[104:107], v[80:83], v[180:183]
    ds_read_b64_tr_b16 v[66:67], v8 offset:37376
    v_mfma_f32_16x16x32_bf16 v[184:187], v[104:107], v[84:87], v[184:187]
    ds_read_b64_tr_b16 v[68:69], v9 offset:36864
    v_mfma_f32_16x16x32_bf16 v[188:191], v[104:107], v[88:91], v[188:191]
    ds_read_b64_tr_b16 v[70:71], v9 offset:37376
    v_mfma_f32_16x16x32_bf16 v[192:195], v[76:79], v[108:111], v[192:195]
    v_mfma_f32_16x16x32_bf16 v[196:199], v[80:83], v[108:111], v[196:199]
    v_mfma_f32_16x16x32_bf16 v[200:203], v[84:87], v[108:111], v[200:203]
    v_mfma_f32_16x16x32_bf16 v[204:207], v[88:91], v[108:111], v[204:207]
    v_mfma_f32_16x16x32_bf16 v[208:211], v[76:79], v[112:115], v[208:211]
    v_mfma_f32_16x16x32_bf16 v[212:215], v[80:83], v[112:115], v[212:215]
    v_mfma_f32_16x16x32_bf16 v[216:219], v[84:87], v[112:115], v[216:219]
    v_mfma_f32_16x16x32_bf16 v[220:223], v[88:91], v[112:115], v[220:223]
    s_waitcnt lgkmcnt(0)
    s_waitcnt vmcnt(0)
    s_barrier
    v_mfma_f32_16x16x32_bf16 v[128:131], v[48:51], v[32:35], v[128:131]
    ds_read_b128 v[76:79], v3 offset:0
    v_mfma_f32_16x16x32_bf16 v[132:135], v[48:51], v[36:39], v[132:135]
    ds_read_b128 v[80:83], v3 offset:2048
    v_mfma_f32_16x16x32_bf16 v[136:139], v[48:51], v[40:43], v[136:139]
    ds_read_b128 v[84:87], v3 offset:4096
    v_mfma_f32_16x16x32_bf16 v[140:143], v[48:51], v[44:47], v[140:143]
    ds_read_b128 v[88:91], v3 offset:6144
    v_mfma_f32_16x16x32_bf16 v[144:147], v[52:55], v[32:35], v[144:147]
    ds_read_b64_tr_b16 v[92:93], v8 offset:43008
    v_mfma_f32_16x16x32_bf16 v[148:151], v[52:55], v[36:39], v[148:151]
    ds_read_b64_tr_b16 v[94:95], v8 offset:43520
    v_mfma_f32_16x16x32_bf16 v[152:155], v[52:55], v[40:43], v[152:155]
    ds_read_b64_tr_b16 v[96:97], v9 offset:43008
    v_mfma_f32_16x16x32_bf16 v[156:159], v[52:55], v[44:47], v[156:159]
    ds_read_b64_tr_b16 v[98:99], v9 offset:43520
    v_mfma_f32_16x16x32_bf16 v[160:163], v[56:59], v[32:35], v[160:163]
    ds_read_b64_tr_b16 v[100:101], v8 offset:47104
    v_mfma_f32_16x16x32_bf16 v[164:167], v[56:59], v[36:39], v[164:167]
    ds_read_b64_tr_b16 v[102:103], v8 offset:47616
    v_mfma_f32_16x16x32_bf16 v[168:171], v[56:59], v[40:43], v[168:171]
    ds_read_b64_tr_b16 v[104:105], v9 offset:47104
    v_mfma_f32_16x16x32_bf16 v[172:175], v[56:59], v[44:47], v[172:175]
    ds_read_b64_tr_b16 v[106:107], v9 offset:47616
    v_mfma_f32_16x16x32_bf16 v[176:179], v[60:63], v[32:35], v[176:179]
    ds_read_b64_tr_b16 v[108:109], v8 offset:51200
    v_mfma_f32_16x16x32_bf16 v[180:183], v[60:63], v[36:39], v[180:183]
    ds_read_b64_tr_b16 v[110:111], v8 offset:51712
    v_mfma_f32_16x16x32_bf16 v[184:187], v[60:63], v[40:43], v[184:187]
    ds_read_b64_tr_b16 v[112:113], v9 offset:51200
    v_mfma_f32_16x16x32_bf16 v[188:191], v[60:63], v[44:47], v[188:191]
    ds_read_b64_tr_b16 v[114:115], v9 offset:51712
    v_mfma_f32_16x16x32_bf16 v[192:195], v[32:35], v[64:67], v[192:195]
    v_mfma_f32_16x16x32_bf16 v[196:199], v[36:39], v[64:67], v[196:199]
    v_mfma_f32_16x16x32_bf16 v[200:203], v[40:43], v[64:67], v[200:203]
    v_mfma_f32_16x16x32_bf16 v[204:207], v[44:47], v[64:67], v[204:207]
    v_mfma_f32_16x16x32_bf16 v[208:211], v[32:35], v[68:71], v[208:211]
    v_mfma_f32_16x16x32_bf16 v[212:215], v[36:39], v[68:71], v[212:215]
    v_mfma_f32_16x16x32_bf16 v[216:219], v[40:43], v[68:71], v[216:219]
    v_mfma_f32_16x16x32_bf16 v[220:223], v[44:47], v[68:71], v[220:223]
    s_waitcnt lgkmcnt(0)
    s_barrier
    v_mfma_f32_16x16x32_bf16 v[128:131], v[92:95], v[76:79], v[128:131]
    v_mfma_f32_16x16x32_bf16 v[132:135], v[92:95], v[80:83], v[132:135]
    v_mfma_f32_16x16x32_bf16 v[136:139], v[92:95], v[84:87], v[136:139]
    v_mfma_f32_16x16x32_bf16 v[140:143], v[92:95], v[88:91], v[140:143]
    v_mfma_f32_16x16x32_bf16 v[144:147], v[96:99], v[76:79], v[144:147]
    v_mfma_f32_16x16x32_bf16 v[148:151], v[96:99], v[80:83], v[148:151]
    v_mfma_f32_16x16x32_bf16 v[152:155], v[96:99], v[84:87], v[152:155]
    v_mfma_f32_16x16x32_bf16 v[156:159], v[96:99], v[88:91], v[156:159]
    v_mfma_f32_16x16x32_bf16 v[160:163], v[100:103], v[76:79], v[160:163]
    v_mfma_f32_16x16x32_bf16 v[164:167], v[100:103], v[80:83], v[164:167]
    v_mfma_f32_16x16x32_bf16 v[168:171], v[100:103], v[84:87], v[168:171]
    v_mfma_f32_16x16x32_bf16 v[172:175], v[100:103], v[88:91], v[172:175]
    v_mfma_f32_16x16x32_bf16 v[176:179], v[104:107], v[76:79], v[176:179]
    v_mfma_f32_16x16x32_bf16 v[180:183], v[104:107], v[80:83], v[180:183]
    v_mfma_f32_16x16x32_bf16 v[184:187], v[104:107], v[84:87], v[184:187]
    v_mfma_f32_16x16x32_bf16 v[188:191], v[104:107], v[88:91], v[188:191]
    v_mfma_f32_16x16x32_bf16 v[192:195], v[76:79], v[108:111], v[192:195]
    v_mfma_f32_16x16x32_bf16 v[196:199], v[80:83], v[108:111], v[196:199]
    v_mfma_f32_16x16x32_bf16 v[200:203], v[84:87], v[108:111], v[200:203]
    v_mfma_f32_16x16x32_bf16 v[204:207], v[88:91], v[108:111], v[204:207]
    v_mfma_f32_16x16x32_bf16 v[208:211], v[76:79], v[112:115], v[208:211]
    v_mfma_f32_16x16x32_bf16 v[212:215], v[80:83], v[112:115], v[212:215]
    v_mfma_f32_16x16x32_bf16 v[216:219], v[84:87], v[112:115], v[216:219]
    v_mfma_f32_16x16x32_bf16 v[220:223], v[88:91], v[112:115], v[220:223]
    s_waitcnt lgkmcnt(0)
    s_mov_b32 s50, 0xffff0000
    s_mov_b32 s51, 0x3fb8aa3b
    v_lshl_or_b32 v240, v225, 16, v224
    v_lshl_or_b32 v241, v227, 16, v226
    v_lshl_or_b32 v242, v229, 16, v228
    v_lshl_or_b32 v243, v231, 16, v230
    v_lshl_or_b32 v244, v233, 16, v232
    v_lshl_or_b32 v245, v235, 16, v234
    v_lshl_or_b32 v246, v237, 16, v236
    v_lshl_or_b32 v247, v239, 16, v238
    v_cvt_pk_bf16_f32 v32, v128, v129
    v_cvt_pk_bf16_f32 v33, v130, v131
    v_cvt_pk_bf16_f32 v48, v160, v161
    v_cvt_pk_bf16_f32 v49, v162, v163
    v_cvt_pk_bf16_f32 v34, v144, v145
    v_cvt_pk_bf16_f32 v35, v146, v147
    v_cvt_pk_bf16_f32 v50, v176, v177
    v_cvt_pk_bf16_f32 v51, v178, v179
    v_cvt_pk_bf16_f32 v36, v132, v133
    v_cvt_pk_bf16_f32 v37, v134, v135
    v_cvt_pk_bf16_f32 v52, v164, v165
    v_cvt_pk_bf16_f32 v53, v166, v167
    v_cvt_pk_bf16_f32 v38, v148, v149
    v_cvt_pk_bf16_f32 v39, v150, v151
    v_cvt_pk_bf16_f32 v54, v180, v181
    v_cvt_pk_bf16_f32 v55, v182, v183
    v_cvt_pk_bf16_f32 v40, v136, v137
    v_cvt_pk_bf16_f32 v41, v138, v139
    v_cvt_pk_bf16_f32 v56, v168, v169
    v_cvt_pk_bf16_f32 v57, v170, v171
    v_cvt_pk_bf16_f32 v42, v152, v153
    v_cvt_pk_bf16_f32 v43, v154, v155
    v_cvt_pk_bf16_f32 v58, v184, v185
    v_cvt_pk_bf16_f32 v59, v186, v187
    v_cvt_pk_bf16_f32 v44, v140, v141
    v_cvt_pk_bf16_f32 v45, v142, v143
    v_cvt_pk_bf16_f32 v60, v172, v173
    v_cvt_pk_bf16_f32 v61, v174, v175
    v_cvt_pk_bf16_f32 v46, v156, v157
    v_cvt_pk_bf16_f32 v47, v158, v159
    v_cvt_pk_bf16_f32 v62, v188, v189
    v_cvt_pk_bf16_f32 v63, v190, v191
    v_cvt_pk_bf16_f32 v64, v192, v193
    v_cvt_pk_bf16_f32 v65, v194, v195
    v_cvt_pk_bf16_f32 v66, v196, v197
    v_cvt_pk_bf16_f32 v67, v198, v199
    v_cvt_pk_bf16_f32 v68, v208, v209
    v_cvt_pk_bf16_f32 v69, v210, v211
    v_cvt_pk_bf16_f32 v70, v212, v213
    v_cvt_pk_bf16_f32 v71, v214, v215
    v_cvt_pk_bf16_f32 v72, v200, v201
    v_cvt_pk_bf16_f32 v73, v202, v203
    v_cvt_pk_bf16_f32 v74, v204, v205
    v_cvt_pk_bf16_f32 v75, v206, v207
    v_cvt_pk_bf16_f32 v76, v216, v217
    v_cvt_pk_bf16_f32 v77, v218, v219
    v_cvt_pk_bf16_f32 v78, v220, v221
    v_cvt_pk_bf16_f32 v79, v222, v223
    v_mfma_f32_16x16x32_bf16 v[160:163], v[48:51], v[240:243], 0
    v_mfma_f32_16x16x32_bf16 v[164:167], v[48:51], v[244:247], 0
    v_mfma_f32_16x16x32_bf16 v[168:171], v[52:55], v[240:243], 0
    v_mfma_f32_16x16x32_bf16 v[172:175], v[52:55], v[244:247], 0
    v_mfma_f32_16x16x32_bf16 v[176:179], v[56:59], v[240:243], 0
    v_mfma_f32_16x16x32_bf16 v[180:183], v[56:59], v[244:247], 0
    v_mfma_f32_16x16x32_bf16 v[184:187], v[60:63], v[240:243], 0
    v_mfma_f32_16x16x32_bf16 v[188:191], v[60:63], v[244:247], 0
    s_lshl_b32 s28, s24, 4
    s_lshl_b32 s29, s21, 2
    s_add_u32 s28, s28, s29
    s_lshl_b32 s28, s28, 10
    s_lshl_b32 s29, s33, 17
    s_add_u32 s28, s28, s29
    buffer_store_dwordx4 v[32:35], v31, s[36:39], s28 offen offset:0 sc1
    buffer_store_dwordx4 v[36:39], v31, s[36:39], s28 offen offset:1024 sc1
    buffer_store_dwordx4 v[40:43], v31, s[36:39], s28 offen offset:2048 sc1
    buffer_store_dwordx4 v[44:47], v31, s[36:39], s28 offen offset:3072 sc1
    s_or_b32 s28, s24, s21
    s_cmp_lg_u32 s28, 0
    s_cbranch_scc1 g1q_nowp
    s_lshl_b32 s28, s33, 11
    s_add_u32 s28, s28, 0x400000
    buffer_store_dwordx4 v[240:243], v31, s[36:39], s28 offen sc1
    buffer_store_dwordx4 v[244:247], v31, s[36:39], s28 offen offset:1024 sc1
g1q_nowp:
    v_cvt_pk_bf16_f32 v17, v160, v161
    v_lshlrev_b32 v160, 16, v17
    v_and_b32 v161, s50, v17
    v_cvt_pk_bf16_f32 v18, v162, v163
    v_lshlrev_b32 v162, 16, v18
    v_and_b32 v163, s50, v18
    v_cvt_pk_bf16_f32 v19, v164, v165
    v_lshlrev_b32 v164, 16, v19
    v_and_b32 v165, s50, v19
    v_cvt_pk_bf16_f32 v20, v166, v167
    v_lshlrev_b32 v166, 16, v20
    v_and_b32 v167, s50, v20
    v_cvt_pk_bf16_f32 v17, v168, v169
    v_lshlrev_b32 v168, 16, v17
    v_and_b32 v169, s50, v17
    v_cvt_pk_bf16_f32 v18, v170, v171
    v_lshlrev_b32 v170, 16, v18
    v_and_b32 v171, s50, v18
    v_cvt_pk_bf16_f32 v19, v172, v173
    v_lshlrev_b32 v172, 16, v19
    v_and_b32 v173, s50, v19
    v_cvt_pk_bf16_f32 v20, v174, v175
    v_lshlrev_b32 v174, 16, v20
    v_and_b32 v175, s50, v20
    v_cvt_pk_bf16_f32 v17, v176, v177
    v_lshlrev_b32 v176, 16, v17
    v_and_b32 v177, s50, v17
    v_cvt_pk_bf16_f32 v18, v178, v179
    v_lshlrev_b32 v178, 16, v18
    v_and_b32 v179, s50, v18
    v_cvt_pk_bf16_f32 v19, v180, v181
    v_lshlrev_b32 v180, 16, v19
    v_and_b32 v181, s50, v19
    v_cvt_pk_bf16_f32 v20, v182, v183
    v_lshlrev_b32 v182, 16, v20
    v_and_b32 v183, s50, v20
    v_cvt_pk_bf16_f32 v17, v184, v185
    v_lshlrev_b32 v184, 16, v17
    v_and_b32 v185, s50, v17
    v_cvt_pk_bf16_f32 v18, v186, v187
    v_lshlrev_b32 v186, 16, v18
    v_and_b32 v187, s50, v18
    v_cvt_pk_bf16_f32 v19, v188, v189
    v_lshlrev_b32 v188, 16, v19
    v_and_b32 v189, s50, v19
    v_cvt_pk_bf16_f32 v20, v190, v191
    v_lshlrev_b32 v190, 16, v20
    v_and_b32 v191, s50, v20
    v_max_f32 v80, v160, v164
    v_min_f32 v96, v160, v164
    v_max_f32 v81, v161, v165
    v_min_f32 v97, v161, v165
    v_max_f32 v82, v162, v166
    v_min_f32 v98, v162, v166
    v_max_f32 v83, v163, v167
    v_min_f32 v99, v163, v167
    v_max_f32 v84, v168, v172
    v_min_f32 v100, v168, v172
    v_max_f32 v85, v169, v173
    v_min_f32 v101, v169, v173
    v_max_f32 v86, v170, v174
    v_min_f32 v102, v170, v174
    v_max_f32 v87, v171, v175
    v_min_f32 v103, v171, v175
    v_max_f32 v88, v176, v180
    v_min_f32 v104, v176, v180
    v_max_f32 v89, v177, v181
    v_min_f32 v105, v177, v181
    v_max_f32 v90, v178, v182
    v_min_f32 v106, v178, v182
    v_max_f32 v91, v179, v183
    v_min_f32 v107, v179, v183
    v_max_f32 v92, v184, v188
    v_min_f32 v108, v184, v188
    v_max_f32 v93, v185, v189
    v_min_f32 v109, v185, v189
    v_max_f32 v94, v186, v190
    v_min_f32 v110, v186, v190
    v_max_f32 v95, v187, v191
    v_min_f32 v111, v187, v191
    v_max_f32_dpp v112, v80, v80 row_ror:8 row_mask:0xf bank_mask:0xf
    v_max_f32_dpp v113, v81, v81 row_ror:8 row_mask:0xf bank_mask:0xf
    v_max_f32_dpp v114, v82, v82 row_ror:8 row_mask:0xf bank_mask:0xf
    v_max_f32_dpp v115, v83, v83 row_ror:8 row_mask:0xf bank_mask:0xf
    v_max_f32_dpp v116, v84, v84 row_ror:8 row_mask:0xf bank_mask:0xf
    v_max_f32_dpp v117, v85, v85 row_ror:8 row_mask:0xf bank_mask:0xf
    v_max_f32_dpp v118, v86, v86 row_ror:8 row_mask:0xf bank_mask:0xf
    v_max_f32_dpp v119, v87, v87 row_ror:8 row_mask:0xf bank_mask:0xf
    v_max_f32_dpp v120, v88, v88 row_ror:8 row_mask:0xf bank_mask:0xf
    v_max_f32_dpp v121, v89, v89 row_ror:8 row_mask:0xf bank_mask:0xf
    v_max_f32_dpp v122, v90, v90 row_ror:8 row_mask:0xf bank_mask:0xf
    v_max_f32_dpp v123, v91, v91 row_ror:8 row_mask:0xf bank_mask:0xf
    v_max_f32_dpp v124, v92, v92 row_ror:8 row_mask:0xf bank_mask:0xf
    v_max_f32_dpp v125, v93, v93 row_ror:8 row_mask:0xf bank_mask:0xf
    v_max_f32_dpp v126, v94, v94 row_ror:8 row_mask:0xf bank_mask:0xf
    v_max_f32_dpp v127, v95, v95 row_ror:8 row_mask:0xf bank_mask:0xf
    v_max_f32_dpp v80, v112, v112 row_ror:4 row_mask:0xf bank_mask:0xf
    v_max_f32_dpp v81, v113, v113 row_ror:4 row_mask:0xf bank_mask:0xf
    v_max_f32_dpp v82, v114, v114 row_ror:4 row_mask:0xf bank_mask:0xf
    v_max_f32_dpp v83, v115, v115 row_ror:4 row_mask:0xf bank_mask:0xf
    v_max_f32_dpp v84, v116, v116 row_ror:4 row_mask:0xf bank_mask:0xf
    v_max_f32_dpp v85, v117, v117 row_ror:4 row_mask:0xf bank_mask:0xf
    v_max_f32_dpp v86, v118, v118 row_ror:4 row_mask:0xf bank_mask:0xf
    v_max_f32_dpp v87, v119, v119 row_ror:4 row_mask:0xf bank_mask:0xf
    v_max_f32_dpp v88, v120, v120 row_ror:4 row_mask:0xf bank_mask:0xf
    v_max_f32_dpp v89, v121, v121 row_ror:4 row_mask:0xf bank_mask:0xf
    v_max_f32_dpp v90, v122, v122 row_ror:4 row_mask:0xf bank_mask:0xf
    v_max_f32_dpp v91, v123, v123 row_ror:4 row_mask:0xf bank_mask:0xf
    v_max_f32_dpp v92, v124, v124 row_ror:4 row_mask:0xf bank_mask:0xf
    v_max_f32_dpp v93, v125, v125 row_ror:4 row_mask:0xf bank_mask:0xf
    v_max_f32_dpp v94, v126, v126 row_ror:4 row_mask:0xf bank_mask:0xf
    v_max_f32_dpp v95, v127, v127 row_ror:4 row_mask:0xf bank_mask:0xf
    v_max_f32_dpp v112, v80, v80 row_ror:2 row_mask:0xf bank_mask:0xf
    v_max_f32_dpp v113, v81, v81 row_ror:2 row_mask:0xf bank_mask:0xf
    v_max_f32_dpp v114, v82, v82 row_ror:2 row_mask:0xf bank_mask:0xf
    v_max_f32_dpp v115, v83, v83 row_ror:2 row_mask:0xf bank_mask:0xf
    v_max_f32_dpp v116, v84, v84 row_ror:2 row_mask:0xf bank_mask:0xf
    v_max_f32_dpp v117, v85, v85 row_ror:2 row_mask:0xf bank_mask:0xf
    v_max_f32_dpp v118, v86, v86 row_ror:2 row_mask:0xf bank_mask:0xf
    v_max_f32_dpp v119, v87, v87 row_ror:2 row_mask:0xf bank_mask:0xf
    v_max_f32_dpp v120, v88, v88 row_ror:2 row_mask:0xf bank_mask:0xf
    v_max_f32_dpp v121, v89, v89 row_ror:2 row_mask:0xf bank_mask:0xf
    v_max_f32_dpp v122, v90, v90 row_ror:2 row_mask:0xf bank_mask:0xf
    v_max_f32_dpp v123, v91, v91 row_ror:2 row_mask:0xf bank_mask:0xf
    v_max_f32_dpp v124, v92, v92 row_ror:2 row_mask:0xf bank_mask:0xf
    v_max_f32_dpp v125, v93, v93 row_ror:2 row_mask:0xf bank_mask:0xf
    v_max_f32_dpp v126, v94, v94 row_ror:2 row_mask:0xf bank_mask:0xf
    v_max_f32_dpp v127, v95, v95 row_ror:2 row_mask:0xf bank_mask:0xf
    v_max_f32_dpp v80, v112, v112 row_ror:1 row_mask:0xf bank_mask:0xf
    v_max_f32_dpp v81, v113, v113 row_ror:1 row_mask:0xf bank_mask:0xf
    v_max_f32_dpp v82, v114, v114 row_ror:1 row_mask:0xf bank_mask:0xf
    v_max_f32_dpp v83, v115, v115 row_ror:1 row_mask:0xf bank_mask:0xf
    v_max_f32_dpp v84, v116, v116 row_ror:1 row_mask:0xf bank_mask:0xf
    v_max_f32_dpp v85, v117, v117 row_ror:1 row_mask:0xf bank_mask:0xf
    v_max_f32_dpp v86, v118, v118 row_ror:1 row_mask:0xf bank_mask:0xf
    v_max_f32_dpp v87, v119, v119 row_ror:1 row_mask:0xf bank_mask:0xf
    v_max_f32_dpp v88, v120, v120 row_ror:1 row_mask:0xf bank_mask:0xf
    v_max_f32_dpp v89, v121, v121 row_ror:1 row_mask:0xf bank_mask:0xf
    v_max_f32_dpp v90, v122, v122 row_ror:1 row_mask:0xf bank_mask:0xf
    v_max_f32_dpp v91, v123, v123 row_ror:1 row_mask:0xf bank_mask:0xf
    v_max_f32_dpp v92, v124, v124 row_ror:1 row_mask:0xf bank_mask:0xf
    v_max_f32_dpp v93, v125, v125 row_ror:1 row_mask:0xf bank_mask:0xf
    v_max_f32_dpp v94, v126, v126 row_ror:1 row_mask:0xf bank_mask:0xf
    v_max_f32_dpp v95, v127, v127 row_ror:1 row_mask:0xf bank_mask:0xf
    v_min_f32_dpp v112, v96, v96 row_ror:8 row_mask:0xf bank_mask:0xf
    v_min_f32_dpp v113, v97, v97 row_ror:8 row_mask:0xf bank_mask:0xf
    v_min_f32_dpp v114, v98, v98 row_ror:8 row_mask:0xf bank_mask:0xf
    v_min_f32_dpp v115, v99, v99 row_ror:8 row_mask:0xf bank_mask:0xf
    v_min_f32_dpp v116, v100, v100 row_ror:8 row_mask:0xf bank_mask:0xf
    v_min_f32_dpp v117, v101, v101 row_ror:8 row_mask:0xf bank_mask:0xf
    v_min_f32_dpp v118, v102, v102 row_ror:8 row_mask:0xf bank_mask:0xf
    v_min_f32_dpp v119, v103, v103 row_ror:8 row_mask:0xf bank_mask:0xf
    v_min_f32_dpp v120, v104, v104 row_ror:8 row_mask:0xf bank_mask:0xf
    v_min_f32_dpp v121, v105, v105 row_ror:8 row_mask:0xf bank_mask:0xf
    v_min_f32_dpp v122, v106, v106 row_ror:8 row_mask:0xf bank_mask:0xf
    v_min_f32_dpp v123, v107, v107 row_ror:8 row_mask:0xf bank_mask:0xf
    v_min_f32_dpp v124, v108, v108 row_ror:8 row_mask:0xf bank_mask:0xf
    v_min_f32_dpp v125, v109, v109 row_ror:8 row_mask:0xf bank_mask:0xf
    v_min_f32_dpp v126, v110, v110 row_ror:8 row_mask:0xf bank_mask:0xf
    v_min_f32_dpp v127, v111, v111 row_ror:8 row_mask:0xf bank_mask:0xf
    v_min_f32_dpp v96, v112, v112 row_ror:4 row_mask:0xf bank_mask:0xf
    v_min_f32_dpp v97, v113, v113 row_ror:4 row_mask:0xf bank_mask:0xf
    v_min_f32_dpp v98, v114, v114 row_ror:4 row_mask:0xf bank_mask:0xf
    v_min_f32_dpp v99, v115, v115 row_ror:4 row_mask:0xf bank_mask:0xf
    v_min_f32_dpp v100, v116, v116 row_ror:4 row_mask:0xf bank_mask:0xf
    v_min_f32_dpp v101, v117, v117 row_ror:4 row_mask:0xf bank_mask:0xf
    v_min_f32_dpp v102, v118, v118 row_ror:4 row_mask:0xf bank_mask:0xf
    v_min_f32_dpp v103, v119, v119 row_ror:4 row_mask:0xf bank_mask:0xf
    v_min_f32_dpp v104, v120, v120 row_ror:4 row_mask:0xf bank_mask:0xf
    v_min_f32_dpp v105, v121, v121 row_ror:4 row_mask:0xf bank_mask:0xf
    v_min_f32_dpp v106, v122, v122 row_ror:4 row_mask:0xf bank_mask:0xf
    v_min_f32_dpp v107, v123, v123 row_ror:4 row_mask:0xf bank_mask:0xf
    v_min_f32_dpp v108, v124, v124 row_ror:4 row_mask:0xf bank_mask:0xf
    v_min_f32_dpp v109, v125, v125 row_ror:4 row_mask:0xf bank_mask:0xf
    v_min_f32_dpp v110, v126, v126 row_ror:4 row_mask:0xf bank_mask:0xf
    v_min_f32_dpp v111, v127, v127 row_ror:4 row_mask:0xf bank_mask:0xf
    v_min_f32_dpp v112, v96, v96 row_ror:2 row_mask:0xf bank_mask:0xf
    v_min_f32_dpp v113, v97, v97 row_ror:2 row_mask:0xf bank_mask:0xf
    v_min_f32_dpp v114, v98, v98 row_ror:2 row_mask:0xf bank_mask:0xf
    v_min_f32_dpp v115, v99, v99 row_ror:2 row_mask:0xf bank_mask:0xf
    v_min_f32_dpp v116, v100, v100 row_ror:2 row_mask:0xf bank_mask:0xf
    v_min_f32_dpp v117, v101, v101 row_ror:2 row_mask:0xf bank_mask:0xf
    v_min_f32_dpp v118, v102, v102 row_ror:2 row_mask:0xf bank_mask:0xf
    v_min_f32_dpp v119, v103, v103 row_ror:2 row_mask:0xf bank_mask:0xf
    v_min_f32_dpp v120, v104, v104 row_ror:2 row_mask:0xf bank_mask:0xf
    v_min_f32_dpp v121, v105, v105 row_ror:2 row_mask:0xf bank_mask:0xf
    v_min_f32_dpp v122, v106, v106 row_ror:2 row_mask:0xf bank_mask:0xf
    v_min_f32_dpp v123, v107, v107 row_ror:2 row_mask:0xf bank_mask:0xf
    v_min_f32_dpp v124, v108, v108 row_ror:2 row_mask:0xf bank_mask:0xf
    v_min_f32_dpp v125, v109, v109 row_ror:2 row_mask:0xf bank_mask:0xf
    v_min_f32_dpp v126, v110, v110 row_ror:2 row_mask:0xf bank_mask:0xf
    v_min_f32_dpp v127, v111, v111 row_ror:2 row_mask:0xf bank_mask:0xf
    v_min_f32_dpp v96, v112, v112 row_ror:1 row_mask:0xf bank_mask:0xf
    v_min_f32_dpp v97, v113, v113 row_ror:1 row_mask:0xf bank_mask:0xf
    v_min_f32_dpp v98, v114, v114 row_ror:1 row_mask:0xf bank_mask:0xf
    v_min_f32_dpp v99, v115, v115 row_ror:1 row_mask:0xf bank_mask:0xf
    v_min_f32_dpp v100, v116, v116 row_ror:1 row_mask:0xf bank_mask:0xf
    v_min_f32_dpp v101, v117, v117 row_ror:1 row_mask:0xf bank_mask:0xf
    v_min_f32_dpp v102, v118, v118 row_ror:1 row_mask:0xf bank_mask:0xf
    v_min_f32_dpp v103, v119, v119 row_ror:1 row_mask:0xf bank_mask:0xf
    v_min_f32_dpp v104, v120, v120 row_ror:1 row_mask:0xf bank_mask:0xf
    v_min_f32_dpp v105, v121, v121 row_ror:1 row_mask:0xf bank_mask:0xf
    v_min_f32_dpp v106, v122, v122 row_ror:1 row_mask:0xf bank_mask:0xf
    v_min_f32_dpp v107, v123, v123 row_ror:1 row_mask:0xf bank_mask:0xf
    v_min_f32_dpp v108, v124, v124 row_ror:1 row_mask:0xf bank_mask:0xf
    v_min_f32_dpp v109, v125, v125 row_ror:1 row_mask:0xf bank_mask:0xf
    v_min_f32_dpp v110, v126, v126 row_ror:1 row_mask:0xf bank_mask:0xf
    v_min_f32_dpp v111, v127, v127 row_ror:1 row_mask:0xf bank_mask:0xf
    v_mul_f32 v80, s51, v80
    v_mul_f32 v96, s51, v96
    v_mul_f32 v81, s51, v81
    v_mul_f32 v97, s51, v97
    v_mul_f32 v82, s51, v82
    v_mul_f32 v98, s51, v98
    v_mul_f32 v83, s51, v83
    v_mul_f32 v99, s51, v99
    v_mul_f32 v84, s51, v84
    v_mul_f32 v100, s51, v100
    v_mul_f32 v85, s51, v85
    v_mul_f32 v101, s51, v101
    v_mul_f32 v86, s51, v86
    v_mul_f32 v102, s51, v102
    v_mul_f32 v87, s51, v87
    v_mul_f32 v103, s51, v103
    v_mul_f32 v88, s51, v88
    v_mul_f32 v104, s51, v104
    v_mul_f32 v89, s51, v89
    v_mul_f32 v105, s51, v105
    v_mul_f32 v90, s51, v90
    v_mul_f32 v106, s51, v106
    v_mul_f32 v91, s51, v91
    v_mul_f32 v107, s51, v107
    v_mul_f32 v92, s51, v92
    v_mul_f32 v108, s51, v108
    v_mul_f32 v93, s51, v93
    v_mul_f32 v109, s51, v109
    v_mul_f32 v94, s51, v94
    v_mul_f32 v110, s51, v110
    v_mul_f32 v95, s51, v95
    v_mul_f32 v111, s51, v111
    v_fma_f32 v128, v160, s51, -v80
    v_fma_f32 v160, -v160, s51, v96
    v_fma_f32 v132, v164, s51, -v80
    v_fma_f32 v164, -v164, s51, v96
    v_fma_f32 v129, v161, s51, -v81
    v_fma_f32 v161, -v161, s51, v97
    v_fma_f32 v133, v165, s51, -v81
    v_fma_f32 v165, -v165, s51, v97
    v_fma_f32 v130, v162, s51, -v82
    v_fma_f32 v162, -v162, s51, v98
    v_fma_f32 v134, v166, s51, -v82
    v_fma_f32 v166, -v166, s51, v98
    v_fma_f32 v131, v163, s51, -v83
    v_fma_f32 v163, -v163, s51, v99
    v_fma_f32 v135, v167, s51, -v83
    v_fma_f32 v167, -v167, s51, v99
    v_fma_f32 v136, v168, s51, -v84
    v_fma_f32 v168, -v168, s51, v100
    v_fma_f32 v140, v172, s51, -v84
    v_fma_f32 v172, -v172, s51, v100
    v_fma_f32 v137, v169, s51, -v85
    v_fma_f32 v169, -v169, s51, v101
    v_fma_f32 v141, v173, s51, -v85
    v_fma_f32 v173, -v173, s51, v101
    v_fma_f32 v138, v170, s51, -v86
    v_fma_f32 v170, -v170, s51, v102
    v_fma_f32 v142, v174, s51, -v86
    v_fma_f32 v174, -v174, s51, v102
    v_fma_f32 v139, v171, s51, -v87
    v_fma_f32 v171, -v171, s51, v103
    v_fma_f32 v143, v175, s51, -v87
    v_fma_f32 v175, -v175, s51, v103
    v_fma_f32 v144, v176, s51, -v88
    v_fma_f32 v176, -v176, s51, v104
    v_fma_f32 v148, v180, s51, -v88
    v_fma_f32 v180, -v180, s51, v104
    v_fma_f32 v145, v177, s51, -v89
    v_fma_f32 v177, -v177, s51, v105
    v_fma_f32 v149, v181, s51, -v89
    v_fma_f32 v181, -v181, s51, v105
    v_fma_f32 v146, v178, s51, -v90
    v_fma_f32 v178, -v178, s51, v106
    v_fma_f32 v150, v182, s51, -v90
    v_fma_f32 v182, -v182, s51, v106
    v_fma_f32 v147, v179, s51, -v91
    v_fma_f32 v179, -v179, s51, v107
    v_fma_f32 v151, v183, s51, -v91
    v_fma_f32 v183, -v183, s51, v107
    v_fma_f32 v152, v184, s51, -v92
    v_fma_f32 v184, -v184, s51, v108
    v_fma_f32 v156, v188, s51, -v92
    v_fma_f32 v188, -v188, s51, v108
    v_fma_f32 v153, v185, s51, -v93
    v_fma_f32 v185, -v185, s51, v109
    v_fma_f32 v157, v189, s51, -v93
    v_fma_f32 v189, -v189, s51, v109
    v_fma_f32 v154, v186, s51, -v94
    v_fma_f32 v186, -v186, s51, v110
    v_fma_f32 v158, v190, s51, -v94
    v_fma_f32 v190, -v190, s51, v110
    v_fma_f32 v155, v187, s51, -v95
    v_fma_f32 v187, -v187, s51, v111
    v_fma_f32 v159, v191, s51, -v95
    v_fma_f32 v191, -v191, s51, v111
    v_exp_f32 v128, v128
    v_exp_f32 v129, v129
    v_exp_f32 v130, v130
    v_exp_f32 v131, v131
    v_exp_f32 v132, v132
    v_exp_f32 v133, v133
    v_exp_f32 v134, v134
    v_exp_f32 v135, v135
    v_exp_f32 v136, v136
    v_exp_f32 v137, v137
    v_exp_f32 v138, v138
    v_exp_f32 v139, v139
    v_exp_f32 v140, v140
    v_exp_f32 v141, v141
    v_exp_f32 v142, v142
    v_exp_f32 v143, v143
    v_exp_f32 v144, v144
    v_exp_f32 v145, v145
    v_exp_f32 v146, v146
    v_exp_f32 v147, v147
    v_exp_f32 v148, v148
    v_exp_f32 v149, v149
    v_exp_f32 v150, v150
    v_exp_f32 v151, v151
    v_exp_f32 v152, v152
    v_exp_f32 v153, v153
    v_exp_f32 v154, v154
    v_exp_f32 v155, v155
    v_exp_f32 v156, v156
    v_exp_f32 v157, v157
    v_exp_f32 v158, v158
    v_exp_f32 v159, v159
    v_exp_f32 v160, v160
    v_exp_f32 v161, v161
    v_exp_f32 v162, v162
    v_exp_f32 v163, v163
    v_exp_f32 v164, v164
    v_exp_f32 v165, v165
    v_exp_f32 v166, v166
    v_exp_f32 v167, v167
    v_exp_f32 v168, v168
    v_exp_f32 v169, v169
    v_exp_f32 v170, v170
    v_exp_f32 v171, v171
    v_exp_f32 v172, v172
    v_exp_f32 v173, v173
    v_exp_f32 v174, v174
    v_exp_f32 v175, v175
    v_exp_f32 v176, v176
    v_exp_f32 v177, v177
    v_exp_f32 v178, v178
    v_exp_f32 v179, v179
    v_exp_f32 v180, v180
    v_exp_f32 v181, v181
    v_exp_f32 v182, v182
    v_exp_f32 v183, v183
    v_exp_f32 v184, v184
    v_exp_f32 v185, v185
    v_exp_f32 v186, v186
    v_exp_f32 v187, v187
    v_exp_f32 v188, v188
    v_exp_f32 v189, v189
    v_exp_f32 v190, v190
    v_exp_f32 v191, v191
    v_add_f32 v32, v128, v132
    v_add_f32 v48, v160, v164
    v_add_f32 v33, v129, v133
    v_add_f32 v49, v161, v165
    v_add_f32 v34, v130, v134
    v_add_f32 v50, v162, v166
    v_add_f32 v35, v131, v135
    v_add_f32 v51, v163, v167
    v_add_f32 v36, v136, v140
    v_add_f32 v52, v168, v172
    v_add_f32 v37, v137, v141
    v_add_f32 v53, v169, v173
    v_add_f32 v38, v138, v142
    v_add_f32 v54, v170, v174
    v_add_f32 v39, v139, v143
    v_add_f32 v55, v171, v175
    v_add_f32 v40, v144, v148
    v_add_f32 v56, v176, v180
    v_add_f32 v41, v145, v149
    v_add_f32 v57, v177, v181
    v_add_f32 v42, v146, v150
    v_add_f32 v58, v178, v182
    v_add_f32 v43, v147, v151
    v_add_f32 v59, v179, v183
    v_add_f32 v44, v152, v156
    v_add_f32 v60, v184, v188
    v_add_f32 v45, v153, v157
    v_add_f32 v61, v185, v189
    v_add_f32 v46, v154, v158
    v_add_f32 v62, v186, v190
    v_add_f32 v47, v155, v159
    v_add_f32 v63, v187, v191
    v_add_f32_dpp v112, v32, v32 row_ror:8 row_mask:0xf bank_mask:0xf
    v_add_f32_dpp v113, v33, v33 row_ror:8 row_mask:0xf bank_mask:0xf
    v_add_f32_dpp v114, v34, v34 row_ror:8 row_mask:0xf bank_mask:0xf
    v_add_f32_dpp v115, v35, v35 row_ror:8 row_mask:0xf bank_mask:0xf
    v_add_f32_dpp v116, v36, v36 row_ror:8 row_mask:0xf bank_mask:0xf
    v_add_f32_dpp v117, v37, v37 row_ror:8 row_mask:0xf bank_mask:0xf
    v_add_f32_dpp v118, v38, v38 row_ror:8 row_mask:0xf bank_mask:0xf
    v_add_f32_dpp v119, v39, v39 row_ror:8 row_mask:0xf bank_mask:0xf
    v_add_f32_dpp v120, v40, v40 row_ror:8 row_mask:0xf bank_mask:0xf
    v_add_f32_dpp v121, v41, v41 row_ror:8 row_mask:0xf bank_mask:0xf
    v_add_f32_dpp v122, v42, v42 row_ror:8 row_mask:0xf bank_mask:0xf
    v_add_f32_dpp v123, v43, v43 row_ror:8 row_mask:0xf bank_mask:0xf
    v_add_f32_dpp v124, v44, v44 row_ror:8 row_mask:0xf bank_mask:0xf
    v_add_f32_dpp v125, v45, v45 row_ror:8 row_mask:0xf bank_mask:0xf
    v_add_f32_dpp v126, v46, v46 row_ror:8 row_mask:0xf bank_mask:0xf
    v_add_f32_dpp v127, v47, v47 row_ror:8 row_mask:0xf bank_mask:0xf
    v_add_f32_dpp v32, v112, v112 row_ror:4 row_mask:0xf bank_mask:0xf
    v_add_f32_dpp v33, v113, v113 row_ror:4 row_mask:0xf bank_mask:0xf
    v_add_f32_dpp v34, v114, v114 row_ror:4 row_mask:0xf bank_mask:0xf
    v_add_f32_dpp v35, v115, v115 row_ror:4 row_mask:0xf bank_mask:0xf
    v_add_f32_dpp v36, v116, v116 row_ror:4 row_mask:0xf bank_mask:0xf
    v_add_f32_dpp v37, v117, v117 row_ror:4 row_mask:0xf bank_mask:0xf
    v_add_f32_dpp v38, v118, v118 row_ror:4 row_mask:0xf bank_mask:0xf
    v_add_f32_dpp v39, v119, v119 row_ror:4 row_mask:0xf bank_mask:0xf
    v_add_f32_dpp v40, v120, v120 row_ror:4 row_mask:0xf bank_mask:0xf
    v_add_f32_dpp v41, v121, v121 row_ror:4 row_mask:0xf bank_mask:0xf
    v_add_f32_dpp v42, v122, v122 row_ror:4 row_mask:0xf bank_mask:0xf
    v_add_f32_dpp v43, v123, v123 row_ror:4 row_mask:0xf bank_mask:0xf
    v_add_f32_dpp v44, v124, v124 row_ror:4 row_mask:0xf bank_mask:0xf
    v_add_f32_dpp v45, v125, v125 row_ror:4 row_mask:0xf bank_mask:0xf
    v_add_f32_dpp v46, v126, v126 row_ror:4 row_mask:0xf bank_mask:0xf
    v_add_f32_dpp v47, v127, v127 row_ror:4 row_mask:0xf bank_mask:0xf
    v_add_f32_dpp v112, v32, v32 row_ror:2 row_mask:0xf bank_mask:0xf
    v_add_f32_dpp v113, v33, v33 row_ror:2 row_mask:0xf bank_mask:0xf
    v_add_f32_dpp v114, v34, v34 row_ror:2 row_mask:0xf bank_mask:0xf
    v_add_f32_dpp v115, v35, v35 row_ror:2 row_mask:0xf bank_mask:0xf
    v_add_f32_dpp v116, v36, v36 row_ror:2 row_mask:0xf bank_mask:0xf
    v_add_f32_dpp v117, v37, v37 row_ror:2 row_mask:0xf bank_mask:0xf
    v_add_f32_dpp v118, v38, v38 row_ror:2 row_mask:0xf bank_mask:0xf
    v_add_f32_dpp v119, v39, v39 row_ror:2 row_mask:0xf bank_mask:0xf
    v_add_f32_dpp v120, v40, v40 row_ror:2 row_mask:0xf bank_mask:0xf
    v_add_f32_dpp v121, v41, v41 row_ror:2 row_mask:0xf bank_mask:0xf
    v_add_f32_dpp v122, v42, v42 row_ror:2 row_mask:0xf bank_mask:0xf
    v_add_f32_dpp v123, v43, v43 row_ror:2 row_mask:0xf bank_mask:0xf
    v_add_f32_dpp v124, v44, v44 row_ror:2 row_mask:0xf bank_mask:0xf
    v_add_f32_dpp v125, v45, v45 row_ror:2 row_mask:0xf bank_mask:0xf
    v_add_f32_dpp v126, v46, v46 row_ror:2 row_mask:0xf bank_mask:0xf
    v_add_f32_dpp v127, v47, v47 row_ror:2 row_mask:0xf bank_mask:0xf
    v_add_f32_dpp v32, v112, v112 row_ror:1 row_mask:0xf bank_mask:0xf
    v_add_f32_dpp v33, v113, v113 row_ror:1 row_mask:0xf bank_mask:0xf
    v_add_f32_dpp v34, v114, v114 row_ror:1 row_mask:0xf bank_mask:0xf
    v_add_f32_dpp v35, v115, v115 row_ror:1 row_mask:0xf bank_mask:0xf
    v_add_f32_dpp v36, v116, v116 row_ror:1 row_mask:0xf bank_mask:0xf
    v_add_f32_dpp v37, v117, v117 row_ror:1 row_mask:0xf bank_mask:0xf
    v_add_f32_dpp v38, v118, v118 row_ror:1 row_mask:0xf bank_mask:0xf
    v_add_f32_dpp v39, v119, v119 row_ror:1 row_mask:0xf bank_mask:0xf
    v_add_f32_dpp v40, v120, v120 row_ror:1 row_mask:0xf bank_mask:0xf
    v_add_f32_dpp v41, v121, v121 row_ror:1 row_mask:0xf bank_mask:0xf
    v_add_f32_dpp v42, v122, v122 row_ror:1 row_mask:0xf bank_mask:0xf
    v_add_f32_dpp v43, v123, v123 row_ror:1 row_mask:0xf bank_mask:0xf
    v_add_f32_dpp v44, v124, v124 row_ror:1 row_mask:0xf bank_mask:0xf
    v_add_f32_dpp v45, v125, v125 row_ror:1 row_mask:0xf bank_mask:0xf
    v_add_f32_dpp v46, v126, v126 row_ror:1 row_mask:0xf bank_mask:0xf
    v_add_f32_dpp v47, v127, v127 row_ror:1 row_mask:0xf bank_mask:0xf
    v_add_f32_dpp v112, v48, v48 row_ror:8 row_mask:0xf bank_mask:0xf
    v_add_f32_dpp v113, v49, v49 row_ror:8 row_mask:0xf bank_mask:0xf
    v_add_f32_dpp v114, v50, v50 row_ror:8 row_mask:0xf bank_mask:0xf
    v_add_f32_dpp v115, v51, v51 row_ror:8 row_mask:0xf bank_mask:0xf
    v_add_f32_dpp v116, v52, v52 row_ror:8 row_mask:0xf bank_mask:0xf
    v_add_f32_dpp v117, v53, v53 row_ror:8 row_mask:0xf bank_mask:0xf
    v_add_f32_dpp v118, v54, v54 row_ror:8 row_mask:0xf bank_mask:0xf
    v_add_f32_dpp v119, v55, v55 row_ror:8 row_mask:0xf bank_mask:0xf
    v_add_f32_dpp v120, v56, v56 row_ror:8 row_mask:0xf bank_mask:0xf
    v_add_f32_dpp v121, v57, v57 row_ror:8 row_mask:0xf bank_mask:0xf
    v_add_f32_dpp v122, v58, v58 row_ror:8 row_mask:0xf bank_mask:0xf
    v_add_f32_dpp v123, v59, v59 row_ror:8 row_mask:0xf bank_mask:0xf
    v_add_f32_dpp v124, v60, v60 row_ror:8 row_mask:0xf bank_mask:0xf
    v_add_f32_dpp v125, v61, v61 row_ror:8 row_mask:0xf bank_mask:0xf
    v_add_f32_dpp v126, v62, v62 row_ror:8 row_mask:0xf bank_mask:0xf
    v_add_f32_dpp v127, v63, v63 row_ror:8 row_mask:0xf bank_mask:0xf
    v_add_f32_dpp v48, v112, v112 row_ror:4 row_mask:0xf bank_mask:0xf
    v_add_f32_dpp v49, v113, v113 row_ror:4 row_mask:0xf bank_mask:0xf
    v_add_f32_dpp v50, v114, v114 row_ror:4 row_mask:0xf bank_mask:0xf
    v_add_f32_dpp v51, v115, v115 row_ror:4 row_mask:0xf bank_mask:0xf
    v_add_f32_dpp v52, v116, v116 row_ror:4 row_mask:0xf bank_mask:0xf
    v_add_f32_dpp v53, v117, v117 row_ror:4 row_mask:0xf bank_mask:0xf
    v_add_f32_dpp v54, v118, v118 row_ror:4 row_mask:0xf bank_mask:0xf
    v_add_f32_dpp v55, v119, v119 row_ror:4 row_mask:0xf bank_mask:0xf
    v_add_f32_dpp v56, v120, v120 row_ror:4 row_mask:0xf bank_mask:0xf
    v_add_f32_dpp v57, v121, v121 row_ror:4 row_mask:0xf bank_mask:0xf
    v_add_f32_dpp v58, v122, v122 row_ror:4 row_mask:0xf bank_mask:0xf
    v_add_f32_dpp v59, v123, v123 row_ror:4 row_mask:0xf bank_mask:0xf
    v_add_f32_dpp v60, v124, v124 row_ror:4 row_mask:0xf bank_mask:0xf
    v_add_f32_dpp v61, v125, v125 row_ror:4 row_mask:0xf bank_mask:0xf
    v_add_f32_dpp v62, v126, v126 row_ror:4 row_mask:0xf bank_mask:0xf
    v_add_f32_dpp v63, v127, v127 row_ror:4 row_mask:0xf bank_mask:0xf
    v_add_f32_dpp v112, v48, v48 row_ror:2 row_mask:0xf bank_mask:0xf
    v_add_f32_dpp v113, v49, v49 row_ror:2 row_mask:0xf bank_mask:0xf
    v_add_f32_dpp v114, v50, v50 row_ror:2 row_mask:0xf bank_mask:0xf
    v_add_f32_dpp v115, v51, v51 row_ror:2 row_mask:0xf bank_mask:0xf
    v_add_f32_dpp v116, v52, v52 row_ror:2 row_mask:0xf bank_mask:0xf
    v_add_f32_dpp v117, v53, v53 row_ror:2 row_mask:0xf bank_mask:0xf
    v_add_f32_dpp v118, v54, v54 row_ror:2 row_mask:0xf bank_mask:0xf
    v_add_f32_dpp v119, v55, v55 row_ror:2 row_mask:0xf bank_mask:0xf
    v_add_f32_dpp v120, v56, v56 row_ror:2 row_mask:0xf bank_mask:0xf
    v_add_f32_dpp v121, v57, v57 row_ror:2 row_mask:0xf bank_mask:0xf
    v_add_f32_dpp v122, v58, v58 row_ror:2 row_mask:0xf bank_mask:0xf
    v_add_f32_dpp v123, v59, v59 row_ror:2 row_mask:0xf bank_mask:0xf
    v_add_f32_dpp v124, v60, v60 row_ror:2 row_mask:0xf bank_mask:0xf
    v_add_f32_dpp v125, v61, v61 row_ror:2 row_mask:0xf bank_mask:0xf
    v_add_f32_dpp v126, v62, v62 row_ror:2 row_mask:0xf bank_mask:0xf
    v_add_f32_dpp v127, v63, v63 row_ror:2 row_mask:0xf bank_mask:0xf
    v_add_f32_dpp v48, v112, v112 row_ror:1 row_mask:0xf bank_mask:0xf
    v_add_f32_dpp v49, v113, v113 row_ror:1 row_mask:0xf bank_mask:0xf
    v_add_f32_dpp v50, v114, v114 row_ror:1 row_mask:0xf bank_mask:0xf
    v_add_f32_dpp v51, v115, v115 row_ror:1 row_mask:0xf bank_mask:0xf
    v_add_f32_dpp v52, v116, v116 row_ror:1 row_mask:0xf bank_mask:0xf
    v_add_f32_dpp v53, v117, v117 row_ror:1 row_mask:0xf bank_mask:0xf
    v_add_f32_dpp v54, v118, v118 row_ror:1 row_mask:0xf bank_mask:0xf
    v_add_f32_dpp v55, v119, v119 row_ror:1 row_mask:0xf bank_mask:0xf
    v_add_f32_dpp v56, v120, v120 row_ror:1 row_mask:0xf bank_mask:0xf
    v_add_f32_dpp v57, v121, v121 row_ror:1 row_mask:0xf bank_mask:0xf
    v_add_f32_dpp v58, v122, v122 row_ror:1 row_mask:0xf bank_mask:0xf
    v_add_f32_dpp v59, v123, v123 row_ror:1 row_mask:0xf bank_mask:0xf
    v_add_f32_dpp v60, v124, v124 row_ror:1 row_mask:0xf bank_mask:0xf
    v_add_f32_dpp v61, v125, v125 row_ror:1 row_mask:0xf bank_mask:0xf
    v_add_f32_dpp v62, v126, v126 row_ror:1 row_mask:0xf bank_mask:0xf
    v_add_f32_dpp v63, v127, v127 row_ror:1 row_mask:0xf bank_mask:0xf
    v_rcp_f32 v32, v32
    v_rcp_f32 v48, v48
    v_rcp_f32 v33, v33
    v_rcp_f32 v49, v49
    v_rcp_f32 v34, v34
    v_rcp_f32 v50, v50
    v_rcp_f32 v35, v35
    v_rcp_f32 v51, v51
    v_rcp_f32 v36, v36
    v_rcp_f32 v52, v52
    v_rcp_f32 v37, v37
    v_rcp_f32 v53, v53
    v_rcp_f32 v38, v38
    v_rcp_f32 v54, v54
    v_rcp_f32 v39, v39
    v_rcp_f32 v55, v55
    v_rcp_f32 v40, v40
    v_rcp_f32 v56, v56
    v_rcp_f32 v41, v41
    v_rcp_f32 v57, v57
    v_rcp_f32 v42, v42
    v_rcp_f32 v58, v58
    v_rcp_f32 v43, v43
    v_rcp_f32 v59, v59
    v_rcp_f32 v44, v44
    v_rcp_f32 v60, v60
    v_rcp_f32 v45, v45
    v_rcp_f32 v61, v61
    v_rcp_f32 v46, v46
    v_rcp_f32 v62, v62
    v_rcp_f32 v47, v47
    v_rcp_f32 v63, v63
    v_mul_f32 v128, v128, v32
    v_mul_f32 v160, v160, v48
    v_mul_f32 v132, v132, v32
    v_mul_f32 v164, v164, v48
    v_mul_f32 v129, v129, v33
    v_mul_f32 v161, v161, v49
    v_mul_f32 v133, v133, v33
    v_mul_f32 v165, v165, v49
    v_mul_f32 v130, v130, v34
    v_mul_f32 v162, v162, v50
    v_mul_f32 v134, v134, v34
    v_mul_f32 v166, v166, v50
    v_mul_f32 v131, v131, v35
    v_mul_f32 v163, v163, v51
    v_mul_f32 v135, v135, v35
    v_mul_f32 v167, v167, v51
    v_mul_f32 v136, v136, v36
    v_mul_f32 v168, v168, v52
    v_mul_f32 v140, v140, v36
    v_mul_f32 v172, v172, v52
    v_mul_f32 v137, v137, v37
    v_mul_f32 v169, v169, v53
    v_mul_f32 v141, v141, v37
    v_mul_f32 v173, v173, v53
    v_mul_f32 v138, v138, v38
    v_mul_f32 v170, v170, v54
    v_mul_f32 v142, v142, v38
    v_mul_f32 v174, v174, v54
    v_mul_f32 v139, v139, v39
    v_mul_f32 v171, v171, v55
    v_mul_f32 v143, v143, v39
    v_mul_f32 v175, v175, v55
    v_mul_f32 v144, v144, v40
    v_mul_f32 v176, v176, v56
    v_mul_f32 v148, v148, v40
    v_mul_f32 v180, v180, v56
    v_mul_f32 v145, v145, v41
    v_mul_f32 v177, v177, v57
    v_mul_f32 v149, v149, v41
    v_mul_f32 v181, v181, v57
    v_mul_f32 v146, v146, v42
    v_mul_f32 v178, v178, v58
    v_mul_f32 v150, v150, v42
    v_mul_f32 v182, v182, v58
    v_mul_f32 v147, v147, v43
    v_mul_f32 v179, v179, v59
    v_mul_f32 v151, v151, v43
    v_mul_f32 v183, v183, v59
    v_mul_f32 v152, v152, v44
    v_mul_f32 v184, v184, v60
    v_mul_f32 v156, v156, v44
    v_mul_f32 v188, v188, v60
    v_mul_f32 v153, v153, v45
    v_mul_f32 v185, v185, v61
    v_mul_f32 v157, v157, v45
    v_mul_f32 v189, v189, v61
    v_mul_f32 v154, v154, v46
    v_mul_f32 v186, v186, v62
    v_mul_f32 v158, v158, v46
    v_mul_f32 v190, v190, v62
    v_mul_f32 v155, v155, v47
    v_mul_f32 v187, v187, v63
    v_mul_f32 v159, v159, v47
    v_mul_f32 v191, v191, v63
    v_cvt_pk_bf16_f32 v80, v128, v129
    v_cvt_pk_bf16_f32 v81, v130, v131
    v_cvt_pk_bf16_f32 v82, v136, v137
    v_cvt_pk_bf16_f32 v83, v138, v139
    v_cvt_pk_bf16_f32 v84, v144, v145
    v_cvt_pk_bf16_f32 v85, v146, v147
    v_cvt_pk_bf16_f32 v86, v152, v153
    v_cvt_pk_bf16_f32 v87, v154, v155
    v_cvt_pk_bf16_f32 v88, v132, v133
    v_cvt_pk_bf16_f32 v89, v134, v135
    v_cvt_pk_bf16_f32 v90, v140, v141
    v_cvt_pk_bf16_f32 v91, v142, v143
    v_cvt_pk_bf16_f32 v92, v148, v149
    v_cvt_pk_bf16_f32 v93, v150, v151
    v_cvt_pk_bf16_f32 v94, v156, v157
    v_cvt_pk_bf16_f32 v95, v158, v159
    v_cvt_pk_bf16_f32 v96, v160, v161
    v_cvt_pk_bf16_f32 v97, v162, v163
    v_cvt_pk_bf16_f32 v98, v168, v169
    v_cvt_pk_bf16_f32 v99, v170, v171
    v_cvt_pk_bf16_f32 v100, v176, v177
    v_cvt_pk_bf16_f32 v101, v178, v179
    v_cvt_pk_bf16_f32 v102, v184, v185
    v_cvt_pk_bf16_f32 v103, v186, v187
    v_cvt_pk_bf16_f32 v104, v164, v165
    v_cvt_pk_bf16_f32 v105, v166, v167
    v_cvt_pk_bf16_f32 v106, v172, v173
    v_cvt_pk_bf16_f32 v107, v174, v175
    v_cvt_pk_bf16_f32 v108, v180, v181
    v_cvt_pk_bf16_f32 v109, v182, v183
    v_cvt_pk_bf16_f32 v110, v188, v189
    v_cvt_pk_bf16_f32 v111, v190, v191
    v_mov_b32 v112, 0x3f803f80
    v_mov_b32 v113, 0x3f803f80
    v_mov_b32 v114, 0x3f803f80
    v_mov_b32 v115, 0x3f803f80
    v_mfma_f32_16x16x32_bf16 v[128:131], v[80:83], v[64:67], 0
    v_mfma_f32_16x16x32_bf16 v[132:135], v[80:83], v[68:71], 0
    v_mfma_f32_16x16x32_bf16 v[160:163], v[80:83], v[112:115], 0
    v_mfma_f32_16x16x32_bf16 v[136:139], v[88:91], v[64:67], 0
    v_mfma_f32_16x16x32_bf16 v[140:143], v[88:91], v[68:71], 0
    v_mfma_f32_16x16x32_bf16 v[164:167], v[88:91], v[112:115], 0
    v_mfma_f32_16x16x32_bf16 v[144:147], v[96:99], v[64:67], 0
    v_mfma_f32_16x16x32_bf16 v[148:151], v[96:99], v[68:71], 0
    v_mfma_f32_16x16x32_bf16 v[168:171], v[96:99], v[112:115], 0
    v_mfma_f32_16x16x32_bf16 v[152:155], v[104:107], v[64:67], 0
    v_mfma_f32_16x16x32_bf16 v[156:159], v[104:107], v[68:71], 0
    v_mfma_f32_16x16x32_bf16 v[172:175], v[104:107], v[112:115], 0
    v_mfma_f32_16x16x32_bf16 v[128:131], v[84:87], v[72:75], v[128:131]
    v_mfma_f32_16x16x32_bf16 v[132:135], v[84:87], v[76:79], v[132:135]
    v_mfma_f32_16x16x32_bf16 v[160:163], v[84:87], v[112:115], v[160:163]
    v_mfma_f32_16x16x32_bf16 v[136:139], v[92:95], v[72:75], v[136:139]
    v_mfma_f32_16x16x32_bf16 v[140:143], v[92:95], v[76:79], v[140:143]
    v_mfma_f32_16x16x32_bf16 v[164:167], v[92:95], v[112:115], v[164:167]
    v_mfma_f32_16x16x32_bf16 v[144:147], v[100:103], v[72:75], v[144:147]
    v_mfma_f32_16x16x32_bf16 v[148:151], v[100:103], v[76:79], v[148:151]
    v_mfma_f32_16x16x32_bf16 v[168:171], v[100:103], v[112:115], v[168:171]
    v_mfma_f32_16x16x32_bf16 v[152:155], v[108:111], v[72:75], v[152:155]
    v_mfma_f32_16x16x32_bf16 v[156:159], v[108:111], v[76:79], v[156:159]
    v_mfma_f32_16x16x32_bf16 v[172:175], v[108:111], v[112:115], v[172:175]
    s_lshl_b32 s28, s22, 2
    s_add_u32 s28, s28, s21
    s_mul_i32 s28, s28, 12288
    v_add_u32 v23, s28, v31
    ds_write_b128 v23, v[128:131] offset:0
    ds_write_b128 v23, v[132:135] offset:1024
    ds_write_b128 v23, v[136:139] offset:2048
    ds_write_b128 v23, v[140:143] offset:3072
    ds_write_b128 v23, v[144:147] offset:4096
    ds_write_b128 v23, v[148:151] offset:5120
    ds_write_b128 v23, v[152:155] offset:6144
    ds_write_b128 v23, v[156:159] offset:7168
    ds_write_b128 v23, v[160:163] offset:8192
    ds_write_b128 v23, v[164:167] offset:9216
    ds_write_b128 v23, v[168:171] offset:10240
    ds_write_b128 v23, v[172:175] offset:11264
    s_mul_i32 s28, s22, 49152
    s_mul_i32 s29, s21, 3072
    s_add_u32 s28, s28, s29
    v_add_u32 v23, s28, v31
    s_waitcnt lgkmcnt(0)
    s_barrier
    ds_read_b128 v[32:35], v23 offset:0
    ds_read_b128 v[36:39], v23 offset:1024
    ds_read_b128 v[40:43], v23 offset:2048
    ds_read_b128 v[44:47], v23 offset:12288
    ds_read_b128 v[48:51], v23 offset:13312
    ds_read_b128 v[52:55], v23 offset:14336
    ds_read_b128 v[56:59], v23 offset:24576
    ds_read_b128 v[60:63], v23 offset:25600
    ds_read_b128 v[64:67], v23 offset:26624
    ds_read_b128 v[68:71], v23 offset:36864
    ds_read_b128 v[72:75], v23 offset:37888
    ds_read_b128 v[76:79], v23 offset:38912
    s_lshl_b32 s28, s33, 3
    s_add_u32 s28, s28, s24
    s_mul_i32 s28, s28, 8448
    v_lshlrev_b32 v24, 4, v15
    v_cmp_eq_u32 vcc, 0, v16
    s_nop 1
    s_waitcnt lgkmcnt(0)
    v_add_f32 v32, v32, v44
    v_add_f32 v56, v56, v68
    v_add_f32 v33, v33, v45
    v_add_f32 v57, v57, v69
    v_add_f32 v34, v34, v46
    v_add_f32 v58, v58, v70
    v_add_f32 v35, v35, v47
    v_add_f32 v59, v59, v71
    v_add_f32 v36, v36, v48
    v_add_f32 v60, v60, v72
    v_add_f32 v37, v37, v49
    v_add_f32 v61, v61, v73
    v_add_f32 v38, v38, v50
    v_add_f32 v62, v62, v74
    v_add_f32 v39, v39, v51
    v_add_f32 v63, v63, v75
    v_add_f32 v40, v40, v52
    v_add_f32 v64, v64, v76
    v_add_f32 v41, v41, v53
    v_add_f32 v65, v65, v77
    v_add_f32 v42, v42, v54
    v_add_f32 v66, v66, v78
    v_add_f32 v43, v43, v55
    v_add_f32 v67, v67, v79
    v_add_f32 v32, v32, v56
    v_add_f32 v33, v33, v57
    v_add_f32 v34, v34, v58
    v_add_f32 v35, v35, v59
    v_add_f32 v36, v36, v60
    v_add_f32 v37, v37, v61
    v_add_f32 v38, v38, v62
    v_add_f32 v39, v39, v63
    v_add_f32 v40, v40, v64
    v_add_f32 v41, v41, v65
    v_add_f32 v42, v42, v66
    v_add_f32 v43, v43, v67
    s_cmp_lg_u32 s21, 0
    s_cbranch_scc1 g1q_st0
    s_add_u32 s29, s28, 0
    buffer_store_dwordx4 v[32:35], v31, s[44:47], s29 offen sc1
    s_add_u32 s29, s28, 4096
    buffer_store_dwordx4 v[36:39], v31, s[44:47], s29 offen sc1
    s_add_u32 s29, s28, 1024
    buffer_store_dwordx4 v[40:43], v31, s[44:47], s29 offen sc1
g1q_st0:
    s_cmp_lg_u32 s21, 1
    s_cbranch_scc1 g1q_st1
    s_add_u32 s29, s28, 5120
    buffer_store_dwordx4 v[32:35], v31, s[44:47], s29 offen sc1
    s_add_u32 s29, s28, 2048
    buffer_store_dwordx4 v[36:39], v31, s[44:47], s29 offen sc1
    s_add_u32 s29, s28, 6144
    buffer_store_dwordx4 v[40:43], v31, s[44:47], s29 offen sc1
g1q_st1:
    s_cmp_lg_u32 s21, 2
    s_cbranch_scc1 g1q_st2
    s_add_u32 s29, s28, 3072
    buffer_store_dwordx4 v[32:35], v31, s[44:47], s29 offen sc1
    s_add_u32 s29, s28, 7168
    buffer_store_dwordx4 v[36:39], v31, s[44:47], s29 offen sc1
    s_add_u32 s29, s28, 8192
    s_and_saveexec_b64 s[34:35], vcc
    buffer_store_dwordx4 v[40:43], v24, s[44:47], s29 offen sc1
    s_mov_b64 exec, s[34:35]
g1q_st2:
    s_cmp_lg_u32 s21, 3
    s_cbranch_scc1 g1q_st3
    s_add_u32 s29, s28, 8256
    s_and_saveexec_b64 s[34:35], vcc
    buffer_store_dwordx4 v[32:35], v24, s[44:47], s29 offen sc1
    s_mov_b64 exec, s[34:35]
    s_add_u32 s29, s28, 8320
    s_and_saveexec_b64 s[34:35], vcc
    buffer_store_dwordx4 v[36:39], v24, s[44:47], s29 offen sc1
    s_mov_b64 exec, s[34:35]
    s_add_u32 s29, s28, 8384
    s_and_saveexec_b64 s[34:35], vcc
    buffer_store_dwordx4 v[40:43], v24, s[44:47], s29 offen sc1
    s_mov_b64 exec, s[34:35]
g1q_st3:
g1q_end:
    s_waitcnt vmcnt(0)
    s_barrier
    s_add_u32 s28, s25, 16
    s_lshl_b32 s28, s28, 7
    s_add_u32 s28, s28, 0x200000
    v_mov_b32 v17, 0
    v_mov_b32 v18, 1
    v_cmp_eq_u32 vcc, 0, v0
    s_nop 1
    s_and_saveexec_b64 s[34:35], vcc
    buffer_atomic_add v18, v17, s[92:95], s28 offen sc1
    s_mov_b64 exec, s[34:35]
    s_branch g12_p2
g1_w1:
    v_lshrrev_b32 v17, 2, v16
    v_lshl_add_u32 v18, v15, 3, v17
    v_lshrrev_b32 v19, 1, v17
    v_and_b32 v20, 1, v15
    v_lshl_or_b32 v19, v20, 1, v19
    v_and_b32 v21, 3, v14
    v_lshlrev_b32 v21, 3, v21
    v_lshl_add_u32 v22, v18, 7, v21
    v_add_u32 v22, 0x18000, v22
    s_add_u32 s28, s22, 0
    v_xor_b32 v23, s28, v19
    v_lshl_add_u32 v8, v23, 5, v22
    s_add_u32 s28, s22, 2
    v_xor_b32 v23, s28, v19
    v_lshl_add_u32 v9, v23, 5, v22
    v_xor_b32 v23, s22, v20
    v_lshl_add_u32 v24, v18, 6, v21
    v_lshl_add_u32 v24, v23, 5, v24
    v_add_u32 v10, 0x1b000, v24
    v_lshrrev_b32 v17, 3, v14
    v_bfe_u32 v18, v14, 4, 1
    s_and_b32 s28, s20, 1
    s_lshl_b32 s28, s28, 1
    v_or_b32 v18, s28, v18
    v_bfe_u32 v19, v14, 1, 2
    v_xor_b32 v19, v19, v18
    v_and_b32 v20, 1, v14
    v_lshlrev_b32 v20, 4, v20
    v_lshl_add_u32 v20, v19, 5, v20
    s_and_b32 s28, s20, 3
    s_lshl_b32 s28, s28, 3
    v_add_u32 v17, s28, v17
    s_mov_b32 s29, 7168
    v_mul_lo_u32 v17, v17, s29
    v_add_u32 v17, v17, v20
    s_lshr_b32 s28, s20, 2
    s_mul_i32 s28, s28, 128
    s_sub_u32 s32, s25, 16
    s_mul_i32 s32, s32, 448
    s_add_u32 s28, s28, s32
    v_add_u32 v12, s28, v17
    v_add_u32 v13, 0x100, v12
    v_lshrrev_b32 v17, 2, v14
    s_sub_u32 s28, s20, 4
    s_lshl_b32 s28, s28, 4
    v_add_u32 v17, s28, v17
    v_mul_lo_u32 v17, v17, s29
    v_bfe_u32 v18, v14, 5, 1
    v_bfe_u32 v19, v14, 1, 1
    v_xor_b32 v19, v19, v18
    v_and_b32 v20, 1, v14
    v_lshlrev_b32 v20, 4, v20
    v_lshl_add_u32 v20, v19, 5, v20
    v_add_u32 v17, v17, v20
    s_add_u32 s28, s32, 384
    v_add_u32 v17, s28, v17
    s_cmp_ge_u32 s20, 4
    s_cselect_b64 s[34:35], -1, 0
    v_cndmask_b32 v13, v13, v17, s[34:35]
    s_waitcnt lgkmcnt(0)
    s_mov_b32 s8, s4
    s_mov_b32 s9, s5
    s_and_b32 s9, s9, 0xffff
    s_mov_b32 s10, 0x400000
    s_mov_b32 s11, 0x00020000
    s_mov_b32 s12, s58
    s_mov_b32 s13, s59
    s_and_b32 s13, s13, 0xffff
    s_mov_b32 s14, 0x700000
    s_mov_b32 s15, 0x00020000
    s_mov_b32 s40, s60
    s_mov_b32 s41, s61
    s_and_b32 s41, s41, 0xffff
    s_mov_b32 s42, 0x1c00
    s_mov_b32 s43, 0x00020000
    s_lshl_b32 s28, s22, 5
    v_lshl_add_u32 v17, v15, 3, s28
    buffer_load_dwordx2 v[240:241], v17, s[40:43], s32 offen offset:0
    buffer_load_dwordx2 v[242:243], v17, s[40:43], s32 offen offset:64
    buffer_load_dwordx2 v[244:245], v17, s[40:43], s32 offen offset:128
    buffer_load_dwordx2 v[246:247], v17, s[40:43], s32 offen offset:192
    buffer_load_dwordx2 v[248:249], v17, s[40:43], s32 offen offset:256
    buffer_load_dwordx2 v[250:251], v17, s[40:43], s32 offen offset:320
    buffer_load_dwordx2 v[252:253], v17, s[40:43], s32 offen offset:384
    s_add_u32 m0, s30, 0x0
    s_mov_b32 s28, 0x0
    buffer_load_dwordx4 v11, s[8:11], s28 offen lds
    s_add_u32 m0, s30, 0x400
    s_mov_b32 s28, 0x4000
    buffer_load_dwordx4 v11, s[8:11], s28 offen lds
    s_add_u32 m0, s30, 0x800
    s_mov_b32 s28, 0x8000
    buffer_load_dwordx4 v11, s[8:11], s28 offen lds
    s_add_u32 m0, s30, 0xc00
    s_mov_b32 s28, 0xc000
    buffer_load_dwordx4 v11, s[8:11], s28 offen lds
    s_add_u32 m0, s31, 0x18000
    s_mov_b32 s28, 0x0
    buffer_load_dwordx4 v12, s[12:15], s28 offen lds
    s_cmp_ge_u32 s20, 6
    s_cbranch_scc1 g1w1_sk0
    s_add_u32 m0, s31, 0x1a000
    s_mov_b32 s28, 0x0
    s_nop 0
    buffer_load_dwordx4 v13, s[12:15], s28 offen lds
g1w1_sk0:
    s_add_u32 m0, s31, 0x1b800
    s_mov_b32 s28, 0x38000
    buffer_load_dwordx4 v12, s[12:15], s28 offen lds
    s_cmp_ge_u32 s20, 6
    s_cbranch_scc1 g1w1_sk1
    s_add_u32 m0, s31, 0x1d800
    s_mov_b32 s28, 0x38000
    s_nop 0
    buffer_load_dwordx4 v13, s[12:15], s28 offen lds
g1w1_sk1:
    s_add_u32 m0, s30, 0x8000
    s_mov_b32 s28, 0x80
    buffer_load_dwordx4 v11, s[8:11], s28 offen lds
    s_add_u32 m0, s30, 0x8400
    s_mov_b32 s28, 0x4080
    buffer_load_dwordx4 v11, s[8:11], s28 offen lds
    s_add_u32 m0, s30, 0x8800
    s_mov_b32 s28, 0x8080
    buffer_load_dwordx4 v11, s[8:11], s28 offen lds
    s_add_u32 m0, s30, 0x8c00
    s_mov_b32 s28, 0xc080
    buffer_load_dwordx4 v11, s[8:11], s28 offen lds
    s_add_u32 m0, s31, 0x1f000
    s_mov_b32 s28, 0x70000
    buffer_load_dwordx4 v12, s[12:15], s28 offen lds
    s_cmp_ge_u32 s20, 6
    s_cbranch_scc1 g1w1_sk2
    s_add_u32 m0, s31, 0x21000
    s_mov_b32 s28, 0x70000
    s_nop 0
    buffer_load_dwordx4 v13, s[12:15], s28 offen lds
g1w1_sk2:
    s_add_u32 m0, s31, 0x22800
    s_mov_b32 s28, 0xa8000
    buffer_load_dwordx4 v12, s[12:15], s28 offen lds
    s_cmp_ge_u32 s20, 6
    s_cbranch_scc1 g1w1_sk3
    s_add_u32 m0, s31, 0x24800
    s_mov_b32 s28, 0xa8000
    s_nop 0
    buffer_load_dwordx4 v13, s[12:15], s28 offen lds
g1w1_sk3:
    s_add_u32 m0, s30, 0x10000
    s_mov_b32 s28, 0x100
    buffer_load_dwordx4 v11, s[8:11], s28 offen lds
    s_add_u32 m0, s30, 0x10400
    s_mov_b32 s28, 0x4100
    buffer_load_dwordx4 v11, s[8:11], s28 offen lds
    s_add_u32 m0, s30, 0x10800
    s_mov_b32 s28, 0x8100
    buffer_load_dwordx4 v11, s[8:11], s28 offen lds
    s_add_u32 m0, s30, 0x10c00
    s_mov_b32 s28, 0xc100
    buffer_load_dwordx4 v11, s[8:11], s28 offen lds
    s_add_u32 s16, s4, 0x400000
    s_addc_u32 s17, s5, 0
    s_and_b32 s17, s17, 0xffff
    s_mov_b32 s18, 0x1200000
    s_mov_b32 s19, 0x00020000
    s_mov_b32 s64, s72
    s_mov_b32 s65, s73
    s_and_b32 s65, s65, 0xffff
    s_mov_b32 s66, 0x200000
    s_mov_b32 s67, 0x00020000
    s_mov_b32 s68, s74
    s_mov_b32 s69, s75
    s_and_b32 s69, s69, 0xffff
    s_mov_b32 s70, 0x700000
    s_mov_b32 s71, 0x00020000
    s_add_u32 s92, s4, 0x2a00000
    s_addc_u32 s93, s5, 0
    s_and_b32 s93, s93, 0xffff
    s_mov_b32 s94, 0x300000
    s_mov_b32 s95, 0x00020000
    s_lshl_b32 s28, s2, 3
    s_add_u32 s28, s28, s20
    s_cmp_lt_u32 s28, 1024
    s_cselect_b32 s88, s6, s58
    s_cselect_b32 s89, s7, s59
    s_mov_b32 s90, 0x700000
    s_cselect_b32 s90, 0x600000, s90
    s_cselect_b32 s29, 0xc0000, 0
    s_cselect_b32 s91, 0, 0xe0000
    s_add_u32 s29, s29, s91
    s_and_b32 s89, s89, 0xffff
    s_mov_b32 s91, 0x00020000
    s_and_b32 s28, s28, 1023
    s_lshl_b32 s28, s28, 10
    s_add_u32 s28, s28, s29
    v_add_u32 v30, s28, v31
    s_waitcnt vmcnt(16)
    s_mov_b32 s50, 0xffff0000
    v_lshlrev_b32 v128, 16, v240
    v_and_b32 v129, s50, v240
    v_lshlrev_b32 v130, 16, v241
    v_and_b32 v131, s50, v241
    v_lshlrev_b32 v132, 16, v240
    v_and_b32 v133, s50, v240
    v_lshlrev_b32 v134, 16, v241
    v_and_b32 v135, s50, v241
    v_lshlrev_b32 v136, 16, v240
    v_and_b32 v137, s50, v240
    v_lshlrev_b32 v138, 16, v241
    v_and_b32 v139, s50, v241
    v_lshlrev_b32 v140, 16, v240
    v_and_b32 v141, s50, v240
    v_lshlrev_b32 v142, 16, v241
    v_and_b32 v143, s50, v241
    v_lshlrev_b32 v144, 16, v242
    v_and_b32 v145, s50, v242
    v_lshlrev_b32 v146, 16, v243
    v_and_b32 v147, s50, v243
    v_lshlrev_b32 v148, 16, v242
    v_and_b32 v149, s50, v242
    v_lshlrev_b32 v150, 16, v243
    v_and_b32 v151, s50, v243
    v_lshlrev_b32 v152, 16, v242
    v_and_b32 v153, s50, v242
    v_lshlrev_b32 v154, 16, v243
    v_and_b32 v155, s50, v243
    v_lshlrev_b32 v156, 16, v242
    v_and_b32 v157, s50, v242
    v_lshlrev_b32 v158, 16, v243
    v_and_b32 v159, s50, v243
    v_lshlrev_b32 v160, 16, v244
    v_and_b32 v161, s50, v244
    v_lshlrev_b32 v162, 16, v245
    v_and_b32 v163, s50, v245
    v_lshlrev_b32 v164, 16, v244
    v_and_b32 v165, s50, v244
    v_lshlrev_b32 v166, 16, v245
    v_and_b32 v167, s50, v245
    v_lshlrev_b32 v168, 16, v244
    v_and_b32 v169, s50, v244
    v_lshlrev_b32 v170, 16, v245
    v_and_b32 v171, s50, v245
    v_lshlrev_b32 v172, 16, v244
    v_and_b32 v173, s50, v244
    v_lshlrev_b32 v174, 16, v245
    v_and_b32 v175, s50, v245
    v_lshlrev_b32 v176, 16, v246
    v_and_b32 v177, s50, v246
    v_lshlrev_b32 v178, 16, v247
    v_and_b32 v179, s50, v247
    v_lshlrev_b32 v180, 16, v246
    v_and_b32 v181, s50, v246
    v_lshlrev_b32 v182, 16, v247
    v_and_b32 v183, s50, v247
    v_lshlrev_b32 v184, 16, v246
    v_and_b32 v185, s50, v246
    v_lshlrev_b32 v186, 16, v247
    v_and_b32 v187, s50, v247
    v_lshlrev_b32 v188, 16, v246
    v_and_b32 v189, s50, v246
    v_lshlrev_b32 v190, 16, v247
    v_and_b32 v191, s50, v247
    v_lshlrev_b32 v192, 16, v248
    v_and_b32 v193, s50, v248
    v_lshlrev_b32 v194, 16, v249
    v_and_b32 v195, s50, v249
    v_lshlrev_b32 v196, 16, v248
    v_and_b32 v197, s50, v248
    v_lshlrev_b32 v198, 16, v249
    v_and_b32 v199, s50, v249
    v_lshlrev_b32 v200, 16, v248
    v_and_b32 v201, s50, v248
    v_lshlrev_b32 v202, 16, v249
    v_and_b32 v203, s50, v249
    v_lshlrev_b32 v204, 16, v248
    v_and_b32 v205, s50, v248
    v_lshlrev_b32 v206, 16, v249
    v_and_b32 v207, s50, v249
    v_lshlrev_b32 v208, 16, v250
    v_and_b32 v209, s50, v250
    v_lshlrev_b32 v210, 16, v251
    v_and_b32 v211, s50, v251
    v_lshlrev_b32 v212, 16, v250
    v_and_b32 v213, s50, v250
    v_lshlrev_b32 v214, 16, v251
    v_and_b32 v215, s50, v251
    v_lshlrev_b32 v216, 16, v250
    v_and_b32 v217, s50, v250
    v_lshlrev_b32 v218, 16, v251
    v_and_b32 v219, s50, v251
    v_lshlrev_b32 v220, 16, v250
    v_and_b32 v221, s50, v250
    v_lshlrev_b32 v222, 16, v251
    v_and_b32 v223, s50, v251
    v_lshlrev_b32 v224, 16, v252
    v_and_b32 v225, s50, v252
    v_lshlrev_b32 v226, 16, v253
    v_and_b32 v227, s50, v253
    v_lshlrev_b32 v228, 16, v252
    v_and_b32 v229, s50, v252
    v_lshlrev_b32 v230, 16, v253
    v_and_b32 v231, s50, v253
    v_lshlrev_b32 v232, 16, v252
    v_and_b32 v233, s50, v252
    v_lshlrev_b32 v234, 16, v253
    v_and_b32 v235, s50, v253
    v_lshlrev_b32 v236, 16, v252
    v_and_b32 v237, s50, v252
    v_lshlrev_b32 v238, 16, v253
    v_and_b32 v239, s50, v253
    s_waitcnt vmcnt(11)
    s_barrier
    ds_read_b128 v[32:35], v2 offset:0
    ds_read_b128 v[36:39], v2 offset:2048
    ds_read_b128 v[40:43], v2 offset:4096
    ds_read_b128 v[44:47], v2 offset:6144
    ds_read_b64_tr_b16 v[48:49], v8 offset:0
    ds_read_b64_tr_b16 v[50:51], v8 offset:512
    ds_read_b64_tr_b16 v[52:53], v9 offset:0
    ds_read_b64_tr_b16 v[54:55], v9 offset:512
    ds_read_b64_tr_b16 v[56:57], v8 offset:4096
    ds_read_b64_tr_b16 v[58:59], v8 offset:4608
    ds_read_b64_tr_b16 v[60:61], v9 offset:4096
    ds_read_b64_tr_b16 v[62:63], v9 offset:4608
    ds_read_b64_tr_b16 v[64:65], v8 offset:8192
    ds_read_b64_tr_b16 v[66:67], v8 offset:8704
    ds_read_b64_tr_b16 v[68:69], v9 offset:8192
    ds_read_b64_tr_b16 v[70:71], v9 offset:8704
    ds_read_b64_tr_b16 v[72:73], v10 offset:0
    ds_read_b64_tr_b16 v[74:75], v10 offset:256
    s_waitcnt lgkmcnt(0)
    s_waitcnt vmcnt(10)
    s_barrier
    v_mfma_f32_16x16x32_bf16 v[128:131], v[48:51], v[32:35], v[128:131]
    ds_read_b128 v[76:79], v3 offset:0
    v_mfma_f32_16x16x32_bf16 v[132:135], v[48:51], v[36:39], v[132:135]
    s_add_u32 m0, s31, 0x18000
    s_mov_b32 s28, 0xe0000
    buffer_load_dwordx4 v12, s[12:15], s28 offen lds
    v_mfma_f32_16x16x32_bf16 v[136:139], v[48:51], v[40:43], v[136:139]
    ds_read_b128 v[80:83], v3 offset:2048
    v_mfma_f32_16x16x32_bf16 v[140:143], v[48:51], v[44:47], v[140:143]
    ds_read_b128 v[84:87], v3 offset:4096
    v_mfma_f32_16x16x32_bf16 v[144:147], v[52:55], v[32:35], v[144:147]
    ds_read_b128 v[88:91], v3 offset:6144
    v_mfma_f32_16x16x32_bf16 v[148:151], v[52:55], v[36:39], v[148:151]
    s_cmp_ge_u32 s20, 6
    s_cbranch_scc1 g1w1_sk4
    s_add_u32 m0, s31, 0x1a000
    s_mov_b32 s28, 0xe0000
    s_nop 0
    buffer_load_dwordx4 v13, s[12:15], s28 offen lds
g1w1_sk4:
    v_mfma_f32_16x16x32_bf16 v[152:155], v[52:55], v[40:43], v[152:155]
    ds_read_b64_tr_b16 v[92:93], v8 offset:14336
    v_mfma_f32_16x16x32_bf16 v[156:159], v[52:55], v[44:47], v[156:159]
    ds_read_b64_tr_b16 v[94:95], v8 offset:14848
    v_mfma_f32_16x16x32_bf16 v[160:163], v[56:59], v[32:35], v[160:163]
    ds_read_b64_tr_b16 v[96:97], v9 offset:14336
    v_mfma_f32_16x16x32_bf16 v[164:167], v[56:59], v[36:39], v[164:167]
    s_add_u32 m0, s77, 0x26000
    s_mov_b32 s28, 0x0
    buffer_load_dwordx4 v30, s[88:91], s28 offen lds
    v_mfma_f32_16x16x32_bf16 v[168:171], v[56:59], v[40:43], v[168:171]
    ds_read_b64_tr_b16 v[98:99], v9 offset:14848
    v_mfma_f32_16x16x32_bf16 v[172:175], v[56:59], v[44:47], v[172:175]
    ds_read_b64_tr_b16 v[100:101], v8 offset:18432
    v_mfma_f32_16x16x32_bf16 v[176:179], v[60:63], v[32:35], v[176:179]
    ds_read_b64_tr_b16 v[102:103], v8 offset:18944
    v_mfma_f32_16x16x32_bf16 v[180:183], v[60:63], v[36:39], v[180:183]
    ds_read_b64_tr_b16 v[104:105], v9 offset:18432
    v_mfma_f32_16x16x32_bf16 v[184:187], v[60:63], v[40:43], v[184:187]
    ds_read_b64_tr_b16 v[106:107], v9 offset:18944
    v_mfma_f32_16x16x32_bf16 v[188:191], v[60:63], v[44:47], v[188:191]
    ds_read_b64_tr_b16 v[108:109], v8 offset:22528
    v_mfma_f32_16x16x32_bf16 v[192:195], v[64:67], v[32:35], v[192:195]
    ds_read_b64_tr_b16 v[110:111], v8 offset:23040
    v_mfma_f32_16x16x32_bf16 v[196:199], v[64:67], v[36:39], v[196:199]
    ds_read_b64_tr_b16 v[112:113], v9 offset:22528
    v_mfma_f32_16x16x32_bf16 v[200:203], v[64:67], v[40:43], v[200:203]
    ds_read_b64_tr_b16 v[114:115], v9 offset:23040
    v_mfma_f32_16x16x32_bf16 v[204:207], v[64:67], v[44:47], v[204:207]
    ds_read_b64_tr_b16 v[116:117], v10 offset:14336
    v_mfma_f32_16x16x32_bf16 v[208:211], v[68:71], v[32:35], v[208:211]
    ds_read_b64_tr_b16 v[118:119], v10 offset:14592
    v_mfma_f32_16x16x32_bf16 v[212:215], v[68:71], v[36:39], v[212:215]
    v_mfma_f32_16x16x32_bf16 v[216:219], v[68:71], v[40:43], v[216:219]
    v_mfma_f32_16x16x32_bf16 v[220:223], v[68:71], v[44:47], v[220:223]
    v_mfma_f32_16x16x32_bf16 v[224:227], v[72:75], v[32:35], v[224:227]
    v_mfma_f32_16x16x32_bf16 v[228:231], v[72:75], v[36:39], v[228:231]
    v_mfma_f32_16x16x32_bf16 v[232:235], v[72:75], v[40:43], v[232:235]
    v_mfma_f32_16x16x32_bf16 v[236:239], v[72:75], v[44:47], v[236:239]
    s_waitcnt lgkmcnt(0)
    s_waitcnt vmcnt(6)
    s_barrier
    v_mfma_f32_16x16x32_bf16 v[128:131], v[92:95], v[76:79], v[128:131]
    ds_read_b128 v[32:35], v4 offset:0
    v_mfma_f32_16x16x32_bf16 v[132:135], v[92:95], v[80:83], v[132:135]
    s_add_u32 m0, s31, 0x1b800
    s_mov_b32 s28, 0x118000
    buffer_load_dwordx4 v12, s[12:15], s28 offen lds
    v_mfma_f32_16x16x32_bf16 v[136:139], v[92:95], v[84:87], v[136:139]
    ds_read_b128 v[36:39], v4 offset:2048
    v_mfma_f32_16x16x32_bf16 v[140:143], v[92:95], v[88:91], v[140:143]
    ds_read_b128 v[40:43], v4 offset:4096
    v_mfma_f32_16x16x32_bf16 v[144:147], v[96:99], v[76:79], v[144:147]
    ds_read_b128 v[44:47], v4 offset:6144
    v_mfma_f32_16x16x32_bf16 v[148:151], v[96:99], v[80:83], v[148:151]
    s_cmp_ge_u32 s20, 6
    s_cbranch_scc1 g1w1_sk5
    s_add_u32 m0, s31, 0x1d800
    s_mov_b32 s28, 0x118000
    s_nop 0
    buffer_load_dwordx4 v13, s[12:15], s28 offen lds
g1w1_sk5:
    v_mfma_f32_16x16x32_bf16 v[152:155], v[96:99], v[84:87], v[152:155]
    ds_read_b64_tr_b16 v[48:49], v8 offset:28672
    v_mfma_f32_16x16x32_bf16 v[156:159], v[96:99], v[88:91], v[156:159]
    ds_read_b64_tr_b16 v[50:51], v8 offset:29184
    v_mfma_f32_16x16x32_bf16 v[160:163], v[100:103], v[76:79], v[160:163]
    ds_read_b64_tr_b16 v[52:53], v9 offset:28672
    v_mfma_f32_16x16x32_bf16 v[164:167], v[100:103], v[80:83], v[164:167]
    s_add_u32 m0, s30, 0x0
    s_mov_b32 s28, 0x180
    buffer_load_dwordx4 v11, s[8:11], s28 offen lds
    v_mfma_f32_16x16x32_bf16 v[168:171], v[100:103], v[84:87], v[168:171]
    ds_read_b64_tr_b16 v[54:55], v9 offset:29184
    v_mfma_f32_16x16x32_bf16 v[172:175], v[100:103], v[88:91], v[172:175]
    ds_read_b64_tr_b16 v[56:57], v8 offset:32768
    v_mfma_f32_16x16x32_bf16 v[176:179], v[104:107], v[76:79], v[176:179]
    ds_read_b64_tr_b16 v[58:59], v8 offset:33280
    v_mfma_f32_16x16x32_bf16 v[180:183], v[104:107], v[80:83], v[180:183]
    s_add_u32 m0, s30, 0x400
    s_mov_b32 s28, 0x4180
    buffer_load_dwordx4 v11, s[8:11], s28 offen lds
    v_mfma_f32_16x16x32_bf16 v[184:187], v[104:107], v[84:87], v[184:187]
    ds_read_b64_tr_b16 v[60:61], v9 offset:32768
    v_mfma_f32_16x16x32_bf16 v[188:191], v[104:107], v[88:91], v[188:191]
    ds_read_b64_tr_b16 v[62:63], v9 offset:33280
    v_mfma_f32_16x16x32_bf16 v[192:195], v[108:111], v[76:79], v[192:195]
    ds_read_b64_tr_b16 v[64:65], v8 offset:36864
    v_mfma_f32_16x16x32_bf16 v[196:199], v[108:111], v[80:83], v[196:199]
    s_add_u32 m0, s30, 0x800
    s_mov_b32 s28, 0x8180
    buffer_load_dwordx4 v11, s[8:11], s28 offen lds
    v_mfma_f32_16x16x32_bf16 v[200:203], v[108:111], v[84:87], v[200:203]
    ds_read_b64_tr_b16 v[66:67], v8 offset:37376
    v_mfma_f32_16x16x32_bf16 v[204:207], v[108:111], v[88:91], v[204:207]
    ds_read_b64_tr_b16 v[68:69], v9 offset:36864
    v_mfma_f32_16x16x32_bf16 v[208:211], v[112:115], v[76:79], v[208:211]
    ds_read_b64_tr_b16 v[70:71], v9 offset:37376
    v_mfma_f32_16x16x32_bf16 v[212:215], v[112:115], v[80:83], v[212:215]
    s_add_u32 m0, s30, 0xc00
    s_mov_b32 s28, 0xc180
    buffer_load_dwordx4 v11, s[8:11], s28 offen lds
    v_mfma_f32_16x16x32_bf16 v[216:219], v[112:115], v[84:87], v[216:219]
    ds_read_b64_tr_b16 v[72:73], v10 offset:28672
    v_mfma_f32_16x16x32_bf16 v[220:223], v[112:115], v[88:91], v[220:223]
    ds_read_b64_tr_b16 v[74:75], v10 offset:28928
    v_mfma_f32_16x16x32_bf16 v[224:227], v[116:119], v[76:79], v[224:227]
    s_add_u32 m0, s77, 0x26000
    s_mov_b32 s28, 0x100000
    buffer_load_dwordx4 v30, s[88:91], s28 offen lds
    v_mfma_f32_16x16x32_bf16 v[228:231], v[116:119], v[80:83], v[228:231]
    v_mfma_f32_16x16x32_bf16 v[232:235], v[116:119], v[84:87], v[232:235]
    v_mfma_f32_16x16x32_bf16 v[236:239], v[116:119], v[88:91], v[236:239]
    s_waitcnt lgkmcnt(0)
    s_waitcnt vmcnt(10)
    s_barrier
    v_mfma_f32_16x16x32_bf16 v[128:131], v[48:51], v[32:35], v[128:131]
    ds_read_b128 v[76:79], v5 offset:0
    v_mfma_f32_16x16x32_bf16 v[132:135], v[48:51], v[36:39], v[132:135]
    s_add_u32 m0, s31, 0x1f000
    s_mov_b32 s28, 0x150000
    buffer_load_dwordx4 v12, s[12:15], s28 offen lds
    v_mfma_f32_16x16x32_bf16 v[136:139], v[48:51], v[40:43], v[136:139]
    ds_read_b128 v[80:83], v5 offset:2048
    v_mfma_f32_16x16x32_bf16 v[140:143], v[48:51], v[44:47], v[140:143]
    ds_read_b128 v[84:87], v5 offset:4096
    v_mfma_f32_16x16x32_bf16 v[144:147], v[52:55], v[32:35], v[144:147]
    ds_read_b128 v[88:91], v5 offset:6144
    v_mfma_f32_16x16x32_bf16 v[148:151], v[52:55], v[36:39], v[148:151]
    s_cmp_ge_u32 s20, 6
    s_cbranch_scc1 g1w1_sk6
    s_add_u32 m0, s31, 0x21000
    s_mov_b32 s28, 0x150000
    s_nop 0
    buffer_load_dwordx4 v13, s[12:15], s28 offen lds
g1w1_sk6:
    v_mfma_f32_16x16x32_bf16 v[152:155], v[52:55], v[40:43], v[152:155]
    ds_read_b64_tr_b16 v[92:93], v8 offset:43008
    v_mfma_f32_16x16x32_bf16 v[156:159], v[52:55], v[44:47], v[156:159]
    ds_read_b64_tr_b16 v[94:95], v8 offset:43520
    v_mfma_f32_16x16x32_bf16 v[160:163], v[56:59], v[32:35], v[160:163]
    ds_read_b64_tr_b16 v[96:97], v9 offset:43008
    v_mfma_f32_16x16x32_bf16 v[164:167], v[56:59], v[36:39], v[164:167]
    ds_read_b64_tr_b16 v[98:99], v9 offset:43520
    v_mfma_f32_16x16x32_bf16 v[168:171], v[56:59], v[40:43], v[168:171]
    ds_read_b64_tr_b16 v[100:101], v8 offset:47104
    v_mfma_f32_16x16x32_bf16 v[172:175], v[56:59], v[44:47], v[172:175]
    ds_read_b64_tr_b16 v[102:103], v8 offset:47616
    v_mfma_f32_16x16x32_bf16 v[176:179], v[60:63], v[32:35], v[176:179]
    ds_read_b64_tr_b16 v[104:105], v9 offset:47104
    v_mfma_f32_16x16x32_bf16 v[180:183], v[60:63], v[36:39], v[180:183]
    ds_read_b64_tr_b16 v[106:107], v9 offset:47616
    v_mfma_f32_16x16x32_bf16 v[184:187], v[60:63], v[40:43], v[184:187]
    ds_read_b64_tr_b16 v[108:109], v8 offset:51200
    v_mfma_f32_16x16x32_bf16 v[188:191], v[60:63], v[44:47], v[188:191]
    ds_read_b64_tr_b16 v[110:111], v8 offset:51712
    v_mfma_f32_16x16x32_bf16 v[192:195], v[64:67], v[32:35], v[192:195]
    ds_read_b64_tr_b16 v[112:113], v9 offset:51200
    v_mfma_f32_16x16x32_bf16 v[196:199], v[64:67], v[36:39], v[196:199]
    ds_read_b64_tr_b16 v[114:115], v9 offset:51712
    v_mfma_f32_16x16x32_bf16 v[200:203], v[64:67], v[40:43], v[200:203]
    ds_read_b64_tr_b16 v[116:117], v10 offset:43008
    v_mfma_f32_16x16x32_bf16 v[204:207], v[64:67], v[44:47], v[204:207]
    ds_read_b64_tr_b16 v[118:119], v10 offset:43264
    v_mfma_f32_16x16x32_bf16 v[208:211], v[68:71], v[32:35], v[208:211]
    v_mfma_f32_16x16x32_bf16 v[212:215], v[68:71], v[36:39], v[212:215]
    v_mfma_f32_16x16x32_bf16 v[216:219], v[68:71], v[40:43], v[216:219]
    v_mfma_f32_16x16x32_bf16 v[220:223], v[68:71], v[44:47], v[220:223]
    v_mfma_f32_16x16x32_bf16 v[224:227], v[72:75], v[32:35], v[224:227]
    v_mfma_f32_16x16x32_bf16 v[228:231], v[72:75], v[36:39], v[228:231]
    v_mfma_f32_16x16x32_bf16 v[232:235], v[72:75], v[40:43], v[232:235]
    v_mfma_f32_16x16x32_bf16 v[236:239], v[72:75], v[44:47], v[236:239]
    s_waitcnt lgkmcnt(0)
    s_waitcnt vmcnt(6)
    s_barrier
    v_mfma_f32_16x16x32_bf16 v[128:131], v[92:95], v[76:79], v[128:131]
    ds_read_b128 v[32:35], v6 offset:0
    v_mfma_f32_16x16x32_bf16 v[132:135], v[92:95], v[80:83], v[132:135]
    s_add_u32 m0, s31, 0x22800
    s_mov_b32 s28, 0x188000
    buffer_load_dwordx4 v12, s[12:15], s28 offen lds
    v_mfma_f32_16x16x32_bf16 v[136:139], v[92:95], v[84:87], v[136:139]
    ds_read_b128 v[36:39], v6 offset:2048
    v_mfma_f32_16x16x32_bf16 v[140:143], v[92:95], v[88:91], v[140:143]
    ds_read_b128 v[40:43], v6 offset:4096
    v_mfma_f32_16x16x32_bf16 v[144:147], v[96:99], v[76:79], v[144:147]
    ds_read_b128 v[44:47], v6 offset:6144
    v_mfma_f32_16x16x32_bf16 v[148:151], v[96:99], v[80:83], v[148:151]
    s_cmp_ge_u32 s20, 6
    s_cbranch_scc1 g1w1_sk7
    s_add_u32 m0, s31, 0x24800
    s_mov_b32 s28, 0x188000
    s_nop 0
    buffer_load_dwordx4 v13, s[12:15], s28 offen lds
g1w1_sk7:
    v_mfma_f32_16x16x32_bf16 v[152:155], v[96:99], v[84:87], v[152:155]
    ds_read_b64_tr_b16 v[48:49], v8 offset:0
    v_mfma_f32_16x16x32_bf16 v[156:159], v[96:99], v[88:91], v[156:159]
    ds_read_b64_tr_b16 v[50:51], v8 offset:512
    v_mfma_f32_16x16x32_bf16 v[160:163], v[100:103], v[76:79], v[160:163]
    ds_read_b64_tr_b16 v[52:53], v9 offset:0
    v_mfma_f32_16x16x32_bf16 v[164:167], v[100:103], v[80:83], v[164:167]
    s_add_u32 m0, s30, 0x8000
    s_mov_b32 s28, 0x200
    buffer_load_dwordx4 v11, s[8:11], s28 offen lds
    v_mfma_f32_16x16x32_bf16 v[168:171], v[100:103], v[84:87], v[168:171]
    ds_read_b64_tr_b16 v[54:55], v9 offset:512
    v_mfma_f32_16x16x32_bf16 v[172:175], v[100:103], v[88:91], v[172:175]
    ds_read_b64_tr_b16 v[56:57], v8 offset:4096
    v_mfma_f32_16x16x32_bf16 v[176:179], v[104:107], v[76:79], v[176:179]
    ds_read_b64_tr_b16 v[58:59], v8 offset:4608
    v_mfma_f32_16x16x32_bf16 v[180:183], v[104:107], v[80:83], v[180:183]
    s_add_u32 m0, s30, 0x8400
    s_mov_b32 s28, 0x4200
    buffer_load_dwordx4 v11, s[8:11], s28 offen lds
    v_mfma_f32_16x16x32_bf16 v[184:187], v[104:107], v[84:87], v[184:187]
    ds_read_b64_tr_b16 v[60:61], v9 offset:4096
    v_mfma_f32_16x16x32_bf16 v[188:191], v[104:107], v[88:91], v[188:191]
    ds_read_b64_tr_b16 v[62:63], v9 offset:4608
    v_mfma_f32_16x16x32_bf16 v[192:195], v[108:111], v[76:79], v[192:195]
    ds_read_b64_tr_b16 v[64:65], v8 offset:8192
    v_mfma_f32_16x16x32_bf16 v[196:199], v[108:111], v[80:83], v[196:199]
    s_add_u32 m0, s30, 0x8800
    s_mov_b32 s28, 0x8200
    buffer_load_dwordx4 v11, s[8:11], s28 offen lds
    v_mfma_f32_16x16x32_bf16 v[200:203], v[108:111], v[84:87], v[200:203]
    ds_read_b64_tr_b16 v[66:67], v8 offset:8704
    v_mfma_f32_16x16x32_bf16 v[204:207], v[108:111], v[88:91], v[204:207]
    ds_read_b64_tr_b16 v[68:69], v9 offset:8192
    v_mfma_f32_16x16x32_bf16 v[208:211], v[112:115], v[76:79], v[208:211]
    ds_read_b64_tr_b16 v[70:71], v9 offset:8704
    v_mfma_f32_16x16x32_bf16 v[212:215], v[112:115], v[80:83], v[212:215]
    s_add_u32 m0, s30, 0x8c00
    s_mov_b32 s28, 0xc200
    buffer_load_dwordx4 v11, s[8:11], s28 offen lds
    v_mfma_f32_16x16x32_bf16 v[216:219], v[112:115], v[84:87], v[216:219]
    ds_read_b64_tr_b16 v[72:73], v10 offset:0
    v_mfma_f32_16x16x32_bf16 v[220:223], v[112:115], v[88:91], v[220:223]
    ds_read_b64_tr_b16 v[74:75], v10 offset:256
    v_mfma_f32_16x16x32_bf16 v[224:227], v[116:119], v[76:79], v[224:227]
    v_mfma_f32_16x16x32_bf16 v[228:231], v[116:119], v[80:83], v[228:231]
    v_mfma_f32_16x16x32_bf16 v[232:235], v[116:119], v[84:87], v[232:235]
    v_mfma_f32_16x16x32_bf16 v[236:239], v[116:119], v[88:91], v[236:239]
    s_waitcnt lgkmcnt(0)
    s_waitcnt vmcnt(10)
    s_barrier
    v_mfma_f32_16x16x32_bf16 v[128:131], v[48:51], v[32:35], v[128:131]
    ds_read_b128 v[76:79], v7 offset:0
    v_mfma_f32_16x16x32_bf16 v[132:135], v[48:51], v[36:39], v[132:135]
    s_add_u32 m0, s31, 0x18000
    s_mov_b32 s28, 0x1c0000
    buffer_load_dwordx4 v12, s[12:15], s28 offen lds
    v_mfma_f32_16x16x32_bf16 v[136:139], v[48:51], v[40:43], v[136:139]
    ds_read_b128 v[80:83], v7 offset:2048
    v_mfma_f32_16x16x32_bf16 v[140:143], v[48:51], v[44:47], v[140:143]
    ds_read_b128 v[84:87], v7 offset:4096
    v_mfma_f32_16x16x32_bf16 v[144:147], v[52:55], v[32:35], v[144:147]
    ds_read_b128 v[88:91], v7 offset:6144
    v_mfma_f32_16x16x32_bf16 v[148:151], v[52:55], v[36:39], v[148:151]
    s_cmp_ge_u32 s20, 6
    s_cbranch_scc1 g1w1_sk8
    s_add_u32 m0, s31, 0x1a000
    s_mov_b32 s28, 0x1c0000
    s_nop 0
    buffer_load_dwordx4 v13, s[12:15], s28 offen lds
g1w1_sk8:
    v_mfma_f32_16x16x32_bf16 v[152:155], v[52:55], v[40:43], v[152:155]
    ds_read_b64_tr_b16 v[92:93], v8 offset:14336
    v_mfma_f32_16x16x32_bf16 v[156:159], v[52:55], v[44:47], v[156:159]
    ds_read_b64_tr_b16 v[94:95], v8 offset:14848
    v_mfma_f32_16x16x32_bf16 v[160:163], v[56:59], v[32:35], v[160:163]
    ds_read_b64_tr_b16 v[96:97], v9 offset:14336
    v_mfma_f32_16x16x32_bf16 v[164:167], v[56:59], v[36:39], v[164:167]
    s_add_u32 m0, s77, 0x26000
    s_mov_b32 s28, 0x200000
    buffer_load_dwordx4 v30, s[88:91], s28 offen lds
    v_mfma_f32_16x16x32_bf16 v[168:171], v[56:59], v[40:43], v[168:171]
    ds_read_b64_tr_b16 v[98:99], v9 offset:14848
    v_mfma_f32_16x16x32_bf16 v[172:175], v[56:59], v[44:47], v[172:175]
    ds_read_b64_tr_b16 v[100:101], v8 offset:18432
    v_mfma_f32_16x16x32_bf16 v[176:179], v[60:63], v[32:35], v[176:179]
    ds_read_b64_tr_b16 v[102:103], v8 offset:18944
    v_mfma_f32_16x16x32_bf16 v[180:183], v[60:63], v[36:39], v[180:183]
    ds_read_b64_tr_b16 v[104:105], v9 offset:18432
    v_mfma_f32_16x16x32_bf16 v[184:187], v[60:63], v[40:43], v[184:187]
    ds_read_b64_tr_b16 v[106:107], v9 offset:18944
    v_mfma_f32_16x16x32_bf16 v[188:191], v[60:63], v[44:47], v[188:191]
    ds_read_b64_tr_b16 v[108:109], v8 offset:22528
    v_mfma_f32_16x16x32_bf16 v[192:195], v[64:67], v[32:35], v[192:195]
    ds_read_b64_tr_b16 v[110:111], v8 offset:23040
    v_mfma_f32_16x16x32_bf16 v[196:199], v[64:67], v[36:39], v[196:199]
    ds_read_b64_tr_b16 v[112:113], v9 offset:22528
    v_mfma_f32_16x16x32_bf16 v[200:203], v[64:67], v[40:43], v[200:203]
    ds_read_b64_tr_b16 v[114:115], v9 offset:23040
    v_mfma_f32_16x16x32_bf16 v[204:207], v[64:67], v[44:47], v[204:207]
    ds_read_b64_tr_b16 v[116:117], v10 offset:14336
    v_mfma_f32_16x16x32_bf16 v[208:211], v[68:71], v[32:35], v[208:211]
    ds_read_b64_tr_b16 v[118:119], v10 offset:14592
    v_mfma_f32_16x16x32_bf16 v[212:215], v[68:71], v[36:39], v[212:215]
    v_mfma_f32_16x16x32_bf16 v[216:219], v[68:71], v[40:43], v[216:219]
    v_mfma_f32_16x16x32_bf16 v[220:223], v[68:71], v[44:47], v[220:223]
    v_mfma_f32_16x16x32_bf16 v[224:227], v[72:75], v[32:35], v[224:227]
    v_mfma_f32_16x16x32_bf16 v[228:231], v[72:75], v[36:39], v[228:231]
    v_mfma_f32_16x16x32_bf16 v[232:235], v[72:75], v[40:43], v[232:235]
    v_mfma_f32_16x16x32_bf16 v[236:239], v[72:75], v[44:47], v[236:239]
    s_waitcnt lgkmcnt(0)
    s_waitcnt vmcnt(6)
    s_barrier
    v_mfma_f32_16x16x32_bf16 v[128:131], v[92:95], v[76:79], v[128:131]
    ds_read_b128 v[32:35], v2 offset:0
    v_mfma_f32_16x16x32_bf16 v[132:135], v[92:95], v[80:83], v[132:135]
    s_add_u32 m0, s31, 0x1b800
    s_mov_b32 s28, 0x1f8000
    buffer_load_dwordx4 v12, s[12:15], s28 offen lds
    v_mfma_f32_16x16x32_bf16 v[136:139], v[92:95], v[84:87], v[136:139]
    ds_read_b128 v[36:39], v2 offset:2048
    v_mfma_f32_16x16x32_bf16 v[140:143], v[92:95], v[88:91], v[140:143]
    ds_read_b128 v[40:43], v2 offset:4096
    v_mfma_f32_16x16x32_bf16 v[144:147], v[96:99], v[76:79], v[144:147]
    ds_read_b128 v[44:47], v2 offset:6144
    v_mfma_f32_16x16x32_bf16 v[148:151], v[96:99], v[80:83], v[148:151]
    s_cmp_ge_u32 s20, 6
    s_cbranch_scc1 g1w1_sk9
    s_add_u32 m0, s31, 0x1d800
    s_mov_b32 s28, 0x1f8000
    s_nop 0
    buffer_load_dwordx4 v13, s[12:15], s28 offen lds
g1w1_sk9:
    v_mfma_f32_16x16x32_bf16 v[152:155], v[96:99], v[84:87], v[152:155]
    ds_read_b64_tr_b16 v[48:49], v8 offset:28672
    v_mfma_f32_16x16x32_bf16 v[156:159], v[96:99], v[88:91], v[156:159]
    ds_read_b64_tr_b16 v[50:51], v8 offset:29184
    v_mfma_f32_16x16x32_bf16 v[160:163], v[100:103], v[76:79], v[160:163]
    ds_read_b64_tr_b16 v[52:53], v9 offset:28672
    v_mfma_f32_16x16x32_bf16 v[164:167], v[100:103], v[80:83], v[164:167]
    s_add_u32 m0, s30, 0x10000
    s_mov_b32 s28, 0x280
    buffer_load_dwordx4 v11, s[8:11], s28 offen lds
    v_mfma_f32_16x16x32_bf16 v[168:171], v[100:103], v[84:87], v[168:171]
    ds_read_b64_tr_b16 v[54:55], v9 offset:29184
    v_mfma_f32_16x16x32_bf16 v[172:175], v[100:103], v[88:91], v[172:175]
    ds_read_b64_tr_b16 v[56:57], v8 offset:32768
    v_mfma_f32_16x16x32_bf16 v[176:179], v[104:107], v[76:79], v[176:179]
    ds_read_b64_tr_b16 v[58:59], v8 offset:33280
    v_mfma_f32_16x16x32_bf16 v[180:183], v[104:107], v[80:83], v[180:183]
    s_add_u32 m0, s30, 0x10400
    s_mov_b32 s28, 0x4280
    buffer_load_dwordx4 v11, s[8:11], s28 offen lds
    v_mfma_f32_16x16x32_bf16 v[184:187], v[104:107], v[84:87], v[184:187]
    ds_read_b64_tr_b16 v[60:61], v9 offset:32768
    v_mfma_f32_16x16x32_bf16 v[188:191], v[104:107], v[88:91], v[188:191]
    ds_read_b64_tr_b16 v[62:63], v9 offset:33280
    v_mfma_f32_16x16x32_bf16 v[192:195], v[108:111], v[76:79], v[192:195]
    ds_read_b64_tr_b16 v[64:65], v8 offset:36864
    v_mfma_f32_16x16x32_bf16 v[196:199], v[108:111], v[80:83], v[196:199]
    s_add_u32 m0, s30, 0x10800
    s_mov_b32 s28, 0x8280
    buffer_load_dwordx4 v11, s[8:11], s28 offen lds
    v_mfma_f32_16x16x32_bf16 v[200:203], v[108:111], v[84:87], v[200:203]
    ds_read_b64_tr_b16 v[66:67], v8 offset:37376
    v_mfma_f32_16x16x32_bf16 v[204:207], v[108:111], v[88:91], v[204:207]
    ds_read_b64_tr_b16 v[68:69], v9 offset:36864
    v_mfma_f32_16x16x32_bf16 v[208:211], v[112:115], v[76:79], v[208:211]
    ds_read_b64_tr_b16 v[70:71], v9 offset:37376
    v_mfma_f32_16x16x32_bf16 v[212:215], v[112:115], v[80:83], v[212:215]
    s_add_u32 m0, s30, 0x10c00
    s_mov_b32 s28, 0xc280
    buffer_load_dwordx4 v11, s[8:11], s28 offen lds
    v_mfma_f32_16x16x32_bf16 v[216:219], v[112:115], v[84:87], v[216:219]
    ds_read_b64_tr_b16 v[72:73], v10 offset:28672
    v_mfma_f32_16x16x32_bf16 v[220:223], v[112:115], v[88:91], v[220:223]
    ds_read_b64_tr_b16 v[74:75], v10 offset:28928
    v_mfma_f32_16x16x32_bf16 v[224:227], v[116:119], v[76:79], v[224:227]
    v_mfma_f32_16x16x32_bf16 v[228:231], v[116:119], v[80:83], v[228:231]
    v_mfma_f32_16x16x32_bf16 v[232:235], v[116:119], v[84:87], v[232:235]
    v_mfma_f32_16x16x32_bf16 v[236:239], v[116:119], v[88:91], v[236:239]
    s_waitcnt lgkmcnt(0)
    s_waitcnt vmcnt(10)
    s_barrier
    v_mfma_f32_16x16x32_bf16 v[128:131], v[48:51], v[32:35], v[128:131]
    ds_read_b128 v[76:79], v3 offset:0
    v_mfma_f32_16x16x32_bf16 v[132:135], v[48:51], v[36:39], v[132:135]
    s_add_u32 m0, s31, 0x1f000
    s_mov_b32 s28, 0x230000
    buffer_load_dwordx4 v12, s[12:15], s28 offen lds
    v_mfma_f32_16x16x32_bf16 v[136:139], v[48:51], v[40:43], v[136:139]
    ds_read_b128 v[80:83], v3 offset:2048
    v_mfma_f32_16x16x32_bf16 v[140:143], v[48:51], v[44:47], v[140:143]
    ds_read_b128 v[84:87], v3 offset:4096
    v_mfma_f32_16x16x32_bf16 v[144:147], v[52:55], v[32:35], v[144:147]
    ds_read_b128 v[88:91], v3 offset:6144
    v_mfma_f32_16x16x32_bf16 v[148:151], v[52:55], v[36:39], v[148:151]
    s_cmp_ge_u32 s20, 6
    s_cbranch_scc1 g1w1_sk10
    s_add_u32 m0, s31, 0x21000
    s_mov_b32 s28, 0x230000
    s_nop 0
    buffer_load_dwordx4 v13, s[12:15], s28 offen lds
g1w1_sk10:
    v_mfma_f32_16x16x32_bf16 v[152:155], v[52:55], v[40:43], v[152:155]
    ds_read_b64_tr_b16 v[92:93], v8 offset:43008
    v_mfma_f32_16x16x32_bf16 v[156:159], v[52:55], v[44:47], v[156:159]
    ds_read_b64_tr_b16 v[94:95], v8 offset:43520
    v_mfma_f32_16x16x32_bf16 v[160:163], v[56:59], v[32:35], v[160:163]
    ds_read_b64_tr_b16 v[96:97], v9 offset:43008
    v_mfma_f32_16x16x32_bf16 v[164:167], v[56:59], v[36:39], v[164:167]
    ds_read_b64_tr_b16 v[98:99], v9 offset:43520
    v_mfma_f32_16x16x32_bf16 v[168:171], v[56:59], v[40:43], v[168:171]
    ds_read_b64_tr_b16 v[100:101], v8 offset:47104
    v_mfma_f32_16x16x32_bf16 v[172:175], v[56:59], v[44:47], v[172:175]
    ds_read_b64_tr_b16 v[102:103], v8 offset:47616
    v_mfma_f32_16x16x32_bf16 v[176:179], v[60:63], v[32:35], v[176:179]
    ds_read_b64_tr_b16 v[104:105], v9 offset:47104
    v_mfma_f32_16x16x32_bf16 v[180:183], v[60:63], v[36:39], v[180:183]
    ds_read_b64_tr_b16 v[106:107], v9 offset:47616
    v_mfma_f32_16x16x32_bf16 v[184:187], v[60:63], v[40:43], v[184:187]
    ds_read_b64_tr_b16 v[108:109], v8 offset:51200
    v_mfma_f32_16x16x32_bf16 v[188:191], v[60:63], v[44:47], v[188:191]
    ds_read_b64_tr_b16 v[110:111], v8 offset:51712
    v_mfma_f32_16x16x32_bf16 v[192:195], v[64:67], v[32:35], v[192:195]
    ds_read_b64_tr_b16 v[112:113], v9 offset:51200
    v_mfma_f32_16x16x32_bf16 v[196:199], v[64:67], v[36:39], v[196:199]
    ds_read_b64_tr_b16 v[114:115], v9 offset:51712
    v_mfma_f32_16x16x32_bf16 v[200:203], v[64:67], v[40:43], v[200:203]
    ds_read_b64_tr_b16 v[116:117], v10 offset:43008
    v_mfma_f32_16x16x32_bf16 v[204:207], v[64:67], v[44:47], v[204:207]
    ds_read_b64_tr_b16 v[118:119], v10 offset:43264
    v_mfma_f32_16x16x32_bf16 v[208:211], v[68:71], v[32:35], v[208:211]
    v_mfma_f32_16x16x32_bf16 v[212:215], v[68:71], v[36:39], v[212:215]
    v_mfma_f32_16x16x32_bf16 v[216:219], v[68:71], v[40:43], v[216:219]
    v_mfma_f32_16x16x32_bf16 v[220:223], v[68:71], v[44:47], v[220:223]
    v_mfma_f32_16x16x32_bf16 v[224:227], v[72:75], v[32:35], v[224:227]
    v_mfma_f32_16x16x32_bf16 v[228:231], v[72:75], v[36:39], v[228:231]
    v_mfma_f32_16x16x32_bf16 v[232:235], v[72:75], v[40:43], v[232:235]
    v_mfma_f32_16x16x32_bf16 v[236:239], v[72:75], v[44:47], v[236:239]
    s_waitcnt lgkmcnt(0)
    s_waitcnt vmcnt(6)
    s_barrier
    v_mfma_f32_16x16x32_bf16 v[128:131], v[92:95], v[76:79], v[128:131]
    ds_read_b128 v[32:35], v4 offset:0
    v_mfma_f32_16x16x32_bf16 v[132:135], v[92:95], v[80:83], v[132:135]
    s_add_u32 m0, s31, 0x22800
    s_mov_b32 s28, 0x268000
    buffer_load_dwordx4 v12, s[12:15], s28 offen lds
    v_mfma_f32_16x16x32_bf16 v[136:139], v[92:95], v[84:87], v[136:139]
    ds_read_b128 v[36:39], v4 offset:2048
    v_mfma_f32_16x16x32_bf16 v[140:143], v[92:95], v[88:91], v[140:143]
    ds_read_b128 v[40:43], v4 offset:4096
    v_mfma_f32_16x16x32_bf16 v[144:147], v[96:99], v[76:79], v[144:147]
    ds_read_b128 v[44:47], v4 offset:6144
    v_mfma_f32_16x16x32_bf16 v[148:151], v[96:99], v[80:83], v[148:151]
    s_cmp_ge_u32 s20, 6
    s_cbranch_scc1 g1w1_sk11
    s_add_u32 m0, s31, 0x24800
    s_mov_b32 s28, 0x268000
    s_nop 0
    buffer_load_dwordx4 v13, s[12:15], s28 offen lds
g1w1_sk11:
    v_mfma_f32_16x16x32_bf16 v[152:155], v[96:99], v[84:87], v[152:155]
    ds_read_b64_tr_b16 v[48:49], v8 offset:0
    v_mfma_f32_16x16x32_bf16 v[156:159], v[96:99], v[88:91], v[156:159]
    ds_read_b64_tr_b16 v[50:51], v8 offset:512
    v_mfma_f32_16x16x32_bf16 v[160:163], v[100:103], v[76:79], v[160:163]
    ds_read_b64_tr_b16 v[52:53], v9 offset:0
    v_mfma_f32_16x16x32_bf16 v[164:167], v[100:103], v[80:83], v[164:167]
    s_add_u32 m0, s30, 0x0
    s_mov_b32 s28, 0x300
    buffer_load_dwordx4 v11, s[8:11], s28 offen lds
    v_mfma_f32_16x16x32_bf16 v[168:171], v[100:103], v[84:87], v[168:171]
    ds_read_b64_tr_b16 v[54:55], v9 offset:512
    v_mfma_f32_16x16x32_bf16 v[172:175], v[100:103], v[88:91], v[172:175]
    ds_read_b64_tr_b16 v[56:57], v8 offset:4096
    v_mfma_f32_16x16x32_bf16 v[176:179], v[104:107], v[76:79], v[176:179]
    ds_read_b64_tr_b16 v[58:59], v8 offset:4608
    v_mfma_f32_16x16x32_bf16 v[180:183], v[104:107], v[80:83], v[180:183]
    s_add_u32 m0, s30, 0x400
    s_mov_b32 s28, 0x4300
    buffer_load_dwordx4 v11, s[8:11], s28 offen lds
    v_mfma_f32_16x16x32_bf16 v[184:187], v[104:107], v[84:87], v[184:187]
    ds_read_b64_tr_b16 v[60:61], v9 offset:4096
    v_mfma_f32_16x16x32_bf16 v[188:191], v[104:107], v[88:91], v[188:191]
    ds_read_b64_tr_b16 v[62:63], v9 offset:4608
    v_mfma_f32_16x16x32_bf16 v[192:195], v[108:111], v[76:79], v[192:195]
    ds_read_b64_tr_b16 v[64:65], v8 offset:8192
    v_mfma_f32_16x16x32_bf16 v[196:199], v[108:111], v[80:83], v[196:199]
    s_add_u32 m0, s30, 0x800
    s_mov_b32 s28, 0x8300
    buffer_load_dwordx4 v11, s[8:11], s28 offen lds
    v_mfma_f32_16x16x32_bf16 v[200:203], v[108:111], v[84:87], v[200:203]
    ds_read_b64_tr_b16 v[66:67], v8 offset:8704
    v_mfma_f32_16x16x32_bf16 v[204:207], v[108:111], v[88:91], v[204:207]
    ds_read_b64_tr_b16 v[68:69], v9 offset:8192
    v_mfma_f32_16x16x32_bf16 v[208:211], v[112:115], v[76:79], v[208:211]
    ds_read_b64_tr_b16 v[70:71], v9 offset:8704
    v_mfma_f32_16x16x32_bf16 v[212:215], v[112:115], v[80:83], v[212:215]
    s_add_u32 m0, s30, 0xc00
    s_mov_b32 s28, 0xc300
    buffer_load_dwordx4 v11, s[8:11], s28 offen lds
    v_mfma_f32_16x16x32_bf16 v[216:219], v[112:115], v[84:87], v[216:219]
    ds_read_b64_tr_b16 v[72:73], v10 offset:0
    v_mfma_f32_16x16x32_bf16 v[220:223], v[112:115], v[88:91], v[220:223]
    ds_read_b64_tr_b16 v[74:75], v10 offset:256
    v_mfma_f32_16x16x32_bf16 v[224:227], v[116:119], v[76:79], v[224:227]
    v_mfma_f32_16x16x32_bf16 v[228:231], v[116:119], v[80:83], v[228:231]
    v_mfma_f32_16x16x32_bf16 v[232:235], v[116:119], v[84:87], v[232:235]
    v_mfma_f32_16x16x32_bf16 v[236:239], v[116:119], v[88:91], v[236:239]
    s_waitcnt lgkmcnt(0)
    s_waitcnt vmcnt(10)
    s_barrier
    v_mfma_f32_16x16x32_bf16 v[128:131], v[48:51], v[32:35], v[128:131]
    ds_read_b128 v[76:79], v5 offset:0
    v_mfma_f32_16x16x32_bf16 v[132:135], v[48:51], v[36:39], v[132:135]
    s_add_u32 m0, s31, 0x18000
    s_mov_b32 s28, 0x2a0000
    buffer_load_dwordx4 v12, s[12:15], s28 offen lds
    v_mfma_f32_16x16x32_bf16 v[136:139], v[48:51], v[40:43], v[136:139]
    ds_read_b128 v[80:83], v5 offset:2048
    v_mfma_f32_16x16x32_bf16 v[140:143], v[48:51], v[44:47], v[140:143]
    ds_read_b128 v[84:87], v5 offset:4096
    v_mfma_f32_16x16x32_bf16 v[144:147], v[52:55], v[32:35], v[144:147]
    ds_read_b128 v[88:91], v5 offset:6144
    v_mfma_f32_16x16x32_bf16 v[148:151], v[52:55], v[36:39], v[148:151]
    s_cmp_ge_u32 s20, 6
    s_cbranch_scc1 g1w1_sk12
    s_add_u32 m0, s31, 0x1a000
    s_mov_b32 s28, 0x2a0000
    s_nop 0
    buffer_load_dwordx4 v13, s[12:15], s28 offen lds
g1w1_sk12:
    v_mfma_f32_16x16x32_bf16 v[152:155], v[52:55], v[40:43], v[152:155]
    ds_read_b64_tr_b16 v[92:93], v8 offset:14336
    v_mfma_f32_16x16x32_bf16 v[156:159], v[52:55], v[44:47], v[156:159]
    ds_read_b64_tr_b16 v[94:95], v8 offset:14848
    v_mfma_f32_16x16x32_bf16 v[160:163], v[56:59], v[32:35], v[160:163]
    ds_read_b64_tr_b16 v[96:97], v9 offset:14336
    v_mfma_f32_16x16x32_bf16 v[164:167], v[56:59], v[36:39], v[164:167]
    ds_read_b64_tr_b16 v[98:99], v9 offset:14848
    v_mfma_f32_16x16x32_bf16 v[168:171], v[56:59], v[40:43], v[168:171]
    ds_read_b64_tr_b16 v[100:101], v8 offset:18432
    v_mfma_f32_16x16x32_bf16 v[172:175], v[56:59], v[44:47], v[172:175]
    ds_read_b64_tr_b16 v[102:103], v8 offset:18944
    v_mfma_f32_16x16x32_bf16 v[176:179], v[60:63], v[32:35], v[176:179]
    ds_read_b64_tr_b16 v[104:105], v9 offset:18432
    v_mfma_f32_16x16x32_bf16 v[180:183], v[60:63], v[36:39], v[180:183]
    ds_read_b64_tr_b16 v[106:107], v9 offset:18944
    v_mfma_f32_16x16x32_bf16 v[184:187], v[60:63], v[40:43], v[184:187]
    ds_read_b64_tr_b16 v[108:109], v8 offset:22528
    v_mfma_f32_16x16x32_bf16 v[188:191], v[60:63], v[44:47], v[188:191]
    ds_read_b64_tr_b16 v[110:111], v8 offset:23040
    v_mfma_f32_16x16x32_bf16 v[192:195], v[64:67], v[32:35], v[192:195]
    ds_read_b64_tr_b16 v[112:113], v9 offset:22528
    v_mfma_f32_16x16x32_bf16 v[196:199], v[64:67], v[36:39], v[196:199]
    ds_read_b64_tr_b16 v[114:115], v9 offset:23040
    v_mfma_f32_16x16x32_bf16 v[200:203], v[64:67], v[40:43], v[200:203]
    ds_read_b64_tr_b16 v[116:117], v10 offset:14336
    v_mfma_f32_16x16x32_bf16 v[204:207], v[64:67], v[44:47], v[204:207]
    ds_read_b64_tr_b16 v[118:119], v10 offset:14592
    v_mfma_f32_16x16x32_bf16 v[208:211], v[68:71], v[32:35], v[208:211]
    v_mfma_f32_16x16x32_bf16 v[212:215], v[68:71], v[36:39], v[212:215]
    v_mfma_f32_16x16x32_bf16 v[216:219], v[68:71], v[40:43], v[216:219]
    v_mfma_f32_16x16x32_bf16 v[220:223], v[68:71], v[44:47], v[220:223]
    v_mfma_f32_16x16x32_bf16 v[224:227], v[72:75], v[32:35], v[224:227]
    v_mfma_f32_16x16x32_bf16 v[228:231], v[72:75], v[36:39], v[228:231]
    v_mfma_f32_16x16x32_bf16 v[232:235], v[72:75], v[40:43], v[232:235]
    v_mfma_f32_16x16x32_bf16 v[236:239], v[72:75], v[44:47], v[236:239]
    s_waitcnt lgkmcnt(0)
    s_waitcnt vmcnt(6)
    s_barrier
    v_mfma_f32_16x16x32_bf16 v[128:131], v[92:95], v[76:79], v[128:131]
    ds_read_b128 v[32:35], v6 offset:0
    v_mfma_f32_16x16x32_bf16 v[132:135], v[92:95], v[80:83], v[132:135]
    s_add_u32 m0, s31, 0x1b800
    s_mov_b32 s28, 0x2d8000
    buffer_load_dwordx4 v12, s[12:15], s28 offen lds
    v_mfma_f32_16x16x32_bf16 v[136:139], v[92:95], v[84:87], v[136:139]
    ds_read_b128 v[36:39], v6 offset:2048
    v_mfma_f32_16x16x32_bf16 v[140:143], v[92:95], v[88:91], v[140:143]
    ds_read_b128 v[40:43], v6 offset:4096
    v_mfma_f32_16x16x32_bf16 v[144:147], v[96:99], v[76:79], v[144:147]
    ds_read_b128 v[44:47], v6 offset:6144
    v_mfma_f32_16x16x32_bf16 v[148:151], v[96:99], v[80:83], v[148:151]
    s_cmp_ge_u32 s20, 6
    s_cbranch_scc1 g1w1_sk13
    s_add_u32 m0, s31, 0x1d800
    s_mov_b32 s28, 0x2d8000
    s_nop 0
    buffer_load_dwordx4 v13, s[12:15], s28 offen lds
g1w1_sk13:
    v_mfma_f32_16x16x32_bf16 v[152:155], v[96:99], v[84:87], v[152:155]
    ds_read_b64_tr_b16 v[48:49], v8 offset:28672
    v_mfma_f32_16x16x32_bf16 v[156:159], v[96:99], v[88:91], v[156:159]
    ds_read_b64_tr_b16 v[50:51], v8 offset:29184
    v_mfma_f32_16x16x32_bf16 v[160:163], v[100:103], v[76:79], v[160:163]
    ds_read_b64_tr_b16 v[52:53], v9 offset:28672
    v_mfma_f32_16x16x32_bf16 v[164:167], v[100:103], v[80:83], v[164:167]
    s_add_u32 m0, s30, 0x8000
    s_mov_b32 s28, 0x380
    buffer_load_dwordx4 v11, s[8:11], s28 offen lds
    v_mfma_f32_16x16x32_bf16 v[168:171], v[100:103], v[84:87], v[168:171]
    ds_read_b64_tr_b16 v[54:55], v9 offset:29184
    v_mfma_f32_16x16x32_bf16 v[172:175], v[100:103], v[88:91], v[172:175]
    ds_read_b64_tr_b16 v[56:57], v8 offset:32768
    v_mfma_f32_16x16x32_bf16 v[176:179], v[104:107], v[76:79], v[176:179]
    ds_read_b64_tr_b16 v[58:59], v8 offset:33280
    v_mfma_f32_16x16x32_bf16 v[180:183], v[104:107], v[80:83], v[180:183]
    s_add_u32 m0, s30, 0x8400
    s_mov_b32 s28, 0x4380
    buffer_load_dwordx4 v11, s[8:11], s28 offen lds
    v_mfma_f32_16x16x32_bf16 v[184:187], v[104:107], v[84:87], v[184:187]
    ds_read_b64_tr_b16 v[60:61], v9 offset:32768
    v_mfma_f32_16x16x32_bf16 v[188:191], v[104:107], v[88:91], v[188:191]
    ds_read_b64_tr_b16 v[62:63], v9 offset:33280
    v_mfma_f32_16x16x32_bf16 v[192:195], v[108:111], v[76:79], v[192:195]
    ds_read_b64_tr_b16 v[64:65], v8 offset:36864
    v_mfma_f32_16x16x32_bf16 v[196:199], v[108:111], v[80:83], v[196:199]
    s_add_u32 m0, s30, 0x8800
    s_mov_b32 s28, 0x8380
    buffer_load_dwordx4 v11, s[8:11], s28 offen lds
    v_mfma_f32_16x16x32_bf16 v[200:203], v[108:111], v[84:87], v[200:203]
    ds_read_b64_tr_b16 v[66:67], v8 offset:37376
    v_mfma_f32_16x16x32_bf16 v[204:207], v[108:111], v[88:91], v[204:207]
    ds_read_b64_tr_b16 v[68:69], v9 offset:36864
    v_mfma_f32_16x16x32_bf16 v[208:211], v[112:115], v[76:79], v[208:211]
    ds_read_b64_tr_b16 v[70:71], v9 offset:37376
    v_mfma_f32_16x16x32_bf16 v[212:215], v[112:115], v[80:83], v[212:215]
    s_add_u32 m0, s30, 0x8c00
    s_mov_b32 s28, 0xc380
    buffer_load_dwordx4 v11, s[8:11], s28 offen lds
    v_mfma_f32_16x16x32_bf16 v[216:219], v[112:115], v[84:87], v[216:219]
    ds_read_b64_tr_b16 v[72:73], v10 offset:28672
    v_mfma_f32_16x16x32_bf16 v[220:223], v[112:115], v[88:91], v[220:223]
    ds_read_b64_tr_b16 v[74:75], v10 offset:28928
    v_mfma_f32_16x16x32_bf16 v[224:227], v[116:119], v[76:79], v[224:227]
    s_add_u32 m0, s77, 0x26000
    s_mov_b32 s28, 0x300000
    buffer_load_dwordx4 v30, s[88:91], s28 offen lds
    v_mfma_f32_16x16x32_bf16 v[228:231], v[116:119], v[80:83], v[228:231]
    v_mfma_f32_16x16x32_bf16 v[232:235], v[116:119], v[84:87], v[232:235]
    v_mfma_f32_16x16x32_bf16 v[236:239], v[116:119], v[88:91], v[236:239]
    s_waitcnt lgkmcnt(0)
    s_waitcnt vmcnt(10)
    s_barrier
    v_mfma_f32_16x16x32_bf16 v[128:131], v[48:51], v[32:35], v[128:131]
    ds_read_b128 v[76:79], v7 offset:0
    v_mfma_f32_16x16x32_bf16 v[132:135], v[48:51], v[36:39], v[132:135]
    s_add_u32 m0, s31, 0x1f000
    s_mov_b32 s28, 0x310000
    buffer_load_dwordx4 v12, s[12:15], s28 offen lds
    v_mfma_f32_16x16x32_bf16 v[136:139], v[48:51], v[40:43], v[136:139]
    ds_read_b128 v[80:83], v7 offset:2048
    v_mfma_f32_16x16x32_bf16 v[140:143], v[48:51], v[44:47], v[140:143]
    ds_read_b128 v[84:87], v7 offset:4096
    v_mfma_f32_16x16x32_bf16 v[144:147], v[52:55], v[32:35], v[144:147]
    ds_read_b128 v[88:91], v7 offset:6144
    v_mfma_f32_16x16x32_bf16 v[148:151], v[52:55], v[36:39], v[148:151]
    s_cmp_ge_u32 s20, 6
    s_cbranch_scc1 g1w1_sk14
    s_add_u32 m0, s31, 0x21000
    s_mov_b32 s28, 0x310000
    s_nop 0
    buffer_load_dwordx4 v13, s[12:15], s28 offen lds
g1w1_sk14:
    v_mfma_f32_16x16x32_bf16 v[152:155], v[52:55], v[40:43], v[152:155]
    ds_read_b64_tr_b16 v[92:93], v8 offset:43008
    v_mfma_f32_16x16x32_bf16 v[156:159], v[52:55], v[44:47], v[156:159]
    ds_read_b64_tr_b16 v[94:95], v8 offset:43520
    v_mfma_f32_16x16x32_bf16 v[160:163], v[56:59], v[32:35], v[160:163]
    ds_read_b64_tr_b16 v[96:97], v9 offset:43008
    v_mfma_f32_16x16x32_bf16 v[164:167], v[56:59], v[36:39], v[164:167]
    ds_read_b64_tr_b16 v[98:99], v9 offset:43520
    v_mfma_f32_16x16x32_bf16 v[168:171], v[56:59], v[40:43], v[168:171]
    ds_read_b64_tr_b16 v[100:101], v8 offset:47104
    v_mfma_f32_16x16x32_bf16 v[172:175], v[56:59], v[44:47], v[172:175]
    ds_read_b64_tr_b16 v[102:103], v8 offset:47616
    v_mfma_f32_16x16x32_bf16 v[176:179], v[60:63], v[32:35], v[176:179]
    ds_read_b64_tr_b16 v[104:105], v9 offset:47104
    v_mfma_f32_16x16x32_bf16 v[180:183], v[60:63], v[36:39], v[180:183]
    ds_read_b64_tr_b16 v[106:107], v9 offset:47616
    v_mfma_f32_16x16x32_bf16 v[184:187], v[60:63], v[40:43], v[184:187]
    ds_read_b64_tr_b16 v[108:109], v8 offset:51200
    v_mfma_f32_16x16x32_bf16 v[188:191], v[60:63], v[44:47], v[188:191]
    ds_read_b64_tr_b16 v[110:111], v8 offset:51712
    v_mfma_f32_16x16x32_bf16 v[192:195], v[64:67], v[32:35], v[192:195]
    ds_read_b64_tr_b16 v[112:113], v9 offset:51200
    v_mfma_f32_16x16x32_bf16 v[196:199], v[64:67], v[36:39], v[196:199]
    ds_read_b64_tr_b16 v[114:115], v9 offset:51712
    v_mfma_f32_16x16x32_bf16 v[200:203], v[64:67], v[40:43], v[200:203]
    ds_read_b64_tr_b16 v[116:117], v10 offset:43008
    v_mfma_f32_16x16x32_bf16 v[204:207], v[64:67], v[44:47], v[204:207]
    ds_read_b64_tr_b16 v[118:119], v10 offset:43264
    v_mfma_f32_16x16x32_bf16 v[208:211], v[68:71], v[32:35], v[208:211]
    v_mfma_f32_16x16x32_bf16 v[212:215], v[68:71], v[36:39], v[212:215]
    v_mfma_f32_16x16x32_bf16 v[216:219], v[68:71], v[40:43], v[216:219]
    v_mfma_f32_16x16x32_bf16 v[220:223], v[68:71], v[44:47], v[220:223]
    v_mfma_f32_16x16x32_bf16 v[224:227], v[72:75], v[32:35], v[224:227]
    v_mfma_f32_16x16x32_bf16 v[228:231], v[72:75], v[36:39], v[228:231]
    v_mfma_f32_16x16x32_bf16 v[232:235], v[72:75], v[40:43], v[232:235]
    v_mfma_f32_16x16x32_bf16 v[236:239], v[72:75], v[44:47], v[236:239]
    s_waitcnt lgkmcnt(0)
    s_waitcnt vmcnt(6)
    s_barrier
    v_mfma_f32_16x16x32_bf16 v[128:131], v[92:95], v[76:79], v[128:131]
    ds_read_b128 v[32:35], v2 offset:0
    v_mfma_f32_16x16x32_bf16 v[132:135], v[92:95], v[80:83], v[132:135]
    s_add_u32 m0, s31, 0x22800
    s_mov_b32 s28, 0x348000
    buffer_load_dwordx4 v12, s[12:15], s28 offen lds
    v_mfma_f32_16x16x32_bf16 v[136:139], v[92:95], v[84:87], v[136:139]
    ds_read_b128 v[36:39], v2 offset:2048
    v_mfma_f32_16x16x32_bf16 v[140:143], v[92:95], v[88:91], v[140:143]
    ds_read_b128 v[40:43], v2 offset:4096
    v_mfma_f32_16x16x32_bf16 v[144:147], v[96:99], v[76:79], v[144:147]
    ds_read_b128 v[44:47], v2 offset:6144
    v_mfma_f32_16x16x32_bf16 v[148:151], v[96:99], v[80:83], v[148:151]
    s_cmp_ge_u32 s20, 6
    s_cbranch_scc1 g1w1_sk15
    s_add_u32 m0, s31, 0x24800
    s_mov_b32 s28, 0x348000
    s_nop 0
    buffer_load_dwordx4 v13, s[12:15], s28 offen lds
g1w1_sk15:
    v_mfma_f32_16x16x32_bf16 v[152:155], v[96:99], v[84:87], v[152:155]
    ds_read_b64_tr_b16 v[48:49], v8 offset:0
    v_mfma_f32_16x16x32_bf16 v[156:159], v[96:99], v[88:91], v[156:159]
    ds_read_b64_tr_b16 v[50:51], v8 offset:512
    v_mfma_f32_16x16x32_bf16 v[160:163], v[100:103], v[76:79], v[160:163]
    ds_read_b64_tr_b16 v[52:53], v9 offset:0
    v_mfma_f32_16x16x32_bf16 v[164:167], v[100:103], v[80:83], v[164:167]
    s_add_u32 m0, s30, 0x10000
    s_mov_b32 s28, 0x400
    buffer_load_dwordx4 v11, s[8:11], s28 offen lds
    v_mfma_f32_16x16x32_bf16 v[168:171], v[100:103], v[84:87], v[168:171]
    ds_read_b64_tr_b16 v[54:55], v9 offset:512
    v_mfma_f32_16x16x32_bf16 v[172:175], v[100:103], v[88:91], v[172:175]
    ds_read_b64_tr_b16 v[56:57], v8 offset:4096
    v_mfma_f32_16x16x32_bf16 v[176:179], v[104:107], v[76:79], v[176:179]
    ds_read_b64_tr_b16 v[58:59], v8 offset:4608
    v_mfma_f32_16x16x32_bf16 v[180:183], v[104:107], v[80:83], v[180:183]
    s_add_u32 m0, s30, 0x10400
    s_mov_b32 s28, 0x4400
    buffer_load_dwordx4 v11, s[8:11], s28 offen lds
    v_mfma_f32_16x16x32_bf16 v[184:187], v[104:107], v[84:87], v[184:187]
    ds_read_b64_tr_b16 v[60:61], v9 offset:4096
    v_mfma_f32_16x16x32_bf16 v[188:191], v[104:107], v[88:91], v[188:191]
    ds_read_b64_tr_b16 v[62:63], v9 offset:4608
    v_mfma_f32_16x16x32_bf16 v[192:195], v[108:111], v[76:79], v[192:195]
    ds_read_b64_tr_b16 v[64:65], v8 offset:8192
    v_mfma_f32_16x16x32_bf16 v[196:199], v[108:111], v[80:83], v[196:199]
    s_add_u32 m0, s30, 0x10800
    s_mov_b32 s28, 0x8400
    buffer_load_dwordx4 v11, s[8:11], s28 offen lds
    v_mfma_f32_16x16x32_bf16 v[200:203], v[108:111], v[84:87], v[200:203]
    ds_read_b64_tr_b16 v[66:67], v8 offset:8704
    v_mfma_f32_16x16x32_bf16 v[204:207], v[108:111], v[88:91], v[204:207]
    ds_read_b64_tr_b16 v[68:69], v9 offset:8192
    v_mfma_f32_16x16x32_bf16 v[208:211], v[112:115], v[76:79], v[208:211]
    ds_read_b64_tr_b16 v[70:71], v9 offset:8704
    v_mfma_f32_16x16x32_bf16 v[212:215], v[112:115], v[80:83], v[212:215]
    s_add_u32 m0, s30, 0x10c00
    s_mov_b32 s28, 0xc400
    buffer_load_dwordx4 v11, s[8:11], s28 offen lds
    v_mfma_f32_16x16x32_bf16 v[216:219], v[112:115], v[84:87], v[216:219]
    ds_read_b64_tr_b16 v[72:73], v10 offset:0
    v_mfma_f32_16x16x32_bf16 v[220:223], v[112:115], v[88:91], v[220:223]
    ds_read_b64_tr_b16 v[74:75], v10 offset:256
    v_mfma_f32_16x16x32_bf16 v[224:227], v[116:119], v[76:79], v[224:227]
    v_mfma_f32_16x16x32_bf16 v[228:231], v[116:119], v[80:83], v[228:231]
    v_mfma_f32_16x16x32_bf16 v[232:235], v[116:119], v[84:87], v[232:235]
    v_mfma_f32_16x16x32_bf16 v[236:239], v[116:119], v[88:91], v[236:239]
    s_waitcnt lgkmcnt(0)
    s_waitcnt vmcnt(10)
    s_barrier
    v_mfma_f32_16x16x32_bf16 v[128:131], v[48:51], v[32:35], v[128:131]
    ds_read_b128 v[76:79], v3 offset:0
    v_mfma_f32_16x16x32_bf16 v[132:135], v[48:51], v[36:39], v[132:135]
    s_add_u32 m0, s31, 0x18000
    s_mov_b32 s28, 0x380000
    buffer_load_dwordx4 v12, s[12:15], s28 offen lds
    v_mfma_f32_16x16x32_bf16 v[136:139], v[48:51], v[40:43], v[136:139]
    ds_read_b128 v[80:83], v3 offset:2048
    v_mfma_f32_16x16x32_bf16 v[140:143], v[48:51], v[44:47], v[140:143]
    ds_read_b128 v[84:87], v3 offset:4096
    v_mfma_f32_16x16x32_bf16 v[144:147], v[52:55], v[32:35], v[144:147]
    ds_read_b128 v[88:91], v3 offset:6144
    v_mfma_f32_16x16x32_bf16 v[148:151], v[52:55], v[36:39], v[148:151]
    s_cmp_ge_u32 s20, 6
    s_cbranch_scc1 g1w1_sk16
    s_add_u32 m0, s31, 0x1a000
    s_mov_b32 s28, 0x380000
    s_nop 0
    buffer_load_dwordx4 v13, s[12:15], s28 offen lds
g1w1_sk16:
    v_mfma_f32_16x16x32_bf16 v[152:155], v[52:55], v[40:43], v[152:155]
    ds_read_b64_tr_b16 v[92:93], v8 offset:14336
    v_mfma_f32_16x16x32_bf16 v[156:159], v[52:55], v[44:47], v[156:159]
    ds_read_b64_tr_b16 v[94:95], v8 offset:14848
    v_mfma_f32_16x16x32_bf16 v[160:163], v[56:59], v[32:35], v[160:163]
    ds_read_b64_tr_b16 v[96:97], v9 offset:14336
    v_mfma_f32_16x16x32_bf16 v[164:167], v[56:59], v[36:39], v[164:167]
    ds_read_b64_tr_b16 v[98:99], v9 offset:14848
    v_mfma_f32_16x16x32_bf16 v[168:171], v[56:59], v[40:43], v[168:171]
    ds_read_b64_tr_b16 v[100:101], v8 offset:18432
    v_mfma_f32_16x16x32_bf16 v[172:175], v[56:59], v[44:47], v[172:175]
    ds_read_b64_tr_b16 v[102:103], v8 offset:18944
    v_mfma_f32_16x16x32_bf16 v[176:179], v[60:63], v[32:35], v[176:179]
    ds_read_b64_tr_b16 v[104:105], v9 offset:18432
    v_mfma_f32_16x16x32_bf16 v[180:183], v[60:63], v[36:39], v[180:183]
    ds_read_b64_tr_b16 v[106:107], v9 offset:18944
    v_mfma_f32_16x16x32_bf16 v[184:187], v[60:63], v[40:43], v[184:187]
    ds_read_b64_tr_b16 v[108:109], v8 offset:22528
    v_mfma_f32_16x16x32_bf16 v[188:191], v[60:63], v[44:47], v[188:191]
    ds_read_b64_tr_b16 v[110:111], v8 offset:23040
    v_mfma_f32_16x16x32_bf16 v[192:195], v[64:67], v[32:35], v[192:195]
    ds_read_b64_tr_b16 v[112:113], v9 offset:22528
    v_mfma_f32_16x16x32_bf16 v[196:199], v[64:67], v[36:39], v[196:199]
    ds_read_b64_tr_b16 v[114:115], v9 offset:23040
    v_mfma_f32_16x16x32_bf16 v[200:203], v[64:67], v[40:43], v[200:203]
    ds_read_b64_tr_b16 v[116:117], v10 offset:14336
    v_mfma_f32_16x16x32_bf16 v[204:207], v[64:67], v[44:47], v[204:207]
    ds_read_b64_tr_b16 v[118:119], v10 offset:14592
    v_mfma_f32_16x16x32_bf16 v[208:211], v[68:71], v[32:35], v[208:211]
    v_mfma_f32_16x16x32_bf16 v[212:215], v[68:71], v[36:39], v[212:215]
    v_mfma_f32_16x16x32_bf16 v[216:219], v[68:71], v[40:43], v[216:219]
    v_mfma_f32_16x16x32_bf16 v[220:223], v[68:71], v[44:47], v[220:223]
    v_mfma_f32_16x16x32_bf16 v[224:227], v[72:75], v[32:35], v[224:227]
    v_mfma_f32_16x16x32_bf16 v[228:231], v[72:75], v[36:39], v[228:231]
    v_mfma_f32_16x16x32_bf16 v[232:235], v[72:75], v[40:43], v[232:235]
    v_mfma_f32_16x16x32_bf16 v[236:239], v[72:75], v[44:47], v[236:239]
    s_waitcnt lgkmcnt(0)
    s_waitcnt vmcnt(6)
    s_barrier
    v_mfma_f32_16x16x32_bf16 v[128:131], v[92:95], v[76:79], v[128:131]
    ds_read_b128 v[32:35], v4 offset:0
    v_mfma_f32_16x16x32_bf16 v[132:135], v[92:95], v[80:83], v[132:135]
    s_add_u32 m0, s31, 0x1b800
    s_mov_b32 s28, 0x3b8000
    buffer_load_dwordx4 v12, s[12:15], s28 offen lds
    v_mfma_f32_16x16x32_bf16 v[136:139], v[92:95], v[84:87], v[136:139]
    ds_read_b128 v[36:39], v4 offset:2048
    v_mfma_f32_16x16x32_bf16 v[140:143], v[92:95], v[88:91], v[140:143]
    ds_read_b128 v[40:43], v4 offset:4096
    v_mfma_f32_16x16x32_bf16 v[144:147], v[96:99], v[76:79], v[144:147]
    ds_read_b128 v[44:47], v4 offset:6144
    v_mfma_f32_16x16x32_bf16 v[148:151], v[96:99], v[80:83], v[148:151]
    s_cmp_ge_u32 s20, 6
    s_cbranch_scc1 g1w1_sk17
    s_add_u32 m0, s31, 0x1d800
    s_mov_b32 s28, 0x3b8000
    s_nop 0
    buffer_load_dwordx4 v13, s[12:15], s28 offen lds
g1w1_sk17:
    v_mfma_f32_16x16x32_bf16 v[152:155], v[96:99], v[84:87], v[152:155]
    ds_read_b64_tr_b16 v[48:49], v8 offset:28672
    v_mfma_f32_16x16x32_bf16 v[156:159], v[96:99], v[88:91], v[156:159]
    ds_read_b64_tr_b16 v[50:51], v8 offset:29184
    v_mfma_f32_16x16x32_bf16 v[160:163], v[100:103], v[76:79], v[160:163]
    ds_read_b64_tr_b16 v[52:53], v9 offset:28672
    v_mfma_f32_16x16x32_bf16 v[164:167], v[100:103], v[80:83], v[164:167]
    s_add_u32 m0, s30, 0x0
    s_mov_b32 s28, 0x480
    buffer_load_dwordx4 v11, s[8:11], s28 offen lds
    v_mfma_f32_16x16x32_bf16 v[168:171], v[100:103], v[84:87], v[168:171]
    ds_read_b64_tr_b16 v[54:55], v9 offset:29184
    v_mfma_f32_16x16x32_bf16 v[172:175], v[100:103], v[88:91], v[172:175]
    ds_read_b64_tr_b16 v[56:57], v8 offset:32768
    v_mfma_f32_16x16x32_bf16 v[176:179], v[104:107], v[76:79], v[176:179]
    ds_read_b64_tr_b16 v[58:59], v8 offset:33280
    v_mfma_f32_16x16x32_bf16 v[180:183], v[104:107], v[80:83], v[180:183]
    s_add_u32 m0, s30, 0x400
    s_mov_b32 s28, 0x4480
    buffer_load_dwordx4 v11, s[8:11], s28 offen lds
    v_mfma_f32_16x16x32_bf16 v[184:187], v[104:107], v[84:87], v[184:187]
    ds_read_b64_tr_b16 v[60:61], v9 offset:32768
    v_mfma_f32_16x16x32_bf16 v[188:191], v[104:107], v[88:91], v[188:191]
    ds_read_b64_tr_b16 v[62:63], v9 offset:33280
    v_mfma_f32_16x16x32_bf16 v[192:195], v[108:111], v[76:79], v[192:195]
    ds_read_b64_tr_b16 v[64:65], v8 offset:36864
    v_mfma_f32_16x16x32_bf16 v[196:199], v[108:111], v[80:83], v[196:199]
    s_add_u32 m0, s30, 0x800
    s_mov_b32 s28, 0x8480
    buffer_load_dwordx4 v11, s[8:11], s28 offen lds
    v_mfma_f32_16x16x32_bf16 v[200:203], v[108:111], v[84:87], v[200:203]
    ds_read_b64_tr_b16 v[66:67], v8 offset:37376
    v_mfma_f32_16x16x32_bf16 v[204:207], v[108:111], v[88:91], v[204:207]
    ds_read_b64_tr_b16 v[68:69], v9 offset:36864
    v_mfma_f32_16x16x32_bf16 v[208:211], v[112:115], v[76:79], v[208:211]
    ds_read_b64_tr_b16 v[70:71], v9 offset:37376
    v_mfma_f32_16x16x32_bf16 v[212:215], v[112:115], v[80:83], v[212:215]
    s_add_u32 m0, s30, 0xc00
    s_mov_b32 s28, 0xc480
    buffer_load_dwordx4 v11, s[8:11], s28 offen lds
    v_mfma_f32_16x16x32_bf16 v[216:219], v[112:115], v[84:87], v[216:219]
    ds_read_b64_tr_b16 v[72:73], v10 offset:28672
    v_mfma_f32_16x16x32_bf16 v[220:223], v[112:115], v[88:91], v[220:223]
    ds_read_b64_tr_b16 v[74:75], v10 offset:28928
    v_mfma_f32_16x16x32_bf16 v[224:227], v[116:119], v[76:79], v[224:227]
    v_mfma_f32_16x16x32_bf16 v[228:231], v[116:119], v[80:83], v[228:231]
    v_mfma_f32_16x16x32_bf16 v[232:235], v[116:119], v[84:87], v[232:235]
    v_mfma_f32_16x16x32_bf16 v[236:239], v[116:119], v[88:91], v[236:239]
    s_waitcnt lgkmcnt(0)
    s_waitcnt vmcnt(10)
    s_barrier
    v_mfma_f32_16x16x32_bf16 v[128:131], v[48:51], v[32:35], v[128:131]
    ds_read_b128 v[76:79], v5 offset:0
    v_mfma_f32_16x16x32_bf16 v[132:135], v[48:51], v[36:39], v[132:135]
    s_add_u32 m0, s31, 0x1f000
    s_mov_b32 s28, 0x3f0000
    buffer_load_dwordx4 v12, s[12:15], s28 offen lds
    v_mfma_f32_16x16x32_bf16 v[136:139], v[48:51], v[40:43], v[136:139]
    ds_read_b128 v[80:83], v5 offset:2048
    v_mfma_f32_16x16x32_bf16 v[140:143], v[48:51], v[44:47], v[140:143]
    ds_read_b128 v[84:87], v5 offset:4096
    v_mfma_f32_16x16x32_bf16 v[144:147], v[52:55], v[32:35], v[144:147]
    ds_read_b128 v[88:91], v5 offset:6144
    v_mfma_f32_16x16x32_bf16 v[148:151], v[52:55], v[36:39], v[148:151]
    s_cmp_ge_u32 s20, 6
    s_cbranch_scc1 g1w1_sk18
    s_add_u32 m0, s31, 0x21000
    s_mov_b32 s28, 0x3f0000
    s_nop 0
    buffer_load_dwordx4 v13, s[12:15], s28 offen lds
g1w1_sk18:
    v_mfma_f32_16x16x32_bf16 v[152:155], v[52:55], v[40:43], v[152:155]
    ds_read_b64_tr_b16 v[92:93], v8 offset:43008
    v_mfma_f32_16x16x32_bf16 v[156:159], v[52:55], v[44:47], v[156:159]
    ds_read_b64_tr_b16 v[94:95], v8 offset:43520
    v_mfma_f32_16x16x32_bf16 v[160:163], v[56:59], v[32:35], v[160:163]
    ds_read_b64_tr_b16 v[96:97], v9 offset:43008
    v_mfma_f32_16x16x32_bf16 v[164:167], v[56:59], v[36:39], v[164:167]
    s_add_u32 m0, s77, 0x26000
    s_mov_b32 s28, 0x400000
    buffer_load_dwordx4 v30, s[88:91], s28 offen lds
    v_mfma_f32_16x16x32_bf16 v[168:171], v[56:59], v[40:43], v[168:171]
    ds_read_b64_tr_b16 v[98:99], v9 offset:43520
    v_mfma_f32_16x16x32_bf16 v[172:175], v[56:59], v[44:47], v[172:175]
    ds_read_b64_tr_b16 v[100:101], v8 offset:47104
    v_mfma_f32_16x16x32_bf16 v[176:179], v[60:63], v[32:35], v[176:179]
    ds_read_b64_tr_b16 v[102:103], v8 offset:47616
    v_mfma_f32_16x16x32_bf16 v[180:183], v[60:63], v[36:39], v[180:183]
    ds_read_b64_tr_b16 v[104:105], v9 offset:47104
    v_mfma_f32_16x16x32_bf16 v[184:187], v[60:63], v[40:43], v[184:187]
    ds_read_b64_tr_b16 v[106:107], v9 offset:47616
    v_mfma_f32_16x16x32_bf16 v[188:191], v[60:63], v[44:47], v[188:191]
    ds_read_b64_tr_b16 v[108:109], v8 offset:51200
    v_mfma_f32_16x16x32_bf16 v[192:195], v[64:67], v[32:35], v[192:195]
    ds_read_b64_tr_b16 v[110:111], v8 offset:51712
    v_mfma_f32_16x16x32_bf16 v[196:199], v[64:67], v[36:39], v[196:199]
    ds_read_b64_tr_b16 v[112:113], v9 offset:51200
    v_mfma_f32_16x16x32_bf16 v[200:203], v[64:67], v[40:43], v[200:203]
    ds_read_b64_tr_b16 v[114:115], v9 offset:51712
    v_mfma_f32_16x16x32_bf16 v[204:207], v[64:67], v[44:47], v[204:207]
    ds_read_b64_tr_b16 v[116:117], v10 offset:43008
    v_mfma_f32_16x16x32_bf16 v[208:211], v[68:71], v[32:35], v[208:211]
    ds_read_b64_tr_b16 v[118:119], v10 offset:43264
    v_mfma_f32_16x16x32_bf16 v[212:215], v[68:71], v[36:39], v[212:215]
    v_mfma_f32_16x16x32_bf16 v[216:219], v[68:71], v[40:43], v[216:219]
    v_mfma_f32_16x16x32_bf16 v[220:223], v[68:71], v[44:47], v[220:223]
    v_mfma_f32_16x16x32_bf16 v[224:227], v[72:75], v[32:35], v[224:227]
    v_mfma_f32_16x16x32_bf16 v[228:231], v[72:75], v[36:39], v[228:231]
    v_mfma_f32_16x16x32_bf16 v[232:235], v[72:75], v[40:43], v[232:235]
    v_mfma_f32_16x16x32_bf16 v[236:239], v[72:75], v[44:47], v[236:239]
    s_waitcnt lgkmcnt(0)
    s_waitcnt vmcnt(6)
    s_barrier
    v_mfma_f32_16x16x32_bf16 v[128:131], v[92:95], v[76:79], v[128:131]
    ds_read_b128 v[32:35], v6 offset:0
    v_mfma_f32_16x16x32_bf16 v[132:135], v[92:95], v[80:83], v[132:135]
    s_add_u32 m0, s31, 0x22800
    s_mov_b32 s28, 0x428000
    buffer_load_dwordx4 v12, s[12:15], s28 offen lds
    v_mfma_f32_16x16x32_bf16 v[136:139], v[92:95], v[84:87], v[136:139]
    ds_read_b128 v[36:39], v6 offset:2048
    v_mfma_f32_16x16x32_bf16 v[140:143], v[92:95], v[88:91], v[140:143]
    ds_read_b128 v[40:43], v6 offset:4096
    v_mfma_f32_16x16x32_bf16 v[144:147], v[96:99], v[76:79], v[144:147]
    ds_read_b128 v[44:47], v6 offset:6144
    v_mfma_f32_16x16x32_bf16 v[148:151], v[96:99], v[80:83], v[148:151]
    s_cmp_ge_u32 s20, 6
    s_cbranch_scc1 g1w1_sk19
    s_add_u32 m0, s31, 0x24800
    s_mov_b32 s28, 0x428000
    s_nop 0
    buffer_load_dwordx4 v13, s[12:15], s28 offen lds
g1w1_sk19:
    v_mfma_f32_16x16x32_bf16 v[152:155], v[96:99], v[84:87], v[152:155]
    ds_read_b64_tr_b16 v[48:49], v8 offset:0
    v_mfma_f32_16x16x32_bf16 v[156:159], v[96:99], v[88:91], v[156:159]
    ds_read_b64_tr_b16 v[50:51], v8 offset:512
    v_mfma_f32_16x16x32_bf16 v[160:163], v[100:103], v[76:79], v[160:163]
    ds_read_b64_tr_b16 v[52:53], v9 offset:0
    v_mfma_f32_16x16x32_bf16 v[164:167], v[100:103], v[80:83], v[164:167]
    s_add_u32 m0, s30, 0x8000
    s_mov_b32 s28, 0x500
    buffer_load_dwordx4 v11, s[8:11], s28 offen lds
    v_mfma_f32_16x16x32_bf16 v[168:171], v[100:103], v[84:87], v[168:171]
    ds_read_b64_tr_b16 v[54:55], v9 offset:512
    v_mfma_f32_16x16x32_bf16 v[172:175], v[100:103], v[88:91], v[172:175]
    ds_read_b64_tr_b16 v[56:57], v8 offset:4096
    v_mfma_f32_16x16x32_bf16 v[176:179], v[104:107], v[76:79], v[176:179]
    ds_read_b64_tr_b16 v[58:59], v8 offset:4608
    v_mfma_f32_16x16x32_bf16 v[180:183], v[104:107], v[80:83], v[180:183]
    s_add_u32 m0, s30, 0x8400
    s_mov_b32 s28, 0x4500
    buffer_load_dwordx4 v11, s[8:11], s28 offen lds
    v_mfma_f32_16x16x32_bf16 v[184:187], v[104:107], v[84:87], v[184:187]
    ds_read_b64_tr_b16 v[60:61], v9 offset:4096
    v_mfma_f32_16x16x32_bf16 v[188:191], v[104:107], v[88:91], v[188:191]
    ds_read_b64_tr_b16 v[62:63], v9 offset:4608
    v_mfma_f32_16x16x32_bf16 v[192:195], v[108:111], v[76:79], v[192:195]
    ds_read_b64_tr_b16 v[64:65], v8 offset:8192
    v_mfma_f32_16x16x32_bf16 v[196:199], v[108:111], v[80:83], v[196:199]
    s_add_u32 m0, s30, 0x8800
    s_mov_b32 s28, 0x8500
    buffer_load_dwordx4 v11, s[8:11], s28 offen lds
    v_mfma_f32_16x16x32_bf16 v[200:203], v[108:111], v[84:87], v[200:203]
    ds_read_b64_tr_b16 v[66:67], v8 offset:8704
    v_mfma_f32_16x16x32_bf16 v[204:207], v[108:111], v[88:91], v[204:207]
    ds_read_b64_tr_b16 v[68:69], v9 offset:8192
    v_mfma_f32_16x16x32_bf16 v[208:211], v[112:115], v[76:79], v[208:211]
    ds_read_b64_tr_b16 v[70:71], v9 offset:8704
    v_mfma_f32_16x16x32_bf16 v[212:215], v[112:115], v[80:83], v[212:215]
    s_add_u32 m0, s30, 0x8c00
    s_mov_b32 s28, 0xc500
    buffer_load_dwordx4 v11, s[8:11], s28 offen lds
    v_mfma_f32_16x16x32_bf16 v[216:219], v[112:115], v[84:87], v[216:219]
    ds_read_b64_tr_b16 v[72:73], v10 offset:0
    v_mfma_f32_16x16x32_bf16 v[220:223], v[112:115], v[88:91], v[220:223]
    ds_read_b64_tr_b16 v[74:75], v10 offset:256
    v_mfma_f32_16x16x32_bf16 v[224:227], v[116:119], v[76:79], v[224:227]
    v_mfma_f32_16x16x32_bf16 v[228:231], v[116:119], v[80:83], v[228:231]
    v_mfma_f32_16x16x32_bf16 v[232:235], v[116:119], v[84:87], v[232:235]
    v_mfma_f32_16x16x32_bf16 v[236:239], v[116:119], v[88:91], v[236:239]
    s_waitcnt lgkmcnt(0)
    s_waitcnt vmcnt(10)
    s_barrier
    v_mfma_f32_16x16x32_bf16 v[128:131], v[48:51], v[32:35], v[128:131]
    ds_read_b128 v[76:79], v7 offset:0
    v_mfma_f32_16x16x32_bf16 v[132:135], v[48:51], v[36:39], v[132:135]
    s_add_u32 m0, s31, 0x18000
    s_mov_b32 s28, 0x460000
    buffer_load_dwordx4 v12, s[12:15], s28 offen lds
    v_mfma_f32_16x16x32_bf16 v[136:139], v[48:51], v[40:43], v[136:139]
    ds_read_b128 v[80:83], v7 offset:2048
    v_mfma_f32_16x16x32_bf16 v[140:143], v[48:51], v[44:47], v[140:143]
    ds_read_b128 v[84:87], v7 offset:4096
    v_mfma_f32_16x16x32_bf16 v[144:147], v[52:55], v[32:35], v[144:147]
    ds_read_b128 v[88:91], v7 offset:6144
    v_mfma_f32_16x16x32_bf16 v[148:151], v[52:55], v[36:39], v[148:151]
    s_cmp_ge_u32 s20, 6
    s_cbranch_scc1 g1w1_sk20
    s_add_u32 m0, s31, 0x1a000
    s_mov_b32 s28, 0x460000
    s_nop 0
    buffer_load_dwordx4 v13, s[12:15], s28 offen lds
g1w1_sk20:
    v_mfma_f32_16x16x32_bf16 v[152:155], v[52:55], v[40:43], v[152:155]
    ds_read_b64_tr_b16 v[92:93], v8 offset:14336
    v_mfma_f32_16x16x32_bf16 v[156:159], v[52:55], v[44:47], v[156:159]
    ds_read_b64_tr_b16 v[94:95], v8 offset:14848
    v_mfma_f32_16x16x32_bf16 v[160:163], v[56:59], v[32:35], v[160:163]
    ds_read_b64_tr_b16 v[96:97], v9 offset:14336
    v_mfma_f32_16x16x32_bf16 v[164:167], v[56:59], v[36:39], v[164:167]
    ds_read_b64_tr_b16 v[98:99], v9 offset:14848
    v_mfma_f32_16x16x32_bf16 v[168:171], v[56:59], v[40:43], v[168:171]
    ds_read_b64_tr_b16 v[100:101], v8 offset:18432
    v_mfma_f32_16x16x32_bf16 v[172:175], v[56:59], v[44:47], v[172:175]
    ds_read_b64_tr_b16 v[102:103], v8 offset:18944
    v_mfma_f32_16x16x32_bf16 v[176:179], v[60:63], v[32:35], v[176:179]
    ds_read_b64_tr_b16 v[104:105], v9 offset:18432
    v_mfma_f32_16x16x32_bf16 v[180:183], v[60:63], v[36:39], v[180:183]
    ds_read_b64_tr_b16 v[106:107], v9 offset:18944
    v_mfma_f32_16x16x32_bf16 v[184:187], v[60:63], v[40:43], v[184:187]
    ds_read_b64_tr_b16 v[108:109], v8 offset:22528
    v_mfma_f32_16x16x32_bf16 v[188:191], v[60:63], v[44:47], v[188:191]
    ds_read_b64_tr_b16 v[110:111], v8 offset:23040
    v_mfma_f32_16x16x32_bf16 v[192:195], v[64:67], v[32:35], v[192:195]
    ds_read_b64_tr_b16 v[112:113], v9 offset:22528
    v_mfma_f32_16x16x32_bf16 v[196:199], v[64:67], v[36:39], v[196:199]
    ds_read_b64_tr_b16 v[114:115], v9 offset:23040
    v_mfma_f32_16x16x32_bf16 v[200:203], v[64:67], v[40:43], v[200:203]
    ds_read_b64_tr_b16 v[116:117], v10 offset:14336
    v_mfma_f32_16x16x32_bf16 v[204:207], v[64:67], v[44:47], v[204:207]
    ds_read_b64_tr_b16 v[118:119], v10 offset:14592
    v_mfma_f32_16x16x32_bf16 v[208:211], v[68:71], v[32:35], v[208:211]
    v_mfma_f32_16x16x32_bf16 v[212:215], v[68:71], v[36:39], v[212:215]
    v_mfma_f32_16x16x32_bf16 v[216:219], v[68:71], v[40:43], v[216:219]
    v_mfma_f32_16x16x32_bf16 v[220:223], v[68:71], v[44:47], v[220:223]
    v_mfma_f32_16x16x32_bf16 v[224:227], v[72:75], v[32:35], v[224:227]
    v_mfma_f32_16x16x32_bf16 v[228:231], v[72:75], v[36:39], v[228:231]
    v_mfma_f32_16x16x32_bf16 v[232:235], v[72:75], v[40:43], v[232:235]
    v_mfma_f32_16x16x32_bf16 v[236:239], v[72:75], v[44:47], v[236:239]
    s_waitcnt lgkmcnt(0)
    s_waitcnt vmcnt(6)
    s_barrier
    v_mfma_f32_16x16x32_bf16 v[128:131], v[92:95], v[76:79], v[128:131]
    ds_read_b128 v[32:35], v2 offset:0
    v_mfma_f32_16x16x32_bf16 v[132:135], v[92:95], v[80:83], v[132:135]
    s_add_u32 m0, s31, 0x1b800
    s_mov_b32 s28, 0x498000
    buffer_load_dwordx4 v12, s[12:15], s28 offen lds
    v_mfma_f32_16x16x32_bf16 v[136:139], v[92:95], v[84:87], v[136:139]
    ds_read_b128 v[36:39], v2 offset:2048
    v_mfma_f32_16x16x32_bf16 v[140:143], v[92:95], v[88:91], v[140:143]
    ds_read_b128 v[40:43], v2 offset:4096
    v_mfma_f32_16x16x32_bf16 v[144:147], v[96:99], v[76:79], v[144:147]
    ds_read_b128 v[44:47], v2 offset:6144
    v_mfma_f32_16x16x32_bf16 v[148:151], v[96:99], v[80:83], v[148:151]
    s_cmp_ge_u32 s20, 6
    s_cbranch_scc1 g1w1_sk21
    s_add_u32 m0, s31, 0x1d800
    s_mov_b32 s28, 0x498000
    s_nop 0
    buffer_load_dwordx4 v13, s[12:15], s28 offen lds
g1w1_sk21:
    v_mfma_f32_16x16x32_bf16 v[152:155], v[96:99], v[84:87], v[152:155]
    ds_read_b64_tr_b16 v[48:49], v8 offset:28672
    v_mfma_f32_16x16x32_bf16 v[156:159], v[96:99], v[88:91], v[156:159]
    ds_read_b64_tr_b16 v[50:51], v8 offset:29184
    v_mfma_f32_16x16x32_bf16 v[160:163], v[100:103], v[76:79], v[160:163]
    ds_read_b64_tr_b16 v[52:53], v9 offset:28672
    v_mfma_f32_16x16x32_bf16 v[164:167], v[100:103], v[80:83], v[164:167]
    s_add_u32 m0, s30, 0x10000
    s_mov_b32 s28, 0x580
    buffer_load_dwordx4 v11, s[8:11], s28 offen lds
    v_mfma_f32_16x16x32_bf16 v[168:171], v[100:103], v[84:87], v[168:171]
    ds_read_b64_tr_b16 v[54:55], v9 offset:29184
    v_mfma_f32_16x16x32_bf16 v[172:175], v[100:103], v[88:91], v[172:175]
    ds_read_b64_tr_b16 v[56:57], v8 offset:32768
    v_mfma_f32_16x16x32_bf16 v[176:179], v[104:107], v[76:79], v[176:179]
    ds_read_b64_tr_b16 v[58:59], v8 offset:33280
    v_mfma_f32_16x16x32_bf16 v[180:183], v[104:107], v[80:83], v[180:183]
    s_add_u32 m0, s30, 0x10400
    s_mov_b32 s28, 0x4580
    buffer_load_dwordx4 v11, s[8:11], s28 offen lds
    v_mfma_f32_16x16x32_bf16 v[184:187], v[104:107], v[84:87], v[184:187]
    ds_read_b64_tr_b16 v[60:61], v9 offset:32768
    v_mfma_f32_16x16x32_bf16 v[188:191], v[104:107], v[88:91], v[188:191]
    ds_read_b64_tr_b16 v[62:63], v9 offset:33280
    v_mfma_f32_16x16x32_bf16 v[192:195], v[108:111], v[76:79], v[192:195]
    ds_read_b64_tr_b16 v[64:65], v8 offset:36864
    v_mfma_f32_16x16x32_bf16 v[196:199], v[108:111], v[80:83], v[196:199]
    s_add_u32 m0, s30, 0x10800
    s_mov_b32 s28, 0x8580
    buffer_load_dwordx4 v11, s[8:11], s28 offen lds
    v_mfma_f32_16x16x32_bf16 v[200:203], v[108:111], v[84:87], v[200:203]
    ds_read_b64_tr_b16 v[66:67], v8 offset:37376
    v_mfma_f32_16x16x32_bf16 v[204:207], v[108:111], v[88:91], v[204:207]
    ds_read_b64_tr_b16 v[68:69], v9 offset:36864
    v_mfma_f32_16x16x32_bf16 v[208:211], v[112:115], v[76:79], v[208:211]
    ds_read_b64_tr_b16 v[70:71], v9 offset:37376
    v_mfma_f32_16x16x32_bf16 v[212:215], v[112:115], v[80:83], v[212:215]
    s_add_u32 m0, s30, 0x10c00
    s_mov_b32 s28, 0xc580
    buffer_load_dwordx4 v11, s[8:11], s28 offen lds
    v_mfma_f32_16x16x32_bf16 v[216:219], v[112:115], v[84:87], v[216:219]
    ds_read_b64_tr_b16 v[72:73], v10 offset:28672
    v_mfma_f32_16x16x32_bf16 v[220:223], v[112:115], v[88:91], v[220:223]
    ds_read_b64_tr_b16 v[74:75], v10 offset:28928
    v_mfma_f32_16x16x32_bf16 v[224:227], v[116:119], v[76:79], v[224:227]
    v_mfma_f32_16x16x32_bf16 v[228:231], v[116:119], v[80:83], v[228:231]
    v_mfma_f32_16x16x32_bf16 v[232:235], v[116:119], v[84:87], v[232:235]
    v_mfma_f32_16x16x32_bf16 v[236:239], v[116:119], v[88:91], v[236:239]
    s_waitcnt lgkmcnt(0)
    s_waitcnt vmcnt(10)
    s_barrier
    v_mfma_f32_16x16x32_bf16 v[128:131], v[48:51], v[32:35], v[128:131]
    ds_read_b128 v[76:79], v3 offset:0
    v_mfma_f32_16x16x32_bf16 v[132:135], v[48:51], v[36:39], v[132:135]
    s_add_u32 m0, s31, 0x1f000
    s_mov_b32 s28, 0x4d0000
    buffer_load_dwordx4 v12, s[12:15], s28 offen lds
    v_mfma_f32_16x16x32_bf16 v[136:139], v[48:51], v[40:43], v[136:139]
    ds_read_b128 v[80:83], v3 offset:2048
    v_mfma_f32_16x16x32_bf16 v[140:143], v[48:51], v[44:47], v[140:143]
    ds_read_b128 v[84:87], v3 offset:4096
    v_mfma_f32_16x16x32_bf16 v[144:147], v[52:55], v[32:35], v[144:147]
    ds_read_b128 v[88:91], v3 offset:6144
    v_mfma_f32_16x16x32_bf16 v[148:151], v[52:55], v[36:39], v[148:151]
    s_cmp_ge_u32 s20, 6
    s_cbranch_scc1 g1w1_sk22
    s_add_u32 m0, s31, 0x21000
    s_mov_b32 s28, 0x4d0000
    s_nop 0
    buffer_load_dwordx4 v13, s[12:15], s28 offen lds
g1w1_sk22:
    v_mfma_f32_16x16x32_bf16 v[152:155], v[52:55], v[40:43], v[152:155]
    ds_read_b64_tr_b16 v[92:93], v8 offset:43008
    v_mfma_f32_16x16x32_bf16 v[156:159], v[52:55], v[44:47], v[156:159]
    ds_read_b64_tr_b16 v[94:95], v8 offset:43520
    v_mfma_f32_16x16x32_bf16 v[160:163], v[56:59], v[32:35], v[160:163]
    ds_read_b64_tr_b16 v[96:97], v9 offset:43008
    v_mfma_f32_16x16x32_bf16 v[164:167], v[56:59], v[36:39], v[164:167]
    ds_read_b64_tr_b16 v[98:99], v9 offset:43520
    v_mfma_f32_16x16x32_bf16 v[168:171], v[56:59], v[40:43], v[168:171]
    ds_read_b64_tr_b16 v[100:101], v8 offset:47104
    v_mfma_f32_16x16x32_bf16 v[172:175], v[56:59], v[44:47], v[172:175]
    ds_read_b64_tr_b16 v[102:103], v8 offset:47616
    v_mfma_f32_16x16x32_bf16 v[176:179], v[60:63], v[32:35], v[176:179]
    ds_read_b64_tr_b16 v[104:105], v9 offset:47104
    v_mfma_f32_16x16x32_bf16 v[180:183], v[60:63], v[36:39], v[180:183]
    ds_read_b64_tr_b16 v[106:107], v9 offset:47616
    v_mfma_f32_16x16x32_bf16 v[184:187], v[60:63], v[40:43], v[184:187]
    ds_read_b64_tr_b16 v[108:109], v8 offset:51200
    v_mfma_f32_16x16x32_bf16 v[188:191], v[60:63], v[44:47], v[188:191]
    ds_read_b64_tr_b16 v[110:111], v8 offset:51712
    v_mfma_f32_16x16x32_bf16 v[192:195], v[64:67], v[32:35], v[192:195]
    ds_read_b64_tr_b16 v[112:113], v9 offset:51200
    v_mfma_f32_16x16x32_bf16 v[196:199], v[64:67], v[36:39], v[196:199]
    ds_read_b64_tr_b16 v[114:115], v9 offset:51712
    v_mfma_f32_16x16x32_bf16 v[200:203], v[64:67], v[40:43], v[200:203]
    ds_read_b64_tr_b16 v[116:117], v10 offset:43008
    v_mfma_f32_16x16x32_bf16 v[204:207], v[64:67], v[44:47], v[204:207]
    ds_read_b64_tr_b16 v[118:119], v10 offset:43264
    v_mfma_f32_16x16x32_bf16 v[208:211], v[68:71], v[32:35], v[208:211]
    v_mfma_f32_16x16x32_bf16 v[212:215], v[68:71], v[36:39], v[212:215]
    v_mfma_f32_16x16x32_bf16 v[216:219], v[68:71], v[40:43], v[216:219]
    v_mfma_f32_16x16x32_bf16 v[220:223], v[68:71], v[44:47], v[220:223]
    v_mfma_f32_16x16x32_bf16 v[224:227], v[72:75], v[32:35], v[224:227]
    v_mfma_f32_16x16x32_bf16 v[228:231], v[72:75], v[36:39], v[228:231]
    v_mfma_f32_16x16x32_bf16 v[232:235], v[72:75], v[40:43], v[232:235]
    v_mfma_f32_16x16x32_bf16 v[236:239], v[72:75], v[44:47], v[236:239]
    s_waitcnt lgkmcnt(0)
    s_waitcnt vmcnt(6)
    s_barrier
    v_mfma_f32_16x16x32_bf16 v[128:131], v[92:95], v[76:79], v[128:131]
    ds_read_b128 v[32:35], v4 offset:0
    v_mfma_f32_16x16x32_bf16 v[132:135], v[92:95], v[80:83], v[132:135]
    s_add_u32 m0, s31, 0x22800
    s_mov_b32 s28, 0x508000
    buffer_load_dwordx4 v12, s[12:15], s28 offen lds
    v_mfma_f32_16x16x32_bf16 v[136:139], v[92:95], v[84:87], v[136:139]
    ds_read_b128 v[36:39], v4 offset:2048
    v_mfma_f32_16x16x32_bf16 v[140:143], v[92:95], v[88:91], v[140:143]
    ds_read_b128 v[40:43], v4 offset:4096
    v_mfma_f32_16x16x32_bf16 v[144:147], v[96:99], v[76:79], v[144:147]
    ds_read_b128 v[44:47], v4 offset:6144
    v_mfma_f32_16x16x32_bf16 v[148:151], v[96:99], v[80:83], v[148:151]
    s_cmp_ge_u32 s20, 6
    s_cbranch_scc1 g1w1_sk23
    s_add_u32 m0, s31, 0x24800
    s_mov_b32 s28, 0x508000
    s_nop 0
    buffer_load_dwordx4 v13, s[12:15], s28 offen lds
g1w1_sk23:
    v_mfma_f32_16x16x32_bf16 v[152:155], v[96:99], v[84:87], v[152:155]
    ds_read_b64_tr_b16 v[48:49], v8 offset:0
    v_mfma_f32_16x16x32_bf16 v[156:159], v[96:99], v[88:91], v[156:159]
    ds_read_b64_tr_b16 v[50:51], v8 offset:512
    v_mfma_f32_16x16x32_bf16 v[160:163], v[100:103], v[76:79], v[160:163]
    ds_read_b64_tr_b16 v[52:53], v9 offset:0
    v_mfma_f32_16x16x32_bf16 v[164:167], v[100:103], v[80:83], v[164:167]
    s_add_u32 m0, s30, 0x0
    s_mov_b32 s28, 0x600
    buffer_load_dwordx4 v11, s[8:11], s28 offen lds
    v_mfma_f32_16x16x32_bf16 v[168:171], v[100:103], v[84:87], v[168:171]
    ds_read_b64_tr_b16 v[54:55], v9 offset:512
    v_mfma_f32_16x16x32_bf16 v[172:175], v[100:103], v[88:91], v[172:175]
    ds_read_b64_tr_b16 v[56:57], v8 offset:4096
    v_mfma_f32_16x16x32_bf16 v[176:179], v[104:107], v[76:79], v[176:179]
    ds_read_b64_tr_b16 v[58:59], v8 offset:4608
    v_mfma_f32_16x16x32_bf16 v[180:183], v[104:107], v[80:83], v[180:183]
    s_add_u32 m0, s30, 0x400
    s_mov_b32 s28, 0x4600
    buffer_load_dwordx4 v11, s[8:11], s28 offen lds
    v_mfma_f32_16x16x32_bf16 v[184:187], v[104:107], v[84:87], v[184:187]
    ds_read_b64_tr_b16 v[60:61], v9 offset:4096
    v_mfma_f32_16x16x32_bf16 v[188:191], v[104:107], v[88:91], v[188:191]
    ds_read_b64_tr_b16 v[62:63], v9 offset:4608
    v_mfma_f32_16x16x32_bf16 v[192:195], v[108:111], v[76:79], v[192:195]
    ds_read_b64_tr_b16 v[64:65], v8 offset:8192
    v_mfma_f32_16x16x32_bf16 v[196:199], v[108:111], v[80:83], v[196:199]
    s_add_u32 m0, s30, 0x800
    s_mov_b32 s28, 0x8600
    buffer_load_dwordx4 v11, s[8:11], s28 offen lds
    v_mfma_f32_16x16x32_bf16 v[200:203], v[108:111], v[84:87], v[200:203]
    ds_read_b64_tr_b16 v[66:67], v8 offset:8704
    v_mfma_f32_16x16x32_bf16 v[204:207], v[108:111], v[88:91], v[204:207]
    ds_read_b64_tr_b16 v[68:69], v9 offset:8192
    v_mfma_f32_16x16x32_bf16 v[208:211], v[112:115], v[76:79], v[208:211]
    ds_read_b64_tr_b16 v[70:71], v9 offset:8704
    v_mfma_f32_16x16x32_bf16 v[212:215], v[112:115], v[80:83], v[212:215]
    s_add_u32 m0, s30, 0xc00
    s_mov_b32 s28, 0xc600
    buffer_load_dwordx4 v11, s[8:11], s28 offen lds
    v_mfma_f32_16x16x32_bf16 v[216:219], v[112:115], v[84:87], v[216:219]
    ds_read_b64_tr_b16 v[72:73], v10 offset:0
    v_mfma_f32_16x16x32_bf16 v[220:223], v[112:115], v[88:91], v[220:223]
    ds_read_b64_tr_b16 v[74:75], v10 offset:256
    v_mfma_f32_16x16x32_bf16 v[224:227], v[116:119], v[76:79], v[224:227]
    s_add_u32 m0, s77, 0x26000
    s_mov_b32 s28, 0x500000
    buffer_load_dwordx4 v30, s[88:91], s28 offen lds
    v_mfma_f32_16x16x32_bf16 v[228:231], v[116:119], v[80:83], v[228:231]
    v_mfma_f32_16x16x32_bf16 v[232:235], v[116:119], v[84:87], v[232:235]
    v_mfma_f32_16x16x32_bf16 v[236:239], v[116:119], v[88:91], v[236:239]
    s_waitcnt lgkmcnt(0)
    s_waitcnt vmcnt(10)
    s_barrier
    v_mfma_f32_16x16x32_bf16 v[128:131], v[48:51], v[32:35], v[128:131]
    ds_read_b128 v[76:79], v5 offset:0
    v_mfma_f32_16x16x32_bf16 v[132:135], v[48:51], v[36:39], v[132:135]
    s_add_u32 m0, s31, 0x18000
    s_mov_b32 s28, 0x540000
    buffer_load_dwordx4 v12, s[12:15], s28 offen lds
    v_mfma_f32_16x16x32_bf16 v[136:139], v[48:51], v[40:43], v[136:139]
    ds_read_b128 v[80:83], v5 offset:2048
    v_mfma_f32_16x16x32_bf16 v[140:143], v[48:51], v[44:47], v[140:143]
    ds_read_b128 v[84:87], v5 offset:4096
    v_mfma_f32_16x16x32_bf16 v[144:147], v[52:55], v[32:35], v[144:147]
    ds_read_b128 v[88:91], v5 offset:6144
    v_mfma_f32_16x16x32_bf16 v[148:151], v[52:55], v[36:39], v[148:151]
    s_cmp_ge_u32 s20, 6
    s_cbranch_scc1 g1w1_sk24
    s_add_u32 m0, s31, 0x1a000
    s_mov_b32 s28, 0x540000
    s_nop 0
    buffer_load_dwordx4 v13, s[12:15], s28 offen lds
g1w1_sk24:
    v_mfma_f32_16x16x32_bf16 v[152:155], v[52:55], v[40:43], v[152:155]
    ds_read_b64_tr_b16 v[92:93], v8 offset:14336
    v_mfma_f32_16x16x32_bf16 v[156:159], v[52:55], v[44:47], v[156:159]
    ds_read_b64_tr_b16 v[94:95], v8 offset:14848
    v_mfma_f32_16x16x32_bf16 v[160:163], v[56:59], v[32:35], v[160:163]
    ds_read_b64_tr_b16 v[96:97], v9 offset:14336
    v_mfma_f32_16x16x32_bf16 v[164:167], v[56:59], v[36:39], v[164:167]
    ds_read_b64_tr_b16 v[98:99], v9 offset:14848
    v_mfma_f32_16x16x32_bf16 v[168:171], v[56:59], v[40:43], v[168:171]
    ds_read_b64_tr_b16 v[100:101], v8 offset:18432
    v_mfma_f32_16x16x32_bf16 v[172:175], v[56:59], v[44:47], v[172:175]
    ds_read_b64_tr_b16 v[102:103], v8 offset:18944
    v_mfma_f32_16x16x32_bf16 v[176:179], v[60:63], v[32:35], v[176:179]
    ds_read_b64_tr_b16 v[104:105], v9 offset:18432
    v_mfma_f32_16x16x32_bf16 v[180:183], v[60:63], v[36:39], v[180:183]
    ds_read_b64_tr_b16 v[106:107], v9 offset:18944
    v_mfma_f32_16x16x32_bf16 v[184:187], v[60:63], v[40:43], v[184:187]
    ds_read_b64_tr_b16 v[108:109], v8 offset:22528
    v_mfma_f32_16x16x32_bf16 v[188:191], v[60:63], v[44:47], v[188:191]
    ds_read_b64_tr_b16 v[110:111], v8 offset:23040
    v_mfma_f32_16x16x32_bf16 v[192:195], v[64:67], v[32:35], v[192:195]
    ds_read_b64_tr_b16 v[112:113], v9 offset:22528
    v_mfma_f32_16x16x32_bf16 v[196:199], v[64:67], v[36:39], v[196:199]
    ds_read_b64_tr_b16 v[114:115], v9 offset:23040
    v_mfma_f32_16x16x32_bf16 v[200:203], v[64:67], v[40:43], v[200:203]
    ds_read_b64_tr_b16 v[116:117], v10 offset:14336
    v_mfma_f32_16x16x32_bf16 v[204:207], v[64:67], v[44:47], v[204:207]
    ds_read_b64_tr_b16 v[118:119], v10 offset:14592
    v_mfma_f32_16x16x32_bf16 v[208:211], v[68:71], v[32:35], v[208:211]
    v_mfma_f32_16x16x32_bf16 v[212:215], v[68:71], v[36:39], v[212:215]
    v_mfma_f32_16x16x32_bf16 v[216:219], v[68:71], v[40:43], v[216:219]
    v_mfma_f32_16x16x32_bf16 v[220:223], v[68:71], v[44:47], v[220:223]
    v_mfma_f32_16x16x32_bf16 v[224:227], v[72:75], v[32:35], v[224:227]
    v_mfma_f32_16x16x32_bf16 v[228:231], v[72:75], v[36:39], v[228:231]
    v_mfma_f32_16x16x32_bf16 v[232:235], v[72:75], v[40:43], v[232:235]
    v_mfma_f32_16x16x32_bf16 v[236:239], v[72:75], v[44:47], v[236:239]
    s_waitcnt lgkmcnt(0)
    s_waitcnt vmcnt(6)
    s_barrier
    v_mfma_f32_16x16x32_bf16 v[128:131], v[92:95], v[76:79], v[128:131]
    ds_read_b128 v[32:35], v6 offset:0
    v_mfma_f32_16x16x32_bf16 v[132:135], v[92:95], v[80:83], v[132:135]
    s_add_u32 m0, s31, 0x1b800
    s_mov_b32 s28, 0x578000
    buffer_load_dwordx4 v12, s[12:15], s28 offen lds
    v_mfma_f32_16x16x32_bf16 v[136:139], v[92:95], v[84:87], v[136:139]
    ds_read_b128 v[36:39], v6 offset:2048
    v_mfma_f32_16x16x32_bf16 v[140:143], v[92:95], v[88:91], v[140:143]
    ds_read_b128 v[40:43], v6 offset:4096
    v_mfma_f32_16x16x32_bf16 v[144:147], v[96:99], v[76:79], v[144:147]
    ds_read_b128 v[44:47], v6 offset:6144
    v_mfma_f32_16x16x32_bf16 v[148:151], v[96:99], v[80:83], v[148:151]
    s_cmp_ge_u32 s20, 6
    s_cbranch_scc1 g1w1_sk25
    s_add_u32 m0, s31, 0x1d800
    s_mov_b32 s28, 0x578000
    s_nop 0
    buffer_load_dwordx4 v13, s[12:15], s28 offen lds
g1w1_sk25:
    v_mfma_f32_16x16x32_bf16 v[152:155], v[96:99], v[84:87], v[152:155]
    ds_read_b64_tr_b16 v[48:49], v8 offset:28672
    v_mfma_f32_16x16x32_bf16 v[156:159], v[96:99], v[88:91], v[156:159]
    ds_read_b64_tr_b16 v[50:51], v8 offset:29184
    v_mfma_f32_16x16x32_bf16 v[160:163], v[100:103], v[76:79], v[160:163]
    ds_read_b64_tr_b16 v[52:53], v9 offset:28672
    v_mfma_f32_16x16x32_bf16 v[164:167], v[100:103], v[80:83], v[164:167]
    s_add_u32 m0, s30, 0x8000
    s_mov_b32 s28, 0x680
    buffer_load_dwordx4 v11, s[8:11], s28 offen lds
    v_mfma_f32_16x16x32_bf16 v[168:171], v[100:103], v[84:87], v[168:171]
    ds_read_b64_tr_b16 v[54:55], v9 offset:29184
    v_mfma_f32_16x16x32_bf16 v[172:175], v[100:103], v[88:91], v[172:175]
    ds_read_b64_tr_b16 v[56:57], v8 offset:32768
    v_mfma_f32_16x16x32_bf16 v[176:179], v[104:107], v[76:79], v[176:179]
    ds_read_b64_tr_b16 v[58:59], v8 offset:33280
    v_mfma_f32_16x16x32_bf16 v[180:183], v[104:107], v[80:83], v[180:183]
    s_add_u32 m0, s30, 0x8400
    s_mov_b32 s28, 0x4680
    buffer_load_dwordx4 v11, s[8:11], s28 offen lds
    v_mfma_f32_16x16x32_bf16 v[184:187], v[104:107], v[84:87], v[184:187]
    ds_read_b64_tr_b16 v[60:61], v9 offset:32768
    v_mfma_f32_16x16x32_bf16 v[188:191], v[104:107], v[88:91], v[188:191]
    ds_read_b64_tr_b16 v[62:63], v9 offset:33280
    v_mfma_f32_16x16x32_bf16 v[192:195], v[108:111], v[76:79], v[192:195]
    ds_read_b64_tr_b16 v[64:65], v8 offset:36864
    v_mfma_f32_16x16x32_bf16 v[196:199], v[108:111], v[80:83], v[196:199]
    s_add_u32 m0, s30, 0x8800
    s_mov_b32 s28, 0x8680
    buffer_load_dwordx4 v11, s[8:11], s28 offen lds
    v_mfma_f32_16x16x32_bf16 v[200:203], v[108:111], v[84:87], v[200:203]
    ds_read_b64_tr_b16 v[66:67], v8 offset:37376
    v_mfma_f32_16x16x32_bf16 v[204:207], v[108:111], v[88:91], v[204:207]
    ds_read_b64_tr_b16 v[68:69], v9 offset:36864
    v_mfma_f32_16x16x32_bf16 v[208:211], v[112:115], v[76:79], v[208:211]
    ds_read_b64_tr_b16 v[70:71], v9 offset:37376
    v_mfma_f32_16x16x32_bf16 v[212:215], v[112:115], v[80:83], v[212:215]
    s_add_u32 m0, s30, 0x8c00
    s_mov_b32 s28, 0xc680
    buffer_load_dwordx4 v11, s[8:11], s28 offen lds
    v_mfma_f32_16x16x32_bf16 v[216:219], v[112:115], v[84:87], v[216:219]
    ds_read_b64_tr_b16 v[72:73], v10 offset:28672
    v_mfma_f32_16x16x32_bf16 v[220:223], v[112:115], v[88:91], v[220:223]
    ds_read_b64_tr_b16 v[74:75], v10 offset:28928
    v_mfma_f32_16x16x32_bf16 v[224:227], v[116:119], v[76:79], v[224:227]
    v_mfma_f32_16x16x32_bf16 v[228:231], v[116:119], v[80:83], v[228:231]
    v_mfma_f32_16x16x32_bf16 v[232:235], v[116:119], v[84:87], v[232:235]
    v_mfma_f32_16x16x32_bf16 v[236:239], v[116:119], v[88:91], v[236:239]
    s_waitcnt lgkmcnt(0)
    s_waitcnt vmcnt(10)
    s_barrier
    v_mfma_f32_16x16x32_bf16 v[128:131], v[48:51], v[32:35], v[128:131]
    ds_read_b128 v[76:79], v7 offset:0
    v_mfma_f32_16x16x32_bf16 v[132:135], v[48:51], v[36:39], v[132:135]
    s_add_u32 m0, s31, 0x1f000
    s_mov_b32 s28, 0x5b0000
    buffer_load_dwordx4 v12, s[12:15], s28 offen lds
    v_mfma_f32_16x16x32_bf16 v[136:139], v[48:51], v[40:43], v[136:139]
    ds_read_b128 v[80:83], v7 offset:2048
    v_mfma_f32_16x16x32_bf16 v[140:143], v[48:51], v[44:47], v[140:143]
    ds_read_b128 v[84:87], v7 offset:4096
    v_mfma_f32_16x16x32_bf16 v[144:147], v[52:55], v[32:35], v[144:147]
    ds_read_b128 v[88:91], v7 offset:6144
    v_mfma_f32_16x16x32_bf16 v[148:151], v[52:55], v[36:39], v[148:151]
    s_cmp_ge_u32 s20, 6
    s_cbranch_scc1 g1w1_sk26
    s_add_u32 m0, s31, 0x21000
    s_mov_b32 s28, 0x5b0000
    s_nop 0
    buffer_load_dwordx4 v13, s[12:15], s28 offen lds
g1w1_sk26:
    v_mfma_f32_16x16x32_bf16 v[152:155], v[52:55], v[40:43], v[152:155]
    ds_read_b64_tr_b16 v[92:93], v8 offset:43008
    v_mfma_f32_16x16x32_bf16 v[156:159], v[52:55], v[44:47], v[156:159]
    ds_read_b64_tr_b16 v[94:95], v8 offset:43520
    v_mfma_f32_16x16x32_bf16 v[160:163], v[56:59], v[32:35], v[160:163]
    ds_read_b64_tr_b16 v[96:97], v9 offset:43008
    v_mfma_f32_16x16x32_bf16 v[164:167], v[56:59], v[36:39], v[164:167]
    ds_read_b64_tr_b16 v[98:99], v9 offset:43520
    v_mfma_f32_16x16x32_bf16 v[168:171], v[56:59], v[40:43], v[168:171]
    ds_read_b64_tr_b16 v[100:101], v8 offset:47104
    v_mfma_f32_16x16x32_bf16 v[172:175], v[56:59], v[44:47], v[172:175]
    ds_read_b64_tr_b16 v[102:103], v8 offset:47616
    v_mfma_f32_16x16x32_bf16 v[176:179], v[60:63], v[32:35], v[176:179]
    ds_read_b64_tr_b16 v[104:105], v9 offset:47104
    v_mfma_f32_16x16x32_bf16 v[180:183], v[60:63], v[36:39], v[180:183]
    ds_read_b64_tr_b16 v[106:107], v9 offset:47616
    v_mfma_f32_16x16x32_bf16 v[184:187], v[60:63], v[40:43], v[184:187]
    ds_read_b64_tr_b16 v[108:109], v8 offset:51200
    v_mfma_f32_16x16x32_bf16 v[188:191], v[60:63], v[44:47], v[188:191]
    ds_read_b64_tr_b16 v[110:111], v8 offset:51712
    v_mfma_f32_16x16x32_bf16 v[192:195], v[64:67], v[32:35], v[192:195]
    ds_read_b64_tr_b16 v[112:113], v9 offset:51200
    v_mfma_f32_16x16x32_bf16 v[196:199], v[64:67], v[36:39], v[196:199]
    ds_read_b64_tr_b16 v[114:115], v9 offset:51712
    v_mfma_f32_16x16x32_bf16 v[200:203], v[64:67], v[40:43], v[200:203]
    ds_read_b64_tr_b16 v[116:117], v10 offset:43008
    v_mfma_f32_16x16x32_bf16 v[204:207], v[64:67], v[44:47], v[204:207]
    ds_read_b64_tr_b16 v[118:119], v10 offset:43264
    v_mfma_f32_16x16x32_bf16 v[208:211], v[68:71], v[32:35], v[208:211]
    v_mfma_f32_16x16x32_bf16 v[212:215], v[68:71], v[36:39], v[212:215]
    v_mfma_f32_16x16x32_bf16 v[216:219], v[68:71], v[40:43], v[216:219]
    v_mfma_f32_16x16x32_bf16 v[220:223], v[68:71], v[44:47], v[220:223]
    v_mfma_f32_16x16x32_bf16 v[224:227], v[72:75], v[32:35], v[224:227]
    v_mfma_f32_16x16x32_bf16 v[228:231], v[72:75], v[36:39], v[228:231]
    v_mfma_f32_16x16x32_bf16 v[232:235], v[72:75], v[40:43], v[232:235]
    v_mfma_f32_16x16x32_bf16 v[236:239], v[72:75], v[44:47], v[236:239]
    s_waitcnt lgkmcnt(0)
    s_waitcnt vmcnt(6)
    s_barrier
    v_mfma_f32_16x16x32_bf16 v[128:131], v[92:95], v[76:79], v[128:131]
    ds_read_b128 v[32:35], v2 offset:0
    v_mfma_f32_16x16x32_bf16 v[132:135], v[92:95], v[80:83], v[132:135]
    s_add_u32 m0, s31, 0x22800
    s_mov_b32 s28, 0x5e8000
    buffer_load_dwordx4 v12, s[12:15], s28 offen lds
    v_mfma_f32_16x16x32_bf16 v[136:139], v[92:95], v[84:87], v[136:139]
    ds_read_b128 v[36:39], v2 offset:2048
    v_mfma_f32_16x16x32_bf16 v[140:143], v[92:95], v[88:91], v[140:143]
    ds_read_b128 v[40:43], v2 offset:4096
    v_mfma_f32_16x16x32_bf16 v[144:147], v[96:99], v[76:79], v[144:147]
    ds_read_b128 v[44:47], v2 offset:6144
    v_mfma_f32_16x16x32_bf16 v[148:151], v[96:99], v[80:83], v[148:151]
    s_cmp_ge_u32 s20, 6
    s_cbranch_scc1 g1w1_sk27
    s_add_u32 m0, s31, 0x24800
    s_mov_b32 s28, 0x5e8000
    s_nop 0
    buffer_load_dwordx4 v13, s[12:15], s28 offen lds
g1w1_sk27:
    v_mfma_f32_16x16x32_bf16 v[152:155], v[96:99], v[84:87], v[152:155]
    ds_read_b64_tr_b16 v[48:49], v8 offset:0
    v_mfma_f32_16x16x32_bf16 v[156:159], v[96:99], v[88:91], v[156:159]
    ds_read_b64_tr_b16 v[50:51], v8 offset:512
    v_mfma_f32_16x16x32_bf16 v[160:163], v[100:103], v[76:79], v[160:163]
    ds_read_b64_tr_b16 v[52:53], v9 offset:0
    v_mfma_f32_16x16x32_bf16 v[164:167], v[100:103], v[80:83], v[164:167]
    s_add_u32 m0, s30, 0x10000
    s_mov_b32 s28, 0x700
    buffer_load_dwordx4 v11, s[8:11], s28 offen lds
    v_mfma_f32_16x16x32_bf16 v[168:171], v[100:103], v[84:87], v[168:171]
    ds_read_b64_tr_b16 v[54:55], v9 offset:512
    v_mfma_f32_16x16x32_bf16 v[172:175], v[100:103], v[88:91], v[172:175]
    ds_read_b64_tr_b16 v[56:57], v8 offset:4096
    v_mfma_f32_16x16x32_bf16 v[176:179], v[104:107], v[76:79], v[176:179]
    ds_read_b64_tr_b16 v[58:59], v8 offset:4608
    v_mfma_f32_16x16x32_bf16 v[180:183], v[104:107], v[80:83], v[180:183]
    s_add_u32 m0, s30, 0x10400
    s_mov_b32 s28, 0x4700
    buffer_load_dwordx4 v11, s[8:11], s28 offen lds
    v_mfma_f32_16x16x32_bf16 v[184:187], v[104:107], v[84:87], v[184:187]
    ds_read_b64_tr_b16 v[60:61], v9 offset:4096
    v_mfma_f32_16x16x32_bf16 v[188:191], v[104:107], v[88:91], v[188:191]
    ds_read_b64_tr_b16 v[62:63], v9 offset:4608
    v_mfma_f32_16x16x32_bf16 v[192:195], v[108:111], v[76:79], v[192:195]
    ds_read_b64_tr_b16 v[64:65], v8 offset:8192
    v_mfma_f32_16x16x32_bf16 v[196:199], v[108:111], v[80:83], v[196:199]
    s_add_u32 m0, s30, 0x10800
    s_mov_b32 s28, 0x8700
    buffer_load_dwordx4 v11, s[8:11], s28 offen lds
    v_mfma_f32_16x16x32_bf16 v[200:203], v[108:111], v[84:87], v[200:203]
    ds_read_b64_tr_b16 v[66:67], v8 offset:8704
    v_mfma_f32_16x16x32_bf16 v[204:207], v[108:111], v[88:91], v[204:207]
    ds_read_b64_tr_b16 v[68:69], v9 offset:8192
    v_mfma_f32_16x16x32_bf16 v[208:211], v[112:115], v[76:79], v[208:211]
    ds_read_b64_tr_b16 v[70:71], v9 offset:8704
    v_mfma_f32_16x16x32_bf16 v[212:215], v[112:115], v[80:83], v[212:215]
    s_add_u32 m0, s30, 0x10c00
    s_mov_b32 s28, 0xc700
    buffer_load_dwordx4 v11, s[8:11], s28 offen lds
    v_mfma_f32_16x16x32_bf16 v[216:219], v[112:115], v[84:87], v[216:219]
    ds_read_b64_tr_b16 v[72:73], v10 offset:0
    v_mfma_f32_16x16x32_bf16 v[220:223], v[112:115], v[88:91], v[220:223]
    ds_read_b64_tr_b16 v[74:75], v10 offset:256
    v_mfma_f32_16x16x32_bf16 v[224:227], v[116:119], v[76:79], v[224:227]
    v_mfma_f32_16x16x32_bf16 v[228:231], v[116:119], v[80:83], v[228:231]
    v_mfma_f32_16x16x32_bf16 v[232:235], v[116:119], v[84:87], v[232:235]
    v_mfma_f32_16x16x32_bf16 v[236:239], v[116:119], v[88:91], v[236:239]
    s_waitcnt lgkmcnt(0)
    s_waitcnt vmcnt(10)
    s_barrier
    v_mfma_f32_16x16x32_bf16 v[128:131], v[48:51], v[32:35], v[128:131]
    ds_read_b128 v[76:79], v3 offset:0
    v_mfma_f32_16x16x32_bf16 v[132:135], v[48:51], v[36:39], v[132:135]
    s_add_u32 m0, s31, 0x18000
    s_mov_b32 s28, 0x620000
    buffer_load_dwordx4 v12, s[12:15], s28 offen lds
    v_mfma_f32_16x16x32_bf16 v[136:139], v[48:51], v[40:43], v[136:139]
    ds_read_b128 v[80:83], v3 offset:2048
    v_mfma_f32_16x16x32_bf16 v[140:143], v[48:51], v[44:47], v[140:143]
    ds_read_b128 v[84:87], v3 offset:4096
    v_mfma_f32_16x16x32_bf16 v[144:147], v[52:55], v[32:35], v[144:147]
    ds_read_b128 v[88:91], v3 offset:6144
    v_mfma_f32_16x16x32_bf16 v[148:151], v[52:55], v[36:39], v[148:151]
    s_cmp_ge_u32 s20, 6
    s_cbranch_scc1 g1w1_sk28
    s_add_u32 m0, s31, 0x1a000
    s_mov_b32 s28, 0x620000
    s_nop 0
    buffer_load_dwordx4 v13, s[12:15], s28 offen lds
g1w1_sk28:
    v_mfma_f32_16x16x32_bf16 v[152:155], v[52:55], v[40:43], v[152:155]
    ds_read_b64_tr_b16 v[92:93], v8 offset:14336
    v_mfma_f32_16x16x32_bf16 v[156:159], v[52:55], v[44:47], v[156:159]
    ds_read_b64_tr_b16 v[94:95], v8 offset:14848
    v_mfma_f32_16x16x32_bf16 v[160:163], v[56:59], v[32:35], v[160:163]
    ds_read_b64_tr_b16 v[96:97], v9 offset:14336
    v_mfma_f32_16x16x32_bf16 v[164:167], v[56:59], v[36:39], v[164:167]
    ds_read_b64_tr_b16 v[98:99], v9 offset:14848
    v_mfma_f32_16x16x32_bf16 v[168:171], v[56:59], v[40:43], v[168:171]
    ds_read_b64_tr_b16 v[100:101], v8 offset:18432
    v_mfma_f32_16x16x32_bf16 v[172:175], v[56:59], v[44:47], v[172:175]
    ds_read_b64_tr_b16 v[102:103], v8 offset:18944
    v_mfma_f32_16x16x32_bf16 v[176:179], v[60:63], v[32:35], v[176:179]
    ds_read_b64_tr_b16 v[104:105], v9 offset:18432
    v_mfma_f32_16x16x32_bf16 v[180:183], v[60:63], v[36:39], v[180:183]
    ds_read_b64_tr_b16 v[106:107], v9 offset:18944
    v_mfma_f32_16x16x32_bf16 v[184:187], v[60:63], v[40:43], v[184:187]
    ds_read_b64_tr_b16 v[108:109], v8 offset:22528
    v_mfma_f32_16x16x32_bf16 v[188:191], v[60:63], v[44:47], v[188:191]
    ds_read_b64_tr_b16 v[110:111], v8 offset:23040
    v_mfma_f32_16x16x32_bf16 v[192:195], v[64:67], v[32:35], v[192:195]
    ds_read_b64_tr_b16 v[112:113], v9 offset:22528
    v_mfma_f32_16x16x32_bf16 v[196:199], v[64:67], v[36:39], v[196:199]
    ds_read_b64_tr_b16 v[114:115], v9 offset:23040
    v_mfma_f32_16x16x32_bf16 v[200:203], v[64:67], v[40:43], v[200:203]
    ds_read_b64_tr_b16 v[116:117], v10 offset:14336
    v_mfma_f32_16x16x32_bf16 v[204:207], v[64:67], v[44:47], v[204:207]
    ds_read_b64_tr_b16 v[118:119], v10 offset:14592
    v_mfma_f32_16x16x32_bf16 v[208:211], v[68:71], v[32:35], v[208:211]
    v_mfma_f32_16x16x32_bf16 v[212:215], v[68:71], v[36:39], v[212:215]
    v_mfma_f32_16x16x32_bf16 v[216:219], v[68:71], v[40:43], v[216:219]
    v_mfma_f32_16x16x32_bf16 v[220:223], v[68:71], v[44:47], v[220:223]
    v_mfma_f32_16x16x32_bf16 v[224:227], v[72:75], v[32:35], v[224:227]
    v_mfma_f32_16x16x32_bf16 v[228:231], v[72:75], v[36:39], v[228:231]
    v_mfma_f32_16x16x32_bf16 v[232:235], v[72:75], v[40:43], v[232:235]
    v_mfma_f32_16x16x32_bf16 v[236:239], v[72:75], v[44:47], v[236:239]
    s_waitcnt lgkmcnt(0)
    s_waitcnt vmcnt(6)
    s_barrier
    v_mfma_f32_16x16x32_bf16 v[128:131], v[92:95], v[76:79], v[128:131]
    ds_read_b128 v[32:35], v4 offset:0
    v_mfma_f32_16x16x32_bf16 v[132:135], v[92:95], v[80:83], v[132:135]
    s_add_u32 m0, s31, 0x1b800
    s_mov_b32 s28, 0x658000
    buffer_load_dwordx4 v12, s[12:15], s28 offen lds
    v_mfma_f32_16x16x32_bf16 v[136:139], v[92:95], v[84:87], v[136:139]
    ds_read_b128 v[36:39], v4 offset:2048
    v_mfma_f32_16x16x32_bf16 v[140:143], v[92:95], v[88:91], v[140:143]
    ds_read_b128 v[40:43], v4 offset:4096
    v_mfma_f32_16x16x32_bf16 v[144:147], v[96:99], v[76:79], v[144:147]
    ds_read_b128 v[44:47], v4 offset:6144
    v_mfma_f32_16x16x32_bf16 v[148:151], v[96:99], v[80:83], v[148:151]
    s_cmp_ge_u32 s20, 6
    s_cbranch_scc1 g1w1_sk29
    s_add_u32 m0, s31, 0x1d800
    s_mov_b32 s28, 0x658000
    s_nop 0
    buffer_load_dwordx4 v13, s[12:15], s28 offen lds
g1w1_sk29:
    v_mfma_f32_16x16x32_bf16 v[152:155], v[96:99], v[84:87], v[152:155]
    ds_read_b64_tr_b16 v[48:49], v8 offset:28672
    v_mfma_f32_16x16x32_bf16 v[156:159], v[96:99], v[88:91], v[156:159]
    ds_read_b64_tr_b16 v[50:51], v8 offset:29184
    v_mfma_f32_16x16x32_bf16 v[160:163], v[100:103], v[76:79], v[160:163]
    ds_read_b64_tr_b16 v[52:53], v9 offset:28672
    v_mfma_f32_16x16x32_bf16 v[164:167], v[100:103], v[80:83], v[164:167]
    s_add_u32 m0, s30, 0x0
    s_mov_b32 s28, 0x780
    buffer_load_dwordx4 v11, s[8:11], s28 offen lds
    v_mfma_f32_16x16x32_bf16 v[168:171], v[100:103], v[84:87], v[168:171]
    ds_read_b64_tr_b16 v[54:55], v9 offset:29184
    v_mfma_f32_16x16x32_bf16 v[172:175], v[100:103], v[88:91], v[172:175]
    ds_read_b64_tr_b16 v[56:57], v8 offset:32768
    v_mfma_f32_16x16x32_bf16 v[176:179], v[104:107], v[76:79], v[176:179]
    ds_read_b64_tr_b16 v[58:59], v8 offset:33280
    v_mfma_f32_16x16x32_bf16 v[180:183], v[104:107], v[80:83], v[180:183]
    s_add_u32 m0, s30, 0x400
    s_mov_b32 s28, 0x4780
    buffer_load_dwordx4 v11, s[8:11], s28 offen lds
    v_mfma_f32_16x16x32_bf16 v[184:187], v[104:107], v[84:87], v[184:187]
    ds_read_b64_tr_b16 v[60:61], v9 offset:32768
    v_mfma_f32_16x16x32_bf16 v[188:191], v[104:107], v[88:91], v[188:191]
    ds_read_b64_tr_b16 v[62:63], v9 offset:33280
    v_mfma_f32_16x16x32_bf16 v[192:195], v[108:111], v[76:79], v[192:195]
    ds_read_b64_tr_b16 v[64:65], v8 offset:36864
    v_mfma_f32_16x16x32_bf16 v[196:199], v[108:111], v[80:83], v[196:199]
    s_add_u32 m0, s30, 0x800
    s_mov_b32 s28, 0x8780
    buffer_load_dwordx4 v11, s[8:11], s28 offen lds
    v_mfma_f32_16x16x32_bf16 v[200:203], v[108:111], v[84:87], v[200:203]
    ds_read_b64_tr_b16 v[66:67], v8 offset:37376
    v_mfma_f32_16x16x32_bf16 v[204:207], v[108:111], v[88:91], v[204:207]
    ds_read_b64_tr_b16 v[68:69], v9 offset:36864
    v_mfma_f32_16x16x32_bf16 v[208:211], v[112:115], v[76:79], v[208:211]
    ds_read_b64_tr_b16 v[70:71], v9 offset:37376
    v_mfma_f32_16x16x32_bf16 v[212:215], v[112:115], v[80:83], v[212:215]
    s_add_u32 m0, s30, 0xc00
    s_mov_b32 s28, 0xc780
    buffer_load_dwordx4 v11, s[8:11], s28 offen lds
    v_mfma_f32_16x16x32_bf16 v[216:219], v[112:115], v[84:87], v[216:219]
    ds_read_b64_tr_b16 v[72:73], v10 offset:28672
    v_mfma_f32_16x16x32_bf16 v[220:223], v[112:115], v[88:91], v[220:223]
    ds_read_b64_tr_b16 v[74:75], v10 offset:28928
    v_mfma_f32_16x16x32_bf16 v[224:227], v[116:119], v[76:79], v[224:227]
    v_mfma_f32_16x16x32_bf16 v[228:231], v[116:119], v[80:83], v[228:231]
    v_mfma_f32_16x16x32_bf16 v[232:235], v[116:119], v[84:87], v[232:235]
    v_mfma_f32_16x16x32_bf16 v[236:239], v[116:119], v[88:91], v[236:239]
    s_waitcnt lgkmcnt(0)
    s_waitcnt vmcnt(10)
    s_barrier
    v_mfma_f32_16x16x32_bf16 v[128:131], v[48:51], v[32:35], v[128:131]
    ds_read_b128 v[76:79], v5 offset:0
    v_mfma_f32_16x16x32_bf16 v[132:135], v[48:51], v[36:39], v[132:135]
    s_add_u32 m0, s31, 0x1f000
    s_mov_b32 s28, 0x690000
    buffer_load_dwordx4 v12, s[12:15], s28 offen lds
    v_mfma_f32_16x16x32_bf16 v[136:139], v[48:51], v[40:43], v[136:139]
    ds_read_b128 v[80:83], v5 offset:2048
    v_mfma_f32_16x16x32_bf16 v[140:143], v[48:51], v[44:47], v[140:143]
    ds_read_b128 v[84:87], v5 offset:4096
    v_mfma_f32_16x16x32_bf16 v[144:147], v[52:55], v[32:35], v[144:147]
    ds_read_b128 v[88:91], v5 offset:6144
    v_mfma_f32_16x16x32_bf16 v[148:151], v[52:55], v[36:39], v[148:151]
    s_cmp_ge_u32 s20, 6
    s_cbranch_scc1 g1w1_sk30
    s_add_u32 m0, s31, 0x21000
    s_mov_b32 s28, 0x690000
    s_nop 0
    buffer_load_dwordx4 v13, s[12:15], s28 offen lds
g1w1_sk30:
    v_mfma_f32_16x16x32_bf16 v[152:155], v[52:55], v[40:43], v[152:155]
    ds_read_b64_tr_b16 v[92:93], v8 offset:43008
    v_mfma_f32_16x16x32_bf16 v[156:159], v[52:55], v[44:47], v[156:159]
    ds_read_b64_tr_b16 v[94:95], v8 offset:43520
    v_mfma_f32_16x16x32_bf16 v[160:163], v[56:59], v[32:35], v[160:163]
    ds_read_b64_tr_b16 v[96:97], v9 offset:43008
    v_mfma_f32_16x16x32_bf16 v[164:167], v[56:59], v[36:39], v[164:167]
    ds_read_b64_tr_b16 v[98:99], v9 offset:43520
    v_mfma_f32_16x16x32_bf16 v[168:171], v[56:59], v[40:43], v[168:171]
    ds_read_b64_tr_b16 v[100:101], v8 offset:47104
    v_mfma_f32_16x16x32_bf16 v[172:175], v[56:59], v[44:47], v[172:175]
    ds_read_b64_tr_b16 v[102:103], v8 offset:47616
    v_mfma_f32_16x16x32_bf16 v[176:179], v[60:63], v[32:35], v[176:179]
    ds_read_b64_tr_b16 v[104:105], v9 offset:47104
    v_mfma_f32_16x16x32_bf16 v[180:183], v[60:63], v[36:39], v[180:183]
    ds_read_b64_tr_b16 v[106:107], v9 offset:47616
    v_mfma_f32_16x16x32_bf16 v[184:187], v[60:63], v[40:43], v[184:187]
    ds_read_b64_tr_b16 v[108:109], v8 offset:51200
    v_mfma_f32_16x16x32_bf16 v[188:191], v[60:63], v[44:47], v[188:191]
    ds_read_b64_tr_b16 v[110:111], v8 offset:51712
    v_mfma_f32_16x16x32_bf16 v[192:195], v[64:67], v[32:35], v[192:195]
    ds_read_b64_tr_b16 v[112:113], v9 offset:51200
    v_mfma_f32_16x16x32_bf16 v[196:199], v[64:67], v[36:39], v[196:199]
    ds_read_b64_tr_b16 v[114:115], v9 offset:51712
    v_mfma_f32_16x16x32_bf16 v[200:203], v[64:67], v[40:43], v[200:203]
    ds_read_b64_tr_b16 v[116:117], v10 offset:43008
    v_mfma_f32_16x16x32_bf16 v[204:207], v[64:67], v[44:47], v[204:207]
    ds_read_b64_tr_b16 v[118:119], v10 offset:43264
    v_mfma_f32_16x16x32_bf16 v[208:211], v[68:71], v[32:35], v[208:211]
    v_mfma_f32_16x16x32_bf16 v[212:215], v[68:71], v[36:39], v[212:215]
    v_mfma_f32_16x16x32_bf16 v[216:219], v[68:71], v[40:43], v[216:219]
    v_mfma_f32_16x16x32_bf16 v[220:223], v[68:71], v[44:47], v[220:223]
    v_mfma_f32_16x16x32_bf16 v[224:227], v[72:75], v[32:35], v[224:227]
    v_mfma_f32_16x16x32_bf16 v[228:231], v[72:75], v[36:39], v[228:231]
    v_mfma_f32_16x16x32_bf16 v[232:235], v[72:75], v[40:43], v[232:235]
    v_mfma_f32_16x16x32_bf16 v[236:239], v[72:75], v[44:47], v[236:239]
    s_waitcnt lgkmcnt(0)
    s_waitcnt vmcnt(6)
    s_barrier
    v_mfma_f32_16x16x32_bf16 v[128:131], v[92:95], v[76:79], v[128:131]
    ds_read_b128 v[32:35], v6 offset:0
    v_mfma_f32_16x16x32_bf16 v[132:135], v[92:95], v[80:83], v[132:135]
    s_add_u32 m0, s31, 0x22800
    s_mov_b32 s28, 0x6c8000
    buffer_load_dwordx4 v12, s[12:15], s28 offen lds
    v_mfma_f32_16x16x32_bf16 v[136:139], v[92:95], v[84:87], v[136:139]
    ds_read_b128 v[36:39], v6 offset:2048
    v_mfma_f32_16x16x32_bf16 v[140:143], v[92:95], v[88:91], v[140:143]
    ds_read_b128 v[40:43], v6 offset:4096
    v_mfma_f32_16x16x32_bf16 v[144:147], v[96:99], v[76:79], v[144:147]
    ds_read_b128 v[44:47], v6 offset:6144
    v_mfma_f32_16x16x32_bf16 v[148:151], v[96:99], v[80:83], v[148:151]
    s_cmp_ge_u32 s20, 6
    s_cbranch_scc1 g1w1_sk31
    s_add_u32 m0, s31, 0x24800
    s_mov_b32 s28, 0x6c8000
    s_nop 0
    buffer_load_dwordx4 v13, s[12:15], s28 offen lds
g1w1_sk31:
    v_mfma_f32_16x16x32_bf16 v[152:155], v[96:99], v[84:87], v[152:155]
    ds_read_b64_tr_b16 v[48:49], v8 offset:0
    v_mfma_f32_16x16x32_bf16 v[156:159], v[96:99], v[88:91], v[156:159]
    ds_read_b64_tr_b16 v[50:51], v8 offset:512
    v_mfma_f32_16x16x32_bf16 v[160:163], v[100:103], v[76:79], v[160:163]
    ds_read_b64_tr_b16 v[52:53], v9 offset:0
    v_mfma_f32_16x16x32_bf16 v[164:167], v[100:103], v[80:83], v[164:167]
    ds_read_b64_tr_b16 v[54:55], v9 offset:512
    v_mfma_f32_16x16x32_bf16 v[168:171], v[100:103], v[84:87], v[168:171]
    ds_read_b64_tr_b16 v[56:57], v8 offset:4096
    v_mfma_f32_16x16x32_bf16 v[172:175], v[100:103], v[88:91], v[172:175]
    ds_read_b64_tr_b16 v[58:59], v8 offset:4608
    v_mfma_f32_16x16x32_bf16 v[176:179], v[104:107], v[76:79], v[176:179]
    ds_read_b64_tr_b16 v[60:61], v9 offset:4096
    v_mfma_f32_16x16x32_bf16 v[180:183], v[104:107], v[80:83], v[180:183]
    ds_read_b64_tr_b16 v[62:63], v9 offset:4608
    v_mfma_f32_16x16x32_bf16 v[184:187], v[104:107], v[84:87], v[184:187]
    ds_read_b64_tr_b16 v[64:65], v8 offset:8192
    v_mfma_f32_16x16x32_bf16 v[188:191], v[104:107], v[88:91], v[188:191]
    ds_read_b64_tr_b16 v[66:67], v8 offset:8704
    v_mfma_f32_16x16x32_bf16 v[192:195], v[108:111], v[76:79], v[192:195]
    ds_read_b64_tr_b16 v[68:69], v9 offset:8192
    v_mfma_f32_16x16x32_bf16 v[196:199], v[108:111], v[80:83], v[196:199]
    ds_read_b64_tr_b16 v[70:71], v9 offset:8704
    v_mfma_f32_16x16x32_bf16 v[200:203], v[108:111], v[84:87], v[200:203]
    ds_read_b64_tr_b16 v[72:73], v10 offset:0
    v_mfma_f32_16x16x32_bf16 v[204:207], v[108:111], v[88:91], v[204:207]
    ds_read_b64_tr_b16 v[74:75], v10 offset:256
    v_mfma_f32_16x16x32_bf16 v[208:211], v[112:115], v[76:79], v[208:211]
    v_mfma_f32_16x16x32_bf16 v[212:215], v[112:115], v[80:83], v[212:215]
    v_mfma_f32_16x16x32_bf16 v[216:219], v[112:115], v[84:87], v[216:219]
    v_mfma_f32_16x16x32_bf16 v[220:223], v[112:115], v[88:91], v[220:223]
    v_mfma_f32_16x16x32_bf16 v[224:227], v[116:119], v[76:79], v[224:227]
    v_mfma_f32_16x16x32_bf16 v[228:231], v[116:119], v[80:83], v[228:231]
    v_mfma_f32_16x16x32_bf16 v[232:235], v[116:119], v[84:87], v[232:235]
    v_mfma_f32_16x16x32_bf16 v[236:239], v[116:119], v[88:91], v[236:239]
    s_waitcnt lgkmcnt(0)
    s_waitcnt vmcnt(6)
    s_barrier
    v_mfma_f32_16x16x32_bf16 v[128:131], v[48:51], v[32:35], v[128:131]
    ds_read_b128 v[76:79], v7 offset:0
    v_mfma_f32_16x16x32_bf16 v[132:135], v[48:51], v[36:39], v[132:135]
    s_add_u32 m0, s77, 0x26000
    s_lshl_b32 s28, s2, 13
    s_add_u32 s28, s28, s31
    buffer_load_dwordx4 v31, s[64:67], s28 offen lds
    s_mul_i32 s76, s2, 28672
    s_mul_i32 s29, s20, 3584
    s_add_u32 s76, s76, s29
    v_mfma_f32_16x16x32_bf16 v[136:139], v[48:51], v[40:43], v[136:139]
    ds_read_b128 v[80:83], v7 offset:2048
    v_mfma_f32_16x16x32_bf16 v[140:143], v[48:51], v[44:47], v[140:143]
    ds_read_b128 v[84:87], v7 offset:4096
    v_mfma_f32_16x16x32_bf16 v[144:147], v[52:55], v[32:35], v[144:147]
    ds_read_b128 v[88:91], v7 offset:6144
    v_mfma_f32_16x16x32_bf16 v[148:151], v[52:55], v[36:39], v[148:151]
    buffer_load_dwordx4 v31, s[68:71], s76 offen lds
    s_add_u32 s76, s76, 1024
    v_mfma_f32_16x16x32_bf16 v[152:155], v[52:55], v[40:43], v[152:155]
    ds_read_b64_tr_b16 v[92:93], v8 offset:14336
    v_mfma_f32_16x16x32_bf16 v[156:159], v[52:55], v[44:47], v[156:159]
    ds_read_b64_tr_b16 v[94:95], v8 offset:14848
    v_mfma_f32_16x16x32_bf16 v[160:163], v[56:59], v[32:35], v[160:163]
    ds_read_b64_tr_b16 v[96:97], v9 offset:14336
    v_mfma_f32_16x16x32_bf16 v[164:167], v[56:59], v[36:39], v[164:167]
    buffer_load_dwordx4 v31, s[68:71], s76 offen lds
    s_add_u32 s76, s76, 1024
    v_mfma_f32_16x16x32_bf16 v[168:171], v[56:59], v[40:43], v[168:171]
    ds_read_b64_tr_b16 v[98:99], v9 offset:14848
    v_mfma_f32_16x16x32_bf16 v[172:175], v[56:59], v[44:47], v[172:175]
    ds_read_b64_tr_b16 v[100:101], v8 offset:18432
    v_mfma_f32_16x16x32_bf16 v[176:179], v[60:63], v[32:35], v[176:179]
    ds_read_b64_tr_b16 v[102:103], v8 offset:18944
    v_mfma_f32_16x16x32_bf16 v[180:183], v[60:63], v[36:39], v[180:183]
    buffer_load_dwordx4 v31, s[68:71], s76 offen lds
    s_add_u32 s76, s76, 1024
    v_mfma_f32_16x16x32_bf16 v[184:187], v[60:63], v[40:43], v[184:187]
    ds_read_b64_tr_b16 v[104:105], v9 offset:18432
    v_mfma_f32_16x16x32_bf16 v[188:191], v[60:63], v[44:47], v[188:191]
    ds_read_b64_tr_b16 v[106:107], v9 offset:18944
    v_mfma_f32_16x16x32_bf16 v[192:195], v[64:67], v[32:35], v[192:195]
    ds_read_b64_tr_b16 v[108:109], v8 offset:22528
    v_mfma_f32_16x16x32_bf16 v[196:199], v[64:67], v[36:39], v[196:199]
    buffer_load_dwordx4 v31, s[68:71], s76 offen lds
    s_add_u32 s76, s76, 1024
    v_mfma_f32_16x16x32_bf16 v[200:203], v[64:67], v[40:43], v[200:203]
    ds_read_b64_tr_b16 v[110:111], v8 offset:23040
    v_mfma_f32_16x16x32_bf16 v[204:207], v[64:67], v[44:47], v[204:207]
    ds_read_b64_tr_b16 v[112:113], v9 offset:22528
    v_mfma_f32_16x16x32_bf16 v[208:211], v[68:71], v[32:35], v[208:211]
    ds_read_b64_tr_b16 v[114:115], v9 offset:23040
    v_mfma_f32_16x16x32_bf16 v[212:215], v[68:71], v[36:39], v[212:215]
    ds_read_b64_tr_b16 v[116:117], v10 offset:14336
    v_mfma_f32_16x16x32_bf16 v[216:219], v[68:71], v[40:43], v[216:219]
    ds_read_b64_tr_b16 v[118:119], v10 offset:14592
    v_mfma_f32_16x16x32_bf16 v[220:223], v[68:71], v[44:47], v[220:223]
    v_mfma_f32_16x16x32_bf16 v[224:227], v[72:75], v[32:35], v[224:227]
    v_mfma_f32_16x16x32_bf16 v[228:231], v[72:75], v[36:39], v[228:231]
    v_mfma_f32_16x16x32_bf16 v[232:235], v[72:75], v[40:43], v[232:235]
    v_mfma_f32_16x16x32_bf16 v[236:239], v[72:75], v[44:47], v[236:239]
    s_waitcnt lgkmcnt(0)
    s_waitcnt vmcnt(1)
    s_barrier
    v_mfma_f32_16x16x32_bf16 v[128:131], v[92:95], v[76:79], v[128:131]
    ds_read_b128 v[32:35], v2 offset:0
    v_mfma_f32_16x16x32_bf16 v[132:135], v[92:95], v[80:83], v[132:135]
    ds_read_b128 v[36:39], v2 offset:2048
    v_mfma_f32_16x16x32_bf16 v[136:139], v[92:95], v[84:87], v[136:139]
    ds_read_b128 v[40:43], v2 offset:4096
    v_mfma_f32_16x16x32_bf16 v[140:143], v[92:95], v[88:91], v[140:143]
    ds_read_b128 v[44:47], v2 offset:6144
    v_mfma_f32_16x16x32_bf16 v[144:147], v[96:99], v[76:79], v[144:147]
    ds_read_b64_tr_b16 v[48:49], v8 offset:28672
    v_mfma_f32_16x16x32_bf16 v[148:151], v[96:99], v[80:83], v[148:151]
    ds_read_b64_tr_b16 v[50:51], v8 offset:29184
    v_mfma_f32_16x16x32_bf16 v[152:155], v[96:99], v[84:87], v[152:155]
    ds_read_b64_tr_b16 v[52:53], v9 offset:28672
    v_mfma_f32_16x16x32_bf16 v[156:159], v[96:99], v[88:91], v[156:159]
    ds_read_b64_tr_b16 v[54:55], v9 offset:29184
    v_mfma_f32_16x16x32_bf16 v[160:163], v[100:103], v[76:79], v[160:163]
    ds_read_b64_tr_b16 v[56:57], v8 offset:32768
    v_mfma_f32_16x16x32_bf16 v[164:167], v[100:103], v[80:83], v[164:167]
    ds_read_b64_tr_b16 v[58:59], v8 offset:33280
    v_mfma_f32_16x16x32_bf16 v[168:171], v[100:103], v[84:87], v[168:171]
    ds_read_b64_tr_b16 v[60:61], v9 offset:32768
    v_mfma_f32_16x16x32_bf16 v[172:175], v[100:103], v[88:91], v[172:175]
    ds_read_b64_tr_b16 v[62:63], v9 offset:33280
    v_mfma_f32_16x16x32_bf16 v[176:179], v[104:107], v[76:79], v[176:179]
    ds_read_b64_tr_b16 v[64:65], v8 offset:36864
    v_mfma_f32_16x16x32_bf16 v[180:183], v[104:107], v[80:83], v[180:183]
    ds_read_b64_tr_b16 v[66:67], v8 offset:37376
    v_mfma_f32_16x16x32_bf16 v[184:187], v[104:107], v[84:87], v[184:187]
    ds_read_b64_tr_b16 v[68:69], v9 offset:36864
    v_mfma_f32_16x16x32_bf16 v[188:191], v[104:107], v[88:91], v[188:191]
    ds_read_b64_tr_b16 v[70:71], v9 offset:37376
    v_mfma_f32_16x16x32_bf16 v[192:195], v[108:111], v[76:79], v[192:195]
    ds_read_b64_tr_b16 v[72:73], v10 offset:28672
    v_mfma_f32_16x16x32_bf16 v[196:199], v[108:111], v[80:83], v[196:199]
    ds_read_b64_tr_b16 v[74:75], v10 offset:28928
    v_mfma_f32_16x16x32_bf16 v[200:203], v[108:111], v[84:87], v[200:203]
    v_mfma_f32_16x16x32_bf16 v[204:207], v[108:111], v[88:91], v[204:207]
    v_mfma_f32_16x16x32_bf16 v[208:211], v[112:115], v[76:79], v[208:211]
    v_mfma_f32_16x16x32_bf16 v[212:215], v[112:115], v[80:83], v[212:215]
    v_mfma_f32_16x16x32_bf16 v[216:219], v[112:115], v[84:87], v[216:219]
    v_mfma_f32_16x16x32_bf16 v[220:223], v[112:115], v[88:91], v[220:223]
    v_mfma_f32_16x16x32_bf16 v[224:227], v[116:119], v[76:79], v[224:227]
    v_mfma_f32_16x16x32_bf16 v[228:231], v[116:119], v[80:83], v[228:231]
    v_mfma_f32_16x16x32_bf16 v[232:235], v[116:119], v[84:87], v[232:235]
    v_mfma_f32_16x16x32_bf16 v[236:239], v[116:119], v[88:91], v[236:239]
    s_waitcnt lgkmcnt(0)
    s_waitcnt vmcnt(0)
    s_barrier
    v_mfma_f32_16x16x32_bf16 v[128:131], v[48:51], v[32:35], v[128:131]
    ds_read_b128 v[76:79], v3 offset:0
    v_mfma_f32_16x16x32_bf16 v[132:135], v[48:51], v[36:39], v[132:135]
    ds_read_b128 v[80:83], v3 offset:2048
    v_mfma_f32_16x16x32_bf16 v[136:139], v[48:51], v[40:43], v[136:139]
    ds_read_b128 v[84:87], v3 offset:4096
    v_mfma_f32_16x16x32_bf16 v[140:143], v[48:51], v[44:47], v[140:143]
    ds_read_b128 v[88:91], v3 offset:6144
    v_mfma_f32_16x16x32_bf16 v[144:147], v[52:55], v[32:35], v[144:147]
    ds_read_b64_tr_b16 v[92:93], v8 offset:43008
    v_mfma_f32_16x16x32_bf16 v[148:151], v[52:55], v[36:39], v[148:151]
    ds_read_b64_tr_b16 v[94:95], v8 offset:43520
    v_mfma_f32_16x16x32_bf16 v[152:155], v[52:55], v[40:43], v[152:155]
    ds_read_b64_tr_b16 v[96:97], v9 offset:43008
    v_mfma_f32_16x16x32_bf16 v[156:159], v[52:55], v[44:47], v[156:159]
    ds_read_b64_tr_b16 v[98:99], v9 offset:43520
    v_mfma_f32_16x16x32_bf16 v[160:163], v[56:59], v[32:35], v[160:163]
    ds_read_b64_tr_b16 v[100:101], v8 offset:47104
    v_mfma_f32_16x16x32_bf16 v[164:167], v[56:59], v[36:39], v[164:167]
    ds_read_b64_tr_b16 v[102:103], v8 offset:47616
    v_mfma_f32_16x16x32_bf16 v[168:171], v[56:59], v[40:43], v[168:171]
    ds_read_b64_tr_b16 v[104:105], v9 offset:47104
    v_mfma_f32_16x16x32_bf16 v[172:175], v[56:59], v[44:47], v[172:175]
    ds_read_b64_tr_b16 v[106:107], v9 offset:47616
    v_mfma_f32_16x16x32_bf16 v[176:179], v[60:63], v[32:35], v[176:179]
    ds_read_b64_tr_b16 v[108:109], v8 offset:51200
    v_mfma_f32_16x16x32_bf16 v[180:183], v[60:63], v[36:39], v[180:183]
    ds_read_b64_tr_b16 v[110:111], v8 offset:51712
    v_mfma_f32_16x16x32_bf16 v[184:187], v[60:63], v[40:43], v[184:187]
    ds_read_b64_tr_b16 v[112:113], v9 offset:51200
    v_mfma_f32_16x16x32_bf16 v[188:191], v[60:63], v[44:47], v[188:191]
    ds_read_b64_tr_b16 v[114:115], v9 offset:51712
    v_mfma_f32_16x16x32_bf16 v[192:195], v[64:67], v[32:35], v[192:195]
    ds_read_b64_tr_b16 v[116:117], v10 offset:43008
    v_mfma_f32_16x16x32_bf16 v[196:199], v[64:67], v[36:39], v[196:199]
    ds_read_b64_tr_b16 v[118:119], v10 offset:43264
    v_mfma_f32_16x16x32_bf16 v[200:203], v[64:67], v[40:43], v[200:203]
    v_mfma_f32_16x16x32_bf16 v[204:207], v[64:67], v[44:47], v[204:207]
    v_mfma_f32_16x16x32_bf16 v[208:211], v[68:71], v[32:35], v[208:211]
    v_mfma_f32_16x16x32_bf16 v[212:215], v[68:71], v[36:39], v[212:215]
    v_mfma_f32_16x16x32_bf16 v[216:219], v[68:71], v[40:43], v[216:219]
    v_mfma_f32_16x16x32_bf16 v[220:223], v[68:71], v[44:47], v[220:223]
    v_mfma_f32_16x16x32_bf16 v[224:227], v[72:75], v[32:35], v[224:227]
    v_mfma_f32_16x16x32_bf16 v[228:231], v[72:75], v[36:39], v[228:231]
    v_mfma_f32_16x16x32_bf16 v[232:235], v[72:75], v[40:43], v[232:235]
    v_mfma_f32_16x16x32_bf16 v[236:239], v[72:75], v[44:47], v[236:239]
    s_waitcnt lgkmcnt(0)
    s_barrier
    v_mfma_f32_16x16x32_bf16 v[128:131], v[92:95], v[76:79], v[128:131]
    v_mfma_f32_16x16x32_bf16 v[132:135], v[92:95], v[80:83], v[132:135]
    v_mfma_f32_16x16x32_bf16 v[136:139], v[92:95], v[84:87], v[136:139]
    v_mfma_f32_16x16x32_bf16 v[140:143], v[92:95], v[88:91], v[140:143]
    v_mfma_f32_16x16x32_bf16 v[144:147], v[96:99], v[76:79], v[144:147]
    v_mfma_f32_16x16x32_bf16 v[148:151], v[96:99], v[80:83], v[148:151]
    v_mfma_f32_16x16x32_bf16 v[152:155], v[96:99], v[84:87], v[152:155]
    v_mfma_f32_16x16x32_bf16 v[156:159], v[96:99], v[88:91], v[156:159]
    v_mfma_f32_16x16x32_bf16 v[160:163], v[100:103], v[76:79], v[160:163]
    v_mfma_f32_16x16x32_bf16 v[164:167], v[100:103], v[80:83], v[164:167]
    v_mfma_f32_16x16x32_bf16 v[168:171], v[100:103], v[84:87], v[168:171]
    v_mfma_f32_16x16x32_bf16 v[172:175], v[100:103], v[88:91], v[172:175]
    v_mfma_f32_16x16x32_bf16 v[176:179], v[104:107], v[76:79], v[176:179]
    v_mfma_f32_16x16x32_bf16 v[180:183], v[104:107], v[80:83], v[180:183]
    v_mfma_f32_16x16x32_bf16 v[184:187], v[104:107], v[84:87], v[184:187]
    v_mfma_f32_16x16x32_bf16 v[188:191], v[104:107], v[88:91], v[188:191]
    v_mfma_f32_16x16x32_bf16 v[192:195], v[108:111], v[76:79], v[192:195]
    v_mfma_f32_16x16x32_bf16 v[196:199], v[108:111], v[80:83], v[196:199]
    v_mfma_f32_16x16x32_bf16 v[200:203], v[108:111], v[84:87], v[200:203]
    v_mfma_f32_16x16x32_bf16 v[204:207], v[108:111], v[88:91], v[204:207]
    v_mfma_f32_16x16x32_bf16 v[208:211], v[112:115], v[76:79], v[208:211]
    v_mfma_f32_16x16x32_bf16 v[212:215], v[112:115], v[80:83], v[212:215]
    v_mfma_f32_16x16x32_bf16 v[216:219], v[112:115], v[84:87], v[216:219]
    v_mfma_f32_16x16x32_bf16 v[220:223], v[112:115], v[88:91], v[220:223]
    v_mfma_f32_16x16x32_bf16 v[224:227], v[116:119], v[76:79], v[224:227]
    v_mfma_f32_16x16x32_bf16 v[228:231], v[116:119], v[80:83], v[228:231]
    v_mfma_f32_16x16x32_bf16 v[232:235], v[116:119], v[84:87], v[232:235]
    v_mfma_f32_16x16x32_bf16 v[236:239], v[116:119], v[88:91], v[236:239]
    s_waitcnt lgkmcnt(0)
    s_mov_b32 s44, 0xc0135761
    s_mov_b32 s46, 0xbdd2d3e8
    s_mov_b32 s47, 0xbdd2d3e8
    s_mov_b32 s48, 1.0
    s_mov_b32 s49, 1.0
    s_lshl_b32 s28, s24, 8
    s_lshl_b32 s29, s21, 6
    s_add_u32 s28, s28, s29
    v_add_u32 v17, s28, v16
    v_and_b32 v18, 1, v15
    v_lshl_add_u32 v17, v18, 4, v17
    v_lshrrev_b32 v18, 1, v15
    v_lshl_add_u32 v17, v18, 11, v17
    v_lshlrev_b32 v17, 4, v17
    s_lshr_b32 s28, s32, 4
    s_lshl_b32 s29, s22, 1
    s_add_u32 s28, s28, s29
    s_add_u32 s28, s28, 128
    s_lshl_b32 s52, s28, 15
    v_mov_b32 v60, s44
    v_mov_b32 v61, s44
    v_pk_mul_f32 v[64:65], v[128:129], v[128:129]
    v_pk_mul_f32 v[66:67], v[130:131], v[130:131]
    v_pk_fma_f32 v[64:65], v[64:65], s[46:47], v[60:61]
    v_pk_fma_f32 v[66:67], v[66:67], s[46:47], v[60:61]
    v_pk_mul_f32 v[64:65], v[64:65], v[128:129]
    v_pk_mul_f32 v[66:67], v[66:67], v[130:131]
    v_pk_mul_f32 v[68:69], v[132:133], v[132:133]
    v_pk_mul_f32 v[70:71], v[134:135], v[134:135]
    v_pk_fma_f32 v[68:69], v[68:69], s[46:47], v[60:61]
    v_pk_fma_f32 v[70:71], v[70:71], s[46:47], v[60:61]
    v_pk_mul_f32 v[68:69], v[68:69], v[132:133]
    v_pk_mul_f32 v[70:71], v[70:71], v[134:135]
    v_pk_mul_f32 v[72:73], v[136:137], v[136:137]
    v_pk_mul_f32 v[74:75], v[138:139], v[138:139]
    v_pk_fma_f32 v[72:73], v[72:73], s[46:47], v[60:61]
    v_pk_fma_f32 v[74:75], v[74:75], s[46:47], v[60:61]
    v_pk_mul_f32 v[72:73], v[72:73], v[136:137]
    v_pk_mul_f32 v[74:75], v[74:75], v[138:139]
    v_pk_mul_f32 v[76:77], v[140:141], v[140:141]
    v_pk_mul_f32 v[78:79], v[142:143], v[142:143]
    v_pk_fma_f32 v[76:77], v[76:77], s[46:47], v[60:61]
    v_pk_fma_f32 v[78:79], v[78:79], s[46:47], v[60:61]
    v_pk_mul_f32 v[76:77], v[76:77], v[140:141]
    v_pk_mul_f32 v[78:79], v[78:79], v[142:143]
    v_exp_f32 v64, v64
    v_exp_f32 v65, v65
    v_exp_f32 v66, v66
    v_exp_f32 v67, v67
    v_exp_f32 v68, v68
    v_exp_f32 v69, v69
    v_exp_f32 v70, v70
    v_exp_f32 v71, v71
    v_exp_f32 v72, v72
    v_exp_f32 v73, v73
    v_exp_f32 v74, v74
    v_exp_f32 v75, v75
    v_exp_f32 v76, v76
    v_exp_f32 v77, v77
    v_exp_f32 v78, v78
    v_exp_f32 v79, v79
    v_pk_add_f32 v[64:65], v[64:65], s[48:49]
    v_pk_add_f32 v[66:67], v[66:67], s[48:49]
    v_pk_add_f32 v[68:69], v[68:69], s[48:49]
    v_pk_add_f32 v[70:71], v[70:71], s[48:49]
    v_pk_add_f32 v[72:73], v[72:73], s[48:49]
    v_pk_add_f32 v[74:75], v[74:75], s[48:49]
    v_pk_add_f32 v[76:77], v[76:77], s[48:49]
    v_pk_add_f32 v[78:79], v[78:79], s[48:49]
    v_rcp_f32 v64, v64
    v_rcp_f32 v65, v65
    v_rcp_f32 v66, v66
    v_rcp_f32 v67, v67
    v_rcp_f32 v68, v68
    v_rcp_f32 v69, v69
    v_rcp_f32 v70, v70
    v_rcp_f32 v71, v71
    v_rcp_f32 v72, v72
    v_rcp_f32 v73, v73
    v_rcp_f32 v74, v74
    v_rcp_f32 v75, v75
    v_rcp_f32 v76, v76
    v_rcp_f32 v77, v77
    v_rcp_f32 v78, v78
    v_rcp_f32 v79, v79
    v_pk_mul_f32 v[64:65], v[64:65], v[128:129]
    v_pk_mul_f32 v[66:67], v[66:67], v[130:131]
    v_cvt_pk_bf16_f32 v32, v64, v65
    v_cvt_pk_bf16_f32 v33, v66, v67
    v_pk_mul_f32 v[68:69], v[68:69], v[132:133]
    v_pk_mul_f32 v[70:71], v[70:71], v[134:135]
    v_cvt_pk_bf16_f32 v34, v68, v69
    v_cvt_pk_bf16_f32 v35, v70, v71
    v_pk_mul_f32 v[72:73], v[72:73], v[136:137]
    v_pk_mul_f32 v[74:75], v[74:75], v[138:139]
    v_cvt_pk_bf16_f32 v36, v72, v73
    v_cvt_pk_bf16_f32 v37, v74, v75
    v_pk_mul_f32 v[76:77], v[76:77], v[140:141]
    v_pk_mul_f32 v[78:79], v[78:79], v[142:143]
    v_cvt_pk_bf16_f32 v38, v76, v77
    v_cvt_pk_bf16_f32 v39, v78, v79
    v_permlane16_swap_b32 v32, v34
    v_permlane16_swap_b32 v33, v35
    v_permlane16_swap_b32 v36, v38
    v_permlane16_swap_b32 v37, v39
    s_add_u32 s28, s52, 0x0
    buffer_store_dwordx4 v[32:35], v17, s[16:19], s28 offen offset:0 sc1
    buffer_store_dwordx4 v[36:39], v17, s[16:19], s28 offen offset:512 sc1
    v_pk_mul_f32 v[64:65], v[144:145], v[144:145]
    v_pk_mul_f32 v[66:67], v[146:147], v[146:147]
    v_pk_fma_f32 v[64:65], v[64:65], s[46:47], v[60:61]
    v_pk_fma_f32 v[66:67], v[66:67], s[46:47], v[60:61]
    v_pk_mul_f32 v[64:65], v[64:65], v[144:145]
    v_pk_mul_f32 v[66:67], v[66:67], v[146:147]
    v_pk_mul_f32 v[68:69], v[148:149], v[148:149]
    v_pk_mul_f32 v[70:71], v[150:151], v[150:151]
    v_pk_fma_f32 v[68:69], v[68:69], s[46:47], v[60:61]
    v_pk_fma_f32 v[70:71], v[70:71], s[46:47], v[60:61]
    v_pk_mul_f32 v[68:69], v[68:69], v[148:149]
    v_pk_mul_f32 v[70:71], v[70:71], v[150:151]
    v_pk_mul_f32 v[72:73], v[152:153], v[152:153]
    v_pk_mul_f32 v[74:75], v[154:155], v[154:155]
    v_pk_fma_f32 v[72:73], v[72:73], s[46:47], v[60:61]
    v_pk_fma_f32 v[74:75], v[74:75], s[46:47], v[60:61]
    v_pk_mul_f32 v[72:73], v[72:73], v[152:153]
    v_pk_mul_f32 v[74:75], v[74:75], v[154:155]
    v_pk_mul_f32 v[76:77], v[156:157], v[156:157]
    v_pk_mul_f32 v[78:79], v[158:159], v[158:159]
    v_pk_fma_f32 v[76:77], v[76:77], s[46:47], v[60:61]
    v_pk_fma_f32 v[78:79], v[78:79], s[46:47], v[60:61]
    v_pk_mul_f32 v[76:77], v[76:77], v[156:157]
    v_pk_mul_f32 v[78:79], v[78:79], v[158:159]
    v_exp_f32 v64, v64
    v_exp_f32 v65, v65
    v_exp_f32 v66, v66
    v_exp_f32 v67, v67
    v_exp_f32 v68, v68
    v_exp_f32 v69, v69
    v_exp_f32 v70, v70
    v_exp_f32 v71, v71
    v_exp_f32 v72, v72
    v_exp_f32 v73, v73
    v_exp_f32 v74, v74
    v_exp_f32 v75, v75
    v_exp_f32 v76, v76
    v_exp_f32 v77, v77
    v_exp_f32 v78, v78
    v_exp_f32 v79, v79
    v_pk_add_f32 v[64:65], v[64:65], s[48:49]
    v_pk_add_f32 v[66:67], v[66:67], s[48:49]
    v_pk_add_f32 v[68:69], v[68:69], s[48:49]
    v_pk_add_f32 v[70:71], v[70:71], s[48:49]
    v_pk_add_f32 v[72:73], v[72:73], s[48:49]
    v_pk_add_f32 v[74:75], v[74:75], s[48:49]
    v_pk_add_f32 v[76:77], v[76:77], s[48:49]
    v_pk_add_f32 v[78:79], v[78:79], s[48:49]
    v_rcp_f32 v64, v64
    v_rcp_f32 v65, v65
    v_rcp_f32 v66, v66
    v_rcp_f32 v67, v67
    v_rcp_f32 v68, v68
    v_rcp_f32 v69, v69
    v_rcp_f32 v70, v70
    v_rcp_f32 v71, v71
    v_rcp_f32 v72, v72
    v_rcp_f32 v73, v73
    v_rcp_f32 v74, v74
    v_rcp_f32 v75, v75
    v_rcp_f32 v76, v76
    v_rcp_f32 v77, v77
    v_rcp_f32 v78, v78
    v_rcp_f32 v79, v79
    v_pk_mul_f32 v[64:65], v[64:65], v[144:145]
    v_pk_mul_f32 v[66:67], v[66:67], v[146:147]
    v_cvt_pk_bf16_f32 v40, v64, v65
    v_cvt_pk_bf16_f32 v41, v66, v67
    v_pk_mul_f32 v[68:69], v[68:69], v[148:149]
    v_pk_mul_f32 v[70:71], v[70:71], v[150:151]
    v_cvt_pk_bf16_f32 v42, v68, v69
    v_cvt_pk_bf16_f32 v43, v70, v71
    v_pk_mul_f32 v[72:73], v[72:73], v[152:153]
    v_pk_mul_f32 v[74:75], v[74:75], v[154:155]
    v_cvt_pk_bf16_f32 v44, v72, v73
    v_cvt_pk_bf16_f32 v45, v74, v75
    v_pk_mul_f32 v[76:77], v[76:77], v[156:157]
    v_pk_mul_f32 v[78:79], v[78:79], v[158:159]
    v_cvt_pk_bf16_f32 v46, v76, v77
    v_cvt_pk_bf16_f32 v47, v78, v79
    v_permlane16_swap_b32 v40, v42
    v_permlane16_swap_b32 v41, v43
    v_permlane16_swap_b32 v44, v46
    v_permlane16_swap_b32 v45, v47
    s_add_u32 s28, s52, 0x20000
    buffer_store_dwordx4 v[40:43], v17, s[16:19], s28 offen offset:0 sc1
    buffer_store_dwordx4 v[44:47], v17, s[16:19], s28 offen offset:512 sc1
    v_pk_mul_f32 v[64:65], v[160:161], v[160:161]
    v_pk_mul_f32 v[66:67], v[162:163], v[162:163]
    v_pk_fma_f32 v[64:65], v[64:65], s[46:47], v[60:61]
    v_pk_fma_f32 v[66:67], v[66:67], s[46:47], v[60:61]
    v_pk_mul_f32 v[64:65], v[64:65], v[160:161]
    v_pk_mul_f32 v[66:67], v[66:67], v[162:163]
    v_pk_mul_f32 v[68:69], v[164:165], v[164:165]
    v_pk_mul_f32 v[70:71], v[166:167], v[166:167]
    v_pk_fma_f32 v[68:69], v[68:69], s[46:47], v[60:61]
    v_pk_fma_f32 v[70:71], v[70:71], s[46:47], v[60:61]
    v_pk_mul_f32 v[68:69], v[68:69], v[164:165]
    v_pk_mul_f32 v[70:71], v[70:71], v[166:167]
    v_pk_mul_f32 v[72:73], v[168:169], v[168:169]
    v_pk_mul_f32 v[74:75], v[170:171], v[170:171]
    v_pk_fma_f32 v[72:73], v[72:73], s[46:47], v[60:61]
    v_pk_fma_f32 v[74:75], v[74:75], s[46:47], v[60:61]
    v_pk_mul_f32 v[72:73], v[72:73], v[168:169]
    v_pk_mul_f32 v[74:75], v[74:75], v[170:171]
    v_pk_mul_f32 v[76:77], v[172:173], v[172:173]
    v_pk_mul_f32 v[78:79], v[174:175], v[174:175]
    v_pk_fma_f32 v[76:77], v[76:77], s[46:47], v[60:61]
    v_pk_fma_f32 v[78:79], v[78:79], s[46:47], v[60:61]
    v_pk_mul_f32 v[76:77], v[76:77], v[172:173]
    v_pk_mul_f32 v[78:79], v[78:79], v[174:175]
    v_exp_f32 v64, v64
    v_exp_f32 v65, v65
    v_exp_f32 v66, v66
    v_exp_f32 v67, v67
    v_exp_f32 v68, v68
    v_exp_f32 v69, v69
    v_exp_f32 v70, v70
    v_exp_f32 v71, v71
    v_exp_f32 v72, v72
    v_exp_f32 v73, v73
    v_exp_f32 v74, v74
    v_exp_f32 v75, v75
    v_exp_f32 v76, v76
    v_exp_f32 v77, v77
    v_exp_f32 v78, v78
    v_exp_f32 v79, v79
    v_pk_add_f32 v[64:65], v[64:65], s[48:49]
    v_pk_add_f32 v[66:67], v[66:67], s[48:49]
    v_pk_add_f32 v[68:69], v[68:69], s[48:49]
    v_pk_add_f32 v[70:71], v[70:71], s[48:49]
    v_pk_add_f32 v[72:73], v[72:73], s[48:49]
    v_pk_add_f32 v[74:75], v[74:75], s[48:49]
    v_pk_add_f32 v[76:77], v[76:77], s[48:49]
    v_pk_add_f32 v[78:79], v[78:79], s[48:49]
    v_rcp_f32 v64, v64
    v_rcp_f32 v65, v65
    v_rcp_f32 v66, v66
    v_rcp_f32 v67, v67
    v_rcp_f32 v68, v68
    v_rcp_f32 v69, v69
    v_rcp_f32 v70, v70
    v_rcp_f32 v71, v71
    v_rcp_f32 v72, v72
    v_rcp_f32 v73, v73
    v_rcp_f32 v74, v74
    v_rcp_f32 v75, v75
    v_rcp_f32 v76, v76
    v_rcp_f32 v77, v77
    v_rcp_f32 v78, v78
    v_rcp_f32 v79, v79
    v_pk_mul_f32 v[64:65], v[64:65], v[160:161]
    v_pk_mul_f32 v[66:67], v[66:67], v[162:163]
    v_cvt_pk_bf16_f32 v32, v64, v65
    v_cvt_pk_bf16_f32 v33, v66, v67
    v_pk_mul_f32 v[68:69], v[68:69], v[164:165]
    v_pk_mul_f32 v[70:71], v[70:71], v[166:167]
    v_cvt_pk_bf16_f32 v34, v68, v69
    v_cvt_pk_bf16_f32 v35, v70, v71
    v_pk_mul_f32 v[72:73], v[72:73], v[168:169]
    v_pk_mul_f32 v[74:75], v[74:75], v[170:171]
    v_cvt_pk_bf16_f32 v36, v72, v73
    v_cvt_pk_bf16_f32 v37, v74, v75
    v_pk_mul_f32 v[76:77], v[76:77], v[172:173]
    v_pk_mul_f32 v[78:79], v[78:79], v[174:175]
    v_cvt_pk_bf16_f32 v38, v76, v77
    v_cvt_pk_bf16_f32 v39, v78, v79
    v_permlane16_swap_b32 v32, v34
    v_permlane16_swap_b32 v33, v35
    v_permlane16_swap_b32 v36, v38
    v_permlane16_swap_b32 v37, v39
    s_add_u32 s28, s52, 0x40000
    buffer_store_dwordx4 v[32:35], v17, s[16:19], s28 offen offset:0 sc1
    buffer_store_dwordx4 v[36:39], v17, s[16:19], s28 offen offset:512 sc1
    v_pk_mul_f32 v[64:65], v[176:177], v[176:177]
    v_pk_mul_f32 v[66:67], v[178:179], v[178:179]
    v_pk_fma_f32 v[64:65], v[64:65], s[46:47], v[60:61]
    v_pk_fma_f32 v[66:67], v[66:67], s[46:47], v[60:61]
    v_pk_mul_f32 v[64:65], v[64:65], v[176:177]
    v_pk_mul_f32 v[66:67], v[66:67], v[178:179]
    v_pk_mul_f32 v[68:69], v[180:181], v[180:181]
    v_pk_mul_f32 v[70:71], v[182:183], v[182:183]
    v_pk_fma_f32 v[68:69], v[68:69], s[46:47], v[60:61]
    v_pk_fma_f32 v[70:71], v[70:71], s[46:47], v[60:61]
    v_pk_mul_f32 v[68:69], v[68:69], v[180:181]
    v_pk_mul_f32 v[70:71], v[70:71], v[182:183]
    v_pk_mul_f32 v[72:73], v[184:185], v[184:185]
    v_pk_mul_f32 v[74:75], v[186:187], v[186:187]
    v_pk_fma_f32 v[72:73], v[72:73], s[46:47], v[60:61]
    v_pk_fma_f32 v[74:75], v[74:75], s[46:47], v[60:61]
    v_pk_mul_f32 v[72:73], v[72:73], v[184:185]
    v_pk_mul_f32 v[74:75], v[74:75], v[186:187]
    v_pk_mul_f32 v[76:77], v[188:189], v[188:189]
    v_pk_mul_f32 v[78:79], v[190:191], v[190:191]
    v_pk_fma_f32 v[76:77], v[76:77], s[46:47], v[60:61]
    v_pk_fma_f32 v[78:79], v[78:79], s[46:47], v[60:61]
    v_pk_mul_f32 v[76:77], v[76:77], v[188:189]
    v_pk_mul_f32 v[78:79], v[78:79], v[190:191]
    v_exp_f32 v64, v64
    v_exp_f32 v65, v65
    v_exp_f32 v66, v66
    v_exp_f32 v67, v67
    v_exp_f32 v68, v68
    v_exp_f32 v69, v69
    v_exp_f32 v70, v70
    v_exp_f32 v71, v71
    v_exp_f32 v72, v72
    v_exp_f32 v73, v73
    v_exp_f32 v74, v74
    v_exp_f32 v75, v75
    v_exp_f32 v76, v76
    v_exp_f32 v77, v77
    v_exp_f32 v78, v78
    v_exp_f32 v79, v79
    v_pk_add_f32 v[64:65], v[64:65], s[48:49]
    v_pk_add_f32 v[66:67], v[66:67], s[48:49]
    v_pk_add_f32 v[68:69], v[68:69], s[48:49]
    v_pk_add_f32 v[70:71], v[70:71], s[48:49]
    v_pk_add_f32 v[72:73], v[72:73], s[48:49]
    v_pk_add_f32 v[74:75], v[74:75], s[48:49]
    v_pk_add_f32 v[76:77], v[76:77], s[48:49]
    v_pk_add_f32 v[78:79], v[78:79], s[48:49]
    v_rcp_f32 v64, v64
    v_rcp_f32 v65, v65
    v_rcp_f32 v66, v66
    v_rcp_f32 v67, v67
    v_rcp_f32 v68, v68
    v_rcp_f32 v69, v69
    v_rcp_f32 v70, v70
    v_rcp_f32 v71, v71
    v_rcp_f32 v72, v72
    v_rcp_f32 v73, v73
    v_rcp_f32 v74, v74
    v_rcp_f32 v75, v75
    v_rcp_f32 v76, v76
    v_rcp_f32 v77, v77
    v_rcp_f32 v78, v78
    v_rcp_f32 v79, v79
    v_pk_mul_f32 v[64:65], v[64:65], v[176:177]
    v_pk_mul_f32 v[66:67], v[66:67], v[178:179]
    v_cvt_pk_bf16_f32 v40, v64, v65
    v_cvt_pk_bf16_f32 v41, v66, v67
    v_pk_mul_f32 v[68:69], v[68:69], v[180:181]
    v_pk_mul_f32 v[70:71], v[70:71], v[182:183]
    v_cvt_pk_bf16_f32 v42, v68, v69
    v_cvt_pk_bf16_f32 v43, v70, v71
    v_pk_mul_f32 v[72:73], v[72:73], v[184:185]
    v_pk_mul_f32 v[74:75], v[74:75], v[186:187]
    v_cvt_pk_bf16_f32 v44, v72, v73
    v_cvt_pk_bf16_f32 v45, v74, v75
    v_pk_mul_f32 v[76:77], v[76:77], v[188:189]
    v_pk_mul_f32 v[78:79], v[78:79], v[190:191]
    v_cvt_pk_bf16_f32 v46, v76, v77
    v_cvt_pk_bf16_f32 v47, v78, v79
    v_permlane16_swap_b32 v40, v42
    v_permlane16_swap_b32 v41, v43
    v_permlane16_swap_b32 v44, v46
    v_permlane16_swap_b32 v45, v47
    s_add_u32 s28, s52, 0x60000
    buffer_store_dwordx4 v[40:43], v17, s[16:19], s28 offen offset:0 sc1
    buffer_store_dwordx4 v[44:47], v17, s[16:19], s28 offen offset:512 sc1
    v_pk_mul_f32 v[64:65], v[192:193], v[192:193]
    v_pk_mul_f32 v[66:67], v[194:195], v[194:195]
    v_pk_fma_f32 v[64:65], v[64:65], s[46:47], v[60:61]
    v_pk_fma_f32 v[66:67], v[66:67], s[46:47], v[60:61]
    v_pk_mul_f32 v[64:65], v[64:65], v[192:193]
    v_pk_mul_f32 v[66:67], v[66:67], v[194:195]
    v_pk_mul_f32 v[68:69], v[196:197], v[196:197]
    v_pk_mul_f32 v[70:71], v[198:199], v[198:199]
    v_pk_fma_f32 v[68:69], v[68:69], s[46:47], v[60:61]
    v_pk_fma_f32 v[70:71], v[70:71], s[46:47], v[60:61]
    v_pk_mul_f32 v[68:69], v[68:69], v[196:197]
    v_pk_mul_f32 v[70:71], v[70:71], v[198:199]
    v_pk_mul_f32 v[72:73], v[200:201], v[200:201]
    v_pk_mul_f32 v[74:75], v[202:203], v[202:203]
    v_pk_fma_f32 v[72:73], v[72:73], s[46:47], v[60:61]
    v_pk_fma_f32 v[74:75], v[74:75], s[46:47], v[60:61]
    v_pk_mul_f32 v[72:73], v[72:73], v[200:201]
    v_pk_mul_f32 v[74:75], v[74:75], v[202:203]
    v_pk_mul_f32 v[76:77], v[204:205], v[204:205]
    v_pk_mul_f32 v[78:79], v[206:207], v[206:207]
    v_pk_fma_f32 v[76:77], v[76:77], s[46:47], v[60:61]
    v_pk_fma_f32 v[78:79], v[78:79], s[46:47], v[60:61]
    v_pk_mul_f32 v[76:77], v[76:77], v[204:205]
    v_pk_mul_f32 v[78:79], v[78:79], v[206:207]
    v_exp_f32 v64, v64
    v_exp_f32 v65, v65
    v_exp_f32 v66, v66
    v_exp_f32 v67, v67
    v_exp_f32 v68, v68
    v_exp_f32 v69, v69
    v_exp_f32 v70, v70
    v_exp_f32 v71, v71
    v_exp_f32 v72, v72
    v_exp_f32 v73, v73
    v_exp_f32 v74, v74
    v_exp_f32 v75, v75
    v_exp_f32 v76, v76
    v_exp_f32 v77, v77
    v_exp_f32 v78, v78
    v_exp_f32 v79, v79
    v_pk_add_f32 v[64:65], v[64:65], s[48:49]
    v_pk_add_f32 v[66:67], v[66:67], s[48:49]
    v_pk_add_f32 v[68:69], v[68:69], s[48:49]
    v_pk_add_f32 v[70:71], v[70:71], s[48:49]
    v_pk_add_f32 v[72:73], v[72:73], s[48:49]
    v_pk_add_f32 v[74:75], v[74:75], s[48:49]
    v_pk_add_f32 v[76:77], v[76:77], s[48:49]
    v_pk_add_f32 v[78:79], v[78:79], s[48:49]
    v_rcp_f32 v64, v64
    v_rcp_f32 v65, v65
    v_rcp_f32 v66, v66
    v_rcp_f32 v67, v67
    v_rcp_f32 v68, v68
    v_rcp_f32 v69, v69
    v_rcp_f32 v70, v70
    v_rcp_f32 v71, v71
    v_rcp_f32 v72, v72
    v_rcp_f32 v73, v73
    v_rcp_f32 v74, v74
    v_rcp_f32 v75, v75
    v_rcp_f32 v76, v76
    v_rcp_f32 v77, v77
    v_rcp_f32 v78, v78
    v_rcp_f32 v79, v79
    v_pk_mul_f32 v[64:65], v[64:65], v[192:193]
    v_pk_mul_f32 v[66:67], v[66:67], v[194:195]
    v_cvt_pk_bf16_f32 v32, v64, v65
    v_cvt_pk_bf16_f32 v33, v66, v67
    v_pk_mul_f32 v[68:69], v[68:69], v[196:197]
    v_pk_mul_f32 v[70:71], v[70:71], v[198:199]
    v_cvt_pk_bf16_f32 v34, v68, v69
    v_cvt_pk_bf16_f32 v35, v70, v71
    v_pk_mul_f32 v[72:73], v[72:73], v[200:201]
    v_pk_mul_f32 v[74:75], v[74:75], v[202:203]
    v_cvt_pk_bf16_f32 v36, v72, v73
    v_cvt_pk_bf16_f32 v37, v74, v75
    v_pk_mul_f32 v[76:77], v[76:77], v[204:205]
    v_pk_mul_f32 v[78:79], v[78:79], v[206:207]
    v_cvt_pk_bf16_f32 v38, v76, v77
    v_cvt_pk_bf16_f32 v39, v78, v79
    v_permlane16_swap_b32 v32, v34
    v_permlane16_swap_b32 v33, v35
    v_permlane16_swap_b32 v36, v38
    v_permlane16_swap_b32 v37, v39
    s_add_u32 s28, s52, 0x80000
    buffer_store_dwordx4 v[32:35], v17, s[16:19], s28 offen offset:0 sc1
    buffer_store_dwordx4 v[36:39], v17, s[16:19], s28 offen offset:512 sc1
    v_pk_mul_f32 v[64:65], v[208:209], v[208:209]
    v_pk_mul_f32 v[66:67], v[210:211], v[210:211]
    v_pk_fma_f32 v[64:65], v[64:65], s[46:47], v[60:61]
    v_pk_fma_f32 v[66:67], v[66:67], s[46:47], v[60:61]
    v_pk_mul_f32 v[64:65], v[64:65], v[208:209]
    v_pk_mul_f32 v[66:67], v[66:67], v[210:211]
    v_pk_mul_f32 v[68:69], v[212:213], v[212:213]
    v_pk_mul_f32 v[70:71], v[214:215], v[214:215]
    v_pk_fma_f32 v[68:69], v[68:69], s[46:47], v[60:61]
    v_pk_fma_f32 v[70:71], v[70:71], s[46:47], v[60:61]
    v_pk_mul_f32 v[68:69], v[68:69], v[212:213]
    v_pk_mul_f32 v[70:71], v[70:71], v[214:215]
    v_pk_mul_f32 v[72:73], v[216:217], v[216:217]
    v_pk_mul_f32 v[74:75], v[218:219], v[218:219]
    v_pk_fma_f32 v[72:73], v[72:73], s[46:47], v[60:61]
    v_pk_fma_f32 v[74:75], v[74:75], s[46:47], v[60:61]
    v_pk_mul_f32 v[72:73], v[72:73], v[216:217]
    v_pk_mul_f32 v[74:75], v[74:75], v[218:219]
    v_pk_mul_f32 v[76:77], v[220:221], v[220:221]
    v_pk_mul_f32 v[78:79], v[222:223], v[222:223]
    v_pk_fma_f32 v[76:77], v[76:77], s[46:47], v[60:61]
    v_pk_fma_f32 v[78:79], v[78:79], s[46:47], v[60:61]
    v_pk_mul_f32 v[76:77], v[76:77], v[220:221]
    v_pk_mul_f32 v[78:79], v[78:79], v[222:223]
    v_exp_f32 v64, v64
    v_exp_f32 v65, v65
    v_exp_f32 v66, v66
    v_exp_f32 v67, v67
    v_exp_f32 v68, v68
    v_exp_f32 v69, v69
    v_exp_f32 v70, v70
    v_exp_f32 v71, v71
    v_exp_f32 v72, v72
    v_exp_f32 v73, v73
    v_exp_f32 v74, v74
    v_exp_f32 v75, v75
    v_exp_f32 v76, v76
    v_exp_f32 v77, v77
    v_exp_f32 v78, v78
    v_exp_f32 v79, v79
    v_pk_add_f32 v[64:65], v[64:65], s[48:49]
    v_pk_add_f32 v[66:67], v[66:67], s[48:49]
    v_pk_add_f32 v[68:69], v[68:69], s[48:49]
    v_pk_add_f32 v[70:71], v[70:71], s[48:49]
    v_pk_add_f32 v[72:73], v[72:73], s[48:49]
    v_pk_add_f32 v[74:75], v[74:75], s[48:49]
    v_pk_add_f32 v[76:77], v[76:77], s[48:49]
    v_pk_add_f32 v[78:79], v[78:79], s[48:49]
    v_rcp_f32 v64, v64
    v_rcp_f32 v65, v65
    v_rcp_f32 v66, v66
    v_rcp_f32 v67, v67
    v_rcp_f32 v68, v68
    v_rcp_f32 v69, v69
    v_rcp_f32 v70, v70
    v_rcp_f32 v71, v71
    v_rcp_f32 v72, v72
    v_rcp_f32 v73, v73
    v_rcp_f32 v74, v74
    v_rcp_f32 v75, v75
    v_rcp_f32 v76, v76
    v_rcp_f32 v77, v77
    v_rcp_f32 v78, v78
    v_rcp_f32 v79, v79
    v_pk_mul_f32 v[64:65], v[64:65], v[208:209]
    v_pk_mul_f32 v[66:67], v[66:67], v[210:211]
    v_cvt_pk_bf16_f32 v40, v64, v65
    v_cvt_pk_bf16_f32 v41, v66, v67
    v_pk_mul_f32 v[68:69], v[68:69], v[212:213]
    v_pk_mul_f32 v[70:71], v[70:71], v[214:215]
    v_cvt_pk_bf16_f32 v42, v68, v69
    v_cvt_pk_bf16_f32 v43, v70, v71
    v_pk_mul_f32 v[72:73], v[72:73], v[216:217]
    v_pk_mul_f32 v[74:75], v[74:75], v[218:219]
    v_cvt_pk_bf16_f32 v44, v72, v73
    v_cvt_pk_bf16_f32 v45, v74, v75
    v_pk_mul_f32 v[76:77], v[76:77], v[220:221]
    v_pk_mul_f32 v[78:79], v[78:79], v[222:223]
    v_cvt_pk_bf16_f32 v46, v76, v77
    v_cvt_pk_bf16_f32 v47, v78, v79
    v_permlane16_swap_b32 v40, v42
    v_permlane16_swap_b32 v41, v43
    v_permlane16_swap_b32 v44, v46
    v_permlane16_swap_b32 v45, v47
    s_add_u32 s28, s52, 0xa0000
    buffer_store_dwordx4 v[40:43], v17, s[16:19], s28 offen offset:0 sc1
    buffer_store_dwordx4 v[44:47], v17, s[16:19], s28 offen offset:512 sc1
    v_pk_mul_f32 v[64:65], v[224:225], v[224:225]
    v_pk_mul_f32 v[66:67], v[226:227], v[226:227]
    v_pk_fma_f32 v[64:65], v[64:65], s[46:47], v[60:61]
    v_pk_fma_f32 v[66:67], v[66:67], s[46:47], v[60:61]
    v_pk_mul_f32 v[64:65], v[64:65], v[224:225]
    v_pk_mul_f32 v[66:67], v[66:67], v[226:227]
    v_pk_mul_f32 v[68:69], v[228:229], v[228:229]
    v_pk_mul_f32 v[70:71], v[230:231], v[230:231]
    v_pk_fma_f32 v[68:69], v[68:69], s[46:47], v[60:61]
    v_pk_fma_f32 v[70:71], v[70:71], s[46:47], v[60:61]
    v_pk_mul_f32 v[68:69], v[68:69], v[228:229]
    v_pk_mul_f32 v[70:71], v[70:71], v[230:231]
    v_pk_mul_f32 v[72:73], v[232:233], v[232:233]
    v_pk_mul_f32 v[74:75], v[234:235], v[234:235]
    v_pk_fma_f32 v[72:73], v[72:73], s[46:47], v[60:61]
    v_pk_fma_f32 v[74:75], v[74:75], s[46:47], v[60:61]
    v_pk_mul_f32 v[72:73], v[72:73], v[232:233]
    v_pk_mul_f32 v[74:75], v[74:75], v[234:235]
    v_pk_mul_f32 v[76:77], v[236:237], v[236:237]
    v_pk_mul_f32 v[78:79], v[238:239], v[238:239]
    v_pk_fma_f32 v[76:77], v[76:77], s[46:47], v[60:61]
    v_pk_fma_f32 v[78:79], v[78:79], s[46:47], v[60:61]
    v_pk_mul_f32 v[76:77], v[76:77], v[236:237]
    v_pk_mul_f32 v[78:79], v[78:79], v[238:239]
    v_exp_f32 v64, v64
    v_exp_f32 v65, v65
    v_exp_f32 v66, v66
    v_exp_f32 v67, v67
    v_exp_f32 v68, v68
    v_exp_f32 v69, v69
    v_exp_f32 v70, v70
    v_exp_f32 v71, v71
    v_exp_f32 v72, v72
    v_exp_f32 v73, v73
    v_exp_f32 v74, v74
    v_exp_f32 v75, v75
    v_exp_f32 v76, v76
    v_exp_f32 v77, v77
    v_exp_f32 v78, v78
    v_exp_f32 v79, v79
    v_pk_add_f32 v[64:65], v[64:65], s[48:49]
    v_pk_add_f32 v[66:67], v[66:67], s[48:49]
    v_pk_add_f32 v[68:69], v[68:69], s[48:49]
    v_pk_add_f32 v[70:71], v[70:71], s[48:49]
    v_pk_add_f32 v[72:73], v[72:73], s[48:49]
    v_pk_add_f32 v[74:75], v[74:75], s[48:49]
    v_pk_add_f32 v[76:77], v[76:77], s[48:49]
    v_pk_add_f32 v[78:79], v[78:79], s[48:49]
    v_rcp_f32 v64, v64
    v_rcp_f32 v65, v65
    v_rcp_f32 v66, v66
    v_rcp_f32 v67, v67
    v_rcp_f32 v68, v68
    v_rcp_f32 v69, v69
    v_rcp_f32 v70, v70
    v_rcp_f32 v71, v71
    v_rcp_f32 v72, v72
    v_rcp_f32 v73, v73
    v_rcp_f32 v74, v74
    v_rcp_f32 v75, v75
    v_rcp_f32 v76, v76
    v_rcp_f32 v77, v77
    v_rcp_f32 v78, v78
    v_rcp_f32 v79, v79
    v_pk_mul_f32 v[64:65], v[64:65], v[224:225]
    v_pk_mul_f32 v[66:67], v[66:67], v[226:227]
    v_cvt_pk_bf16_f32 v32, v64, v65
    v_cvt_pk_bf16_f32 v33, v66, v67
    v_pk_mul_f32 v[68:69], v[68:69], v[228:229]
    v_pk_mul_f32 v[70:71], v[70:71], v[230:231]
    v_cvt_pk_bf16_f32 v34, v68, v69
    v_cvt_pk_bf16_f32 v35, v70, v71
    v_pk_mul_f32 v[72:73], v[72:73], v[232:233]
    v_pk_mul_f32 v[74:75], v[74:75], v[234:235]
    v_cvt_pk_bf16_f32 v36, v72, v73
    v_cvt_pk_bf16_f32 v37, v74, v75
    v_pk_mul_f32 v[76:77], v[76:77], v[236:237]
    v_pk_mul_f32 v[78:79], v[78:79], v[238:239]
    v_cvt_pk_bf16_f32 v38, v76, v77
    v_cvt_pk_bf16_f32 v39, v78, v79
    v_permlane16_swap_b32 v32, v34
    v_permlane16_swap_b32 v33, v35
    v_permlane16_swap_b32 v36, v38
    v_permlane16_swap_b32 v37, v39
    s_add_u32 s28, s52, 0xc0000
    buffer_store_dwordx4 v[32:35], v17, s[16:19], s28 offen offset:0 sc1
    buffer_store_dwordx4 v[36:39], v17, s[16:19], s28 offen offset:512 sc1
    s_waitcnt vmcnt(0)
    s_barrier
    s_sub_u32 s29, s25, 16
    s_cmp_gt_u32 s29, 11
    s_cselect_b32 s28, 1, 0
    s_lshl_b32 s76, s24, 1
    s_add_u32 s28, s28, s76
    s_lshl_b32 s28, s28, 7
    s_add_u32 s28, s28, 0x200000
    v_mov_b32 v17, 0
    v_mov_b32 v18, 1
    v_cmp_eq_u32 vcc, 0, v0
    s_nop 1
    s_and_saveexec_b64 s[34:35], vcc
    buffer_atomic_add v18, v17, s[92:95], s28 offen sc1
    s_cmp_lg_u32 s29, 11
    s_cbranch_scc1 g12_one
    buffer_atomic_add v18, v17, s[92:95], s28 offen offset:128 sc1
g12_one:
    s_mov_b64 exec, s[34:35]
    s_branch g12_p2
g1_exit:
    s_endpgm
g12_p2:
    s_load_dwordx2 s[4:5], s[0:1], 88
    s_load_dwordx2 s[6:7], s[0:1], 24
    s_load_dwordx2 s[56:57], s[0:1], 56
    s_load_dwordx2 s[58:59], s[0:1], 64
    s_load_dwordx2 s[60:61], s[0:1], 0
    s_load_dwordx2 s[62:63], s[0:1], 72
    v_lshrrev_b32 v1, 6, v0
    v_and_b32 v14, 63, v0
    s_nop 0
    v_readfirstlane_b32 s20, v1
    v_lshrrev_b32 v15, 4, v14
    v_and_b32 v16, 15, v14
    s_nop 1
    s_and_b32 s21, s20, 1
    s_bfe_u32 s23, s20, 0x10001
    s_lshr_b32 s22, s20, 2
    s_lshr_b32 s33, s2, 7
    s_and_b32 s26, s2, 7
    s_bfe_u32 s27, s2, 0x40003
    s_lshr_b32 s24, s26, 1
    s_lshl_b32 s24, s24, 2
    s_and_b32 s28, s27, 3
    s_add_u32 s24, s24, s28
    s_and_b32 s25, s26, 1
    s_lshl_b32 s25, s25, 2
    s_lshr_b32 s28, s27, 2
    s_add_u32 s25, s25, s28
    s_lshl_b32 s28, s20, 11
    s_lshl_b32 s29, s24, 7
    s_add_u32 s28, s28, s29
    v_add_u32 v17, s28, v14
    v_lshlrev_b32 v9, 4, v17
    s_lshl_b32 s31, s20, 11
    s_lshl_b32 s30, s20, 10
    v_lshrrev_b32 v17, 3, v14
    v_bfe_u32 v18, v14, 4, 1
    s_lshl_b32 s28, s21, 1
    v_or_b32 v18, s28, v18
    v_bfe_u32 v19, v14, 1, 2
    v_xor_b32 v19, v19, v18
    v_and_b32 v20, 1, v14
    v_lshlrev_b32 v20, 4, v20
    v_lshl_add_u32 v20, v19, 5, v20
    s_lshl_b32 s28, s20, 3
    v_add_u32 v17, s28, v17
    v_lshl_add_u32 v17, v17, 11, v20
    s_lshl_b32 s32, s25, 8
    v_add_u32 v10, s32, v17
    s_waitcnt lgkmcnt(0)
    s_add_u32 s8, s4, 0x400000
    s_addc_u32 s9, s5, 0
    s_and_b32 s9, s9, 0xffff
    s_mov_b32 s10, 0x1200000
    s_mov_b32 s11, 0x00020000
    s_mov_b32 s12, s56
    s_mov_b32 s13, s57
    s_and_b32 s13, s13, 0xffff
    s_mov_b32 s14, 0x700000
    s_mov_b32 s15, 0x00020000
    s_mov_b32 s16, s6
    s_mov_b32 s17, s7
    s_and_b32 s17, s17, 0xffff
    s_mov_b32 s18, 0x200000
    s_mov_b32 s19, 0x00020000
    s_add_u32 s36, s4, 0x2c00000
    s_addc_u32 s37, s5, 0
    s_and_b32 s37, s37, 0xffff
    s_mov_b32 s38, 0x2000
    s_mov_b32 s39, 0x00020000
    s_cmp_lg_u32 s33, 0
    s_cbranch_scc1 g2_hi
    s_add_u32 m0, s30, 0x4000
    s_mov_b32 s28, 0x520000
    buffer_load_dwordx4 v10, s[12:15], s28 offen lds
    s_add_u32 m0, s30, 0x6000
    s_mov_b32 s28, 0x520080
    buffer_load_dwordx4 v10, s[12:15], s28 offen lds
    s_add_u32 m0, s30, 0xc000
    s_mov_b32 s28, 0x540000
    buffer_load_dwordx4 v10, s[12:15], s28 offen lds
    s_add_u32 m0, s30, 0xe000
    s_mov_b32 s28, 0x540080
    buffer_load_dwordx4 v10, s[12:15], s28 offen lds
    s_add_u32 m0, s30, 0x14000
    s_mov_b32 s28, 0x560000
    buffer_load_dwordx4 v10, s[12:15], s28 offen lds
    s_add_u32 m0, s30, 0x16000
    s_mov_b32 s28, 0x560080
    buffer_load_dwordx4 v10, s[12:15], s28 offen lds
    s_add_u32 m0, s30, 0x1c000
    s_mov_b32 s28, 0x580000
    buffer_load_dwordx4 v10, s[12:15], s28 offen lds
    s_add_u32 m0, s30, 0x1e000
    s_mov_b32 s28, 0x580080
    buffer_load_dwordx4 v10, s[12:15], s28 offen lds
    s_lshr_b32 s67, s24, 1
    s_lshl_b32 s67, s67, 1
    s_add_u32 s67, s67, 1
    s_lshl_b32 s67, s67, 7
    s_bfe_u32 s29, s2, 0x40001
    s_add_u32 s29, s29, 16
    s_lshl_b32 s29, s29, 7
    v_mov_b32 v31, 0
g12_pq:
    buffer_load_dword v1, v31, s[36:39], s29 offen sc1
    s_waitcnt vmcnt(0)
    v_readfirstlane_b32 s34, v1
    s_nop 1
    s_nop 3
    s_cmp_ge_u32 s34, 8
    s_cbranch_scc1 g12_pqok
    s_sleep 2
    s_branch g12_pq
g12_pqok:
    s_add_u32 s80, s4, 0x1e00000
    s_addc_u32 s81, s5, 0
    s_and_b32 s81, s81, 0xffff
    s_mov_b32 s82, 0x210000
    s_mov_b32 s83, 0x00020000
    s_add_u32 s84, s4, 0x1600000
    s_addc_u32 s85, s5, 0
    s_and_b32 s85, s85, 0xffff
    s_mov_b32 s86, 0x800000
    s_mov_b32 s87, 0x00020000
    s_and_b32 s70, s2, 31
    s_lshr_b32 s71, s2, 5
    s_lshl_b32 s28, s21, 12
    s_bfe_u32 s29, s20, 0x10001
    s_lshl_b32 s29, s29, 11
    s_add_u32 s28, s28, s29
    v_lshl_add_u32 v17, v14, 4, s28
    v_add_u32 v18, 1024, v17
    s_lshl_b32 s29, s21, 7
    s_add_u32 s29, s29, 8192
    v_lshl_add_u32 v19, v15, 4, s29
    v_add_u32 v20, 64, v19
    s_cmp_lt_u32 s20, 4
    s_cselect_b64 s[34:35], -1, 0
    s_cselect_b32 s94, -1, 0x00010001
    s_mov_b32 s95, s94
    v_cndmask_b32 v11, v19, v17, s[34:35]
    v_cndmask_b32 v13, v20, v18, s[34:35]
    s_mul_i32 s72, s70, 67584
    s_lshl_b32 s28, s71, 5
    s_lshl_b32 s29, s20, 2
    s_add_u32 s28, s28, s29
    s_lshl_b32 s28, s28, 10
    s_lshl_b32 s29, s70, 17
    s_add_u32 s28, s28, s29
    v_lshl_add_u32 v12, v14, 4, s28
    s_lshl_b32 s28, s70, 11
    s_add_u32 s28, s28, 0x400000
    v_lshl_add_u32 v27, v14, 4, s28
    buffer_load_dwordx4 v[128:131], v12, s[84:87], 0 offen offset:0
    buffer_load_dwordx4 v[132:135], v12, s[84:87], 0 offen offset:1024
    buffer_load_dwordx4 v[136:139], v12, s[84:87], 0 offen offset:2048
    buffer_load_dwordx4 v[140:143], v12, s[84:87], 0 offen offset:3072
    buffer_load_dwordx4 v[144:147], v27, s[84:87], 0 offen offset:0
    buffer_load_dwordx4 v[148:151], v27, s[84:87], 0 offen offset:1024
    s_mov_b64 exec, s[94:95]
    s_add_u32 s28, s72, 0
    buffer_load_dwordx4 v[64:67], v11, s[80:83], s28 offen
    buffer_load_dwordx4 v[68:71], v13, s[80:83], s28 offen
    s_add_u32 s28, s72, 8448
    buffer_load_dwordx4 v[72:75], v11, s[80:83], s28 offen
    buffer_load_dwordx4 v[76:79], v13, s[80:83], s28 offen
    s_add_u32 s28, s72, 16896
    buffer_load_dwordx4 v[80:83], v11, s[80:83], s28 offen
    buffer_load_dwordx4 v[84:87], v13, s[80:83], s28 offen
    s_add_u32 s28, s72, 25344
    buffer_load_dwordx4 v[88:91], v11, s[80:83], s28 offen
    buffer_load_dwordx4 v[92:95], v13, s[80:83], s28 offen
    s_add_u32 s28, s72, 33792
    buffer_load_dwordx4 v[96:99], v11, s[80:83], s28 offen
    buffer_load_dwordx4 v[100:103], v13, s[80:83], s28 offen
    s_add_u32 s28, s72, 42240
    buffer_load_dwordx4 v[104:107], v11, s[80:83], s28 offen
    buffer_load_dwordx4 v[108:111], v13, s[80:83], s28 offen
    s_add_u32 s28, s72, 50688
    buffer_load_dwordx4 v[112:115], v11, s[80:83], s28 offen
    buffer_load_dwordx4 v[116:119], v13, s[80:83], s28 offen
    s_add_u32 s28, s72, 59136
    buffer_load_dwordx4 v[120:123], v11, s[80:83], s28 offen
    buffer_load_dwordx4 v[124:127], v13, s[80:83], s28 offen
    s_mov_b64 exec, -1
    s_lshl_b32 s28, s71, 9
    s_lshl_b32 s29, s20, 6
    s_add_u32 s28, s28, s29
    s_lshl_b32 s29, s70, 13
    s_add_u32 s28, s28, s29
    v_add_u32 v28, s28, v16
    v_and_b32 v20, 1, v15
    v_lshl_add_u32 v28, v20, 4, v28
    v_lshrrev_b32 v20, 1, v15
    v_lshl_add_u32 v28, v20, 11, v28
    v_lshlrev_b32 v28, 4, v28
    v_lshlrev_b32 v29, 4, v14
    v_add_u32 v29, 0x20000, v29
    v_add_u32 v30, s30, v29
    v_lshlrev_b32 v26, 8, v15
    v_add_u32 v26, 0x20000, v26
    s_mov_b32 s66, 0xffff0000
    s_mov_b32 s76, 0x3fb8aa3b
    s_waitcnt vmcnt(16)
    v_mfma_f32_16x16x32_bf16 v[152:155], v[144:147], v[128:131], 0
    v_mfma_f32_16x16x32_bf16 v[156:159], v[148:151], v[128:131], 0
    v_mfma_f32_16x16x32_bf16 v[160:163], v[144:147], v[132:135], 0
    v_mfma_f32_16x16x32_bf16 v[164:167], v[148:151], v[132:135], 0
    v_mfma_f32_16x16x32_bf16 v[168:171], v[144:147], v[136:139], 0
    v_mfma_f32_16x16x32_bf16 v[172:175], v[148:151], v[136:139], 0
    v_mfma_f32_16x16x32_bf16 v[176:179], v[144:147], v[140:143], 0
    v_mfma_f32_16x16x32_bf16 v[180:183], v[148:151], v[140:143], 0
    s_nop 0
    v_cvt_pk_bf16_f32 v32, v152, v153
    v_lshlrev_b32 v152, 16, v32
    v_and_b32 v153, s66, v32
    v_cvt_pk_bf16_f32 v33, v154, v155
    v_lshlrev_b32 v154, 16, v33
    v_and_b32 v155, s66, v33
    v_cvt_pk_bf16_f32 v34, v156, v157
    v_lshlrev_b32 v156, 16, v34
    v_and_b32 v157, s66, v34
    v_cvt_pk_bf16_f32 v35, v158, v159
    v_lshlrev_b32 v158, 16, v35
    v_and_b32 v159, s66, v35
    v_cvt_pk_bf16_f32 v36, v160, v161
    v_lshlrev_b32 v160, 16, v36
    v_and_b32 v161, s66, v36
    v_cvt_pk_bf16_f32 v37, v162, v163
    v_lshlrev_b32 v162, 16, v37
    v_and_b32 v163, s66, v37
    v_cvt_pk_bf16_f32 v38, v164, v165
    v_lshlrev_b32 v164, 16, v38
    v_and_b32 v165, s66, v38
    v_cvt_pk_bf16_f32 v39, v166, v167
    v_lshlrev_b32 v166, 16, v39
    v_and_b32 v167, s66, v39
    v_cvt_pk_bf16_f32 v32, v168, v169
    v_lshlrev_b32 v168, 16, v32
    v_and_b32 v169, s66, v32
    v_cvt_pk_bf16_f32 v33, v170, v171
    v_lshlrev_b32 v170, 16, v33
    v_and_b32 v171, s66, v33
    v_cvt_pk_bf16_f32 v34, v172, v173
    v_lshlrev_b32 v172, 16, v34
    v_and_b32 v173, s66, v34
    v_cvt_pk_bf16_f32 v35, v174, v175
    v_lshlrev_b32 v174, 16, v35
    v_and_b32 v175, s66, v35
    v_cvt_pk_bf16_f32 v36, v176, v177
    v_lshlrev_b32 v176, 16, v36
    v_and_b32 v177, s66, v36
    v_cvt_pk_bf16_f32 v37, v178, v179
    v_lshlrev_b32 v178, 16, v37
    v_and_b32 v179, s66, v37
    v_cvt_pk_bf16_f32 v38, v180, v181
    v_lshlrev_b32 v180, 16, v38
    v_and_b32 v181, s66, v38
    v_cvt_pk_bf16_f32 v39, v182, v183
    v_lshlrev_b32 v182, 16, v39
    v_and_b32 v183, s66, v39
    v_max3_f32 v32, v152, v153, v154
    v_min3_f32 v36, v152, v153, v154
    v_max3_f32 v32, v32, v155, v156
    v_min3_f32 v36, v36, v155, v156
    v_max3_f32 v32, v32, v157, v158
    v_min3_f32 v36, v36, v157, v158
    v_max_f32 v32, v32, v159
    v_min_f32 v36, v36, v159
    v_max3_f32 v33, v160, v161, v162
    v_min3_f32 v37, v160, v161, v162
    v_max3_f32 v33, v33, v163, v164
    v_min3_f32 v37, v37, v163, v164
    v_max3_f32 v33, v33, v165, v166
    v_min3_f32 v37, v37, v165, v166
    v_max_f32 v33, v33, v167
    v_min_f32 v37, v37, v167
    v_max3_f32 v34, v168, v169, v170
    v_min3_f32 v38, v168, v169, v170
    v_max3_f32 v34, v34, v171, v172
    v_min3_f32 v38, v38, v171, v172
    v_max3_f32 v34, v34, v173, v174
    v_min3_f32 v38, v38, v173, v174
    v_max_f32 v34, v34, v175
    v_min_f32 v38, v38, v175
    v_max3_f32 v35, v176, v177, v178
    v_min3_f32 v39, v176, v177, v178
    v_max3_f32 v35, v35, v179, v180
    v_min3_f32 v39, v39, v179, v180
    v_max3_f32 v35, v35, v181, v182
    v_min3_f32 v39, v39, v181, v182
    v_max_f32 v35, v35, v183
    v_min_f32 v39, v39, v183
    v_mov_b32 v48, v32
    s_nop 1
    v_permlane32_swap_b32 v32, v48
    v_max_f32 v32, v32, v48
    v_mov_b32 v48, v32
    s_nop 1
    v_permlane16_swap_b32 v32, v48
    v_max_f32 v32, v32, v48
    v_mov_b32 v49, v36
    s_nop 1
    v_permlane32_swap_b32 v36, v49
    v_min_f32 v36, v36, v49
    v_mov_b32 v49, v36
    s_nop 1
    v_permlane16_swap_b32 v36, v49
    v_min_f32 v36, v36, v49
    v_mov_b32 v48, v33
    s_nop 1
    v_permlane32_swap_b32 v33, v48
    v_max_f32 v33, v33, v48
    v_mov_b32 v48, v33
    s_nop 1
    v_permlane16_swap_b32 v33, v48
    v_max_f32 v33, v33, v48
    v_mov_b32 v49, v37
    s_nop 1
    v_permlane32_swap_b32 v37, v49
    v_min_f32 v37, v37, v49
    v_mov_b32 v49, v37
    s_nop 1
    v_permlane16_swap_b32 v37, v49
    v_min_f32 v37, v37, v49
    v_mov_b32 v48, v34
    s_nop 1
    v_permlane32_swap_b32 v34, v48
    v_max_f32 v34, v34, v48
    v_mov_b32 v48, v34
    s_nop 1
    v_permlane16_swap_b32 v34, v48
    v_max_f32 v34, v34, v48
    v_mov_b32 v49, v38
    s_nop 1
    v_permlane32_swap_b32 v38, v49
    v_min_f32 v38, v38, v49
    v_mov_b32 v49, v38
    s_nop 1
    v_permlane16_swap_b32 v38, v49
    v_min_f32 v38, v38, v49
    v_mov_b32 v48, v35
    s_nop 1
    v_permlane32_swap_b32 v35, v48
    v_max_f32 v35, v35, v48
    v_mov_b32 v48, v35
    s_nop 1
    v_permlane16_swap_b32 v35, v48
    v_max_f32 v35, v35, v48
    v_mov_b32 v49, v39
    s_nop 1
    v_permlane32_swap_b32 v39, v49
    v_min_f32 v39, v39, v49
    v_mov_b32 v49, v39
    s_nop 1
    v_permlane16_swap_b32 v39, v49
    v_min_f32 v39, v39, v49
    v_mul_f32 v32, s76, v32
    v_mul_f32 v36, s76, v36
    v_mul_f32 v33, s76, v33
    v_mul_f32 v37, s76, v37
    v_mul_f32 v34, s76, v34
    v_mul_f32 v38, s76, v38
    v_mul_f32 v35, s76, v35
    v_mul_f32 v39, s76, v39
    v_fma_f32 v184, v152, s76, -v32
    v_fma_f32 v192, -v152, s76, v36
    v_fma_f32 v185, v153, s76, -v32
    v_fma_f32 v193, -v153, s76, v36
    v_fma_f32 v186, v154, s76, -v32
    v_fma_f32 v194, -v154, s76, v36
    v_fma_f32 v187, v155, s76, -v32
    v_fma_f32 v195, -v155, s76, v36
    v_fma_f32 v188, v156, s76, -v32
    v_fma_f32 v196, -v156, s76, v36
    v_fma_f32 v189, v157, s76, -v32
    v_fma_f32 v197, -v157, s76, v36
    v_fma_f32 v190, v158, s76, -v32
    v_fma_f32 v198, -v158, s76, v36
    v_fma_f32 v191, v159, s76, -v32
    v_fma_f32 v199, -v159, s76, v36
    v_fma_f32 v200, v160, s76, -v33
    v_fma_f32 v208, -v160, s76, v37
    v_fma_f32 v201, v161, s76, -v33
    v_fma_f32 v209, -v161, s76, v37
    v_fma_f32 v202, v162, s76, -v33
    v_fma_f32 v210, -v162, s76, v37
    v_fma_f32 v203, v163, s76, -v33
    v_fma_f32 v211, -v163, s76, v37
    v_fma_f32 v204, v164, s76, -v33
    v_fma_f32 v212, -v164, s76, v37
    v_fma_f32 v205, v165, s76, -v33
    v_fma_f32 v213, -v165, s76, v37
    v_fma_f32 v206, v166, s76, -v33
    v_fma_f32 v214, -v166, s76, v37
    v_fma_f32 v207, v167, s76, -v33
    v_fma_f32 v215, -v167, s76, v37
    v_fma_f32 v216, v168, s76, -v34
    v_fma_f32 v224, -v168, s76, v38
    v_fma_f32 v217, v169, s76, -v34
    v_fma_f32 v225, -v169, s76, v38
    v_fma_f32 v218, v170, s76, -v34
    v_fma_f32 v226, -v170, s76, v38
    v_fma_f32 v219, v171, s76, -v34
    v_fma_f32 v227, -v171, s76, v38
    v_fma_f32 v220, v172, s76, -v34
    v_fma_f32 v228, -v172, s76, v38
    v_fma_f32 v221, v173, s76, -v34
    v_fma_f32 v229, -v173, s76, v38
    v_fma_f32 v222, v174, s76, -v34
    v_fma_f32 v230, -v174, s76, v38
    v_fma_f32 v223, v175, s76, -v34
    v_fma_f32 v231, -v175, s76, v38
    v_fma_f32 v232, v176, s76, -v35
    v_fma_f32 v240, -v176, s76, v39
    v_fma_f32 v233, v177, s76, -v35
    v_fma_f32 v241, -v177, s76, v39
    v_fma_f32 v234, v178, s76, -v35
    v_fma_f32 v242, -v178, s76, v39
    v_fma_f32 v235, v179, s76, -v35
    v_fma_f32 v243, -v179, s76, v39
    v_fma_f32 v236, v180, s76, -v35
    v_fma_f32 v244, -v180, s76, v39
    v_fma_f32 v237, v181, s76, -v35
    v_fma_f32 v245, -v181, s76, v39
    v_fma_f32 v238, v182, s76, -v35
    v_fma_f32 v246, -v182, s76, v39
    v_fma_f32 v239, v183, s76, -v35
    v_fma_f32 v247, -v183, s76, v39
    v_exp_f32 v184, v184
    v_exp_f32 v185, v185
    v_exp_f32 v186, v186
    v_exp_f32 v187, v187
    v_exp_f32 v188, v188
    v_exp_f32 v189, v189
    v_exp_f32 v190, v190
    v_exp_f32 v191, v191
    v_exp_f32 v192, v192
    v_exp_f32 v193, v193
    v_exp_f32 v194, v194
    v_exp_f32 v195, v195
    v_exp_f32 v196, v196
    v_exp_f32 v197, v197
    v_exp_f32 v198, v198
    v_exp_f32 v199, v199
    v_exp_f32 v200, v200
    v_exp_f32 v201, v201
    v_exp_f32 v202, v202
    v_exp_f32 v203, v203
    v_exp_f32 v204, v204
    v_exp_f32 v205, v205
    v_exp_f32 v206, v206
    v_exp_f32 v207, v207
    v_exp_f32 v208, v208
    v_exp_f32 v209, v209
    v_exp_f32 v210, v210
    v_exp_f32 v211, v211
    v_exp_f32 v212, v212
    v_exp_f32 v213, v213
    v_exp_f32 v214, v214
    v_exp_f32 v215, v215
    v_exp_f32 v216, v216
    v_exp_f32 v217, v217
    v_exp_f32 v218, v218
    v_exp_f32 v219, v219
    v_exp_f32 v220, v220
    v_exp_f32 v221, v221
    v_exp_f32 v222, v222
    v_exp_f32 v223, v223
    v_exp_f32 v224, v224
    v_exp_f32 v225, v225
    v_exp_f32 v226, v226
    v_exp_f32 v227, v227
    v_exp_f32 v228, v228
    v_exp_f32 v229, v229
    v_exp_f32 v230, v230
    v_exp_f32 v231, v231
    v_exp_f32 v232, v232
    v_exp_f32 v233, v233
    v_exp_f32 v234, v234
    v_exp_f32 v235, v235
    v_exp_f32 v236, v236
    v_exp_f32 v237, v237
    v_exp_f32 v238, v238
    v_exp_f32 v239, v239
    v_exp_f32 v240, v240
    v_exp_f32 v241, v241
    v_exp_f32 v242, v242
    v_exp_f32 v243, v243
    v_exp_f32 v244, v244
    v_exp_f32 v245, v245
    v_exp_f32 v246, v246
    v_exp_f32 v247, v247
    v_add_f32 v40, v184, v185
    v_add_f32 v40, v40, v186
    v_add_f32 v40, v40, v187
    v_add_f32 v40, v40, v188
    v_add_f32 v40, v40, v189
    v_add_f32 v40, v40, v190
    v_add_f32 v40, v40, v191
    v_add_f32 v44, v192, v193
    v_add_f32 v44, v44, v194
    v_add_f32 v44, v44, v195
    v_add_f32 v44, v44, v196
    v_add_f32 v44, v44, v197
    v_add_f32 v44, v44, v198
    v_add_f32 v44, v44, v199
    v_add_f32 v41, v200, v201
    v_add_f32 v41, v41, v202
    v_add_f32 v41, v41, v203
    v_add_f32 v41, v41, v204
    v_add_f32 v41, v41, v205
    v_add_f32 v41, v41, v206
    v_add_f32 v41, v41, v207
    v_add_f32 v45, v208, v209
    v_add_f32 v45, v45, v210
    v_add_f32 v45, v45, v211
    v_add_f32 v45, v45, v212
    v_add_f32 v45, v45, v213
    v_add_f32 v45, v45, v214
    v_add_f32 v45, v45, v215
    v_add_f32 v42, v216, v217
    v_add_f32 v42, v42, v218
    v_add_f32 v42, v42, v219
    v_add_f32 v42, v42, v220
    v_add_f32 v42, v42, v221
    v_add_f32 v42, v42, v222
    v_add_f32 v42, v42, v223
    v_add_f32 v46, v224, v225
    v_add_f32 v46, v46, v226
    v_add_f32 v46, v46, v227
    v_add_f32 v46, v46, v228
    v_add_f32 v46, v46, v229
    v_add_f32 v46, v46, v230
    v_add_f32 v46, v46, v231
    v_add_f32 v43, v232, v233
    v_add_f32 v43, v43, v234
    v_add_f32 v43, v43, v235
    v_add_f32 v43, v43, v236
    v_add_f32 v43, v43, v237
    v_add_f32 v43, v43, v238
    v_add_f32 v43, v43, v239
    v_add_f32 v47, v240, v241
    v_add_f32 v47, v47, v242
    v_add_f32 v47, v47, v243
    v_add_f32 v47, v47, v244
    v_add_f32 v47, v47, v245
    v_add_f32 v47, v47, v246
    v_add_f32 v47, v47, v247
    v_mov_b32 v48, v40
    s_nop 1
    v_permlane32_swap_b32 v40, v48
    v_add_f32 v40, v40, v48
    v_mov_b32 v48, v40
    s_nop 1
    v_permlane16_swap_b32 v40, v48
    v_add_f32 v40, v40, v48
    v_mov_b32 v49, v44
    s_nop 1
    v_permlane32_swap_b32 v44, v49
    v_add_f32 v44, v44, v49
    v_mov_b32 v49, v44
    s_nop 1
    v_permlane16_swap_b32 v44, v49
    v_add_f32 v44, v44, v49
    v_mov_b32 v48, v41
    s_nop 1
    v_permlane32_swap_b32 v41, v48
    v_add_f32 v41, v41, v48
    v_mov_b32 v48, v41
    s_nop 1
    v_permlane16_swap_b32 v41, v48
    v_add_f32 v41, v41, v48
    v_mov_b32 v49, v45
    s_nop 1
    v_permlane32_swap_b32 v45, v49
    v_add_f32 v45, v45, v49
    v_mov_b32 v49, v45
    s_nop 1
    v_permlane16_swap_b32 v45, v49
    v_add_f32 v45, v45, v49
    v_mov_b32 v48, v42
    s_nop 1
    v_permlane32_swap_b32 v42, v48
    v_add_f32 v42, v42, v48
    v_mov_b32 v48, v42
    s_nop 1
    v_permlane16_swap_b32 v42, v48
    v_add_f32 v42, v42, v48
    v_mov_b32 v49, v46
    s_nop 1
    v_permlane32_swap_b32 v46, v49
    v_add_f32 v46, v46, v49
    v_mov_b32 v49, v46
    s_nop 1
    v_permlane16_swap_b32 v46, v49
    v_add_f32 v46, v46, v49
    v_mov_b32 v48, v43
    s_nop 1
    v_permlane32_swap_b32 v43, v48
    v_add_f32 v43, v43, v48
    v_mov_b32 v48, v43
    s_nop 1
    v_permlane16_swap_b32 v43, v48
    v_add_f32 v43, v43, v48
    v_mov_b32 v49, v47
    s_nop 1
    v_permlane32_swap_b32 v47, v49
    v_add_f32 v47, v47, v49
    v_mov_b32 v49, v47
    s_nop 1
    v_permlane16_swap_b32 v47, v49
    v_add_f32 v47, v47, v49
    v_rcp_f32 v40, v40
    v_rcp_f32 v44, v44
    v_rcp_f32 v41, v41
    v_rcp_f32 v45, v45
    v_rcp_f32 v42, v42
    v_rcp_f32 v46, v46
    v_rcp_f32 v43, v43
    v_rcp_f32 v47, v47
    v_mul_f32 v184, v184, v40
    v_mul_f32 v192, v192, v44
    v_mul_f32 v185, v185, v40
    v_mul_f32 v193, v193, v44
    v_mul_f32 v186, v186, v40
    v_mul_f32 v194, v194, v44
    v_mul_f32 v187, v187, v40
    v_mul_f32 v195, v195, v44
    v_mul_f32 v188, v188, v40
    v_mul_f32 v196, v196, v44
    v_mul_f32 v189, v189, v40
    v_mul_f32 v197, v197, v44
    v_mul_f32 v190, v190, v40
    v_mul_f32 v198, v198, v44
    v_mul_f32 v191, v191, v40
    v_mul_f32 v199, v199, v44
    v_mul_f32 v200, v200, v41
    v_mul_f32 v208, v208, v45
    v_mul_f32 v201, v201, v41
    v_mul_f32 v209, v209, v45
    v_mul_f32 v202, v202, v41
    v_mul_f32 v210, v210, v45
    v_mul_f32 v203, v203, v41
    v_mul_f32 v211, v211, v45
    v_mul_f32 v204, v204, v41
    v_mul_f32 v212, v212, v45
    v_mul_f32 v205, v205, v41
    v_mul_f32 v213, v213, v45
    v_mul_f32 v206, v206, v41
    v_mul_f32 v214, v214, v45
    v_mul_f32 v207, v207, v41
    v_mul_f32 v215, v215, v45
    v_mul_f32 v216, v216, v42
    v_mul_f32 v224, v224, v46
    v_mul_f32 v217, v217, v42
    v_mul_f32 v225, v225, v46
    v_mul_f32 v218, v218, v42
    v_mul_f32 v226, v226, v46
    v_mul_f32 v219, v219, v42
    v_mul_f32 v227, v227, v46
    v_mul_f32 v220, v220, v42
    v_mul_f32 v228, v228, v46
    v_mul_f32 v221, v221, v42
    v_mul_f32 v229, v229, v46
    v_mul_f32 v222, v222, v42
    v_mul_f32 v230, v230, v46
    v_mul_f32 v223, v223, v42
    v_mul_f32 v231, v231, v46
    v_mul_f32 v232, v232, v43
    v_mul_f32 v240, v240, v47
    v_mul_f32 v233, v233, v43
    v_mul_f32 v241, v241, v47
    v_mul_f32 v234, v234, v43
    v_mul_f32 v242, v242, v47
    v_mul_f32 v235, v235, v43
    v_mul_f32 v243, v243, v47
    v_mul_f32 v236, v236, v43
    v_mul_f32 v244, v244, v47
    v_mul_f32 v237, v237, v43
    v_mul_f32 v245, v245, v47
    v_mul_f32 v238, v238, v43
    v_mul_f32 v246, v246, v47
    v_mul_f32 v239, v239, v43
    v_mul_f32 v247, v247, v47
    v_cvt_pk_bf16_f32 v128, v184, v185
    v_cvt_pk_bf16_f32 v129, v186, v187
    v_cvt_pk_bf16_f32 v130, v188, v189
    v_cvt_pk_bf16_f32 v131, v190, v191
    v_cvt_pk_bf16_f32 v132, v192, v193
    v_cvt_pk_bf16_f32 v133, v194, v195
    v_cvt_pk_bf16_f32 v134, v196, v197
    v_cvt_pk_bf16_f32 v135, v198, v199
    v_cvt_pk_bf16_f32 v136, v200, v201
    v_cvt_pk_bf16_f32 v137, v202, v203
    v_cvt_pk_bf16_f32 v138, v204, v205
    v_cvt_pk_bf16_f32 v139, v206, v207
    v_cvt_pk_bf16_f32 v140, v208, v209
    v_cvt_pk_bf16_f32 v141, v210, v211
    v_cvt_pk_bf16_f32 v142, v212, v213
    v_cvt_pk_bf16_f32 v143, v214, v215
    v_cvt_pk_bf16_f32 v144, v216, v217
    v_cvt_pk_bf16_f32 v145, v218, v219
    v_cvt_pk_bf16_f32 v146, v220, v221
    v_cvt_pk_bf16_f32 v147, v222, v223
    v_cvt_pk_bf16_f32 v148, v224, v225
    v_cvt_pk_bf16_f32 v149, v226, v227
    v_cvt_pk_bf16_f32 v150, v228, v229
    v_cvt_pk_bf16_f32 v151, v230, v231
    v_cvt_pk_bf16_f32 v152, v232, v233
    v_cvt_pk_bf16_f32 v153, v234, v235
    v_cvt_pk_bf16_f32 v154, v236, v237
    v_cvt_pk_bf16_f32 v155, v238, v239
    v_cvt_pk_bf16_f32 v156, v240, v241
    v_cvt_pk_bf16_f32 v157, v242, v243
    v_cvt_pk_bf16_f32 v158, v244, v245
    v_cvt_pk_bf16_f32 v159, v246, v247
    s_waitcnt vmcnt(0)
    v_add_f32 v64, v64, v72
    v_add_f32 v65, v65, v73
    v_add_f32 v66, v66, v74
    v_add_f32 v67, v67, v75
    v_add_f32 v68, v68, v76
    v_add_f32 v69, v69, v77
    v_add_f32 v70, v70, v78
    v_add_f32 v71, v71, v79
    v_add_f32 v64, v64, v80
    v_add_f32 v65, v65, v81
    v_add_f32 v66, v66, v82
    v_add_f32 v67, v67, v83
    v_add_f32 v68, v68, v84
    v_add_f32 v69, v69, v85
    v_add_f32 v70, v70, v86
    v_add_f32 v71, v71, v87
    v_add_f32 v64, v64, v88
    v_add_f32 v65, v65, v89
    v_add_f32 v66, v66, v90
    v_add_f32 v67, v67, v91
    v_add_f32 v68, v68, v92
    v_add_f32 v69, v69, v93
    v_add_f32 v70, v70, v94
    v_add_f32 v71, v71, v95
    v_add_f32 v64, v64, v96
    v_add_f32 v65, v65, v97
    v_add_f32 v66, v66, v98
    v_add_f32 v67, v67, v99
    v_add_f32 v68, v68, v100
    v_add_f32 v69, v69, v101
    v_add_f32 v70, v70, v102
    v_add_f32 v71, v71, v103
    v_add_f32 v64, v64, v104
    v_add_f32 v65, v65, v105
    v_add_f32 v66, v66, v106
    v_add_f32 v67, v67, v107
    v_add_f32 v68, v68, v108
    v_add_f32 v69, v69, v109
    v_add_f32 v70, v70, v110
    v_add_f32 v71, v71, v111
    v_add_f32 v64, v64, v112
    v_add_f32 v65, v65, v113
    v_add_f32 v66, v66, v114
    v_add_f32 v67, v67, v115
    v_add_f32 v68, v68, v116
    v_add_f32 v69, v69, v117
    v_add_f32 v70, v70, v118
    v_add_f32 v71, v71, v119
    v_add_f32 v64, v64, v120
    v_add_f32 v65, v65, v121
    v_add_f32 v66, v66, v122
    v_add_f32 v67, v67, v123
    v_add_f32 v68, v68, v124
    v_add_f32 v69, v69, v125
    v_add_f32 v70, v70, v126
    v_add_f32 v71, v71, v127
    v_cvt_pk_bf16_f32 v72, v64, v65
    v_cvt_pk_bf16_f32 v73, v66, v67
    v_cvt_pk_bf16_f32 v74, v68, v69
    v_cvt_pk_bf16_f32 v75, v70, v71
    s_mov_b64 exec, s[94:95]
    ds_write_b128 v30, v[72:75]
    s_mov_b64 exec, -1
    s_waitcnt lgkmcnt(0)
    s_barrier
    ds_read_b128 v[80:83], v29 offset:0
    ds_read_b128 v[84:87], v29 offset:1024
    ds_read_b128 v[88:91], v29 offset:2048
    ds_read_b128 v[92:95], v29 offset:3072
    ds_read_b128 v[96:99], v26 offset:4096
    ds_read_b128 v[100:103], v26 offset:5120
    s_waitcnt lgkmcnt(0)
    v_mfma_f32_16x16x32_bf16 v[160:163], v[80:83], v[128:131], 0
    v_mfma_f32_16x16x32_bf16 v[164:167], v[84:87], v[128:131], 0
    v_mfma_f32_16x16x32_bf16 v[192:195], v[96:99], v[128:131], 0
    v_mfma_f32_16x16x32_bf16 v[168:171], v[80:83], v[136:139], 0
    v_mfma_f32_16x16x32_bf16 v[172:175], v[84:87], v[136:139], 0
    v_mfma_f32_16x16x32_bf16 v[196:199], v[96:99], v[136:139], 0
    v_mfma_f32_16x16x32_bf16 v[176:179], v[80:83], v[144:147], 0
    v_mfma_f32_16x16x32_bf16 v[180:183], v[84:87], v[144:147], 0
    v_mfma_f32_16x16x32_bf16 v[200:203], v[96:99], v[144:147], 0
    v_mfma_f32_16x16x32_bf16 v[184:187], v[80:83], v[152:155], 0
    v_mfma_f32_16x16x32_bf16 v[188:191], v[84:87], v[152:155], 0
    v_mfma_f32_16x16x32_bf16 v[204:207], v[96:99], v[152:155], 0
    v_mfma_f32_16x16x32_bf16 v[160:163], v[88:91], v[132:135], v[160:163]
    v_mfma_f32_16x16x32_bf16 v[164:167], v[92:95], v[132:135], v[164:167]
    v_mfma_f32_16x16x32_bf16 v[192:195], v[100:103], v[132:135], v[192:195]
    v_mfma_f32_16x16x32_bf16 v[168:171], v[88:91], v[140:143], v[168:171]
    v_mfma_f32_16x16x32_bf16 v[172:175], v[92:95], v[140:143], v[172:175]
    v_mfma_f32_16x16x32_bf16 v[196:199], v[100:103], v[140:143], v[196:199]
    v_mfma_f32_16x16x32_bf16 v[176:179], v[88:91], v[148:151], v[176:179]
    v_mfma_f32_16x16x32_bf16 v[180:183], v[92:95], v[148:151], v[180:183]
    v_mfma_f32_16x16x32_bf16 v[200:203], v[100:103], v[148:151], v[200:203]
    v_mfma_f32_16x16x32_bf16 v[184:187], v[88:91], v[156:159], v[184:187]
    v_mfma_f32_16x16x32_bf16 v[188:191], v[92:95], v[156:159], v[188:191]
    v_mfma_f32_16x16x32_bf16 v[204:207], v[100:103], v[156:159], v[204:207]
    s_mov_b32 s73, 65536
    v_cvt_pk_bf16_f32 v192, v192, v192
    v_lshlrev_b32 v192, 16, v192
    v_add_f32 v192, 0x358637bd, v192
    v_cvt_pk_bf16_f32 v192, v192, v192
    v_lshlrev_b32 v192, 16, v192
    v_rcp_f32 v193, v192
    v_cvt_pk_bf16_f32 v196, v196, v196
    v_lshlrev_b32 v196, 16, v196
    v_add_f32 v196, 0x358637bd, v196
    v_cvt_pk_bf16_f32 v196, v196, v196
    v_lshlrev_b32 v196, 16, v196
    v_rcp_f32 v197, v196
    v_cvt_pk_bf16_f32 v200, v200, v200
    v_lshlrev_b32 v200, 16, v200
    v_add_f32 v200, 0x358637bd, v200
    v_cvt_pk_bf16_f32 v200, v200, v200
    v_lshlrev_b32 v200, 16, v200
    v_rcp_f32 v201, v200
    v_cvt_pk_bf16_f32 v204, v204, v204
    v_lshlrev_b32 v204, 16, v204
    v_add_f32 v204, 0x358637bd, v204
    v_cvt_pk_bf16_f32 v204, v204, v204
    v_lshlrev_b32 v204, 16, v204
    v_rcp_f32 v205, v204
    v_cvt_pk_bf16_f32 v32, v160, v161
    v_lshlrev_b32 v160, 16, v32
    v_and_b32 v161, s66, v32
    v_cvt_pk_bf16_f32 v33, v162, v163
    v_lshlrev_b32 v162, 16, v33
    v_and_b32 v163, s66, v33
    v_mul_f32 v36, v160, v193
    v_mul_f32 v37, v161, v193
    v_mul_f32 v38, v162, v193
    v_mul_f32 v39, v163, v193
    v_fma_f32 v160, -v36, v192, v160
    v_fma_f32 v161, -v37, v192, v161
    v_fma_f32 v162, -v38, v192, v162
    v_fma_f32 v163, -v39, v192, v163
    v_fmac_f32 v36, v160, v193
    v_fmac_f32 v37, v161, v193
    v_fmac_f32 v38, v162, v193
    v_fmac_f32 v39, v163, v193
    v_cvt_pk_bf16_f32 v208, v36, v37
    v_cvt_pk_bf16_f32 v209, v38, v39
    v_cvt_pk_bf16_f32 v40, v164, v165
    v_lshlrev_b32 v164, 16, v40
    v_and_b32 v165, s66, v40
    v_cvt_pk_bf16_f32 v41, v166, v167
    v_lshlrev_b32 v166, 16, v41
    v_and_b32 v167, s66, v41
    v_mul_f32 v44, v164, v193
    v_mul_f32 v45, v165, v193
    v_mul_f32 v46, v166, v193
    v_mul_f32 v47, v167, v193
    v_fma_f32 v164, -v44, v192, v164
    v_fma_f32 v165, -v45, v192, v165
    v_fma_f32 v166, -v46, v192, v166
    v_fma_f32 v167, -v47, v192, v167
    v_fmac_f32 v44, v164, v193
    v_fmac_f32 v45, v165, v193
    v_fmac_f32 v46, v166, v193
    v_fmac_f32 v47, v167, v193
    v_cvt_pk_bf16_f32 v212, v44, v45
    v_cvt_pk_bf16_f32 v213, v46, v47
    v_cvt_pk_bf16_f32 v32, v168, v169
    v_lshlrev_b32 v168, 16, v32
    v_and_b32 v169, s66, v32
    v_cvt_pk_bf16_f32 v33, v170, v171
    v_lshlrev_b32 v170, 16, v33
    v_and_b32 v171, s66, v33
    v_mul_f32 v36, v168, v197
    v_mul_f32 v37, v169, v197
    v_mul_f32 v38, v170, v197
    v_mul_f32 v39, v171, v197
    v_fma_f32 v168, -v36, v196, v168
    v_fma_f32 v169, -v37, v196, v169
    v_fma_f32 v170, -v38, v196, v170
    v_fma_f32 v171, -v39, v196, v171
    v_fmac_f32 v36, v168, v197
    v_fmac_f32 v37, v169, v197
    v_fmac_f32 v38, v170, v197
    v_fmac_f32 v39, v171, v197
    v_cvt_pk_bf16_f32 v210, v36, v37
    v_cvt_pk_bf16_f32 v211, v38, v39
    v_cvt_pk_bf16_f32 v40, v172, v173
    v_lshlrev_b32 v172, 16, v40
    v_and_b32 v173, s66, v40
    v_cvt_pk_bf16_f32 v41, v174, v175
    v_lshlrev_b32 v174, 16, v41
    v_and_b32 v175, s66, v41
    v_mul_f32 v44, v172, v197
    v_mul_f32 v45, v173, v197
    v_mul_f32 v46, v174, v197
    v_mul_f32 v47, v175, v197
    v_fma_f32 v172, -v44, v196, v172
    v_fma_f32 v173, -v45, v196, v173
    v_fma_f32 v174, -v46, v196, v174
    v_fma_f32 v175, -v47, v196, v175
    v_fmac_f32 v44, v172, v197
    v_fmac_f32 v45, v173, v197
    v_fmac_f32 v46, v174, v197
    v_fmac_f32 v47, v175, v197
    v_cvt_pk_bf16_f32 v214, v44, v45
    v_cvt_pk_bf16_f32 v215, v46, v47
    v_cvt_pk_bf16_f32 v32, v176, v177
    v_lshlrev_b32 v176, 16, v32
    v_and_b32 v177, s66, v32
    v_cvt_pk_bf16_f32 v33, v178, v179
    v_lshlrev_b32 v178, 16, v33
    v_and_b32 v179, s66, v33
    v_mul_f32 v36, v176, v201
    v_mul_f32 v37, v177, v201
    v_mul_f32 v38, v178, v201
    v_mul_f32 v39, v179, v201
    v_fma_f32 v176, -v36, v200, v176
    v_fma_f32 v177, -v37, v200, v177
    v_fma_f32 v178, -v38, v200, v178
    v_fma_f32 v179, -v39, v200, v179
    v_fmac_f32 v36, v176, v201
    v_fmac_f32 v37, v177, v201
    v_fmac_f32 v38, v178, v201
    v_fmac_f32 v39, v179, v201
    v_cvt_pk_bf16_f32 v216, v36, v37
    v_cvt_pk_bf16_f32 v217, v38, v39
    v_cvt_pk_bf16_f32 v40, v180, v181
    v_lshlrev_b32 v180, 16, v40
    v_and_b32 v181, s66, v40
    v_cvt_pk_bf16_f32 v41, v182, v183
    v_lshlrev_b32 v182, 16, v41
    v_and_b32 v183, s66, v41
    v_mul_f32 v44, v180, v201
    v_mul_f32 v45, v181, v201
    v_mul_f32 v46, v182, v201
    v_mul_f32 v47, v183, v201
    v_fma_f32 v180, -v44, v200, v180
    v_fma_f32 v181, -v45, v200, v181
    v_fma_f32 v182, -v46, v200, v182
    v_fma_f32 v183, -v47, v200, v183
    v_fmac_f32 v44, v180, v201
    v_fmac_f32 v45, v181, v201
    v_fmac_f32 v46, v182, v201
    v_fmac_f32 v47, v183, v201
    v_cvt_pk_bf16_f32 v220, v44, v45
    v_cvt_pk_bf16_f32 v221, v46, v47
    v_cvt_pk_bf16_f32 v32, v184, v185
    v_lshlrev_b32 v184, 16, v32
    v_and_b32 v185, s66, v32
    v_cvt_pk_bf16_f32 v33, v186, v187
    v_lshlrev_b32 v186, 16, v33
    v_and_b32 v187, s66, v33
    v_mul_f32 v36, v184, v205
    v_mul_f32 v37, v185, v205
    v_mul_f32 v38, v186, v205
    v_mul_f32 v39, v187, v205
    v_fma_f32 v184, -v36, v204, v184
    v_fma_f32 v185, -v37, v204, v185
    v_fma_f32 v186, -v38, v204, v186
    v_fma_f32 v187, -v39, v204, v187
    v_fmac_f32 v36, v184, v205
    v_fmac_f32 v37, v185, v205
    v_fmac_f32 v38, v186, v205
    v_fmac_f32 v39, v187, v205
    v_cvt_pk_bf16_f32 v218, v36, v37
    v_cvt_pk_bf16_f32 v219, v38, v39
    v_cvt_pk_bf16_f32 v40, v188, v189
    v_lshlrev_b32 v188, 16, v40
    v_and_b32 v189, s66, v40
    v_cvt_pk_bf16_f32 v41, v190, v191
    v_lshlrev_b32 v190, 16, v41
    v_and_b32 v191, s66, v41
    v_mul_f32 v44, v188, v205
    v_mul_f32 v45, v189, v205
    v_mul_f32 v46, v190, v205
    v_mul_f32 v47, v191, v205
    v_fma_f32 v188, -v44, v204, v188
    v_fma_f32 v189, -v45, v204, v189
    v_fma_f32 v190, -v46, v204, v190
    v_fma_f32 v191, -v47, v204, v191
    v_fmac_f32 v44, v188, v205
    v_fmac_f32 v45, v189, v205
    v_fmac_f32 v46, v190, v205
    v_fmac_f32 v47, v191, v205
    v_cvt_pk_bf16_f32 v222, v44, v45
    v_cvt_pk_bf16_f32 v223, v46, v47
    v_permlane16_swap_b32 v208, v210
    v_permlane16_swap_b32 v209, v211
    buffer_store_dwordx4 v[208:211], v28, s[8:11], 0 offen offset:0 sc1
    v_permlane16_swap_b32 v212, v214
    v_permlane16_swap_b32 v213, v215
    buffer_store_dwordx4 v[212:215], v28, s[8:11], s73 offen offset:0 sc1
    v_permlane16_swap_b32 v216, v218
    v_permlane16_swap_b32 v217, v219
    buffer_store_dwordx4 v[216:219], v28, s[8:11], 0 offen offset:512 sc1
    v_permlane16_swap_b32 v220, v222
    v_permlane16_swap_b32 v221, v223
    buffer_store_dwordx4 v[220:223], v28, s[8:11], s73 offen offset:512 sc1
    v_mov_b32 v31, 0
g12_phlo:
    buffer_load_dword v1, v31, s[36:39], s67 offen sc1
    s_waitcnt vmcnt(0)
    v_readfirstlane_b32 s34, v1
    s_nop 1
    s_nop 3
    s_cmp_ge_u32 s34, 5
    s_cbranch_scc1 g12_phlook
    s_sleep 2
    s_branch g12_phlo
g12_phlook:
    s_add_u32 m0, s31, 0x0
    s_mov_b32 s28, 0xe40000
    buffer_load_dwordx4 v9, s[8:11], s28 offen lds
    s_add_u32 m0, s31, 0x400
    s_mov_b32 s28, 0xe40400
    buffer_load_dwordx4 v9, s[8:11], s28 offen lds
    s_add_u32 m0, s31, 0x8000
    s_mov_b32 s28, 0xe80000
    buffer_load_dwordx4 v9, s[8:11], s28 offen lds
    s_add_u32 m0, s31, 0x8400
    s_mov_b32 s28, 0xe80400
    buffer_load_dwordx4 v9, s[8:11], s28 offen lds
    s_add_u32 m0, s31, 0x10000
    s_mov_b32 s28, 0xec0000
    buffer_load_dwordx4 v9, s[8:11], s28 offen lds
    s_add_u32 m0, s31, 0x10400
    s_mov_b32 s28, 0xec0400
    buffer_load_dwordx4 v9, s[8:11], s28 offen lds
    s_add_u32 m0, s31, 0x18000
    s_mov_b32 s28, 0xf00000
    buffer_load_dwordx4 v9, s[8:11], s28 offen lds
    s_add_u32 m0, s31, 0x18400
    s_mov_b32 s28, 0xf00400
    buffer_load_dwordx4 v9, s[8:11], s28 offen lds
    s_lshl_b32 s28, s22, 2
    v_add_u32 v17, s28, v15
    v_lshlrev_b32 v17, 11, v17
    v_lshl_add_u32 v17, v16, 4, v17
    s_lshl_b32 s28, s21, 10
    v_add_u32 v2, s28, v17
    v_add_u32 v3, 0x10000, v2
    v_lshrrev_b32 v17, 2, v16
    v_lshl_add_u32 v18, v15, 3, v17
    s_lshl_b32 s28, s22, 5
    v_add_u32 v18, s28, v18
    v_lshrrev_b32 v19, 1, v17
    v_and_b32 v20, 1, v15
    v_lshl_or_b32 v19, v20, 1, v19
    v_and_b32 v21, 3, v14
    v_lshlrev_b32 v21, 3, v21
    v_lshl_add_u32 v22, v18, 7, v21
    s_lshl_b32 s28, s23, 13
    s_add_u32 s28, s28, 16384
    v_add_u32 v22, s28, v22
    v_xor_b32 v23, 0, v19
    v_lshl_add_u32 v4, v23, 5, v22
    v_add_u32 v240, 0x10000, v4
    v_xor_b32 v23, 1, v19
    v_lshl_add_u32 v5, v23, 5, v22
    v_add_u32 v241, 0x10000, v5
    v_xor_b32 v23, 2, v19
    v_lshl_add_u32 v6, v23, 5, v22
    v_add_u32 v242, 0x10000, v6
    v_xor_b32 v23, 3, v19
    v_lshl_add_u32 v7, v23, 5, v22
    v_add_u32 v243, 0x10000, v7
    s_add_u32 s88, s4, 0x2b00000
    s_addc_u32 s89, s5, 0
    s_and_b32 s89, s89, 0xffff
    s_mov_b32 s90, 0x400
    s_mov_b32 s91, 0x00020000
    s_mov_b32 s36, s58
    s_mov_b32 s37, s59
    s_and_b32 s37, s37, 0xffff
    s_mov_b32 s38, 0x800
    s_mov_b32 s39, 0x00020000
    s_mov_b32 s40, s60
    s_mov_b32 s41, s61
    s_and_b32 s41, s41, 0xffff
    s_mov_b32 s42, 0x400000
    s_mov_b32 s43, 0x00020000
    s_mov_b32 s44, s62
    s_mov_b32 s45, s63
    s_and_b32 s45, s45, 0xffff
    s_mov_b32 s46, 0x400000
    s_mov_b32 s47, 0x00020000
    s_add_u32 s48, s4, 0x2200000
    s_addc_u32 s49, s5, 0
    s_and_b32 s49, s49, 0xffff
    s_mov_b32 s50, 0x800000
    s_mov_b32 s51, 0x00020000
    s_add_u32 s52, s4, 0x2a00000
    s_addc_u32 s53, s5, 0
    s_and_b32 s53, s53, 0xffff
    s_mov_b32 s54, 0x20000
    s_mov_b32 s55, 0x00020000
    v_mov_b32 v64, 0
    v_mov_b32 v65, 0
    v_mov_b32 v66, 0
    v_mov_b32 v67, 0
    v_mov_b32 v68, 0
    v_mov_b32 v69, 0
    v_mov_b32 v70, 0
    v_mov_b32 v71, 0
    v_mov_b32 v72, 0
    v_mov_b32 v73, 0
    v_mov_b32 v74, 0
    v_mov_b32 v75, 0
    v_mov_b32 v76, 0
    v_mov_b32 v77, 0
    v_mov_b32 v78, 0
    v_mov_b32 v79, 0
    v_mov_b32 v80, 0
    v_mov_b32 v81, 0
    v_mov_b32 v82, 0
    v_mov_b32 v83, 0
    v_mov_b32 v84, 0
    v_mov_b32 v85, 0
    v_mov_b32 v86, 0
    v_mov_b32 v87, 0
    v_mov_b32 v88, 0
    v_mov_b32 v89, 0
    v_mov_b32 v90, 0
    v_mov_b32 v91, 0
    v_mov_b32 v92, 0
    v_mov_b32 v93, 0
    v_mov_b32 v94, 0
    v_mov_b32 v95, 0
    v_mov_b32 v96, 0
    v_mov_b32 v97, 0
    v_mov_b32 v98, 0
    v_mov_b32 v99, 0
    v_mov_b32 v100, 0
    v_mov_b32 v101, 0
    v_mov_b32 v102, 0
    v_mov_b32 v103, 0
    v_mov_b32 v104, 0
    v_mov_b32 v105, 0
    v_mov_b32 v106, 0
    v_mov_b32 v107, 0
    v_mov_b32 v108, 0
    v_mov_b32 v109, 0
    v_mov_b32 v110, 0
    v_mov_b32 v111, 0
    v_mov_b32 v112, 0
    v_mov_b32 v113, 0
    v_mov_b32 v114, 0
    v_mov_b32 v115, 0
    v_mov_b32 v116, 0
    v_mov_b32 v117, 0
    v_mov_b32 v118, 0
    v_mov_b32 v119, 0
    v_mov_b32 v120, 0
    v_mov_b32 v121, 0
    v_mov_b32 v122, 0
    v_mov_b32 v123, 0
    v_mov_b32 v124, 0
    v_mov_b32 v125, 0
    v_mov_b32 v126, 0
    v_mov_b32 v127, 0
    s_waitcnt vmcnt(6)
    s_barrier
    ds_read_b128 v[32:35], v2 offset:0
    ds_read_b128 v[36:39], v2 offset:256
    ds_read_b128 v[40:43], v2 offset:512
    ds_read_b128 v[44:47], v2 offset:768
    ds_read_b64_tr_b16 v[48:49], v4 offset:0
    ds_read_b64_tr_b16 v[50:51], v4 offset:512
    ds_read_b64_tr_b16 v[52:53], v5 offset:0
    ds_read_b64_tr_b16 v[54:55], v5 offset:512
    ds_read_b64_tr_b16 v[56:57], v6 offset:0
    ds_read_b64_tr_b16 v[58:59], v6 offset:512
    ds_read_b64_tr_b16 v[60:61], v7 offset:0
    ds_read_b64_tr_b16 v[62:63], v7 offset:512
    s_waitcnt lgkmcnt(0)
    s_waitcnt vmcnt(4)
    s_barrier
    s_cmp_lg_u32 s20, 0
    s_cbranch_scc1 g2_noflag
    s_lshl_b32 s28, s2, 2
    v_mov_b32 v1, 1
    v_mov_b32 v31, s28
    s_mov_b64 exec, 1
    buffer_store_dword v1, v31, s[88:91], 0 offen sc1
    s_mov_b64 exec, -1
g2_noflag:
    v_mfma_f32_16x16x32_bf16 v[64:67], v[48:51], v[32:35], v[64:67]
    s_add_u32 m0, s31, 0x0
    s_mov_b32 s28, 0xf40000
    buffer_load_dwordx4 v9, s[8:11], s28 offen lds
    v_mfma_f32_16x16x32_bf16 v[80:83], v[48:51], v[36:39], v[80:83]
    ds_read_b128 v[128:131], v2 offset:32768
    v_mfma_f32_16x16x32_bf16 v[96:99], v[48:51], v[40:43], v[96:99]
    ds_read_b128 v[132:135], v2 offset:33024
    v_mfma_f32_16x16x32_bf16 v[112:115], v[48:51], v[44:47], v[112:115]
    ds_read_b128 v[136:139], v2 offset:33280
    v_mfma_f32_16x16x32_bf16 v[68:71], v[52:55], v[32:35], v[68:71]
    s_add_u32 m0, s31, 0x400
    s_mov_b32 s28, 0xf40400
    buffer_load_dwordx4 v9, s[8:11], s28 offen lds
    v_mfma_f32_16x16x32_bf16 v[84:87], v[52:55], v[36:39], v[84:87]
    ds_read_b128 v[140:143], v2 offset:33536
    v_mfma_f32_16x16x32_bf16 v[100:103], v[52:55], v[40:43], v[100:103]
    ds_read_b64_tr_b16 v[144:145], v4 offset:32768
    v_mfma_f32_16x16x32_bf16 v[116:119], v[52:55], v[44:47], v[116:119]
    ds_read_b64_tr_b16 v[146:147], v4 offset:33280
    v_mfma_f32_16x16x32_bf16 v[72:75], v[56:59], v[32:35], v[72:75]
    s_add_u32 m0, s30, 0x4000
    s_mov_b32 s28, 0x5a0000
    buffer_load_dwordx4 v10, s[12:15], s28 offen lds
    v_mfma_f32_16x16x32_bf16 v[88:91], v[56:59], v[36:39], v[88:91]
    ds_read_b64_tr_b16 v[148:149], v5 offset:32768
    v_mfma_f32_16x16x32_bf16 v[104:107], v[56:59], v[40:43], v[104:107]
    ds_read_b64_tr_b16 v[150:151], v5 offset:33280
    v_mfma_f32_16x16x32_bf16 v[120:123], v[56:59], v[44:47], v[120:123]
    ds_read_b64_tr_b16 v[152:153], v6 offset:32768
    v_mfma_f32_16x16x32_bf16 v[76:79], v[60:63], v[32:35], v[76:79]
    s_add_u32 m0, s30, 0x6000
    s_mov_b32 s28, 0x5a0080
    buffer_load_dwordx4 v10, s[12:15], s28 offen lds
    v_mfma_f32_16x16x32_bf16 v[92:95], v[60:63], v[36:39], v[92:95]
    ds_read_b64_tr_b16 v[154:155], v6 offset:33280
    v_mfma_f32_16x16x32_bf16 v[108:111], v[60:63], v[40:43], v[108:111]
    ds_read_b64_tr_b16 v[156:157], v7 offset:32768
    v_mfma_f32_16x16x32_bf16 v[124:127], v[60:63], v[44:47], v[124:127]
    ds_read_b64_tr_b16 v[158:159], v7 offset:33280
    s_waitcnt lgkmcnt(0)
    s_waitcnt vmcnt(6)
    s_barrier
    v_mfma_f32_16x16x32_bf16 v[64:67], v[144:147], v[128:131], v[64:67]
    s_add_u32 m0, s31, 0x8000
    s_mov_b32 s28, 0xf80000
    buffer_load_dwordx4 v9, s[8:11], s28 offen lds
    v_mfma_f32_16x16x32_bf16 v[80:83], v[144:147], v[132:135], v[80:83]
    ds_read_b128 v[32:35], v3 offset:0
    v_mfma_f32_16x16x32_bf16 v[96:99], v[144:147], v[136:139], v[96:99]
    ds_read_b128 v[36:39], v3 offset:256
    v_mfma_f32_16x16x32_bf16 v[112:115], v[144:147], v[140:143], v[112:115]
    ds_read_b128 v[40:43], v3 offset:512
    v_mfma_f32_16x16x32_bf16 v[68:71], v[148:151], v[128:131], v[68:71]
    s_add_u32 m0, s31, 0x8400
    s_mov_b32 s28, 0xf80400
    buffer_load_dwordx4 v9, s[8:11], s28 offen lds
    v_mfma_f32_16x16x32_bf16 v[84:87], v[148:151], v[132:135], v[84:87]
    ds_read_b128 v[44:47], v3 offset:768
    v_mfma_f32_16x16x32_bf16 v[100:103], v[148:151], v[136:139], v[100:103]
    ds_read_b64_tr_b16 v[48:49], v240 offset:0
    v_mfma_f32_16x16x32_bf16 v[116:119], v[148:151], v[140:143], v[116:119]
    ds_read_b64_tr_b16 v[50:51], v240 offset:512
    v_mfma_f32_16x16x32_bf16 v[72:75], v[152:155], v[128:131], v[72:75]
    s_add_u32 m0, s30, 0xc000
    s_mov_b32 s28, 0x5c0000
    buffer_load_dwordx4 v10, s[12:15], s28 offen lds
    v_mfma_f32_16x16x32_bf16 v[88:91], v[152:155], v[132:135], v[88:91]
    ds_read_b64_tr_b16 v[52:53], v241 offset:0
    v_mfma_f32_16x16x32_bf16 v[104:107], v[152:155], v[136:139], v[104:107]
    ds_read_b64_tr_b16 v[54:55], v241 offset:512
    v_mfma_f32_16x16x32_bf16 v[120:123], v[152:155], v[140:143], v[120:123]
    ds_read_b64_tr_b16 v[56:57], v242 offset:0
    v_mfma_f32_16x16x32_bf16 v[76:79], v[156:159], v[128:131], v[76:79]
    s_add_u32 m0, s30, 0xe000
    s_mov_b32 s28, 0x5c0080
    buffer_load_dwordx4 v10, s[12:15], s28 offen lds
    v_mfma_f32_16x16x32_bf16 v[92:95], v[156:159], v[132:135], v[92:95]
    ds_read_b64_tr_b16 v[58:59], v242 offset:512
    v_mfma_f32_16x16x32_bf16 v[108:111], v[156:159], v[136:139], v[108:111]
    ds_read_b64_tr_b16 v[60:61], v243 offset:0
    v_mfma_f32_16x16x32_bf16 v[124:127], v[156:159], v[140:143], v[124:127]
    ds_read_b64_tr_b16 v[62:63], v243 offset:512
    s_waitcnt lgkmcnt(0)
    s_waitcnt vmcnt(8)
    s_barrier
    v_mfma_f32_16x16x32_bf16 v[64:67], v[48:51], v[32:35], v[64:67]
    s_add_u32 m0, s31, 0x10000
    s_mov_b32 s28, 0xfc0000
    buffer_load_dwordx4 v9, s[8:11], s28 offen lds
    v_mfma_f32_16x16x32_bf16 v[80:83], v[48:51], v[36:39], v[80:83]
    ds_read_b128 v[128:131], v3 offset:32768
    v_mfma_f32_16x16x32_bf16 v[96:99], v[48:51], v[40:43], v[96:99]
    ds_read_b128 v[132:135], v3 offset:33024
    v_mfma_f32_16x16x32_bf16 v[112:115], v[48:51], v[44:47], v[112:115]
    ds_read_b128 v[136:139], v3 offset:33280
    v_mfma_f32_16x16x32_bf16 v[68:71], v[52:55], v[32:35], v[68:71]
    s_add_u32 m0, s31, 0x10400
    s_mov_b32 s28, 0xfc0400
    buffer_load_dwordx4 v9, s[8:11], s28 offen lds
    v_mfma_f32_16x16x32_bf16 v[84:87], v[52:55], v[36:39], v[84:87]
    ds_read_b128 v[140:143], v3 offset:33536
    v_mfma_f32_16x16x32_bf16 v[100:103], v[52:55], v[40:43], v[100:103]
    ds_read_b64_tr_b16 v[144:145], v240 offset:32768
    v_mfma_f32_16x16x32_bf16 v[116:119], v[52:55], v[44:47], v[116:119]
    ds_read_b64_tr_b16 v[146:147], v240 offset:33280
    v_mfma_f32_16x16x32_bf16 v[72:75], v[56:59], v[32:35], v[72:75]
    s_add_u32 m0, s30, 0x14000
    s_mov_b32 s28, 0x5e0000
    buffer_load_dwordx4 v10, s[12:15], s28 offen lds
    v_mfma_f32_16x16x32_bf16 v[88:91], v[56:59], v[36:39], v[88:91]
    ds_read_b64_tr_b16 v[148:149], v241 offset:32768
    v_mfma_f32_16x16x32_bf16 v[104:107], v[56:59], v[40:43], v[104:107]
    ds_read_b64_tr_b16 v[150:151], v241 offset:33280
    v_mfma_f32_16x16x32_bf16 v[120:123], v[56:59], v[44:47], v[120:123]
    ds_read_b64_tr_b16 v[152:153], v242 offset:32768
    v_mfma_f32_16x16x32_bf16 v[76:79], v[60:63], v[32:35], v[76:79]
    s_add_u32 m0, s30, 0x16000
    s_mov_b32 s28, 0x5e0080
    buffer_load_dwordx4 v10, s[12:15], s28 offen lds
    v_mfma_f32_16x16x32_bf16 v[92:95], v[60:63], v[36:39], v[92:95]
    ds_read_b64_tr_b16 v[154:155], v242 offset:33280
    v_mfma_f32_16x16x32_bf16 v[108:111], v[60:63], v[40:43], v[108:111]
    ds_read_b64_tr_b16 v[156:157], v243 offset:32768
    v_mfma_f32_16x16x32_bf16 v[124:127], v[60:63], v[44:47], v[124:127]
    ds_read_b64_tr_b16 v[158:159], v243 offset:33280
    s_waitcnt lgkmcnt(0)
    s_waitcnt vmcnt(8)
    s_barrier
    v_mfma_f32_16x16x32_bf16 v[64:67], v[144:147], v[128:131], v[64:67]
    s_add_u32 m0, s31, 0x18000
    s_mov_b32 s28, 0x1000000
    buffer_load_dwordx4 v9, s[8:11], s28 offen lds
    v_mfma_f32_16x16x32_bf16 v[80:83], v[144:147], v[132:135], v[80:83]
    ds_read_b128 v[32:35], v2 offset:0
    v_mfma_f32_16x16x32_bf16 v[96:99], v[144:147], v[136:139], v[96:99]
    ds_read_b128 v[36:39], v2 offset:256
    v_mfma_f32_16x16x32_bf16 v[112:115], v[144:147], v[140:143], v[112:115]
    ds_read_b128 v[40:43], v2 offset:512
    v_mfma_f32_16x16x32_bf16 v[68:71], v[148:151], v[128:131], v[68:71]
    s_add_u32 m0, s31, 0x18400
    s_mov_b32 s28, 0x1000400
    buffer_load_dwordx4 v9, s[8:11], s28 offen lds
    v_mfma_f32_16x16x32_bf16 v[84:87], v[148:151], v[132:135], v[84:87]
    ds_read_b128 v[44:47], v2 offset:768
    v_mfma_f32_16x16x32_bf16 v[100:103], v[148:151], v[136:139], v[100:103]
    ds_read_b64_tr_b16 v[48:49], v4 offset:0
    v_mfma_f32_16x16x32_bf16 v[116:119], v[148:151], v[140:143], v[116:119]
    ds_read_b64_tr_b16 v[50:51], v4 offset:512
    v_mfma_f32_16x16x32_bf16 v[72:75], v[152:155], v[128:131], v[72:75]
    s_add_u32 m0, s30, 0x1c000
    s_mov_b32 s28, 0x600000
    buffer_load_dwordx4 v10, s[12:15], s28 offen lds
    v_mfma_f32_16x16x32_bf16 v[88:91], v[152:155], v[132:135], v[88:91]
    ds_read_b64_tr_b16 v[52:53], v5 offset:0
    v_mfma_f32_16x16x32_bf16 v[104:107], v[152:155], v[136:139], v[104:107]
    ds_read_b64_tr_b16 v[54:55], v5 offset:512
    v_mfma_f32_16x16x32_bf16 v[120:123], v[152:155], v[140:143], v[120:123]
    ds_read_b64_tr_b16 v[56:57], v6 offset:0
    v_mfma_f32_16x16x32_bf16 v[76:79], v[156:159], v[128:131], v[76:79]
    s_add_u32 m0, s30, 0x1e000
    s_mov_b32 s28, 0x600080
    buffer_load_dwordx4 v10, s[12:15], s28 offen lds
    v_mfma_f32_16x16x32_bf16 v[92:95], v[156:159], v[132:135], v[92:95]
    ds_read_b64_tr_b16 v[58:59], v6 offset:512
    v_mfma_f32_16x16x32_bf16 v[108:111], v[156:159], v[136:139], v[108:111]
    ds_read_b64_tr_b16 v[60:61], v7 offset:0
    v_mfma_f32_16x16x32_bf16 v[124:127], v[156:159], v[140:143], v[124:127]
    ds_read_b64_tr_b16 v[62:63], v7 offset:512
    s_waitcnt lgkmcnt(0)
    s_waitcnt vmcnt(8)
    s_barrier
    v_mfma_f32_16x16x32_bf16 v[64:67], v[48:51], v[32:35], v[64:67]
    s_add_u32 m0, s31, 0x0
    s_mov_b32 s28, 0x1040000
    buffer_load_dwordx4 v9, s[8:11], s28 offen lds
    v_mfma_f32_16x16x32_bf16 v[80:83], v[48:51], v[36:39], v[80:83]
    ds_read_b128 v[128:131], v2 offset:32768
    v_mfma_f32_16x16x32_bf16 v[96:99], v[48:51], v[40:43], v[96:99]
    ds_read_b128 v[132:135], v2 offset:33024
    v_mfma_f32_16x16x32_bf16 v[112:115], v[48:51], v[44:47], v[112:115]
    ds_read_b128 v[136:139], v2 offset:33280
    v_mfma_f32_16x16x32_bf16 v[68:71], v[52:55], v[32:35], v[68:71]
    s_add_u32 m0, s31, 0x400
    s_mov_b32 s28, 0x1040400
    buffer_load_dwordx4 v9, s[8:11], s28 offen lds
    v_mfma_f32_16x16x32_bf16 v[84:87], v[52:55], v[36:39], v[84:87]
    ds_read_b128 v[140:143], v2 offset:33536
    v_mfma_f32_16x16x32_bf16 v[100:103], v[52:55], v[40:43], v[100:103]
    ds_read_b64_tr_b16 v[144:145], v4 offset:32768
    v_mfma_f32_16x16x32_bf16 v[116:119], v[52:55], v[44:47], v[116:119]
    ds_read_b64_tr_b16 v[146:147], v4 offset:33280
    v_mfma_f32_16x16x32_bf16 v[72:75], v[56:59], v[32:35], v[72:75]
    s_add_u32 m0, s30, 0x4000
    s_mov_b32 s28, 0x620000
    buffer_load_dwordx4 v10, s[12:15], s28 offen lds
    v_mfma_f32_16x16x32_bf16 v[88:91], v[56:59], v[36:39], v[88:91]
    ds_read_b64_tr_b16 v[148:149], v5 offset:32768
    v_mfma_f32_16x16x32_bf16 v[104:107], v[56:59], v[40:43], v[104:107]
    ds_read_b64_tr_b16 v[150:151], v5 offset:33280
    v_mfma_f32_16x16x32_bf16 v[120:123], v[56:59], v[44:47], v[120:123]
    ds_read_b64_tr_b16 v[152:153], v6 offset:32768
    v_mfma_f32_16x16x32_bf16 v[76:79], v[60:63], v[32:35], v[76:79]
    s_add_u32 m0, s30, 0x6000
    s_mov_b32 s28, 0x620080
    buffer_load_dwordx4 v10, s[12:15], s28 offen lds
    v_mfma_f32_16x16x32_bf16 v[92:95], v[60:63], v[36:39], v[92:95]
    ds_read_b64_tr_b16 v[154:155], v6 offset:33280
    v_mfma_f32_16x16x32_bf16 v[108:111], v[60:63], v[40:43], v[108:111]
    ds_read_b64_tr_b16 v[156:157], v7 offset:32768
    v_mfma_f32_16x16x32_bf16 v[124:127], v[60:63], v[44:47], v[124:127]
    ds_read_b64_tr_b16 v[158:159], v7 offset:33280
    s_waitcnt lgkmcnt(0)
    s_waitcnt vmcnt(8)
    s_barrier
    v_mfma_f32_16x16x32_bf16 v[64:67], v[144:147], v[128:131], v[64:67]
    s_add_u32 m0, s31, 0x8000
    s_mov_b32 s28, 0x1080000
    buffer_load_dwordx4 v9, s[8:11], s28 offen lds
    v_mfma_f32_16x16x32_bf16 v[80:83], v[144:147], v[132:135], v[80:83]
    ds_read_b128 v[32:35], v3 offset:0
    v_mfma_f32_16x16x32_bf16 v[96:99], v[144:147], v[136:139], v[96:99]
    ds_read_b128 v[36:39], v3 offset:256
    v_mfma_f32_16x16x32_bf16 v[112:115], v[144:147], v[140:143], v[112:115]
    ds_read_b128 v[40:43], v3 offset:512
    v_mfma_f32_16x16x32_bf16 v[68:71], v[148:151], v[128:131], v[68:71]
    s_add_u32 m0, s31, 0x8400
    s_mov_b32 s28, 0x1080400
    buffer_load_dwordx4 v9, s[8:11], s28 offen lds
    v_mfma_f32_16x16x32_bf16 v[84:87], v[148:151], v[132:135], v[84:87]
    ds_read_b128 v[44:47], v3 offset:768
    v_mfma_f32_16x16x32_bf16 v[100:103], v[148:151], v[136:139], v[100:103]
    ds_read_b64_tr_b16 v[48:49], v240 offset:0
    v_mfma_f32_16x16x32_bf16 v[116:119], v[148:151], v[140:143], v[116:119]
    ds_read_b64_tr_b16 v[50:51], v240 offset:512
    v_mfma_f32_16x16x32_bf16 v[72:75], v[152:155], v[128:131], v[72:75]
    s_add_u32 m0, s30, 0xc000
    s_mov_b32 s28, 0x640000
    buffer_load_dwordx4 v10, s[12:15], s28 offen lds
    v_mfma_f32_16x16x32_bf16 v[88:91], v[152:155], v[132:135], v[88:91]
    ds_read_b64_tr_b16 v[52:53], v241 offset:0
    v_mfma_f32_16x16x32_bf16 v[104:107], v[152:155], v[136:139], v[104:107]
    ds_read_b64_tr_b16 v[54:55], v241 offset:512
    v_mfma_f32_16x16x32_bf16 v[120:123], v[152:155], v[140:143], v[120:123]
    ds_read_b64_tr_b16 v[56:57], v242 offset:0
    v_mfma_f32_16x16x32_bf16 v[76:79], v[156:159], v[128:131], v[76:79]
    s_add_u32 m0, s30, 0xe000
    s_mov_b32 s28, 0x640080
    buffer_load_dwordx4 v10, s[12:15], s28 offen lds
    v_mfma_f32_16x16x32_bf16 v[92:95], v[156:159], v[132:135], v[92:95]
    ds_read_b64_tr_b16 v[58:59], v242 offset:512
    v_mfma_f32_16x16x32_bf16 v[108:111], v[156:159], v[136:139], v[108:111]
    ds_read_b64_tr_b16 v[60:61], v243 offset:0
    v_mfma_f32_16x16x32_bf16 v[124:127], v[156:159], v[140:143], v[124:127]
    ds_read_b64_tr_b16 v[62:63], v243 offset:512
    s_waitcnt lgkmcnt(0)
    s_waitcnt vmcnt(8)
    s_barrier
    v_mfma_f32_16x16x32_bf16 v[64:67], v[48:51], v[32:35], v[64:67]
    s_add_u32 m0, s31, 0x10000
    s_mov_b32 s28, 0x10c0000
    buffer_load_dwordx4 v9, s[8:11], s28 offen lds
    v_mfma_f32_16x16x32_bf16 v[80:83], v[48:51], v[36:39], v[80:83]
    ds_read_b128 v[128:131], v3 offset:32768
    v_mfma_f32_16x16x32_bf16 v[96:99], v[48:51], v[40:43], v[96:99]
    ds_read_b128 v[132:135], v3 offset:33024
    v_mfma_f32_16x16x32_bf16 v[112:115], v[48:51], v[44:47], v[112:115]
    ds_read_b128 v[136:139], v3 offset:33280
    v_mfma_f32_16x16x32_bf16 v[68:71], v[52:55], v[32:35], v[68:71]
    s_add_u32 m0, s31, 0x10400
    s_mov_b32 s28, 0x10c0400
    buffer_load_dwordx4 v9, s[8:11], s28 offen lds
    v_mfma_f32_16x16x32_bf16 v[84:87], v[52:55], v[36:39], v[84:87]
    ds_read_b128 v[140:143], v3 offset:33536
    v_mfma_f32_16x16x32_bf16 v[100:103], v[52:55], v[40:43], v[100:103]
    ds_read_b64_tr_b16 v[144:145], v240 offset:32768
    v_mfma_f32_16x16x32_bf16 v[116:119], v[52:55], v[44:47], v[116:119]
    ds_read_b64_tr_b16 v[146:147], v240 offset:33280
    v_mfma_f32_16x16x32_bf16 v[72:75], v[56:59], v[32:35], v[72:75]
    s_add_u32 m0, s30, 0x14000
    s_mov_b32 s28, 0x660000
    buffer_load_dwordx4 v10, s[12:15], s28 offen lds
    v_mfma_f32_16x16x32_bf16 v[88:91], v[56:59], v[36:39], v[88:91]
    ds_read_b64_tr_b16 v[148:149], v241 offset:32768
    v_mfma_f32_16x16x32_bf16 v[104:107], v[56:59], v[40:43], v[104:107]
    ds_read_b64_tr_b16 v[150:151], v241 offset:33280
    v_mfma_f32_16x16x32_bf16 v[120:123], v[56:59], v[44:47], v[120:123]
    ds_read_b64_tr_b16 v[152:153], v242 offset:32768
    v_mfma_f32_16x16x32_bf16 v[76:79], v[60:63], v[32:35], v[76:79]
    s_add_u32 m0, s30, 0x16000
    s_mov_b32 s28, 0x660080
    buffer_load_dwordx4 v10, s[12:15], s28 offen lds
    v_mfma_f32_16x16x32_bf16 v[92:95], v[60:63], v[36:39], v[92:95]
    ds_read_b64_tr_b16 v[154:155], v242 offset:33280
    v_mfma_f32_16x16x32_bf16 v[108:111], v[60:63], v[40:43], v[108:111]
    ds_read_b64_tr_b16 v[156:157], v243 offset:32768
    v_mfma_f32_16x16x32_bf16 v[124:127], v[60:63], v[44:47], v[124:127]
    ds_read_b64_tr_b16 v[158:159], v243 offset:33280
    s_waitcnt lgkmcnt(0)
    s_waitcnt vmcnt(8)
    s_barrier
    v_mfma_f32_16x16x32_bf16 v[64:67], v[144:147], v[128:131], v[64:67]
    s_add_u32 m0, s31, 0x18000
    s_mov_b32 s28, 0x1100000
    buffer_load_dwordx4 v9, s[8:11], s28 offen lds
    v_mfma_f32_16x16x32_bf16 v[80:83], v[144:147], v[132:135], v[80:83]
    ds_read_b128 v[32:35], v2 offset:0
    v_mfma_f32_16x16x32_bf16 v[96:99], v[144:147], v[136:139], v[96:99]
    ds_read_b128 v[36:39], v2 offset:256
    v_mfma_f32_16x16x32_bf16 v[112:115], v[144:147], v[140:143], v[112:115]
    ds_read_b128 v[40:43], v2 offset:512
    v_mfma_f32_16x16x32_bf16 v[68:71], v[148:151], v[128:131], v[68:71]
    s_add_u32 m0, s31, 0x18400
    s_mov_b32 s28, 0x1100400
    buffer_load_dwordx4 v9, s[8:11], s28 offen lds
    v_mfma_f32_16x16x32_bf16 v[84:87], v[148:151], v[132:135], v[84:87]
    ds_read_b128 v[44:47], v2 offset:768
    v_mfma_f32_16x16x32_bf16 v[100:103], v[148:151], v[136:139], v[100:103]
    ds_read_b64_tr_b16 v[48:49], v4 offset:0
    v_mfma_f32_16x16x32_bf16 v[116:119], v[148:151], v[140:143], v[116:119]
    ds_read_b64_tr_b16 v[50:51], v4 offset:512
    v_mfma_f32_16x16x32_bf16 v[72:75], v[152:155], v[128:131], v[72:75]
    s_add_u32 m0, s30, 0x1c000
    s_mov_b32 s28, 0x680000
    buffer_load_dwordx4 v10, s[12:15], s28 offen lds
    v_mfma_f32_16x16x32_bf16 v[88:91], v[152:155], v[132:135], v[88:91]
    ds_read_b64_tr_b16 v[52:53], v5 offset:0
    v_mfma_f32_16x16x32_bf16 v[104:107], v[152:155], v[136:139], v[104:107]
    ds_read_b64_tr_b16 v[54:55], v5 offset:512
    v_mfma_f32_16x16x32_bf16 v[120:123], v[152:155], v[140:143], v[120:123]
    ds_read_b64_tr_b16 v[56:57], v6 offset:0
    v_mfma_f32_16x16x32_bf16 v[76:79], v[156:159], v[128:131], v[76:79]
    s_add_u32 m0, s30, 0x1e000
    s_mov_b32 s28, 0x680080
    buffer_load_dwordx4 v10, s[12:15], s28 offen lds
    v_mfma_f32_16x16x32_bf16 v[92:95], v[156:159], v[132:135], v[92:95]
    ds_read_b64_tr_b16 v[58:59], v6 offset:512
    v_mfma_f32_16x16x32_bf16 v[108:111], v[156:159], v[136:139], v[108:111]
    ds_read_b64_tr_b16 v[60:61], v7 offset:0
    v_mfma_f32_16x16x32_bf16 v[124:127], v[156:159], v[140:143], v[124:127]
    ds_read_b64_tr_b16 v[62:63], v7 offset:512
    s_waitcnt lgkmcnt(0)
    s_waitcnt vmcnt(8)
    s_barrier
    v_mfma_f32_16x16x32_bf16 v[64:67], v[48:51], v[32:35], v[64:67]
    s_add_u32 m0, s31, 0x0
    s_mov_b32 s28, 0x1140000
    buffer_load_dwordx4 v9, s[8:11], s28 offen lds
    v_mfma_f32_16x16x32_bf16 v[80:83], v[48:51], v[36:39], v[80:83]
    ds_read_b128 v[128:131], v2 offset:32768
    v_mfma_f32_16x16x32_bf16 v[96:99], v[48:51], v[40:43], v[96:99]
    ds_read_b128 v[132:135], v2 offset:33024
    v_mfma_f32_16x16x32_bf16 v[112:115], v[48:51], v[44:47], v[112:115]
    ds_read_b128 v[136:139], v2 offset:33280
    v_mfma_f32_16x16x32_bf16 v[68:71], v[52:55], v[32:35], v[68:71]
    s_add_u32 m0, s31, 0x400
    s_mov_b32 s28, 0x1140400
    buffer_load_dwordx4 v9, s[8:11], s28 offen lds
    v_mfma_f32_16x16x32_bf16 v[84:87], v[52:55], v[36:39], v[84:87]
    ds_read_b128 v[140:143], v2 offset:33536
    v_mfma_f32_16x16x32_bf16 v[100:103], v[52:55], v[40:43], v[100:103]
    ds_read_b64_tr_b16 v[144:145], v4 offset:32768
    v_mfma_f32_16x16x32_bf16 v[116:119], v[52:55], v[44:47], v[116:119]
    ds_read_b64_tr_b16 v[146:147], v4 offset:33280
    v_mfma_f32_16x16x32_bf16 v[72:75], v[56:59], v[32:35], v[72:75]
    s_add_u32 m0, s30, 0x4000
    s_mov_b32 s28, 0x6a0000
    buffer_load_dwordx4 v10, s[12:15], s28 offen lds
    v_mfma_f32_16x16x32_bf16 v[88:91], v[56:59], v[36:39], v[88:91]
    ds_read_b64_tr_b16 v[148:149], v5 offset:32768
    v_mfma_f32_16x16x32_bf16 v[104:107], v[56:59], v[40:43], v[104:107]
    ds_read_b64_tr_b16 v[150:151], v5 offset:33280
    v_mfma_f32_16x16x32_bf16 v[120:123], v[56:59], v[44:47], v[120:123]
    ds_read_b64_tr_b16 v[152:153], v6 offset:32768
    v_mfma_f32_16x16x32_bf16 v[76:79], v[60:63], v[32:35], v[76:79]
    s_add_u32 m0, s30, 0x6000
    s_mov_b32 s28, 0x6a0080
    buffer_load_dwordx4 v10, s[12:15], s28 offen lds
    v_mfma_f32_16x16x32_bf16 v[92:95], v[60:63], v[36:39], v[92:95]
    ds_read_b64_tr_b16 v[154:155], v6 offset:33280
    v_mfma_f32_16x16x32_bf16 v[108:111], v[60:63], v[40:43], v[108:111]
    ds_read_b64_tr_b16 v[156:157], v7 offset:32768
    v_mfma_f32_16x16x32_bf16 v[124:127], v[60:63], v[44:47], v[124:127]
    ds_read_b64_tr_b16 v[158:159], v7 offset:33280
    s_waitcnt lgkmcnt(0)
    s_waitcnt vmcnt(8)
    s_barrier
    v_mfma_f32_16x16x32_bf16 v[64:67], v[144:147], v[128:131], v[64:67]
    s_add_u32 m0, s31, 0x8000
    s_mov_b32 s28, 0x1180000
    buffer_load_dwordx4 v9, s[8:11], s28 offen lds
    v_mfma_f32_16x16x32_bf16 v[80:83], v[144:147], v[132:135], v[80:83]
    ds_read_b128 v[32:35], v3 offset:0
    v_mfma_f32_16x16x32_bf16 v[96:99], v[144:147], v[136:139], v[96:99]
    ds_read_b128 v[36:39], v3 offset:256
    v_mfma_f32_16x16x32_bf16 v[112:115], v[144:147], v[140:143], v[112:115]
    ds_read_b128 v[40:43], v3 offset:512
    v_mfma_f32_16x16x32_bf16 v[68:71], v[148:151], v[128:131], v[68:71]
    s_add_u32 m0, s31, 0x8400
    s_mov_b32 s28, 0x1180400
    buffer_load_dwordx4 v9, s[8:11], s28 offen lds
    v_mfma_f32_16x16x32_bf16 v[84:87], v[148:151], v[132:135], v[84:87]
    ds_read_b128 v[44:47], v3 offset:768
    v_mfma_f32_16x16x32_bf16 v[100:103], v[148:151], v[136:139], v[100:103]
    ds_read_b64_tr_b16 v[48:49], v240 offset:0
    v_mfma_f32_16x16x32_bf16 v[116:119], v[148:151], v[140:143], v[116:119]
    ds_read_b64_tr_b16 v[50:51], v240 offset:512
    v_mfma_f32_16x16x32_bf16 v[72:75], v[152:155], v[128:131], v[72:75]
    s_add_u32 m0, s30, 0xc000
    s_mov_b32 s28, 0x6c0000
    buffer_load_dwordx4 v10, s[12:15], s28 offen lds
    v_mfma_f32_16x16x32_bf16 v[88:91], v[152:155], v[132:135], v[88:91]
    ds_read_b64_tr_b16 v[52:53], v241 offset:0
    v_mfma_f32_16x16x32_bf16 v[104:107], v[152:155], v[136:139], v[104:107]
    ds_read_b64_tr_b16 v[54:55], v241 offset:512
    v_mfma_f32_16x16x32_bf16 v[120:123], v[152:155], v[140:143], v[120:123]
    ds_read_b64_tr_b16 v[56:57], v242 offset:0
    v_mfma_f32_16x16x32_bf16 v[76:79], v[156:159], v[128:131], v[76:79]
    s_add_u32 m0, s30, 0xe000
    s_mov_b32 s28, 0x6c0080
    buffer_load_dwordx4 v10, s[12:15], s28 offen lds
    v_mfma_f32_16x16x32_bf16 v[92:95], v[156:159], v[132:135], v[92:95]
    ds_read_b64_tr_b16 v[58:59], v242 offset:512
    v_mfma_f32_16x16x32_bf16 v[108:111], v[156:159], v[136:139], v[108:111]
    ds_read_b64_tr_b16 v[60:61], v243 offset:0
    v_mfma_f32_16x16x32_bf16 v[124:127], v[156:159], v[140:143], v[124:127]
    ds_read_b64_tr_b16 v[62:63], v243 offset:512
    s_waitcnt lgkmcnt(0)
    s_waitcnt vmcnt(8)
    s_barrier
    v_mfma_f32_16x16x32_bf16 v[64:67], v[48:51], v[32:35], v[64:67]
    s_add_u32 m0, s31, 0x10000
    s_mov_b32 s28, 0x11c0000
    buffer_load_dwordx4 v9, s[8:11], s28 offen lds
    v_mfma_f32_16x16x32_bf16 v[80:83], v[48:51], v[36:39], v[80:83]
    ds_read_b128 v[128:131], v3 offset:32768
    v_mfma_f32_16x16x32_bf16 v[96:99], v[48:51], v[40:43], v[96:99]
    ds_read_b128 v[132:135], v3 offset:33024
    v_mfma_f32_16x16x32_bf16 v[112:115], v[48:51], v[44:47], v[112:115]
    ds_read_b128 v[136:139], v3 offset:33280
    v_mfma_f32_16x16x32_bf16 v[68:71], v[52:55], v[32:35], v[68:71]
    s_add_u32 m0, s31, 0x10400
    s_mov_b32 s28, 0x11c0400
    buffer_load_dwordx4 v9, s[8:11], s28 offen lds
    v_mfma_f32_16x16x32_bf16 v[84:87], v[52:55], v[36:39], v[84:87]
    ds_read_b128 v[140:143], v3 offset:33536
    v_mfma_f32_16x16x32_bf16 v[100:103], v[52:55], v[40:43], v[100:103]
    ds_read_b64_tr_b16 v[144:145], v240 offset:32768
    v_mfma_f32_16x16x32_bf16 v[116:119], v[52:55], v[44:47], v[116:119]
    ds_read_b64_tr_b16 v[146:147], v240 offset:33280
    v_mfma_f32_16x16x32_bf16 v[72:75], v[56:59], v[32:35], v[72:75]
    s_add_u32 m0, s30, 0x14000
    s_mov_b32 s28, 0x6e0000
    buffer_load_dwordx4 v10, s[12:15], s28 offen lds
    v_mfma_f32_16x16x32_bf16 v[88:91], v[56:59], v[36:39], v[88:91]
    ds_read_b64_tr_b16 v[148:149], v241 offset:32768
    v_mfma_f32_16x16x32_bf16 v[104:107], v[56:59], v[40:43], v[104:107]
    ds_read_b64_tr_b16 v[150:151], v241 offset:33280
    v_mfma_f32_16x16x32_bf16 v[120:123], v[56:59], v[44:47], v[120:123]
    ds_read_b64_tr_b16 v[152:153], v242 offset:32768
    v_mfma_f32_16x16x32_bf16 v[76:79], v[60:63], v[32:35], v[76:79]
    s_add_u32 m0, s30, 0x16000
    s_mov_b32 s28, 0x6e0080
    buffer_load_dwordx4 v10, s[12:15], s28 offen lds
    v_mfma_f32_16x16x32_bf16 v[92:95], v[60:63], v[36:39], v[92:95]
    ds_read_b64_tr_b16 v[154:155], v242 offset:33280
    v_mfma_f32_16x16x32_bf16 v[108:111], v[60:63], v[40:43], v[108:111]
    ds_read_b64_tr_b16 v[156:157], v243 offset:32768
    v_mfma_f32_16x16x32_bf16 v[124:127], v[60:63], v[44:47], v[124:127]
    ds_read_b64_tr_b16 v[158:159], v243 offset:33280
    s_waitcnt lgkmcnt(0)
    s_waitcnt vmcnt(8)
    s_barrier
    s_lshr_b32 s28, s24, 2
    s_lshl_b32 s28, s28, 7
    v_and_b32 v31, 31, v14
    v_lshlrev_b32 v31, 2, v31
g2_opoll:
    buffer_load_dword v1, v31, s[88:91], s28 offen sc1
    s_waitcnt vmcnt(0)
    v_cmp_ne_u32 vcc, 1, v1
    s_nop 1
    s_nop 3
    s_cmp_eq_u64 vcc, 0
    s_cbranch_scc1 g2_opolled
    s_sleep 1
    s_branch g2_opoll
g2_opolled:
    v_mfma_f32_16x16x32_bf16 v[64:67], v[144:147], v[128:131], v[64:67]
    s_add_u32 m0, s31, 0x18000
    s_mov_b32 s28, 0x0
    buffer_load_dwordx4 v9, s[8:11], s28 offen lds
    v_mfma_f32_16x16x32_bf16 v[80:83], v[144:147], v[132:135], v[80:83]
    ds_read_b128 v[32:35], v2 offset:0
    v_mfma_f32_16x16x32_bf16 v[96:99], v[144:147], v[136:139], v[96:99]
    ds_read_b128 v[36:39], v2 offset:256
    v_mfma_f32_16x16x32_bf16 v[112:115], v[144:147], v[140:143], v[112:115]
    ds_read_b128 v[40:43], v2 offset:512
    v_mfma_f32_16x16x32_bf16 v[68:71], v[148:151], v[128:131], v[68:71]
    s_add_u32 m0, s31, 0x18400
    s_mov_b32 s28, 0x400
    buffer_load_dwordx4 v9, s[8:11], s28 offen lds
    v_mfma_f32_16x16x32_bf16 v[84:87], v[148:151], v[132:135], v[84:87]
    ds_read_b128 v[44:47], v2 offset:768
    v_mfma_f32_16x16x32_bf16 v[100:103], v[148:151], v[136:139], v[100:103]
    ds_read_b64_tr_b16 v[48:49], v4 offset:0
    v_mfma_f32_16x16x32_bf16 v[116:119], v[148:151], v[140:143], v[116:119]
    ds_read_b64_tr_b16 v[50:51], v4 offset:512
    v_mfma_f32_16x16x32_bf16 v[72:75], v[152:155], v[128:131], v[72:75]
    s_add_u32 m0, s30, 0x1c000
    s_mov_b32 s28, 0x0
    buffer_load_dwordx4 v10, s[16:19], s28 offen lds
    v_mfma_f32_16x16x32_bf16 v[88:91], v[152:155], v[132:135], v[88:91]
    ds_read_b64_tr_b16 v[52:53], v5 offset:0
    v_mfma_f32_16x16x32_bf16 v[104:107], v[152:155], v[136:139], v[104:107]
    ds_read_b64_tr_b16 v[54:55], v5 offset:512
    v_mfma_f32_16x16x32_bf16 v[120:123], v[152:155], v[140:143], v[120:123]
    ds_read_b64_tr_b16 v[56:57], v6 offset:0
    v_mfma_f32_16x16x32_bf16 v[76:79], v[156:159], v[128:131], v[76:79]
    s_add_u32 m0, s30, 0x1e000
    s_mov_b32 s28, 0x80
    buffer_load_dwordx4 v10, s[16:19], s28 offen lds
    v_mfma_f32_16x16x32_bf16 v[92:95], v[156:159], v[132:135], v[92:95]
    ds_read_b64_tr_b16 v[58:59], v6 offset:512
    v_mfma_f32_16x16x32_bf16 v[108:111], v[156:159], v[136:139], v[108:111]
    ds_read_b64_tr_b16 v[60:61], v7 offset:0
    v_mfma_f32_16x16x32_bf16 v[124:127], v[156:159], v[140:143], v[124:127]
    ds_read_b64_tr_b16 v[62:63], v7 offset:512
    s_waitcnt lgkmcnt(0)
    s_waitcnt vmcnt(8)
    s_barrier
    v_mfma_f32_16x16x32_bf16 v[64:67], v[48:51], v[32:35], v[64:67]
    s_add_u32 m0, s31, 0x0
    s_mov_b32 s28, 0x40000
    buffer_load_dwordx4 v9, s[8:11], s28 offen lds
    v_mfma_f32_16x16x32_bf16 v[80:83], v[48:51], v[36:39], v[80:83]
    ds_read_b128 v[128:131], v2 offset:32768
    v_mfma_f32_16x16x32_bf16 v[96:99], v[48:51], v[40:43], v[96:99]
    ds_read_b128 v[132:135], v2 offset:33024
    v_mfma_f32_16x16x32_bf16 v[112:115], v[48:51], v[44:47], v[112:115]
    ds_read_b128 v[136:139], v2 offset:33280
    v_mfma_f32_16x16x32_bf16 v[68:71], v[52:55], v[32:35], v[68:71]
    s_add_u32 m0, s31, 0x400
    s_mov_b32 s28, 0x40400
    buffer_load_dwordx4 v9, s[8:11], s28 offen lds
    v_mfma_f32_16x16x32_bf16 v[84:87], v[52:55], v[36:39], v[84:87]
    ds_read_b128 v[140:143], v2 offset:33536
    v_mfma_f32_16x16x32_bf16 v[100:103], v[52:55], v[40:43], v[100:103]
    ds_read_b64_tr_b16 v[144:145], v4 offset:32768
    v_mfma_f32_16x16x32_bf16 v[116:119], v[52:55], v[44:47], v[116:119]
    ds_read_b64_tr_b16 v[146:147], v4 offset:33280
    v_mfma_f32_16x16x32_bf16 v[72:75], v[56:59], v[32:35], v[72:75]
    s_add_u32 m0, s30, 0x4000
    s_mov_b32 s28, 0x20000
    buffer_load_dwordx4 v10, s[16:19], s28 offen lds
    v_mfma_f32_16x16x32_bf16 v[88:91], v[56:59], v[36:39], v[88:91]
    ds_read_b64_tr_b16 v[148:149], v5 offset:32768
    v_mfma_f32_16x16x32_bf16 v[104:107], v[56:59], v[40:43], v[104:107]
    ds_read_b64_tr_b16 v[150:151], v5 offset:33280
    v_mfma_f32_16x16x32_bf16 v[120:123], v[56:59], v[44:47], v[120:123]
    ds_read_b64_tr_b16 v[152:153], v6 offset:32768
    v_mfma_f32_16x16x32_bf16 v[76:79], v[60:63], v[32:35], v[76:79]
    s_add_u32 m0, s30, 0x6000
    s_mov_b32 s28, 0x20080
    buffer_load_dwordx4 v10, s[16:19], s28 offen lds
    v_mfma_f32_16x16x32_bf16 v[92:95], v[60:63], v[36:39], v[92:95]
    ds_read_b64_tr_b16 v[154:155], v6 offset:33280
    v_mfma_f32_16x16x32_bf16 v[108:111], v[60:63], v[40:43], v[108:111]
    ds_read_b64_tr_b16 v[156:157], v7 offset:32768
    v_mfma_f32_16x16x32_bf16 v[124:127], v[60:63], v[44:47], v[124:127]
    ds_read_b64_tr_b16 v[158:159], v7 offset:33280
    s_waitcnt lgkmcnt(0)
    s_waitcnt vmcnt(8)
    s_barrier
    v_mfma_f32_16x16x32_bf16 v[64:67], v[144:147], v[128:131], v[64:67]
    s_add_u32 m0, s31, 0x8000
    s_mov_b32 s28, 0x80000
    buffer_load_dwordx4 v9, s[8:11], s28 offen lds
    v_mfma_f32_16x16x32_bf16 v[80:83], v[144:147], v[132:135], v[80:83]
    ds_read_b128 v[32:35], v3 offset:0
    v_mfma_f32_16x16x32_bf16 v[96:99], v[144:147], v[136:139], v[96:99]
    ds_read_b128 v[36:39], v3 offset:256
    v_mfma_f32_16x16x32_bf16 v[112:115], v[144:147], v[140:143], v[112:115]
    ds_read_b128 v[40:43], v3 offset:512
    v_mfma_f32_16x16x32_bf16 v[68:71], v[148:151], v[128:131], v[68:71]
    s_add_u32 m0, s31, 0x8400
    s_mov_b32 s28, 0x80400
    buffer_load_dwordx4 v9, s[8:11], s28 offen lds
    v_mfma_f32_16x16x32_bf16 v[84:87], v[148:151], v[132:135], v[84:87]
    ds_read_b128 v[44:47], v3 offset:768
    v_mfma_f32_16x16x32_bf16 v[100:103], v[148:151], v[136:139], v[100:103]
    ds_read_b64_tr_b16 v[48:49], v240 offset:0
    v_mfma_f32_16x16x32_bf16 v[116:119], v[148:151], v[140:143], v[116:119]
    ds_read_b64_tr_b16 v[50:51], v240 offset:512
    v_mfma_f32_16x16x32_bf16 v[72:75], v[152:155], v[128:131], v[72:75]
    s_add_u32 m0, s30, 0xc000
    s_mov_b32 s28, 0x40000
    buffer_load_dwordx4 v10, s[16:19], s28 offen lds
    v_mfma_f32_16x16x32_bf16 v[88:91], v[152:155], v[132:135], v[88:91]
    ds_read_b64_tr_b16 v[52:53], v241 offset:0
    v_mfma_f32_16x16x32_bf16 v[104:107], v[152:155], v[136:139], v[104:107]
    ds_read_b64_tr_b16 v[54:55], v241 offset:512
    v_mfma_f32_16x16x32_bf16 v[120:123], v[152:155], v[140:143], v[120:123]
    ds_read_b64_tr_b16 v[56:57], v242 offset:0
    v_mfma_f32_16x16x32_bf16 v[76:79], v[156:159], v[128:131], v[76:79]
    s_add_u32 m0, s30, 0xe000
    s_mov_b32 s28, 0x40080
    buffer_load_dwordx4 v10, s[16:19], s28 offen lds
    v_mfma_f32_16x16x32_bf16 v[92:95], v[156:159], v[132:135], v[92:95]
    ds_read_b64_tr_b16 v[58:59], v242 offset:512
    v_mfma_f32_16x16x32_bf16 v[108:111], v[156:159], v[136:139], v[108:111]
    ds_read_b64_tr_b16 v[60:61], v243 offset:0
    v_mfma_f32_16x16x32_bf16 v[124:127], v[156:159], v[140:143], v[124:127]
    ds_read_b64_tr_b16 v[62:63], v243 offset:512
    s_waitcnt lgkmcnt(0)
    s_waitcnt vmcnt(8)
    s_barrier
    v_mfma_f32_16x16x32_bf16 v[64:67], v[48:51], v[32:35], v[64:67]
    s_add_u32 m0, s31, 0x10000
    s_mov_b32 s28, 0xc0000
    buffer_load_dwordx4 v9, s[8:11], s28 offen lds
    v_mfma_f32_16x16x32_bf16 v[80:83], v[48:51], v[36:39], v[80:83]
    ds_read_b128 v[128:131], v3 offset:32768
    v_mfma_f32_16x16x32_bf16 v[96:99], v[48:51], v[40:43], v[96:99]
    ds_read_b128 v[132:135], v3 offset:33024
    v_mfma_f32_16x16x32_bf16 v[112:115], v[48:51], v[44:47], v[112:115]
    ds_read_b128 v[136:139], v3 offset:33280
    v_mfma_f32_16x16x32_bf16 v[68:71], v[52:55], v[32:35], v[68:71]
    s_add_u32 m0, s31, 0x10400
    s_mov_b32 s28, 0xc0400
    buffer_load_dwordx4 v9, s[8:11], s28 offen lds
    v_mfma_f32_16x16x32_bf16 v[84:87], v[52:55], v[36:39], v[84:87]
    ds_read_b128 v[140:143], v3 offset:33536
    v_mfma_f32_16x16x32_bf16 v[100:103], v[52:55], v[40:43], v[100:103]
    ds_read_b64_tr_b16 v[144:145], v240 offset:32768
    v_mfma_f32_16x16x32_bf16 v[116:119], v[52:55], v[44:47], v[116:119]
    ds_read_b64_tr_b16 v[146:147], v240 offset:33280
    v_mfma_f32_16x16x32_bf16 v[72:75], v[56:59], v[32:35], v[72:75]
    s_add_u32 m0, s30, 0x14000
    s_mov_b32 s28, 0x60000
    buffer_load_dwordx4 v10, s[16:19], s28 offen lds
    v_mfma_f32_16x16x32_bf16 v[88:91], v[56:59], v[36:39], v[88:91]
    ds_read_b64_tr_b16 v[148:149], v241 offset:32768
    v_mfma_f32_16x16x32_bf16 v[104:107], v[56:59], v[40:43], v[104:107]
    ds_read_b64_tr_b16 v[150:151], v241 offset:33280
    v_mfma_f32_16x16x32_bf16 v[120:123], v[56:59], v[44:47], v[120:123]
    ds_read_b64_tr_b16 v[152:153], v242 offset:32768
    v_mfma_f32_16x16x32_bf16 v[76:79], v[60:63], v[32:35], v[76:79]
    s_add_u32 m0, s30, 0x16000
    s_mov_b32 s28, 0x60080
    buffer_load_dwordx4 v10, s[16:19], s28 offen lds
    v_mfma_f32_16x16x32_bf16 v[92:95], v[60:63], v[36:39], v[92:95]
    ds_read_b64_tr_b16 v[154:155], v242 offset:33280
    v_mfma_f32_16x16x32_bf16 v[108:111], v[60:63], v[40:43], v[108:111]
    ds_read_b64_tr_b16 v[156:157], v243 offset:32768
    v_mfma_f32_16x16x32_bf16 v[124:127], v[60:63], v[44:47], v[124:127]
    ds_read_b64_tr_b16 v[158:159], v243 offset:33280
    s_waitcnt lgkmcnt(0)
    s_waitcnt vmcnt(8)
    s_barrier
    v_mfma_f32_16x16x32_bf16 v[64:67], v[144:147], v[128:131], v[64:67]
    s_add_u32 m0, s31, 0x18000
    s_mov_b32 s28, 0x100000
    buffer_load_dwordx4 v9, s[8:11], s28 offen lds
    v_mfma_f32_16x16x32_bf16 v[80:83], v[144:147], v[132:135], v[80:83]
    ds_read_b128 v[32:35], v2 offset:0
    v_mfma_f32_16x16x32_bf16 v[96:99], v[144:147], v[136:139], v[96:99]
    ds_read_b128 v[36:39], v2 offset:256
    v_mfma_f32_16x16x32_bf16 v[112:115], v[144:147], v[140:143], v[112:115]
    ds_read_b128 v[40:43], v2 offset:512
    v_mfma_f32_16x16x32_bf16 v[68:71], v[148:151], v[128:131], v[68:71]
    s_add_u32 m0, s31, 0x18400
    s_mov_b32 s28, 0x100400
    buffer_load_dwordx4 v9, s[8:11], s28 offen lds
    v_mfma_f32_16x16x32_bf16 v[84:87], v[148:151], v[132:135], v[84:87]
    ds_read_b128 v[44:47], v2 offset:768
    v_mfma_f32_16x16x32_bf16 v[100:103], v[148:151], v[136:139], v[100:103]
    ds_read_b64_tr_b16 v[48:49], v4 offset:0
    v_mfma_f32_16x16x32_bf16 v[116:119], v[148:151], v[140:143], v[116:119]
    ds_read_b64_tr_b16 v[50:51], v4 offset:512
    v_mfma_f32_16x16x32_bf16 v[72:75], v[152:155], v[128:131], v[72:75]
    s_add_u32 m0, s30, 0x1c000
    s_mov_b32 s28, 0x80000
    buffer_load_dwordx4 v10, s[16:19], s28 offen lds
    v_mfma_f32_16x16x32_bf16 v[88:91], v[152:155], v[132:135], v[88:91]
    ds_read_b64_tr_b16 v[52:53], v5 offset:0
    v_mfma_f32_16x16x32_bf16 v[104:107], v[152:155], v[136:139], v[104:107]
    ds_read_b64_tr_b16 v[54:55], v5 offset:512
    v_mfma_f32_16x16x32_bf16 v[120:123], v[152:155], v[140:143], v[120:123]
    ds_read_b64_tr_b16 v[56:57], v6 offset:0
    v_mfma_f32_16x16x32_bf16 v[76:79], v[156:159], v[128:131], v[76:79]
    s_add_u32 m0, s30, 0x1e000
    s_mov_b32 s28, 0x80080
    buffer_load_dwordx4 v10, s[16:19], s28 offen lds
    v_mfma_f32_16x16x32_bf16 v[92:95], v[156:159], v[132:135], v[92:95]
    ds_read_b64_tr_b16 v[58:59], v6 offset:512
    v_mfma_f32_16x16x32_bf16 v[108:111], v[156:159], v[136:139], v[108:111]
    ds_read_b64_tr_b16 v[60:61], v7 offset:0
    v_mfma_f32_16x16x32_bf16 v[124:127], v[156:159], v[140:143], v[124:127]
    ds_read_b64_tr_b16 v[62:63], v7 offset:512
    s_waitcnt lgkmcnt(0)
    s_waitcnt vmcnt(8)
    s_barrier
    v_mfma_f32_16x16x32_bf16 v[64:67], v[48:51], v[32:35], v[64:67]
    s_add_u32 m0, s31, 0x0
    s_mov_b32 s28, 0x140000
    buffer_load_dwordx4 v9, s[8:11], s28 offen lds
    v_mfma_f32_16x16x32_bf16 v[80:83], v[48:51], v[36:39], v[80:83]
    ds_read_b128 v[128:131], v2 offset:32768
    v_mfma_f32_16x16x32_bf16 v[96:99], v[48:51], v[40:43], v[96:99]
    ds_read_b128 v[132:135], v2 offset:33024
    v_mfma_f32_16x16x32_bf16 v[112:115], v[48:51], v[44:47], v[112:115]
    ds_read_b128 v[136:139], v2 offset:33280
    v_mfma_f32_16x16x32_bf16 v[68:71], v[52:55], v[32:35], v[68:71]
    s_add_u32 m0, s31, 0x400
    s_mov_b32 s28, 0x140400
    buffer_load_dwordx4 v9, s[8:11], s28 offen lds
    v_mfma_f32_16x16x32_bf16 v[84:87], v[52:55], v[36:39], v[84:87]
    ds_read_b128 v[140:143], v2 offset:33536
    v_mfma_f32_16x16x32_bf16 v[100:103], v[52:55], v[40:43], v[100:103]
    ds_read_b64_tr_b16 v[144:145], v4 offset:32768
    v_mfma_f32_16x16x32_bf16 v[116:119], v[52:55], v[44:47], v[116:119]
    ds_read_b64_tr_b16 v[146:147], v4 offset:33280
    v_mfma_f32_16x16x32_bf16 v[72:75], v[56:59], v[32:35], v[72:75]
    s_add_u32 m0, s30, 0x4000
    s_mov_b32 s28, 0xa0000
    buffer_load_dwordx4 v10, s[16:19], s28 offen lds
    v_mfma_f32_16x16x32_bf16 v[88:91], v[56:59], v[36:39], v[88:91]
    ds_read_b64_tr_b16 v[148:149], v5 offset:32768
    v_mfma_f32_16x16x32_bf16 v[104:107], v[56:59], v[40:43], v[104:107]
    ds_read_b64_tr_b16 v[150:151], v5 offset:33280
    v_mfma_f32_16x16x32_bf16 v[120:123], v[56:59], v[44:47], v[120:123]
    ds_read_b64_tr_b16 v[152:153], v6 offset:32768
    v_mfma_f32_16x16x32_bf16 v[76:79], v[60:63], v[32:35], v[76:79]
    s_add_u32 m0, s30, 0x6000
    s_mov_b32 s28, 0xa0080
    buffer_load_dwordx4 v10, s[16:19], s28 offen lds
    v_mfma_f32_16x16x32_bf16 v[92:95], v[60:63], v[36:39], v[92:95]
    ds_read_b64_tr_b16 v[154:155], v6 offset:33280
    v_mfma_f32_16x16x32_bf16 v[108:111], v[60:63], v[40:43], v[108:111]
    ds_read_b64_tr_b16 v[156:157], v7 offset:32768
    v_mfma_f32_16x16x32_bf16 v[124:127], v[60:63], v[44:47], v[124:127]
    ds_read_b64_tr_b16 v[158:159], v7 offset:33280
    s_waitcnt lgkmcnt(0)
    s_waitcnt vmcnt(8)
    s_barrier
    v_mfma_f32_16x16x32_bf16 v[64:67], v[144:147], v[128:131], v[64:67]
    s_add_u32 m0, s31, 0x8000
    s_mov_b32 s28, 0x180000
    buffer_load_dwordx4 v9, s[8:11], s28 offen lds
    v_mfma_f32_16x16x32_bf16 v[80:83], v[144:147], v[132:135], v[80:83]
    ds_read_b128 v[32:35], v3 offset:0
    v_mfma_f32_16x16x32_bf16 v[96:99], v[144:147], v[136:139], v[96:99]
    ds_read_b128 v[36:39], v3 offset:256
    v_mfma_f32_16x16x32_bf16 v[112:115], v[144:147], v[140:143], v[112:115]
    ds_read_b128 v[40:43], v3 offset:512
    v_mfma_f32_16x16x32_bf16 v[68:71], v[148:151], v[128:131], v[68:71]
    s_add_u32 m0, s31, 0x8400
    s_mov_b32 s28, 0x180400
    buffer_load_dwordx4 v9, s[8:11], s28 offen lds
    v_mfma_f32_16x16x32_bf16 v[84:87], v[148:151], v[132:135], v[84:87]
    ds_read_b128 v[44:47], v3 offset:768
    v_mfma_f32_16x16x32_bf16 v[100:103], v[148:151], v[136:139], v[100:103]
    ds_read_b64_tr_b16 v[48:49], v240 offset:0
    v_mfma_f32_16x16x32_bf16 v[116:119], v[148:151], v[140:143], v[116:119]
    ds_read_b64_tr_b16 v[50:51], v240 offset:512
    v_mfma_f32_16x16x32_bf16 v[72:75], v[152:155], v[128:131], v[72:75]
    s_add_u32 m0, s30, 0xc000
    s_mov_b32 s28, 0xc0000
    buffer_load_dwordx4 v10, s[16:19], s28 offen lds
    v_mfma_f32_16x16x32_bf16 v[88:91], v[152:155], v[132:135], v[88:91]
    ds_read_b64_tr_b16 v[52:53], v241 offset:0
    v_mfma_f32_16x16x32_bf16 v[104:107], v[152:155], v[136:139], v[104:107]
    ds_read_b64_tr_b16 v[54:55], v241 offset:512
    v_mfma_f32_16x16x32_bf16 v[120:123], v[152:155], v[140:143], v[120:123]
    ds_read_b64_tr_b16 v[56:57], v242 offset:0
    v_mfma_f32_16x16x32_bf16 v[76:79], v[156:159], v[128:131], v[76:79]
    s_add_u32 m0, s30, 0xe000
    s_mov_b32 s28, 0xc0080
    buffer_load_dwordx4 v10, s[16:19], s28 offen lds
    v_mfma_f32_16x16x32_bf16 v[92:95], v[156:159], v[132:135], v[92:95]
    ds_read_b64_tr_b16 v[58:59], v242 offset:512
    v_mfma_f32_16x16x32_bf16 v[108:111], v[156:159], v[136:139], v[108:111]
    ds_read_b64_tr_b16 v[60:61], v243 offset:0
    v_mfma_f32_16x16x32_bf16 v[124:127], v[156:159], v[140:143], v[124:127]
    ds_read_b64_tr_b16 v[62:63], v243 offset:512
    s_waitcnt lgkmcnt(0)
    s_waitcnt vmcnt(8)
    s_barrier
    v_mfma_f32_16x16x32_bf16 v[64:67], v[48:51], v[32:35], v[64:67]
    s_add_u32 m0, s31, 0x10000
    s_mov_b32 s28, 0x1c0000
    buffer_load_dwordx4 v9, s[8:11], s28 offen lds
    v_mfma_f32_16x16x32_bf16 v[80:83], v[48:51], v[36:39], v[80:83]
    ds_read_b128 v[128:131], v3 offset:32768
    v_mfma_f32_16x16x32_bf16 v[96:99], v[48:51], v[40:43], v[96:99]
    ds_read_b128 v[132:135], v3 offset:33024
    v_mfma_f32_16x16x32_bf16 v[112:115], v[48:51], v[44:47], v[112:115]
    ds_read_b128 v[136:139], v3 offset:33280
    v_mfma_f32_16x16x32_bf16 v[68:71], v[52:55], v[32:35], v[68:71]
    s_add_u32 m0, s31, 0x10400
    s_mov_b32 s28, 0x1c0400
    buffer_load_dwordx4 v9, s[8:11], s28 offen lds
    v_mfma_f32_16x16x32_bf16 v[84:87], v[52:55], v[36:39], v[84:87]
    ds_read_b128 v[140:143], v3 offset:33536
    v_mfma_f32_16x16x32_bf16 v[100:103], v[52:55], v[40:43], v[100:103]
    ds_read_b64_tr_b16 v[144:145], v240 offset:32768
    v_mfma_f32_16x16x32_bf16 v[116:119], v[52:55], v[44:47], v[116:119]
    ds_read_b64_tr_b16 v[146:147], v240 offset:33280
    v_mfma_f32_16x16x32_bf16 v[72:75], v[56:59], v[32:35], v[72:75]
    s_add_u32 m0, s30, 0x14000
    s_mov_b32 s28, 0xe0000
    buffer_load_dwordx4 v10, s[16:19], s28 offen lds
    v_mfma_f32_16x16x32_bf16 v[88:91], v[56:59], v[36:39], v[88:91]
    ds_read_b64_tr_b16 v[148:149], v241 offset:32768
    v_mfma_f32_16x16x32_bf16 v[104:107], v[56:59], v[40:43], v[104:107]
    ds_read_b64_tr_b16 v[150:151], v241 offset:33280
    v_mfma_f32_16x16x32_bf16 v[120:123], v[56:59], v[44:47], v[120:123]
    ds_read_b64_tr_b16 v[152:153], v242 offset:32768
    v_mfma_f32_16x16x32_bf16 v[76:79], v[60:63], v[32:35], v[76:79]
    s_add_u32 m0, s30, 0x16000
    s_mov_b32 s28, 0xe0080
    buffer_load_dwordx4 v10, s[16:19], s28 offen lds
    v_mfma_f32_16x16x32_bf16 v[92:95], v[60:63], v[36:39], v[92:95]
    ds_read_b64_tr_b16 v[154:155], v242 offset:33280
    v_mfma_f32_16x16x32_bf16 v[108:111], v[60:63], v[40:43], v[108:111]
    ds_read_b64_tr_b16 v[156:157], v243 offset:32768
    v_mfma_f32_16x16x32_bf16 v[124:127], v[60:63], v[44:47], v[124:127]
    ds_read_b64_tr_b16 v[158:159], v243 offset:33280
    s_waitcnt lgkmcnt(0)
    s_waitcnt vmcnt(8)
    s_barrier
    v_mfma_f32_16x16x32_bf16 v[64:67], v[144:147], v[128:131], v[64:67]
    s_add_u32 m0, s31, 0x18000
    s_mov_b32 s28, 0x200000
    buffer_load_dwordx4 v9, s[8:11], s28 offen lds
    v_mfma_f32_16x16x32_bf16 v[80:83], v[144:147], v[132:135], v[80:83]
    ds_read_b128 v[32:35], v2 offset:0
    v_mfma_f32_16x16x32_bf16 v[96:99], v[144:147], v[136:139], v[96:99]
    ds_read_b128 v[36:39], v2 offset:256
    v_mfma_f32_16x16x32_bf16 v[112:115], v[144:147], v[140:143], v[112:115]
    ds_read_b128 v[40:43], v2 offset:512
    v_mfma_f32_16x16x32_bf16 v[68:71], v[148:151], v[128:131], v[68:71]
    s_add_u32 m0, s31, 0x18400
    s_mov_b32 s28, 0x200400
    buffer_load_dwordx4 v9, s[8:11], s28 offen lds
    v_mfma_f32_16x16x32_bf16 v[84:87], v[148:151], v[132:135], v[84:87]
    ds_read_b128 v[44:47], v2 offset:768
    v_mfma_f32_16x16x32_bf16 v[100:103], v[148:151], v[136:139], v[100:103]
    ds_read_b64_tr_b16 v[48:49], v4 offset:0
    v_mfma_f32_16x16x32_bf16 v[116:119], v[148:151], v[140:143], v[116:119]
    ds_read_b64_tr_b16 v[50:51], v4 offset:512
    v_mfma_f32_16x16x32_bf16 v[72:75], v[152:155], v[128:131], v[72:75]
    s_add_u32 m0, s30, 0x1c000
    s_mov_b32 s28, 0x100000
    buffer_load_dwordx4 v10, s[16:19], s28 offen lds
    v_mfma_f32_16x16x32_bf16 v[88:91], v[152:155], v[132:135], v[88:91]
    ds_read_b64_tr_b16 v[52:53], v5 offset:0
    v_mfma_f32_16x16x32_bf16 v[104:107], v[152:155], v[136:139], v[104:107]
    ds_read_b64_tr_b16 v[54:55], v5 offset:512
    v_mfma_f32_16x16x32_bf16 v[120:123], v[152:155], v[140:143], v[120:123]
    ds_read_b64_tr_b16 v[56:57], v6 offset:0
    v_mfma_f32_16x16x32_bf16 v[76:79], v[156:159], v[128:131], v[76:79]
    s_add_u32 m0, s30, 0x1e000
    s_mov_b32 s28, 0x100080
    buffer_load_dwordx4 v10, s[16:19], s28 offen lds
    v_mfma_f32_16x16x32_bf16 v[92:95], v[156:159], v[132:135], v[92:95]
    ds_read_b64_tr_b16 v[58:59], v6 offset:512
    v_mfma_f32_16x16x32_bf16 v[108:111], v[156:159], v[136:139], v[108:111]
    ds_read_b64_tr_b16 v[60:61], v7 offset:0
    v_mfma_f32_16x16x32_bf16 v[124:127], v[156:159], v[140:143], v[124:127]
    ds_read_b64_tr_b16 v[62:63], v7 offset:512
    s_waitcnt lgkmcnt(0)
    s_waitcnt vmcnt(8)
    s_barrier
    v_mfma_f32_16x16x32_bf16 v[64:67], v[48:51], v[32:35], v[64:67]
    s_add_u32 m0, s31, 0x0
    s_mov_b32 s28, 0x240000
    buffer_load_dwordx4 v9, s[8:11], s28 offen lds
    v_mfma_f32_16x16x32_bf16 v[80:83], v[48:51], v[36:39], v[80:83]
    ds_read_b128 v[128:131], v2 offset:32768
    v_mfma_f32_16x16x32_bf16 v[96:99], v[48:51], v[40:43], v[96:99]
    ds_read_b128 v[132:135], v2 offset:33024
    v_mfma_f32_16x16x32_bf16 v[112:115], v[48:51], v[44:47], v[112:115]
    ds_read_b128 v[136:139], v2 offset:33280
    v_mfma_f32_16x16x32_bf16 v[68:71], v[52:55], v[32:35], v[68:71]
    s_add_u32 m0, s31, 0x400
    s_mov_b32 s28, 0x240400
    buffer_load_dwordx4 v9, s[8:11], s28 offen lds
    v_mfma_f32_16x16x32_bf16 v[84:87], v[52:55], v[36:39], v[84:87]
    ds_read_b128 v[140:143], v2 offset:33536
    v_mfma_f32_16x16x32_bf16 v[100:103], v[52:55], v[40:43], v[100:103]
    ds_read_b64_tr_b16 v[144:145], v4 offset:32768
    v_mfma_f32_16x16x32_bf16 v[116:119], v[52:55], v[44:47], v[116:119]
    ds_read_b64_tr_b16 v[146:147], v4 offset:33280
    v_mfma_f32_16x16x32_bf16 v[72:75], v[56:59], v[32:35], v[72:75]
    s_add_u32 m0, s30, 0x4000
    s_mov_b32 s28, 0x120000
    buffer_load_dwordx4 v10, s[16:19], s28 offen lds
    v_mfma_f32_16x16x32_bf16 v[88:91], v[56:59], v[36:39], v[88:91]
    ds_read_b64_tr_b16 v[148:149], v5 offset:32768
    v_mfma_f32_16x16x32_bf16 v[104:107], v[56:59], v[40:43], v[104:107]
    ds_read_b64_tr_b16 v[150:151], v5 offset:33280
    v_mfma_f32_16x16x32_bf16 v[120:123], v[56:59], v[44:47], v[120:123]
    ds_read_b64_tr_b16 v[152:153], v6 offset:32768
    v_mfma_f32_16x16x32_bf16 v[76:79], v[60:63], v[32:35], v[76:79]
    s_add_u32 m0, s30, 0x6000
    s_mov_b32 s28, 0x120080
    buffer_load_dwordx4 v10, s[16:19], s28 offen lds
    v_mfma_f32_16x16x32_bf16 v[92:95], v[60:63], v[36:39], v[92:95]
    ds_read_b64_tr_b16 v[154:155], v6 offset:33280
    v_mfma_f32_16x16x32_bf16 v[108:111], v[60:63], v[40:43], v[108:111]
    ds_read_b64_tr_b16 v[156:157], v7 offset:32768
    v_mfma_f32_16x16x32_bf16 v[124:127], v[60:63], v[44:47], v[124:127]
    ds_read_b64_tr_b16 v[158:159], v7 offset:33280
    s_waitcnt lgkmcnt(0)
    s_waitcnt vmcnt(8)
    s_barrier
    v_mfma_f32_16x16x32_bf16 v[64:67], v[144:147], v[128:131], v[64:67]
    s_add_u32 m0, s31, 0x8000
    s_mov_b32 s28, 0x280000
    buffer_load_dwordx4 v9, s[8:11], s28 offen lds
    v_mfma_f32_16x16x32_bf16 v[80:83], v[144:147], v[132:135], v[80:83]
    ds_read_b128 v[32:35], v3 offset:0
    v_mfma_f32_16x16x32_bf16 v[96:99], v[144:147], v[136:139], v[96:99]
    ds_read_b128 v[36:39], v3 offset:256
    v_mfma_f32_16x16x32_bf16 v[112:115], v[144:147], v[140:143], v[112:115]
    ds_read_b128 v[40:43], v3 offset:512
    v_mfma_f32_16x16x32_bf16 v[68:71], v[148:151], v[128:131], v[68:71]
    s_add_u32 m0, s31, 0x8400
    s_mov_b32 s28, 0x280400
    buffer_load_dwordx4 v9, s[8:11], s28 offen lds
    v_mfma_f32_16x16x32_bf16 v[84:87], v[148:151], v[132:135], v[84:87]
    ds_read_b128 v[44:47], v3 offset:768
    v_mfma_f32_16x16x32_bf16 v[100:103], v[148:151], v[136:139], v[100:103]
    ds_read_b64_tr_b16 v[48:49], v240 offset:0
    v_mfma_f32_16x16x32_bf16 v[116:119], v[148:151], v[140:143], v[116:119]
    ds_read_b64_tr_b16 v[50:51], v240 offset:512
    v_mfma_f32_16x16x32_bf16 v[72:75], v[152:155], v[128:131], v[72:75]
    s_add_u32 m0, s30, 0xc000
    s_mov_b32 s28, 0x140000
    buffer_load_dwordx4 v10, s[16:19], s28 offen lds
    v_mfma_f32_16x16x32_bf16 v[88:91], v[152:155], v[132:135], v[88:91]
    ds_read_b64_tr_b16 v[52:53], v241 offset:0
    v_mfma_f32_16x16x32_bf16 v[104:107], v[152:155], v[136:139], v[104:107]
    ds_read_b64_tr_b16 v[54:55], v241 offset:512
    v_mfma_f32_16x16x32_bf16 v[120:123], v[152:155], v[140:143], v[120:123]
    ds_read_b64_tr_b16 v[56:57], v242 offset:0
    v_mfma_f32_16x16x32_bf16 v[76:79], v[156:159], v[128:131], v[76:79]
    s_add_u32 m0, s30, 0xe000
    s_mov_b32 s28, 0x140080
    buffer_load_dwordx4 v10, s[16:19], s28 offen lds
    v_mfma_f32_16x16x32_bf16 v[92:95], v[156:159], v[132:135], v[92:95]
    ds_read_b64_tr_b16 v[58:59], v242 offset:512
    v_mfma_f32_16x16x32_bf16 v[108:111], v[156:159], v[136:139], v[108:111]
    ds_read_b64_tr_b16 v[60:61], v243 offset:0
    v_mfma_f32_16x16x32_bf16 v[124:127], v[156:159], v[140:143], v[124:127]
    ds_read_b64_tr_b16 v[62:63], v243 offset:512
    s_waitcnt lgkmcnt(0)
    s_waitcnt vmcnt(8)
    s_barrier
    v_mfma_f32_16x16x32_bf16 v[64:67], v[48:51], v[32:35], v[64:67]
    s_add_u32 m0, s31, 0x10000
    s_mov_b32 s28, 0x2c0000
    buffer_load_dwordx4 v9, s[8:11], s28 offen lds
    v_mfma_f32_16x16x32_bf16 v[80:83], v[48:51], v[36:39], v[80:83]
    ds_read_b128 v[128:131], v3 offset:32768
    v_mfma_f32_16x16x32_bf16 v[96:99], v[48:51], v[40:43], v[96:99]
    ds_read_b128 v[132:135], v3 offset:33024
    v_mfma_f32_16x16x32_bf16 v[112:115], v[48:51], v[44:47], v[112:115]
    ds_read_b128 v[136:139], v3 offset:33280
    v_mfma_f32_16x16x32_bf16 v[68:71], v[52:55], v[32:35], v[68:71]
    s_add_u32 m0, s31, 0x10400
    s_mov_b32 s28, 0x2c0400
    buffer_load_dwordx4 v9, s[8:11], s28 offen lds
    v_mfma_f32_16x16x32_bf16 v[84:87], v[52:55], v[36:39], v[84:87]
    ds_read_b128 v[140:143], v3 offset:33536
    v_mfma_f32_16x16x32_bf16 v[100:103], v[52:55], v[40:43], v[100:103]
    ds_read_b64_tr_b16 v[144:145], v240 offset:32768
    v_mfma_f32_16x16x32_bf16 v[116:119], v[52:55], v[44:47], v[116:119]
    ds_read_b64_tr_b16 v[146:147], v240 offset:33280
    v_mfma_f32_16x16x32_bf16 v[72:75], v[56:59], v[32:35], v[72:75]
    s_add_u32 m0, s30, 0x14000
    s_mov_b32 s28, 0x160000
    buffer_load_dwordx4 v10, s[16:19], s28 offen lds
    v_mfma_f32_16x16x32_bf16 v[88:91], v[56:59], v[36:39], v[88:91]
    ds_read_b64_tr_b16 v[148:149], v241 offset:32768
    v_mfma_f32_16x16x32_bf16 v[104:107], v[56:59], v[40:43], v[104:107]
    ds_read_b64_tr_b16 v[150:151], v241 offset:33280
    v_mfma_f32_16x16x32_bf16 v[120:123], v[56:59], v[44:47], v[120:123]
    ds_read_b64_tr_b16 v[152:153], v242 offset:32768
    v_mfma_f32_16x16x32_bf16 v[76:79], v[60:63], v[32:35], v[76:79]
    s_add_u32 m0, s30, 0x16000
    s_mov_b32 s28, 0x160080
    buffer_load_dwordx4 v10, s[16:19], s28 offen lds
    v_mfma_f32_16x16x32_bf16 v[92:95], v[60:63], v[36:39], v[92:95]
    ds_read_b64_tr_b16 v[154:155], v242 offset:33280
    v_mfma_f32_16x16x32_bf16 v[108:111], v[60:63], v[40:43], v[108:111]
    ds_read_b64_tr_b16 v[156:157], v243 offset:32768
    v_mfma_f32_16x16x32_bf16 v[124:127], v[60:63], v[44:47], v[124:127]
    ds_read_b64_tr_b16 v[158:159], v243 offset:33280
    s_waitcnt lgkmcnt(0)
    s_waitcnt vmcnt(8)
    s_barrier
    v_mfma_f32_16x16x32_bf16 v[64:67], v[144:147], v[128:131], v[64:67]
    s_add_u32 m0, s31, 0x18000
    s_mov_b32 s28, 0x300000
    buffer_load_dwordx4 v9, s[8:11], s28 offen lds
    v_mfma_f32_16x16x32_bf16 v[80:83], v[144:147], v[132:135], v[80:83]
    ds_read_b128 v[32:35], v2 offset:0
    v_mfma_f32_16x16x32_bf16 v[96:99], v[144:147], v[136:139], v[96:99]
    ds_read_b128 v[36:39], v2 offset:256
    v_mfma_f32_16x16x32_bf16 v[112:115], v[144:147], v[140:143], v[112:115]
    ds_read_b128 v[40:43], v2 offset:512
    v_mfma_f32_16x16x32_bf16 v[68:71], v[148:151], v[128:131], v[68:71]
    s_add_u32 m0, s31, 0x18400
    s_mov_b32 s28, 0x300400
    buffer_load_dwordx4 v9, s[8:11], s28 offen lds
    v_mfma_f32_16x16x32_bf16 v[84:87], v[148:151], v[132:135], v[84:87]
    ds_read_b128 v[44:47], v2 offset:768
    v_mfma_f32_16x16x32_bf16 v[100:103], v[148:151], v[136:139], v[100:103]
    ds_read_b64_tr_b16 v[48:49], v4 offset:0
    v_mfma_f32_16x16x32_bf16 v[116:119], v[148:151], v[140:143], v[116:119]
    ds_read_b64_tr_b16 v[50:51], v4 offset:512
    v_mfma_f32_16x16x32_bf16 v[72:75], v[152:155], v[128:131], v[72:75]
    s_add_u32 m0, s30, 0x1c000
    s_mov_b32 s28, 0x180000
    buffer_load_dwordx4 v10, s[16:19], s28 offen lds
    v_mfma_f32_16x16x32_bf16 v[88:91], v[152:155], v[132:135], v[88:91]
    ds_read_b64_tr_b16 v[52:53], v5 offset:0
    v_mfma_f32_16x16x32_bf16 v[104:107], v[152:155], v[136:139], v[104:107]
    ds_read_b64_tr_b16 v[54:55], v5 offset:512
    v_mfma_f32_16x16x32_bf16 v[120:123], v[152:155], v[140:143], v[120:123]
    ds_read_b64_tr_b16 v[56:57], v6 offset:0
    v_mfma_f32_16x16x32_bf16 v[76:79], v[156:159], v[128:131], v[76:79]
    s_add_u32 m0, s30, 0x1e000
    s_mov_b32 s28, 0x180080
    buffer_load_dwordx4 v10, s[16:19], s28 offen lds
    v_mfma_f32_16x16x32_bf16 v[92:95], v[156:159], v[132:135], v[92:95]
    ds_read_b64_tr_b16 v[58:59], v6 offset:512
    v_mfma_f32_16x16x32_bf16 v[108:111], v[156:159], v[136:139], v[108:111]
    ds_read_b64_tr_b16 v[60:61], v7 offset:0
    v_mfma_f32_16x16x32_bf16 v[124:127], v[156:159], v[140:143], v[124:127]
    ds_read_b64_tr_b16 v[62:63], v7 offset:512
    s_waitcnt lgkmcnt(0)
    s_waitcnt vmcnt(8)
    s_barrier
    v_mfma_f32_16x16x32_bf16 v[64:67], v[48:51], v[32:35], v[64:67]
    s_add_u32 m0, s31, 0x0
    s_mov_b32 s28, 0x340000
    buffer_load_dwordx4 v9, s[8:11], s28 offen lds
    v_mfma_f32_16x16x32_bf16 v[80:83], v[48:51], v[36:39], v[80:83]
    ds_read_b128 v[128:131], v2 offset:32768
    v_mfma_f32_16x16x32_bf16 v[96:99], v[48:51], v[40:43], v[96:99]
    ds_read_b128 v[132:135], v2 offset:33024
    v_mfma_f32_16x16x32_bf16 v[112:115], v[48:51], v[44:47], v[112:115]
    ds_read_b128 v[136:139], v2 offset:33280
    v_mfma_f32_16x16x32_bf16 v[68:71], v[52:55], v[32:35], v[68:71]
    s_add_u32 m0, s31, 0x400
    s_mov_b32 s28, 0x340400
    buffer_load_dwordx4 v9, s[8:11], s28 offen lds
    v_mfma_f32_16x16x32_bf16 v[84:87], v[52:55], v[36:39], v[84:87]
    ds_read_b128 v[140:143], v2 offset:33536
    v_mfma_f32_16x16x32_bf16 v[100:103], v[52:55], v[40:43], v[100:103]
    ds_read_b64_tr_b16 v[144:145], v4 offset:32768
    v_mfma_f32_16x16x32_bf16 v[116:119], v[52:55], v[44:47], v[116:119]
    ds_read_b64_tr_b16 v[146:147], v4 offset:33280
    v_mfma_f32_16x16x32_bf16 v[72:75], v[56:59], v[32:35], v[72:75]
    s_add_u32 m0, s30, 0x4000
    s_mov_b32 s28, 0x1a0000
    buffer_load_dwordx4 v10, s[16:19], s28 offen lds
    v_mfma_f32_16x16x32_bf16 v[88:91], v[56:59], v[36:39], v[88:91]
    ds_read_b64_tr_b16 v[148:149], v5 offset:32768
    v_mfma_f32_16x16x32_bf16 v[104:107], v[56:59], v[40:43], v[104:107]
    ds_read_b64_tr_b16 v[150:151], v5 offset:33280
    v_mfma_f32_16x16x32_bf16 v[120:123], v[56:59], v[44:47], v[120:123]
    ds_read_b64_tr_b16 v[152:153], v6 offset:32768
    v_mfma_f32_16x16x32_bf16 v[76:79], v[60:63], v[32:35], v[76:79]
    s_add_u32 m0, s30, 0x6000
    s_mov_b32 s28, 0x1a0080
    buffer_load_dwordx4 v10, s[16:19], s28 offen lds
    v_mfma_f32_16x16x32_bf16 v[92:95], v[60:63], v[36:39], v[92:95]
    ds_read_b64_tr_b16 v[154:155], v6 offset:33280
    v_mfma_f32_16x16x32_bf16 v[108:111], v[60:63], v[40:43], v[108:111]
    ds_read_b64_tr_b16 v[156:157], v7 offset:32768
    v_mfma_f32_16x16x32_bf16 v[124:127], v[60:63], v[44:47], v[124:127]
    ds_read_b64_tr_b16 v[158:159], v7 offset:33280
    s_waitcnt lgkmcnt(0)
    s_waitcnt vmcnt(8)
    s_barrier
    v_mfma_f32_16x16x32_bf16 v[64:67], v[144:147], v[128:131], v[64:67]
    s_add_u32 m0, s31, 0x8000
    s_mov_b32 s28, 0x380000
    buffer_load_dwordx4 v9, s[8:11], s28 offen lds
    v_mfma_f32_16x16x32_bf16 v[80:83], v[144:147], v[132:135], v[80:83]
    ds_read_b128 v[32:35], v3 offset:0
    v_mfma_f32_16x16x32_bf16 v[96:99], v[144:147], v[136:139], v[96:99]
    ds_read_b128 v[36:39], v3 offset:256
    v_mfma_f32_16x16x32_bf16 v[112:115], v[144:147], v[140:143], v[112:115]
    ds_read_b128 v[40:43], v3 offset:512
    v_mfma_f32_16x16x32_bf16 v[68:71], v[148:151], v[128:131], v[68:71]
    s_add_u32 m0, s31, 0x8400
    s_mov_b32 s28, 0x380400
    buffer_load_dwordx4 v9, s[8:11], s28 offen lds
    v_mfma_f32_16x16x32_bf16 v[84:87], v[148:151], v[132:135], v[84:87]
    ds_read_b128 v[44:47], v3 offset:768
    v_mfma_f32_16x16x32_bf16 v[100:103], v[148:151], v[136:139], v[100:103]
    ds_read_b64_tr_b16 v[48:49], v240 offset:0
    v_mfma_f32_16x16x32_bf16 v[116:119], v[148:151], v[140:143], v[116:119]
    ds_read_b64_tr_b16 v[50:51], v240 offset:512
    v_mfma_f32_16x16x32_bf16 v[72:75], v[152:155], v[128:131], v[72:75]
    s_add_u32 m0, s30, 0xc000
    s_mov_b32 s28, 0x1c0000
    buffer_load_dwordx4 v10, s[16:19], s28 offen lds
    v_mfma_f32_16x16x32_bf16 v[88:91], v[152:155], v[132:135], v[88:91]
    ds_read_b64_tr_b16 v[52:53], v241 offset:0
    v_mfma_f32_16x16x32_bf16 v[104:107], v[152:155], v[136:139], v[104:107]
    ds_read_b64_tr_b16 v[54:55], v241 offset:512
    v_mfma_f32_16x16x32_bf16 v[120:123], v[152:155], v[140:143], v[120:123]
    ds_read_b64_tr_b16 v[56:57], v242 offset:0
    v_mfma_f32_16x16x32_bf16 v[76:79], v[156:159], v[128:131], v[76:79]
    s_add_u32 m0, s30, 0xe000
    s_mov_b32 s28, 0x1c0080
    buffer_load_dwordx4 v10, s[16:19], s28 offen lds
    v_mfma_f32_16x16x32_bf16 v[92:95], v[156:159], v[132:135], v[92:95]
    ds_read_b64_tr_b16 v[58:59], v242 offset:512
    v_mfma_f32_16x16x32_bf16 v[108:111], v[156:159], v[136:139], v[108:111]
    ds_read_b64_tr_b16 v[60:61], v243 offset:0
    v_mfma_f32_16x16x32_bf16 v[124:127], v[156:159], v[140:143], v[124:127]
    ds_read_b64_tr_b16 v[62:63], v243 offset:512
    s_waitcnt lgkmcnt(0)
    s_waitcnt vmcnt(8)
    s_barrier
    v_mfma_f32_16x16x32_bf16 v[64:67], v[48:51], v[32:35], v[64:67]
    s_add_u32 m0, s31, 0x10000
    s_mov_b32 s28, 0x3c0000
    buffer_load_dwordx4 v9, s[8:11], s28 offen lds
    v_mfma_f32_16x16x32_bf16 v[80:83], v[48:51], v[36:39], v[80:83]
    ds_read_b128 v[128:131], v3 offset:32768
    v_mfma_f32_16x16x32_bf16 v[96:99], v[48:51], v[40:43], v[96:99]
    ds_read_b128 v[132:135], v3 offset:33024
    v_mfma_f32_16x16x32_bf16 v[112:115], v[48:51], v[44:47], v[112:115]
    ds_read_b128 v[136:139], v3 offset:33280
    v_mfma_f32_16x16x32_bf16 v[68:71], v[52:55], v[32:35], v[68:71]
    s_add_u32 m0, s31, 0x10400
    s_mov_b32 s28, 0x3c0400
    buffer_load_dwordx4 v9, s[8:11], s28 offen lds
    v_mfma_f32_16x16x32_bf16 v[84:87], v[52:55], v[36:39], v[84:87]
    ds_read_b128 v[140:143], v3 offset:33536
    v_mfma_f32_16x16x32_bf16 v[100:103], v[52:55], v[40:43], v[100:103]
    ds_read_b64_tr_b16 v[144:145], v240 offset:32768
    v_mfma_f32_16x16x32_bf16 v[116:119], v[52:55], v[44:47], v[116:119]
    ds_read_b64_tr_b16 v[146:147], v240 offset:33280
    v_mfma_f32_16x16x32_bf16 v[72:75], v[56:59], v[32:35], v[72:75]
    s_add_u32 m0, s30, 0x14000
    s_mov_b32 s28, 0x1e0000
    buffer_load_dwordx4 v10, s[16:19], s28 offen lds
    v_mfma_f32_16x16x32_bf16 v[88:91], v[56:59], v[36:39], v[88:91]
    ds_read_b64_tr_b16 v[148:149], v241 offset:32768
    v_mfma_f32_16x16x32_bf16 v[104:107], v[56:59], v[40:43], v[104:107]
    ds_read_b64_tr_b16 v[150:151], v241 offset:33280
    v_mfma_f32_16x16x32_bf16 v[120:123], v[56:59], v[44:47], v[120:123]
    ds_read_b64_tr_b16 v[152:153], v242 offset:32768
    v_mfma_f32_16x16x32_bf16 v[76:79], v[60:63], v[32:35], v[76:79]
    s_add_u32 m0, s30, 0x16000
    s_mov_b32 s28, 0x1e0080
    buffer_load_dwordx4 v10, s[16:19], s28 offen lds
    v_mfma_f32_16x16x32_bf16 v[92:95], v[60:63], v[36:39], v[92:95]
    ds_read_b64_tr_b16 v[154:155], v242 offset:33280
    v_mfma_f32_16x16x32_bf16 v[108:111], v[60:63], v[40:43], v[108:111]
    ds_read_b64_tr_b16 v[156:157], v243 offset:32768
    v_mfma_f32_16x16x32_bf16 v[124:127], v[60:63], v[44:47], v[124:127]
    ds_read_b64_tr_b16 v[158:159], v243 offset:33280
    s_waitcnt lgkmcnt(0)
    s_waitcnt vmcnt(8)
    s_barrier
    v_mfma_f32_16x16x32_bf16 v[64:67], v[144:147], v[128:131], v[64:67]
    ds_read_b128 v[32:35], v2 offset:0
    v_mfma_f32_16x16x32_bf16 v[80:83], v[144:147], v[132:135], v[80:83]
    ds_read_b128 v[36:39], v2 offset:256
    v_mfma_f32_16x16x32_bf16 v[96:99], v[144:147], v[136:139], v[96:99]
    ds_read_b128 v[40:43], v2 offset:512
    v_mfma_f32_16x16x32_bf16 v[112:115], v[144:147], v[140:143], v[112:115]
    ds_read_b128 v[44:47], v2 offset:768
    v_mfma_f32_16x16x32_bf16 v[68:71], v[148:151], v[128:131], v[68:71]
    ds_read_b64_tr_b16 v[48:49], v4 offset:0
    v_mfma_f32_16x16x32_bf16 v[84:87], v[148:151], v[132:135], v[84:87]
    ds_read_b64_tr_b16 v[50:51], v4 offset:512
    v_mfma_f32_16x16x32_bf16 v[100:103], v[148:151], v[136:139], v[100:103]
    ds_read_b64_tr_b16 v[52:53], v5 offset:0
    v_mfma_f32_16x16x32_bf16 v[116:119], v[148:151], v[140:143], v[116:119]
    ds_read_b64_tr_b16 v[54:55], v5 offset:512
    v_mfma_f32_16x16x32_bf16 v[72:75], v[152:155], v[128:131], v[72:75]
    ds_read_b64_tr_b16 v[56:57], v6 offset:0
    v_mfma_f32_16x16x32_bf16 v[88:91], v[152:155], v[132:135], v[88:91]
    ds_read_b64_tr_b16 v[58:59], v6 offset:512
    v_mfma_f32_16x16x32_bf16 v[104:107], v[152:155], v[136:139], v[104:107]
    ds_read_b64_tr_b16 v[60:61], v7 offset:0
    v_mfma_f32_16x16x32_bf16 v[120:123], v[152:155], v[140:143], v[120:123]
    ds_read_b64_tr_b16 v[62:63], v7 offset:512
    v_mfma_f32_16x16x32_bf16 v[76:79], v[156:159], v[128:131], v[76:79]
    v_mfma_f32_16x16x32_bf16 v[92:95], v[156:159], v[132:135], v[92:95]
    v_mfma_f32_16x16x32_bf16 v[108:111], v[156:159], v[136:139], v[108:111]
    v_mfma_f32_16x16x32_bf16 v[124:127], v[156:159], v[140:143], v[124:127]
    s_waitcnt lgkmcnt(0)
    s_waitcnt vmcnt(4)
    s_barrier
    v_mfma_f32_16x16x32_bf16 v[64:67], v[48:51], v[32:35], v[64:67]
    ds_read_b128 v[128:131], v2 offset:32768
    v_mfma_f32_16x16x32_bf16 v[80:83], v[48:51], v[36:39], v[80:83]
    ds_read_b128 v[132:135], v2 offset:33024
    v_mfma_f32_16x16x32_bf16 v[96:99], v[48:51], v[40:43], v[96:99]
    ds_read_b128 v[136:139], v2 offset:33280
    v_mfma_f32_16x16x32_bf16 v[112:115], v[48:51], v[44:47], v[112:115]
    ds_read_b128 v[140:143], v2 offset:33536
    v_mfma_f32_16x16x32_bf16 v[68:71], v[52:55], v[32:35], v[68:71]
    ds_read_b64_tr_b16 v[144:145], v4 offset:32768
    v_mfma_f32_16x16x32_bf16 v[84:87], v[52:55], v[36:39], v[84:87]
    ds_read_b64_tr_b16 v[146:147], v4 offset:33280
    v_mfma_f32_16x16x32_bf16 v[100:103], v[52:55], v[40:43], v[100:103]
    ds_read_b64_tr_b16 v[148:149], v5 offset:32768
    v_mfma_f32_16x16x32_bf16 v[116:119], v[52:55], v[44:47], v[116:119]
    ds_read_b64_tr_b16 v[150:151], v5 offset:33280
    v_mfma_f32_16x16x32_bf16 v[72:75], v[56:59], v[32:35], v[72:75]
    ds_read_b64_tr_b16 v[152:153], v6 offset:32768
    v_mfma_f32_16x16x32_bf16 v[88:91], v[56:59], v[36:39], v[88:91]
    ds_read_b64_tr_b16 v[154:155], v6 offset:33280
    v_mfma_f32_16x16x32_bf16 v[104:107], v[56:59], v[40:43], v[104:107]
    ds_read_b64_tr_b16 v[156:157], v7 offset:32768
    v_mfma_f32_16x16x32_bf16 v[120:123], v[56:59], v[44:47], v[120:123]
    ds_read_b64_tr_b16 v[158:159], v7 offset:33280
    v_mfma_f32_16x16x32_bf16 v[76:79], v[60:63], v[32:35], v[76:79]
    v_mfma_f32_16x16x32_bf16 v[92:95], v[60:63], v[36:39], v[92:95]
    v_mfma_f32_16x16x32_bf16 v[108:111], v[60:63], v[40:43], v[108:111]
    v_mfma_f32_16x16x32_bf16 v[124:127], v[60:63], v[44:47], v[124:127]
    s_waitcnt lgkmcnt(0)
    s_waitcnt vmcnt(0)
    s_barrier
    v_mfma_f32_16x16x32_bf16 v[64:67], v[144:147], v[128:131], v[64:67]
    ds_read_b128 v[32:35], v3 offset:0
    v_mfma_f32_16x16x32_bf16 v[80:83], v[144:147], v[132:135], v[80:83]
    ds_read_b128 v[36:39], v3 offset:256
    v_mfma_f32_16x16x32_bf16 v[96:99], v[144:147], v[136:139], v[96:99]
    ds_read_b128 v[40:43], v3 offset:512
    v_mfma_f32_16x16x32_bf16 v[112:115], v[144:147], v[140:143], v[112:115]
    ds_read_b128 v[44:47], v3 offset:768
    v_mfma_f32_16x16x32_bf16 v[68:71], v[148:151], v[128:131], v[68:71]
    ds_read_b64_tr_b16 v[48:49], v240 offset:0
    v_mfma_f32_16x16x32_bf16 v[84:87], v[148:151], v[132:135], v[84:87]
    ds_read_b64_tr_b16 v[50:51], v240 offset:512
    v_mfma_f32_16x16x32_bf16 v[100:103], v[148:151], v[136:139], v[100:103]
    ds_read_b64_tr_b16 v[52:53], v241 offset:0
    v_mfma_f32_16x16x32_bf16 v[116:119], v[148:151], v[140:143], v[116:119]
    ds_read_b64_tr_b16 v[54:55], v241 offset:512
    v_mfma_f32_16x16x32_bf16 v[72:75], v[152:155], v[128:131], v[72:75]
    ds_read_b64_tr_b16 v[56:57], v242 offset:0
    v_mfma_f32_16x16x32_bf16 v[88:91], v[152:155], v[132:135], v[88:91]
    ds_read_b64_tr_b16 v[58:59], v242 offset:512
    v_mfma_f32_16x16x32_bf16 v[104:107], v[152:155], v[136:139], v[104:107]
    ds_read_b64_tr_b16 v[60:61], v243 offset:0
    v_mfma_f32_16x16x32_bf16 v[120:123], v[152:155], v[140:143], v[120:123]
    ds_read_b64_tr_b16 v[62:63], v243 offset:512
    v_mfma_f32_16x16x32_bf16 v[76:79], v[156:159], v[128:131], v[76:79]
    v_mfma_f32_16x16x32_bf16 v[92:95], v[156:159], v[132:135], v[92:95]
    v_mfma_f32_16x16x32_bf16 v[108:111], v[156:159], v[136:139], v[108:111]
    v_mfma_f32_16x16x32_bf16 v[124:127], v[156:159], v[140:143], v[124:127]
    s_waitcnt lgkmcnt(0)
    s_barrier
    v_mfma_f32_16x16x32_bf16 v[64:67], v[48:51], v[32:35], v[64:67]
    v_mfma_f32_16x16x32_bf16 v[80:83], v[48:51], v[36:39], v[80:83]
    v_mfma_f32_16x16x32_bf16 v[96:99], v[48:51], v[40:43], v[96:99]
    v_mfma_f32_16x16x32_bf16 v[112:115], v[48:51], v[44:47], v[112:115]
    v_mfma_f32_16x16x32_bf16 v[68:71], v[52:55], v[32:35], v[68:71]
    v_mfma_f32_16x16x32_bf16 v[84:87], v[52:55], v[36:39], v[84:87]
    v_mfma_f32_16x16x32_bf16 v[100:103], v[52:55], v[40:43], v[100:103]
    v_mfma_f32_16x16x32_bf16 v[116:119], v[52:55], v[44:47], v[116:119]
    v_mfma_f32_16x16x32_bf16 v[72:75], v[56:59], v[32:35], v[72:75]
    v_mfma_f32_16x16x32_bf16 v[88:91], v[56:59], v[36:39], v[88:91]
    v_mfma_f32_16x16x32_bf16 v[104:107], v[56:59], v[40:43], v[104:107]
    v_mfma_f32_16x16x32_bf16 v[120:123], v[56:59], v[44:47], v[120:123]
    v_mfma_f32_16x16x32_bf16 v[76:79], v[60:63], v[32:35], v[76:79]
    v_mfma_f32_16x16x32_bf16 v[92:95], v[60:63], v[36:39], v[92:95]
    v_mfma_f32_16x16x32_bf16 v[108:111], v[60:63], v[40:43], v[108:111]
    v_mfma_f32_16x16x32_bf16 v[124:127], v[60:63], v[44:47], v[124:127]
    s_waitcnt lgkmcnt(0)
    s_branch g2_tail
g2_hi:
    s_add_u32 m0, s30, 0x4000
    s_mov_b32 s28, 0x0
    buffer_load_dwordx4 v10, s[12:15], s28 offen lds
    s_add_u32 m0, s30, 0x6000
    s_mov_b32 s28, 0x80
    buffer_load_dwordx4 v10, s[12:15], s28 offen lds
    s_add_u32 m0, s30, 0xc000
    s_mov_b32 s28, 0x20000
    buffer_load_dwordx4 v10, s[12:15], s28 offen lds
    s_add_u32 m0, s30, 0xe000
    s_mov_b32 s28, 0x20080
    buffer_load_dwordx4 v10, s[12:15], s28 offen lds
    s_add_u32 m0, s30, 0x14000
    s_mov_b32 s28, 0x40000
    buffer_load_dwordx4 v10, s[12:15], s28 offen lds
    s_add_u32 m0, s30, 0x16000
    s_mov_b32 s28, 0x40080
    buffer_load_dwordx4 v10, s[12:15], s28 offen lds
    s_add_u32 m0, s30, 0x1c000
    s_mov_b32 s28, 0x60000
    buffer_load_dwordx4 v10, s[12:15], s28 offen lds
    s_add_u32 m0, s30, 0x1e000
    s_mov_b32 s28, 0x60080
    buffer_load_dwordx4 v10, s[12:15], s28 offen lds
    s_lshr_b32 s67, s24, 1
    s_lshl_b32 s67, s67, 1
    s_add_u32 s67, s67, 0
    s_lshl_b32 s67, s67, 7
    v_mov_b32 v31, 0
g12_phhi:
    buffer_load_dword v1, v31, s[36:39], s67 offen sc1
    s_waitcnt vmcnt(0)
    v_readfirstlane_b32 s34, v1
    s_nop 1
    s_nop 3
    s_cmp_ge_u32 s34, 12
    s_cbranch_scc1 g12_phhiok
    s_sleep 2
    s_branch g12_phhi
g12_phhiok:
    s_add_u32 m0, s31, 0x0
    s_mov_b32 s28, 0x400000
    buffer_load_dwordx4 v9, s[8:11], s28 offen lds
    s_add_u32 m0, s31, 0x400
    s_mov_b32 s28, 0x400400
    buffer_load_dwordx4 v9, s[8:11], s28 offen lds
    s_add_u32 m0, s31, 0x8000
    s_mov_b32 s28, 0x440000
    buffer_load_dwordx4 v9, s[8:11], s28 offen lds
    s_add_u32 m0, s31, 0x8400
    s_mov_b32 s28, 0x440400
    buffer_load_dwordx4 v9, s[8:11], s28 offen lds
    s_add_u32 m0, s31, 0x10000
    s_mov_b32 s28, 0x480000
    buffer_load_dwordx4 v9, s[8:11], s28 offen lds
    s_add_u32 m0, s31, 0x10400
    s_mov_b32 s28, 0x480400
    buffer_load_dwordx4 v9, s[8:11], s28 offen lds
    s_add_u32 m0, s31, 0x18000
    s_mov_b32 s28, 0x4c0000
    buffer_load_dwordx4 v9, s[8:11], s28 offen lds
    s_add_u32 m0, s31, 0x18400
    s_mov_b32 s28, 0x4c0400
    buffer_load_dwordx4 v9, s[8:11], s28 offen lds
    s_lshl_b32 s28, s22, 2
    v_add_u32 v17, s28, v15
    v_lshlrev_b32 v17, 11, v17
    v_lshl_add_u32 v17, v16, 4, v17
    s_lshl_b32 s28, s21, 10
    v_add_u32 v2, s28, v17
    v_add_u32 v3, 0x10000, v2
    v_lshrrev_b32 v17, 2, v16
    v_lshl_add_u32 v18, v15, 3, v17
    s_lshl_b32 s28, s22, 5
    v_add_u32 v18, s28, v18
    v_lshrrev_b32 v19, 1, v17
    v_and_b32 v20, 1, v15
    v_lshl_or_b32 v19, v20, 1, v19
    v_and_b32 v21, 3, v14
    v_lshlrev_b32 v21, 3, v21
    v_lshl_add_u32 v22, v18, 7, v21
    s_lshl_b32 s28, s23, 13
    s_add_u32 s28, s28, 16384
    v_add_u32 v22, s28, v22
    v_xor_b32 v23, 0, v19
    v_lshl_add_u32 v4, v23, 5, v22
    v_add_u32 v240, 0x10000, v4
    v_xor_b32 v23, 1, v19
    v_lshl_add_u32 v5, v23, 5, v22
    v_add_u32 v241, 0x10000, v5
    v_xor_b32 v23, 2, v19
    v_lshl_add_u32 v6, v23, 5, v22
    v_add_u32 v242, 0x10000, v6
    v_xor_b32 v23, 3, v19
    v_lshl_add_u32 v7, v23, 5, v22
    v_add_u32 v243, 0x10000, v7
    s_add_u32 s88, s4, 0x2b00000
    s_addc_u32 s89, s5, 0
    s_and_b32 s89, s89, 0xffff
    s_mov_b32 s90, 0x400
    s_mov_b32 s91, 0x00020000
    s_mov_b32 s36, s58
    s_mov_b32 s37, s59
    s_and_b32 s37, s37, 0xffff
    s_mov_b32 s38, 0x800
    s_mov_b32 s39, 0x00020000
    s_mov_b32 s40, s60
    s_mov_b32 s41, s61
    s_and_b32 s41, s41, 0xffff
    s_mov_b32 s42, 0x400000
    s_mov_b32 s43, 0x00020000
    s_mov_b32 s44, s62
    s_mov_b32 s45, s63
    s_and_b32 s45, s45, 0xffff
    s_mov_b32 s46, 0x400000
    s_mov_b32 s47, 0x00020000
    s_add_u32 s48, s4, 0x2200000
    s_addc_u32 s49, s5, 0
    s_and_b32 s49, s49, 0xffff
    s_mov_b32 s50, 0x800000
    s_mov_b32 s51, 0x00020000
    s_add_u32 s52, s4, 0x2a00000
    s_addc_u32 s53, s5, 0
    s_and_b32 s53, s53, 0xffff
    s_mov_b32 s54, 0x20000
    s_mov_b32 s55, 0x00020000
    v_mov_b32 v64, 0
    v_mov_b32 v65, 0
    v_mov_b32 v66, 0
    v_mov_b32 v67, 0
    v_mov_b32 v68, 0
    v_mov_b32 v69, 0
    v_mov_b32 v70, 0
    v_mov_b32 v71, 0
    v_mov_b32 v72, 0
    v_mov_b32 v73, 0
    v_mov_b32 v74, 0
    v_mov_b32 v75, 0
    v_mov_b32 v76, 0
    v_mov_b32 v77, 0
    v_mov_b32 v78, 0
    v_mov_b32 v79, 0
    v_mov_b32 v80, 0
    v_mov_b32 v81, 0
    v_mov_b32 v82, 0
    v_mov_b32 v83, 0
    v_mov_b32 v84, 0
    v_mov_b32 v85, 0
    v_mov_b32 v86, 0
    v_mov_b32 v87, 0
    v_mov_b32 v88, 0
    v_mov_b32 v89, 0
    v_mov_b32 v90, 0
    v_mov_b32 v91, 0
    v_mov_b32 v92, 0
    v_mov_b32 v93, 0
    v_mov_b32 v94, 0
    v_mov_b32 v95, 0
    v_mov_b32 v96, 0
    v_mov_b32 v97, 0
    v_mov_b32 v98, 0
    v_mov_b32 v99, 0
    v_mov_b32 v100, 0
    v_mov_b32 v101, 0
    v_mov_b32 v102, 0
    v_mov_b32 v103, 0
    v_mov_b32 v104, 0
    v_mov_b32 v105, 0
    v_mov_b32 v106, 0
    v_mov_b32 v107, 0
    v_mov_b32 v108, 0
    v_mov_b32 v109, 0
    v_mov_b32 v110, 0
    v_mov_b32 v111, 0
    v_mov_b32 v112, 0
    v_mov_b32 v113, 0
    v_mov_b32 v114, 0
    v_mov_b32 v115, 0
    v_mov_b32 v116, 0
    v_mov_b32 v117, 0
    v_mov_b32 v118, 0
    v_mov_b32 v119, 0
    v_mov_b32 v120, 0
    v_mov_b32 v121, 0
    v_mov_b32 v122, 0
    v_mov_b32 v123, 0
    v_mov_b32 v124, 0
    v_mov_b32 v125, 0
    v_mov_b32 v126, 0
    v_mov_b32 v127, 0
    s_waitcnt vmcnt(6)
    s_barrier
    ds_read_b128 v[32:35], v2 offset:0
    ds_read_b128 v[36:39], v2 offset:256
    ds_read_b128 v[40:43], v2 offset:512
    ds_read_b128 v[44:47], v2 offset:768
    ds_read_b64_tr_b16 v[48:49], v4 offset:0
    ds_read_b64_tr_b16 v[50:51], v4 offset:512
    ds_read_b64_tr_b16 v[52:53], v5 offset:0
    ds_read_b64_tr_b16 v[54:55], v5 offset:512
    ds_read_b64_tr_b16 v[56:57], v6 offset:0
    ds_read_b64_tr_b16 v[58:59], v6 offset:512
    ds_read_b64_tr_b16 v[60:61], v7 offset:0
    ds_read_b64_tr_b16 v[62:63], v7 offset:512
    s_waitcnt lgkmcnt(0)
    s_waitcnt vmcnt(4)
    s_barrier
    v_mfma_f32_16x16x32_bf16 v[64:67], v[48:51], v[32:35], v[64:67]
    s_add_u32 m0, s31, 0x0
    s_mov_b32 s28, 0x500000
    buffer_load_dwordx4 v9, s[8:11], s28 offen lds
    v_mfma_f32_16x16x32_bf16 v[80:83], v[48:51], v[36:39], v[80:83]
    ds_read_b128 v[128:131], v2 offset:32768
    v_mfma_f32_16x16x32_bf16 v[96:99], v[48:51], v[40:43], v[96:99]
    ds_read_b128 v[132:135], v2 offset:33024
    v_mfma_f32_16x16x32_bf16 v[112:115], v[48:51], v[44:47], v[112:115]
    ds_read_b128 v[136:139], v2 offset:33280
    v_mfma_f32_16x16x32_bf16 v[68:71], v[52:55], v[32:35], v[68:71]
    s_add_u32 m0, s31, 0x400
    s_mov_b32 s28, 0x500400
    buffer_load_dwordx4 v9, s[8:11], s28 offen lds
    v_mfma_f32_16x16x32_bf16 v[84:87], v[52:55], v[36:39], v[84:87]
    ds_read_b128 v[140:143], v2 offset:33536
    v_mfma_f32_16x16x32_bf16 v[100:103], v[52:55], v[40:43], v[100:103]
    ds_read_b64_tr_b16 v[144:145], v4 offset:32768
    v_mfma_f32_16x16x32_bf16 v[116:119], v[52:55], v[44:47], v[116:119]
    ds_read_b64_tr_b16 v[146:147], v4 offset:33280
    v_mfma_f32_16x16x32_bf16 v[72:75], v[56:59], v[32:35], v[72:75]
    s_add_u32 m0, s30, 0x4000
    s_mov_b32 s28, 0x80000
    buffer_load_dwordx4 v10, s[12:15], s28 offen lds
    v_mfma_f32_16x16x32_bf16 v[88:91], v[56:59], v[36:39], v[88:91]
    ds_read_b64_tr_b16 v[148:149], v5 offset:32768
    v_mfma_f32_16x16x32_bf16 v[104:107], v[56:59], v[40:43], v[104:107]
    ds_read_b64_tr_b16 v[150:151], v5 offset:33280
    v_mfma_f32_16x16x32_bf16 v[120:123], v[56:59], v[44:47], v[120:123]
    ds_read_b64_tr_b16 v[152:153], v6 offset:32768
    v_mfma_f32_16x16x32_bf16 v[76:79], v[60:63], v[32:35], v[76:79]
    s_add_u32 m0, s30, 0x6000
    s_mov_b32 s28, 0x80080
    buffer_load_dwordx4 v10, s[12:15], s28 offen lds
    v_mfma_f32_16x16x32_bf16 v[92:95], v[60:63], v[36:39], v[92:95]
    ds_read_b64_tr_b16 v[154:155], v6 offset:33280
    v_mfma_f32_16x16x32_bf16 v[108:111], v[60:63], v[40:43], v[108:111]
    ds_read_b64_tr_b16 v[156:157], v7 offset:32768
    v_mfma_f32_16x16x32_bf16 v[124:127], v[60:63], v[44:47], v[124:127]
    ds_read_b64_tr_b16 v[158:159], v7 offset:33280
    s_waitcnt lgkmcnt(0)
    s_waitcnt vmcnt(6)
    s_barrier
    v_mfma_f32_16x16x32_bf16 v[64:67], v[144:147], v[128:131], v[64:67]
    s_add_u32 m0, s31, 0x8000
    s_mov_b32 s28, 0x540000
    buffer_load_dwordx4 v9, s[8:11], s28 offen lds
    v_mfma_f32_16x16x32_bf16 v[80:83], v[144:147], v[132:135], v[80:83]
    ds_read_b128 v[32:35], v3 offset:0
    v_mfma_f32_16x16x32_bf16 v[96:99], v[144:147], v[136:139], v[96:99]
    ds_read_b128 v[36:39], v3 offset:256
    v_mfma_f32_16x16x32_bf16 v[112:115], v[144:147], v[140:143], v[112:115]
    ds_read_b128 v[40:43], v3 offset:512
    v_mfma_f32_16x16x32_bf16 v[68:71], v[148:151], v[128:131], v[68:71]
    s_add_u32 m0, s31, 0x8400
    s_mov_b32 s28, 0x540400
    buffer_load_dwordx4 v9, s[8:11], s28 offen lds
    v_mfma_f32_16x16x32_bf16 v[84:87], v[148:151], v[132:135], v[84:87]
    ds_read_b128 v[44:47], v3 offset:768
    v_mfma_f32_16x16x32_bf16 v[100:103], v[148:151], v[136:139], v[100:103]
    ds_read_b64_tr_b16 v[48:49], v240 offset:0
    v_mfma_f32_16x16x32_bf16 v[116:119], v[148:151], v[140:143], v[116:119]
    ds_read_b64_tr_b16 v[50:51], v240 offset:512
    v_mfma_f32_16x16x32_bf16 v[72:75], v[152:155], v[128:131], v[72:75]
    s_add_u32 m0, s30, 0xc000
    s_mov_b32 s28, 0xa0000
    buffer_load_dwordx4 v10, s[12:15], s28 offen lds
    v_mfma_f32_16x16x32_bf16 v[88:91], v[152:155], v[132:135], v[88:91]
    ds_read_b64_tr_b16 v[52:53], v241 offset:0
    v_mfma_f32_16x16x32_bf16 v[104:107], v[152:155], v[136:139], v[104:107]
    ds_read_b64_tr_b16 v[54:55], v241 offset:512
    v_mfma_f32_16x16x32_bf16 v[120:123], v[152:155], v[140:143], v[120:123]
    ds_read_b64_tr_b16 v[56:57], v242 offset:0
    v_mfma_f32_16x16x32_bf16 v[76:79], v[156:159], v[128:131], v[76:79]
    s_add_u32 m0, s30, 0xe000
    s_mov_b32 s28, 0xa0080
    buffer_load_dwordx4 v10, s[12:15], s28 offen lds
    v_mfma_f32_16x16x32_bf16 v[92:95], v[156:159], v[132:135], v[92:95]
    ds_read_b64_tr_b16 v[58:59], v242 offset:512
    v_mfma_f32_16x16x32_bf16 v[108:111], v[156:159], v[136:139], v[108:111]
    ds_read_b64_tr_b16 v[60:61], v243 offset:0
    v_mfma_f32_16x16x32_bf16 v[124:127], v[156:159], v[140:143], v[124:127]
    ds_read_b64_tr_b16 v[62:63], v243 offset:512
    s_waitcnt lgkmcnt(0)
    s_waitcnt vmcnt(8)
    s_barrier
    v_mfma_f32_16x16x32_bf16 v[64:67], v[48:51], v[32:35], v[64:67]
    s_add_u32 m0, s31, 0x10000
    s_mov_b32 s28, 0x580000
    buffer_load_dwordx4 v9, s[8:11], s28 offen lds
    v_mfma_f32_16x16x32_bf16 v[80:83], v[48:51], v[36:39], v[80:83]
    ds_read_b128 v[128:131], v3 offset:32768
    v_mfma_f32_16x16x32_bf16 v[96:99], v[48:51], v[40:43], v[96:99]
    ds_read_b128 v[132:135], v3 offset:33024
    v_mfma_f32_16x16x32_bf16 v[112:115], v[48:51], v[44:47], v[112:115]
    ds_read_b128 v[136:139], v3 offset:33280
    v_mfma_f32_16x16x32_bf16 v[68:71], v[52:55], v[32:35], v[68:71]
    s_add_u32 m0, s31, 0x10400
    s_mov_b32 s28, 0x580400
    buffer_load_dwordx4 v9, s[8:11], s28 offen lds
    v_mfma_f32_16x16x32_bf16 v[84:87], v[52:55], v[36:39], v[84:87]
    ds_read_b128 v[140:143], v3 offset:33536
    v_mfma_f32_16x16x32_bf16 v[100:103], v[52:55], v[40:43], v[100:103]
    ds_read_b64_tr_b16 v[144:145], v240 offset:32768
    v_mfma_f32_16x16x32_bf16 v[116:119], v[52:55], v[44:47], v[116:119]
    ds_read_b64_tr_b16 v[146:147], v240 offset:33280
    v_mfma_f32_16x16x32_bf16 v[72:75], v[56:59], v[32:35], v[72:75]
    s_add_u32 m0, s30, 0x14000
    s_mov_b32 s28, 0xc0000
    buffer_load_dwordx4 v10, s[12:15], s28 offen lds
    v_mfma_f32_16x16x32_bf16 v[88:91], v[56:59], v[36:39], v[88:91]
    ds_read_b64_tr_b16 v[148:149], v241 offset:32768
    v_mfma_f32_16x16x32_bf16 v[104:107], v[56:59], v[40:43], v[104:107]
    ds_read_b64_tr_b16 v[150:151], v241 offset:33280
    v_mfma_f32_16x16x32_bf16 v[120:123], v[56:59], v[44:47], v[120:123]
    ds_read_b64_tr_b16 v[152:153], v242 offset:32768
    v_mfma_f32_16x16x32_bf16 v[76:79], v[60:63], v[32:35], v[76:79]
    s_add_u32 m0, s30, 0x16000
    s_mov_b32 s28, 0xc0080
    buffer_load_dwordx4 v10, s[12:15], s28 offen lds
    v_mfma_f32_16x16x32_bf16 v[92:95], v[60:63], v[36:39], v[92:95]
    ds_read_b64_tr_b16 v[154:155], v242 offset:33280
    v_mfma_f32_16x16x32_bf16 v[108:111], v[60:63], v[40:43], v[108:111]
    ds_read_b64_tr_b16 v[156:157], v243 offset:32768
    v_mfma_f32_16x16x32_bf16 v[124:127], v[60:63], v[44:47], v[124:127]
    ds_read_b64_tr_b16 v[158:159], v243 offset:33280
    s_waitcnt lgkmcnt(0)
    s_waitcnt vmcnt(8)
    s_barrier
    v_mfma_f32_16x16x32_bf16 v[64:67], v[144:147], v[128:131], v[64:67]
    s_add_u32 m0, s31, 0x18000
    s_mov_b32 s28, 0x5c0000
    buffer_load_dwordx4 v9, s[8:11], s28 offen lds
    v_mfma_f32_16x16x32_bf16 v[80:83], v[144:147], v[132:135], v[80:83]
    ds_read_b128 v[32:35], v2 offset:0
    v_mfma_f32_16x16x32_bf16 v[96:99], v[144:147], v[136:139], v[96:99]
    ds_read_b128 v[36:39], v2 offset:256
    v_mfma_f32_16x16x32_bf16 v[112:115], v[144:147], v[140:143], v[112:115]
    ds_read_b128 v[40:43], v2 offset:512
    v_mfma_f32_16x16x32_bf16 v[68:71], v[148:151], v[128:131], v[68:71]
    s_add_u32 m0, s31, 0x18400
    s_mov_b32 s28, 0x5c0400
    buffer_load_dwordx4 v9, s[8:11], s28 offen lds
    v_mfma_f32_16x16x32_bf16 v[84:87], v[148:151], v[132:135], v[84:87]
    ds_read_b128 v[44:47], v2 offset:768
    v_mfma_f32_16x16x32_bf16 v[100:103], v[148:151], v[136:139], v[100:103]
    ds_read_b64_tr_b16 v[48:49], v4 offset:0
    v_mfma_f32_16x16x32_bf16 v[116:119], v[148:151], v[140:143], v[116:119]
    ds_read_b64_tr_b16 v[50:51], v4 offset:512
    v_mfma_f32_16x16x32_bf16 v[72:75], v[152:155], v[128:131], v[72:75]
    s_add_u32 m0, s30, 0x1c000
    s_mov_b32 s28, 0xe0000
    buffer_load_dwordx4 v10, s[12:15], s28 offen lds
    v_mfma_f32_16x16x32_bf16 v[88:91], v[152:155], v[132:135], v[88:91]
    ds_read_b64_tr_b16 v[52:53], v5 offset:0
    v_mfma_f32_16x16x32_bf16 v[104:107], v[152:155], v[136:139], v[104:107]
    ds_read_b64_tr_b16 v[54:55], v5 offset:512
    v_mfma_f32_16x16x32_bf16 v[120:123], v[152:155], v[140:143], v[120:123]
    ds_read_b64_tr_b16 v[56:57], v6 offset:0
    v_mfma_f32_16x16x32_bf16 v[76:79], v[156:159], v[128:131], v[76:79]
    s_add_u32 m0, s30, 0x1e000
    s_mov_b32 s28, 0xe0080
    buffer_load_dwordx4 v10, s[12:15], s28 offen lds
    v_mfma_f32_16x16x32_bf16 v[92:95], v[156:159], v[132:135], v[92:95]
    ds_read_b64_tr_b16 v[58:59], v6 offset:512
    v_mfma_f32_16x16x32_bf16 v[108:111], v[156:159], v[136:139], v[108:111]
    ds_read_b64_tr_b16 v[60:61], v7 offset:0
    v_mfma_f32_16x16x32_bf16 v[124:127], v[156:159], v[140:143], v[124:127]
    ds_read_b64_tr_b16 v[62:63], v7 offset:512
    s_waitcnt lgkmcnt(0)
    s_waitcnt vmcnt(8)
    s_barrier
    v_mfma_f32_16x16x32_bf16 v[64:67], v[48:51], v[32:35], v[64:67]
    s_add_u32 m0, s31, 0x0
    s_mov_b32 s28, 0x600000
    buffer_load_dwordx4 v9, s[8:11], s28 offen lds
    v_mfma_f32_16x16x32_bf16 v[80:83], v[48:51], v[36:39], v[80:83]
    ds_read_b128 v[128:131], v2 offset:32768
    v_mfma_f32_16x16x32_bf16 v[96:99], v[48:51], v[40:43], v[96:99]
    ds_read_b128 v[132:135], v2 offset:33024
    v_mfma_f32_16x16x32_bf16 v[112:115], v[48:51], v[44:47], v[112:115]
    ds_read_b128 v[136:139], v2 offset:33280
    v_mfma_f32_16x16x32_bf16 v[68:71], v[52:55], v[32:35], v[68:71]
    s_add_u32 m0, s31, 0x400
    s_mov_b32 s28, 0x600400
    buffer_load_dwordx4 v9, s[8:11], s28 offen lds
    v_mfma_f32_16x16x32_bf16 v[84:87], v[52:55], v[36:39], v[84:87]
    ds_read_b128 v[140:143], v2 offset:33536
    v_mfma_f32_16x16x32_bf16 v[100:103], v[52:55], v[40:43], v[100:103]
    ds_read_b64_tr_b16 v[144:145], v4 offset:32768
    v_mfma_f32_16x16x32_bf16 v[116:119], v[52:55], v[44:47], v[116:119]
    ds_read_b64_tr_b16 v[146:147], v4 offset:33280
    v_mfma_f32_16x16x32_bf16 v[72:75], v[56:59], v[32:35], v[72:75]
    s_add_u32 m0, s30, 0x4000
    s_mov_b32 s28, 0x100000
    buffer_load_dwordx4 v10, s[12:15], s28 offen lds
    v_mfma_f32_16x16x32_bf16 v[88:91], v[56:59], v[36:39], v[88:91]
    ds_read_b64_tr_b16 v[148:149], v5 offset:32768
    v_mfma_f32_16x16x32_bf16 v[104:107], v[56:59], v[40:43], v[104:107]
    ds_read_b64_tr_b16 v[150:151], v5 offset:33280
    v_mfma_f32_16x16x32_bf16 v[120:123], v[56:59], v[44:47], v[120:123]
    ds_read_b64_tr_b16 v[152:153], v6 offset:32768
    v_mfma_f32_16x16x32_bf16 v[76:79], v[60:63], v[32:35], v[76:79]
    s_add_u32 m0, s30, 0x6000
    s_mov_b32 s28, 0x100080
    buffer_load_dwordx4 v10, s[12:15], s28 offen lds
    v_mfma_f32_16x16x32_bf16 v[92:95], v[60:63], v[36:39], v[92:95]
    ds_read_b64_tr_b16 v[154:155], v6 offset:33280
    v_mfma_f32_16x16x32_bf16 v[108:111], v[60:63], v[40:43], v[108:111]
    ds_read_b64_tr_b16 v[156:157], v7 offset:32768
    v_mfma_f32_16x16x32_bf16 v[124:127], v[60:63], v[44:47], v[124:127]
    ds_read_b64_tr_b16 v[158:159], v7 offset:33280
    s_waitcnt lgkmcnt(0)
    s_waitcnt vmcnt(8)
    s_barrier
    v_mfma_f32_16x16x32_bf16 v[64:67], v[144:147], v[128:131], v[64:67]
    s_add_u32 m0, s31, 0x8000
    s_mov_b32 s28, 0x640000
    buffer_load_dwordx4 v9, s[8:11], s28 offen lds
    v_mfma_f32_16x16x32_bf16 v[80:83], v[144:147], v[132:135], v[80:83]
    ds_read_b128 v[32:35], v3 offset:0
    v_mfma_f32_16x16x32_bf16 v[96:99], v[144:147], v[136:139], v[96:99]
    ds_read_b128 v[36:39], v3 offset:256
    v_mfma_f32_16x16x32_bf16 v[112:115], v[144:147], v[140:143], v[112:115]
    ds_read_b128 v[40:43], v3 offset:512
    v_mfma_f32_16x16x32_bf16 v[68:71], v[148:151], v[128:131], v[68:71]
    s_add_u32 m0, s31, 0x8400
    s_mov_b32 s28, 0x640400
    buffer_load_dwordx4 v9, s[8:11], s28 offen lds
    v_mfma_f32_16x16x32_bf16 v[84:87], v[148:151], v[132:135], v[84:87]
    ds_read_b128 v[44:47], v3 offset:768
    v_mfma_f32_16x16x32_bf16 v[100:103], v[148:151], v[136:139], v[100:103]
    ds_read_b64_tr_b16 v[48:49], v240 offset:0
    v_mfma_f32_16x16x32_bf16 v[116:119], v[148:151], v[140:143], v[116:119]
    ds_read_b64_tr_b16 v[50:51], v240 offset:512
    v_mfma_f32_16x16x32_bf16 v[72:75], v[152:155], v[128:131], v[72:75]
    s_add_u32 m0, s30, 0xc000
    s_mov_b32 s28, 0x120000
    buffer_load_dwordx4 v10, s[12:15], s28 offen lds
    v_mfma_f32_16x16x32_bf16 v[88:91], v[152:155], v[132:135], v[88:91]
    ds_read_b64_tr_b16 v[52:53], v241 offset:0
    v_mfma_f32_16x16x32_bf16 v[104:107], v[152:155], v[136:139], v[104:107]
    ds_read_b64_tr_b16 v[54:55], v241 offset:512
    v_mfma_f32_16x16x32_bf16 v[120:123], v[152:155], v[140:143], v[120:123]
    ds_read_b64_tr_b16 v[56:57], v242 offset:0
    v_mfma_f32_16x16x32_bf16 v[76:79], v[156:159], v[128:131], v[76:79]
    s_add_u32 m0, s30, 0xe000
    s_mov_b32 s28, 0x120080
    buffer_load_dwordx4 v10, s[12:15], s28 offen lds
    v_mfma_f32_16x16x32_bf16 v[92:95], v[156:159], v[132:135], v[92:95]
    ds_read_b64_tr_b16 v[58:59], v242 offset:512
    v_mfma_f32_16x16x32_bf16 v[108:111], v[156:159], v[136:139], v[108:111]
    ds_read_b64_tr_b16 v[60:61], v243 offset:0
    v_mfma_f32_16x16x32_bf16 v[124:127], v[156:159], v[140:143], v[124:127]
    ds_read_b64_tr_b16 v[62:63], v243 offset:512
    s_waitcnt lgkmcnt(0)
    s_waitcnt vmcnt(8)
    s_barrier
    v_mfma_f32_16x16x32_bf16 v[64:67], v[48:51], v[32:35], v[64:67]
    s_add_u32 m0, s31, 0x10000
    s_mov_b32 s28, 0x680000
    buffer_load_dwordx4 v9, s[8:11], s28 offen lds
    v_mfma_f32_16x16x32_bf16 v[80:83], v[48:51], v[36:39], v[80:83]
    ds_read_b128 v[128:131], v3 offset:32768
    v_mfma_f32_16x16x32_bf16 v[96:99], v[48:51], v[40:43], v[96:99]
    ds_read_b128 v[132:135], v3 offset:33024
    v_mfma_f32_16x16x32_bf16 v[112:115], v[48:51], v[44:47], v[112:115]
    ds_read_b128 v[136:139], v3 offset:33280
    v_mfma_f32_16x16x32_bf16 v[68:71], v[52:55], v[32:35], v[68:71]
    s_add_u32 m0, s31, 0x10400
    s_mov_b32 s28, 0x680400
    buffer_load_dwordx4 v9, s[8:11], s28 offen lds
    v_mfma_f32_16x16x32_bf16 v[84:87], v[52:55], v[36:39], v[84:87]
    ds_read_b128 v[140:143], v3 offset:33536
    v_mfma_f32_16x16x32_bf16 v[100:103], v[52:55], v[40:43], v[100:103]
    ds_read_b64_tr_b16 v[144:145], v240 offset:32768
    v_mfma_f32_16x16x32_bf16 v[116:119], v[52:55], v[44:47], v[116:119]
    ds_read_b64_tr_b16 v[146:147], v240 offset:33280
    v_mfma_f32_16x16x32_bf16 v[72:75], v[56:59], v[32:35], v[72:75]
    s_add_u32 m0, s30, 0x14000
    s_mov_b32 s28, 0x140000
    buffer_load_dwordx4 v10, s[12:15], s28 offen lds
    v_mfma_f32_16x16x32_bf16 v[88:91], v[56:59], v[36:39], v[88:91]
    ds_read_b64_tr_b16 v[148:149], v241 offset:32768
    v_mfma_f32_16x16x32_bf16 v[104:107], v[56:59], v[40:43], v[104:107]
    ds_read_b64_tr_b16 v[150:151], v241 offset:33280
    v_mfma_f32_16x16x32_bf16 v[120:123], v[56:59], v[44:47], v[120:123]
    ds_read_b64_tr_b16 v[152:153], v242 offset:32768
    v_mfma_f32_16x16x32_bf16 v[76:79], v[60:63], v[32:35], v[76:79]
    s_add_u32 m0, s30, 0x16000
    s_mov_b32 s28, 0x140080
    buffer_load_dwordx4 v10, s[12:15], s28 offen lds
    v_mfma_f32_16x16x32_bf16 v[92:95], v[60:63], v[36:39], v[92:95]
    ds_read_b64_tr_b16 v[154:155], v242 offset:33280
    v_mfma_f32_16x16x32_bf16 v[108:111], v[60:63], v[40:43], v[108:111]
    ds_read_b64_tr_b16 v[156:157], v243 offset:32768
    v_mfma_f32_16x16x32_bf16 v[124:127], v[60:63], v[44:47], v[124:127]
    ds_read_b64_tr_b16 v[158:159], v243 offset:33280
    s_waitcnt lgkmcnt(0)
    s_waitcnt vmcnt(8)
    s_barrier
    v_mfma_f32_16x16x32_bf16 v[64:67], v[144:147], v[128:131], v[64:67]
    s_add_u32 m0, s31, 0x18000
    s_mov_b32 s28, 0x6c0000
    buffer_load_dwordx4 v9, s[8:11], s28 offen lds
    v_mfma_f32_16x16x32_bf16 v[80:83], v[144:147], v[132:135], v[80:83]
    ds_read_b128 v[32:35], v2 offset:0
    v_mfma_f32_16x16x32_bf16 v[96:99], v[144:147], v[136:139], v[96:99]
    ds_read_b128 v[36:39], v2 offset:256
    v_mfma_f32_16x16x32_bf16 v[112:115], v[144:147], v[140:143], v[112:115]
    ds_read_b128 v[40:43], v2 offset:512
    v_mfma_f32_16x16x32_bf16 v[68:71], v[148:151], v[128:131], v[68:71]
    s_add_u32 m0, s31, 0x18400
    s_mov_b32 s28, 0x6c0400
    buffer_load_dwordx4 v9, s[8:11], s28 offen lds
    v_mfma_f32_16x16x32_bf16 v[84:87], v[148:151], v[132:135], v[84:87]
    ds_read_b128 v[44:47], v2 offset:768
    v_mfma_f32_16x16x32_bf16 v[100:103], v[148:151], v[136:139], v[100:103]
    ds_read_b64_tr_b16 v[48:49], v4 offset:0
    v_mfma_f32_16x16x32_bf16 v[116:119], v[148:151], v[140:143], v[116:119]
    ds_read_b64_tr_b16 v[50:51], v4 offset:512
    v_mfma_f32_16x16x32_bf16 v[72:75], v[152:155], v[128:131], v[72:75]
    s_add_u32 m0, s30, 0x1c000
    s_mov_b32 s28, 0x160000
    buffer_load_dwordx4 v10, s[12:15], s28 offen lds
    v_mfma_f32_16x16x32_bf16 v[88:91], v[152:155], v[132:135], v[88:91]
    ds_read_b64_tr_b16 v[52:53], v5 offset:0
    v_mfma_f32_16x16x32_bf16 v[104:107], v[152:155], v[136:139], v[104:107]
    ds_read_b64_tr_b16 v[54:55], v5 offset:512
    v_mfma_f32_16x16x32_bf16 v[120:123], v[152:155], v[140:143], v[120:123]
    ds_read_b64_tr_b16 v[56:57], v6 offset:0
    v_mfma_f32_16x16x32_bf16 v[76:79], v[156:159], v[128:131], v[76:79]
    s_add_u32 m0, s30, 0x1e000
    s_mov_b32 s28, 0x160080
    buffer_load_dwordx4 v10, s[12:15], s28 offen lds
    v_mfma_f32_16x16x32_bf16 v[92:95], v[156:159], v[132:135], v[92:95]
    ds_read_b64_tr_b16 v[58:59], v6 offset:512
    v_mfma_f32_16x16x32_bf16 v[108:111], v[156:159], v[136:139], v[108:111]
    ds_read_b64_tr_b16 v[60:61], v7 offset:0
    v_mfma_f32_16x16x32_bf16 v[124:127], v[156:159], v[140:143], v[124:127]
    ds_read_b64_tr_b16 v[62:63], v7 offset:512
    s_waitcnt lgkmcnt(0)
    s_waitcnt vmcnt(8)
    s_barrier
    v_mfma_f32_16x16x32_bf16 v[64:67], v[48:51], v[32:35], v[64:67]
    s_add_u32 m0, s31, 0x0
    s_mov_b32 s28, 0x700000
    buffer_load_dwordx4 v9, s[8:11], s28 offen lds
    v_mfma_f32_16x16x32_bf16 v[80:83], v[48:51], v[36:39], v[80:83]
    ds_read_b128 v[128:131], v2 offset:32768
    v_mfma_f32_16x16x32_bf16 v[96:99], v[48:51], v[40:43], v[96:99]
    ds_read_b128 v[132:135], v2 offset:33024
    v_mfma_f32_16x16x32_bf16 v[112:115], v[48:51], v[44:47], v[112:115]
    ds_read_b128 v[136:139], v2 offset:33280
    v_mfma_f32_16x16x32_bf16 v[68:71], v[52:55], v[32:35], v[68:71]
    s_add_u32 m0, s31, 0x400
    s_mov_b32 s28, 0x700400
    buffer_load_dwordx4 v9, s[8:11], s28 offen lds
    v_mfma_f32_16x16x32_bf16 v[84:87], v[52:55], v[36:39], v[84:87]
    ds_read_b128 v[140:143], v2 offset:33536
    v_mfma_f32_16x16x32_bf16 v[100:103], v[52:55], v[40:43], v[100:103]
    ds_read_b64_tr_b16 v[144:145], v4 offset:32768
    v_mfma_f32_16x16x32_bf16 v[116:119], v[52:55], v[44:47], v[116:119]
    ds_read_b64_tr_b16 v[146:147], v4 offset:33280
    v_mfma_f32_16x16x32_bf16 v[72:75], v[56:59], v[32:35], v[72:75]
    s_add_u32 m0, s30, 0x4000
    s_mov_b32 s28, 0x180000
    buffer_load_dwordx4 v10, s[12:15], s28 offen lds
    v_mfma_f32_16x16x32_bf16 v[88:91], v[56:59], v[36:39], v[88:91]
    ds_read_b64_tr_b16 v[148:149], v5 offset:32768
    v_mfma_f32_16x16x32_bf16 v[104:107], v[56:59], v[40:43], v[104:107]
    ds_read_b64_tr_b16 v[150:151], v5 offset:33280
    v_mfma_f32_16x16x32_bf16 v[120:123], v[56:59], v[44:47], v[120:123]
    ds_read_b64_tr_b16 v[152:153], v6 offset:32768
    v_mfma_f32_16x16x32_bf16 v[76:79], v[60:63], v[32:35], v[76:79]
    s_add_u32 m0, s30, 0x6000
    s_mov_b32 s28, 0x180080
    buffer_load_dwordx4 v10, s[12:15], s28 offen lds
    v_mfma_f32_16x16x32_bf16 v[92:95], v[60:63], v[36:39], v[92:95]
    ds_read_b64_tr_b16 v[154:155], v6 offset:33280
    v_mfma_f32_16x16x32_bf16 v[108:111], v[60:63], v[40:43], v[108:111]
    ds_read_b64_tr_b16 v[156:157], v7 offset:32768
    v_mfma_f32_16x16x32_bf16 v[124:127], v[60:63], v[44:47], v[124:127]
    ds_read_b64_tr_b16 v[158:159], v7 offset:33280
    s_waitcnt lgkmcnt(0)
    s_waitcnt vmcnt(8)
    s_barrier
    v_mfma_f32_16x16x32_bf16 v[64:67], v[144:147], v[128:131], v[64:67]
    s_add_u32 m0, s31, 0x8000
    s_mov_b32 s28, 0x740000
    buffer_load_dwordx4 v9, s[8:11], s28 offen lds
    v_mfma_f32_16x16x32_bf16 v[80:83], v[144:147], v[132:135], v[80:83]
    ds_read_b128 v[32:35], v3 offset:0
    v_mfma_f32_16x16x32_bf16 v[96:99], v[144:147], v[136:139], v[96:99]
    ds_read_b128 v[36:39], v3 offset:256
    v_mfma_f32_16x16x32_bf16 v[112:115], v[144:147], v[140:143], v[112:115]
    ds_read_b128 v[40:43], v3 offset:512
    v_mfma_f32_16x16x32_bf16 v[68:71], v[148:151], v[128:131], v[68:71]
    s_add_u32 m0, s31, 0x8400
    s_mov_b32 s28, 0x740400
    buffer_load_dwordx4 v9, s[8:11], s28 offen lds
    v_mfma_f32_16x16x32_bf16 v[84:87], v[148:151], v[132:135], v[84:87]
    ds_read_b128 v[44:47], v3 offset:768
    v_mfma_f32_16x16x32_bf16 v[100:103], v[148:151], v[136:139], v[100:103]
    ds_read_b64_tr_b16 v[48:49], v240 offset:0
    v_mfma_f32_16x16x32_bf16 v[116:119], v[148:151], v[140:143], v[116:119]
    ds_read_b64_tr_b16 v[50:51], v240 offset:512
    v_mfma_f32_16x16x32_bf16 v[72:75], v[152:155], v[128:131], v[72:75]
    s_add_u32 m0, s30, 0xc000
    s_mov_b32 s28, 0x1a0000
    buffer_load_dwordx4 v10, s[12:15], s28 offen lds
    v_mfma_f32_16x16x32_bf16 v[88:91], v[152:155], v[132:135], v[88:91]
    ds_read_b64_tr_b16 v[52:53], v241 offset:0
    v_mfma_f32_16x16x32_bf16 v[104:107], v[152:155], v[136:139], v[104:107]
    ds_read_b64_tr_b16 v[54:55], v241 offset:512
    v_mfma_f32_16x16x32_bf16 v[120:123], v[152:155], v[140:143], v[120:123]
    ds_read_b64_tr_b16 v[56:57], v242 offset:0
    v_mfma_f32_16x16x32_bf16 v[76:79], v[156:159], v[128:131], v[76:79]
    s_add_u32 m0, s30, 0xe000
    s_mov_b32 s28, 0x1a0080
    buffer_load_dwordx4 v10, s[12:15], s28 offen lds
    v_mfma_f32_16x16x32_bf16 v[92:95], v[156:159], v[132:135], v[92:95]
    ds_read_b64_tr_b16 v[58:59], v242 offset:512
    v_mfma_f32_16x16x32_bf16 v[108:111], v[156:159], v[136:139], v[108:111]
    ds_read_b64_tr_b16 v[60:61], v243 offset:0
    v_mfma_f32_16x16x32_bf16 v[124:127], v[156:159], v[140:143], v[124:127]
    ds_read_b64_tr_b16 v[62:63], v243 offset:512
    s_waitcnt lgkmcnt(0)
    s_waitcnt vmcnt(8)
    s_barrier
    v_mfma_f32_16x16x32_bf16 v[64:67], v[48:51], v[32:35], v[64:67]
    s_add_u32 m0, s31, 0x10000
    s_mov_b32 s28, 0x780000
    buffer_load_dwordx4 v9, s[8:11], s28 offen lds
    v_mfma_f32_16x16x32_bf16 v[80:83], v[48:51], v[36:39], v[80:83]
    ds_read_b128 v[128:131], v3 offset:32768
    v_mfma_f32_16x16x32_bf16 v[96:99], v[48:51], v[40:43], v[96:99]
    ds_read_b128 v[132:135], v3 offset:33024
    v_mfma_f32_16x16x32_bf16 v[112:115], v[48:51], v[44:47], v[112:115]
    ds_read_b128 v[136:139], v3 offset:33280
    v_mfma_f32_16x16x32_bf16 v[68:71], v[52:55], v[32:35], v[68:71]
    s_add_u32 m0, s31, 0x10400
    s_mov_b32 s28, 0x780400
    buffer_load_dwordx4 v9, s[8:11], s28 offen lds
    v_mfma_f32_16x16x32_bf16 v[84:87], v[52:55], v[36:39], v[84:87]
    ds_read_b128 v[140:143], v3 offset:33536
    v_mfma_f32_16x16x32_bf16 v[100:103], v[52:55], v[40:43], v[100:103]
    ds_read_b64_tr_b16 v[144:145], v240 offset:32768
    v_mfma_f32_16x16x32_bf16 v[116:119], v[52:55], v[44:47], v[116:119]
    ds_read_b64_tr_b16 v[146:147], v240 offset:33280
    v_mfma_f32_16x16x32_bf16 v[72:75], v[56:59], v[32:35], v[72:75]
    s_add_u32 m0, s30, 0x14000
    s_mov_b32 s28, 0x1c0000
    buffer_load_dwordx4 v10, s[12:15], s28 offen lds
    v_mfma_f32_16x16x32_bf16 v[88:91], v[56:59], v[36:39], v[88:91]
    ds_read_b64_tr_b16 v[148:149], v241 offset:32768
    v_mfma_f32_16x16x32_bf16 v[104:107], v[56:59], v[40:43], v[104:107]
    ds_read_b64_tr_b16 v[150:151], v241 offset:33280
    v_mfma_f32_16x16x32_bf16 v[120:123], v[56:59], v[44:47], v[120:123]
    ds_read_b64_tr_b16 v[152:153], v242 offset:32768
    v_mfma_f32_16x16x32_bf16 v[76:79], v[60:63], v[32:35], v[76:79]
    s_add_u32 m0, s30, 0x16000
    s_mov_b32 s28, 0x1c0080
    buffer_load_dwordx4 v10, s[12:15], s28 offen lds
    v_mfma_f32_16x16x32_bf16 v[92:95], v[60:63], v[36:39], v[92:95]
    ds_read_b64_tr_b16 v[154:155], v242 offset:33280
    v_mfma_f32_16x16x32_bf16 v[108:111], v[60:63], v[40:43], v[108:111]
    ds_read_b64_tr_b16 v[156:157], v243 offset:32768
    v_mfma_f32_16x16x32_bf16 v[124:127], v[60:63], v[44:47], v[124:127]
    ds_read_b64_tr_b16 v[158:159], v243 offset:33280
    s_waitcnt lgkmcnt(0)
    s_waitcnt vmcnt(8)
    s_barrier
    v_mfma_f32_16x16x32_bf16 v[64:67], v[144:147], v[128:131], v[64:67]
    s_add_u32 m0, s31, 0x18000
    s_mov_b32 s28, 0x7c0000
    buffer_load_dwordx4 v9, s[8:11], s28 offen lds
    v_mfma_f32_16x16x32_bf16 v[80:83], v[144:147], v[132:135], v[80:83]
    ds_read_b128 v[32:35], v2 offset:0
    v_mfma_f32_16x16x32_bf16 v[96:99], v[144:147], v[136:139], v[96:99]
    ds_read_b128 v[36:39], v2 offset:256
    v_mfma_f32_16x16x32_bf16 v[112:115], v[144:147], v[140:143], v[112:115]
    ds_read_b128 v[40:43], v2 offset:512
    v_mfma_f32_16x16x32_bf16 v[68:71], v[148:151], v[128:131], v[68:71]
    s_add_u32 m0, s31, 0x18400
    s_mov_b32 s28, 0x7c0400
    buffer_load_dwordx4 v9, s[8:11], s28 offen lds
    v_mfma_f32_16x16x32_bf16 v[84:87], v[148:151], v[132:135], v[84:87]
    ds_read_b128 v[44:47], v2 offset:768
    v_mfma_f32_16x16x32_bf16 v[100:103], v[148:151], v[136:139], v[100:103]
    ds_read_b64_tr_b16 v[48:49], v4 offset:0
    v_mfma_f32_16x16x32_bf16 v[116:119], v[148:151], v[140:143], v[116:119]
    ds_read_b64_tr_b16 v[50:51], v4 offset:512
    v_mfma_f32_16x16x32_bf16 v[72:75], v[152:155], v[128:131], v[72:75]
    s_add_u32 m0, s30, 0x1c000
    s_mov_b32 s28, 0x1e0000
    buffer_load_dwordx4 v10, s[12:15], s28 offen lds
    v_mfma_f32_16x16x32_bf16 v[88:91], v[152:155], v[132:135], v[88:91]
    ds_read_b64_tr_b16 v[52:53], v5 offset:0
    v_mfma_f32_16x16x32_bf16 v[104:107], v[152:155], v[136:139], v[104:107]
    ds_read_b64_tr_b16 v[54:55], v5 offset:512
    v_mfma_f32_16x16x32_bf16 v[120:123], v[152:155], v[140:143], v[120:123]
    ds_read_b64_tr_b16 v[56:57], v6 offset:0
    v_mfma_f32_16x16x32_bf16 v[76:79], v[156:159], v[128:131], v[76:79]
    s_add_u32 m0, s30, 0x1e000
    s_mov_b32 s28, 0x1e0080
    buffer_load_dwordx4 v10, s[12:15], s28 offen lds
    v_mfma_f32_16x16x32_bf16 v[92:95], v[156:159], v[132:135], v[92:95]
    ds_read_b64_tr_b16 v[58:59], v6 offset:512
    v_mfma_f32_16x16x32_bf16 v[108:111], v[156:159], v[136:139], v[108:111]
    ds_read_b64_tr_b16 v[60:61], v7 offset:0
    v_mfma_f32_16x16x32_bf16 v[124:127], v[156:159], v[140:143], v[124:127]
    ds_read_b64_tr_b16 v[62:63], v7 offset:512
    s_waitcnt lgkmcnt(0)
    s_waitcnt vmcnt(8)
    s_barrier
    v_mfma_f32_16x16x32_bf16 v[64:67], v[48:51], v[32:35], v[64:67]
    s_add_u32 m0, s31, 0x0
    s_mov_b32 s28, 0x800000
    buffer_load_dwordx4 v9, s[8:11], s28 offen lds
    v_mfma_f32_16x16x32_bf16 v[80:83], v[48:51], v[36:39], v[80:83]
    ds_read_b128 v[128:131], v2 offset:32768
    v_mfma_f32_16x16x32_bf16 v[96:99], v[48:51], v[40:43], v[96:99]
    ds_read_b128 v[132:135], v2 offset:33024
    v_mfma_f32_16x16x32_bf16 v[112:115], v[48:51], v[44:47], v[112:115]
    ds_read_b128 v[136:139], v2 offset:33280
    v_mfma_f32_16x16x32_bf16 v[68:71], v[52:55], v[32:35], v[68:71]
    s_add_u32 m0, s31, 0x400
    s_mov_b32 s28, 0x800400
    buffer_load_dwordx4 v9, s[8:11], s28 offen lds
    v_mfma_f32_16x16x32_bf16 v[84:87], v[52:55], v[36:39], v[84:87]
    ds_read_b128 v[140:143], v2 offset:33536
    v_mfma_f32_16x16x32_bf16 v[100:103], v[52:55], v[40:43], v[100:103]
    ds_read_b64_tr_b16 v[144:145], v4 offset:32768
    v_mfma_f32_16x16x32_bf16 v[116:119], v[52:55], v[44:47], v[116:119]
    ds_read_b64_tr_b16 v[146:147], v4 offset:33280
    v_mfma_f32_16x16x32_bf16 v[72:75], v[56:59], v[32:35], v[72:75]
    s_add_u32 m0, s30, 0x4000
    s_mov_b32 s28, 0x200000
    buffer_load_dwordx4 v10, s[12:15], s28 offen lds
    v_mfma_f32_16x16x32_bf16 v[88:91], v[56:59], v[36:39], v[88:91]
    ds_read_b64_tr_b16 v[148:149], v5 offset:32768
    v_mfma_f32_16x16x32_bf16 v[104:107], v[56:59], v[40:43], v[104:107]
    ds_read_b64_tr_b16 v[150:151], v5 offset:33280
    v_mfma_f32_16x16x32_bf16 v[120:123], v[56:59], v[44:47], v[120:123]
    ds_read_b64_tr_b16 v[152:153], v6 offset:32768
    v_mfma_f32_16x16x32_bf16 v[76:79], v[60:63], v[32:35], v[76:79]
    s_add_u32 m0, s30, 0x6000
    s_mov_b32 s28, 0x200080
    buffer_load_dwordx4 v10, s[12:15], s28 offen lds
    v_mfma_f32_16x16x32_bf16 v[92:95], v[60:63], v[36:39], v[92:95]
    ds_read_b64_tr_b16 v[154:155], v6 offset:33280
    v_mfma_f32_16x16x32_bf16 v[108:111], v[60:63], v[40:43], v[108:111]
    ds_read_b64_tr_b16 v[156:157], v7 offset:32768
    v_mfma_f32_16x16x32_bf16 v[124:127], v[60:63], v[44:47], v[124:127]
    ds_read_b64_tr_b16 v[158:159], v7 offset:33280
    s_waitcnt lgkmcnt(0)
    s_waitcnt vmcnt(8)
    s_barrier
    v_mfma_f32_16x16x32_bf16 v[64:67], v[144:147], v[128:131], v[64:67]
    s_add_u32 m0, s31, 0x8000
    s_mov_b32 s28, 0x840000
    buffer_load_dwordx4 v9, s[8:11], s28 offen lds
    v_mfma_f32_16x16x32_bf16 v[80:83], v[144:147], v[132:135], v[80:83]
    ds_read_b128 v[32:35], v3 offset:0
    v_mfma_f32_16x16x32_bf16 v[96:99], v[144:147], v[136:139], v[96:99]
    ds_read_b128 v[36:39], v3 offset:256
    v_mfma_f32_16x16x32_bf16 v[112:115], v[144:147], v[140:143], v[112:115]
    ds_read_b128 v[40:43], v3 offset:512
    v_mfma_f32_16x16x32_bf16 v[68:71], v[148:151], v[128:131], v[68:71]
    s_add_u32 m0, s31, 0x8400
    s_mov_b32 s28, 0x840400
    buffer_load_dwordx4 v9, s[8:11], s28 offen lds
    v_mfma_f32_16x16x32_bf16 v[84:87], v[148:151], v[132:135], v[84:87]
    ds_read_b128 v[44:47], v3 offset:768
    v_mfma_f32_16x16x32_bf16 v[100:103], v[148:151], v[136:139], v[100:103]
    ds_read_b64_tr_b16 v[48:49], v240 offset:0
    v_mfma_f32_16x16x32_bf16 v[116:119], v[148:151], v[140:143], v[116:119]
    ds_read_b64_tr_b16 v[50:51], v240 offset:512
    v_mfma_f32_16x16x32_bf16 v[72:75], v[152:155], v[128:131], v[72:75]
    s_add_u32 m0, s30, 0xc000
    s_mov_b32 s28, 0x220000
    buffer_load_dwordx4 v10, s[12:15], s28 offen lds
    v_mfma_f32_16x16x32_bf16 v[88:91], v[152:155], v[132:135], v[88:91]
    ds_read_b64_tr_b16 v[52:53], v241 offset:0
    v_mfma_f32_16x16x32_bf16 v[104:107], v[152:155], v[136:139], v[104:107]
    ds_read_b64_tr_b16 v[54:55], v241 offset:512
    v_mfma_f32_16x16x32_bf16 v[120:123], v[152:155], v[140:143], v[120:123]
    ds_read_b64_tr_b16 v[56:57], v242 offset:0
    v_mfma_f32_16x16x32_bf16 v[76:79], v[156:159], v[128:131], v[76:79]
    s_add_u32 m0, s30, 0xe000
    s_mov_b32 s28, 0x220080
    buffer_load_dwordx4 v10, s[12:15], s28 offen lds
    v_mfma_f32_16x16x32_bf16 v[92:95], v[156:159], v[132:135], v[92:95]
    ds_read_b64_tr_b16 v[58:59], v242 offset:512
    v_mfma_f32_16x16x32_bf16 v[108:111], v[156:159], v[136:139], v[108:111]
    ds_read_b64_tr_b16 v[60:61], v243 offset:0
    v_mfma_f32_16x16x32_bf16 v[124:127], v[156:159], v[140:143], v[124:127]
    ds_read_b64_tr_b16 v[62:63], v243 offset:512
    s_waitcnt lgkmcnt(0)
    s_waitcnt vmcnt(8)
    s_barrier
    v_mfma_f32_16x16x32_bf16 v[64:67], v[48:51], v[32:35], v[64:67]
    s_add_u32 m0, s31, 0x10000
    s_mov_b32 s28, 0x880000
    buffer_load_dwordx4 v9, s[8:11], s28 offen lds
    v_mfma_f32_16x16x32_bf16 v[80:83], v[48:51], v[36:39], v[80:83]
    ds_read_b128 v[128:131], v3 offset:32768
    v_mfma_f32_16x16x32_bf16 v[96:99], v[48:51], v[40:43], v[96:99]
    ds_read_b128 v[132:135], v3 offset:33024
    v_mfma_f32_16x16x32_bf16 v[112:115], v[48:51], v[44:47], v[112:115]
    ds_read_b128 v[136:139], v3 offset:33280
    v_mfma_f32_16x16x32_bf16 v[68:71], v[52:55], v[32:35], v[68:71]
    s_add_u32 m0, s31, 0x10400
    s_mov_b32 s28, 0x880400
    buffer_load_dwordx4 v9, s[8:11], s28 offen lds
    v_mfma_f32_16x16x32_bf16 v[84:87], v[52:55], v[36:39], v[84:87]
    ds_read_b128 v[140:143], v3 offset:33536
    v_mfma_f32_16x16x32_bf16 v[100:103], v[52:55], v[40:43], v[100:103]
    ds_read_b64_tr_b16 v[144:145], v240 offset:32768
    v_mfma_f32_16x16x32_bf16 v[116:119], v[52:55], v[44:47], v[116:119]
    ds_read_b64_tr_b16 v[146:147], v240 offset:33280
    v_mfma_f32_16x16x32_bf16 v[72:75], v[56:59], v[32:35], v[72:75]
    s_add_u32 m0, s30, 0x14000
    s_mov_b32 s28, 0x240000
    buffer_load_dwordx4 v10, s[12:15], s28 offen lds
    v_mfma_f32_16x16x32_bf16 v[88:91], v[56:59], v[36:39], v[88:91]
    ds_read_b64_tr_b16 v[148:149], v241 offset:32768
    v_mfma_f32_16x16x32_bf16 v[104:107], v[56:59], v[40:43], v[104:107]
    ds_read_b64_tr_b16 v[150:151], v241 offset:33280
    v_mfma_f32_16x16x32_bf16 v[120:123], v[56:59], v[44:47], v[120:123]
    ds_read_b64_tr_b16 v[152:153], v242 offset:32768
    v_mfma_f32_16x16x32_bf16 v[76:79], v[60:63], v[32:35], v[76:79]
    s_add_u32 m0, s30, 0x16000
    s_mov_b32 s28, 0x240080
    buffer_load_dwordx4 v10, s[12:15], s28 offen lds
    v_mfma_f32_16x16x32_bf16 v[92:95], v[60:63], v[36:39], v[92:95]
    ds_read_b64_tr_b16 v[154:155], v242 offset:33280
    v_mfma_f32_16x16x32_bf16 v[108:111], v[60:63], v[40:43], v[108:111]
    ds_read_b64_tr_b16 v[156:157], v243 offset:32768
    v_mfma_f32_16x16x32_bf16 v[124:127], v[60:63], v[44:47], v[124:127]
    ds_read_b64_tr_b16 v[158:159], v243 offset:33280
    s_waitcnt lgkmcnt(0)
    s_waitcnt vmcnt(8)
    s_barrier
    v_mfma_f32_16x16x32_bf16 v[64:67], v[144:147], v[128:131], v[64:67]
    s_add_u32 m0, s31, 0x18000
    s_mov_b32 s28, 0x8c0000
    buffer_load_dwordx4 v9, s[8:11], s28 offen lds
    v_mfma_f32_16x16x32_bf16 v[80:83], v[144:147], v[132:135], v[80:83]
    ds_read_b128 v[32:35], v2 offset:0
    v_mfma_f32_16x16x32_bf16 v[96:99], v[144:147], v[136:139], v[96:99]
    ds_read_b128 v[36:39], v2 offset:256
    v_mfma_f32_16x16x32_bf16 v[112:115], v[144:147], v[140:143], v[112:115]
    ds_read_b128 v[40:43], v2 offset:512
    v_mfma_f32_16x16x32_bf16 v[68:71], v[148:151], v[128:131], v[68:71]
    s_add_u32 m0, s31, 0x18400
    s_mov_b32 s28, 0x8c0400
    buffer_load_dwordx4 v9, s[8:11], s28 offen lds
    v_mfma_f32_16x16x32_bf16 v[84:87], v[148:151], v[132:135], v[84:87]
    ds_read_b128 v[44:47], v2 offset:768
    v_mfma_f32_16x16x32_bf16 v[100:103], v[148:151], v[136:139], v[100:103]
    ds_read_b64_tr_b16 v[48:49], v4 offset:0
    v_mfma_f32_16x16x32_bf16 v[116:119], v[148:151], v[140:143], v[116:119]
    ds_read_b64_tr_b16 v[50:51], v4 offset:512
    v_mfma_f32_16x16x32_bf16 v[72:75], v[152:155], v[128:131], v[72:75]
    s_add_u32 m0, s30, 0x1c000
    s_mov_b32 s28, 0x260000
    buffer_load_dwordx4 v10, s[12:15], s28 offen lds
    v_mfma_f32_16x16x32_bf16 v[88:91], v[152:155], v[132:135], v[88:91]
    ds_read_b64_tr_b16 v[52:53], v5 offset:0
    v_mfma_f32_16x16x32_bf16 v[104:107], v[152:155], v[136:139], v[104:107]
    ds_read_b64_tr_b16 v[54:55], v5 offset:512
    v_mfma_f32_16x16x32_bf16 v[120:123], v[152:155], v[140:143], v[120:123]
    ds_read_b64_tr_b16 v[56:57], v6 offset:0
    v_mfma_f32_16x16x32_bf16 v[76:79], v[156:159], v[128:131], v[76:79]
    s_add_u32 m0, s30, 0x1e000
    s_mov_b32 s28, 0x260080
    buffer_load_dwordx4 v10, s[12:15], s28 offen lds
    v_mfma_f32_16x16x32_bf16 v[92:95], v[156:159], v[132:135], v[92:95]
    ds_read_b64_tr_b16 v[58:59], v6 offset:512
    v_mfma_f32_16x16x32_bf16 v[108:111], v[156:159], v[136:139], v[108:111]
    ds_read_b64_tr_b16 v[60:61], v7 offset:0
    v_mfma_f32_16x16x32_bf16 v[124:127], v[156:159], v[140:143], v[124:127]
    ds_read_b64_tr_b16 v[62:63], v7 offset:512
    s_waitcnt lgkmcnt(0)
    s_waitcnt vmcnt(8)
    s_barrier
    v_mfma_f32_16x16x32_bf16 v[64:67], v[48:51], v[32:35], v[64:67]
    s_add_u32 m0, s31, 0x0
    s_mov_b32 s28, 0x900000
    buffer_load_dwordx4 v9, s[8:11], s28 offen lds
    v_mfma_f32_16x16x32_bf16 v[80:83], v[48:51], v[36:39], v[80:83]
    ds_read_b128 v[128:131], v2 offset:32768
    v_mfma_f32_16x16x32_bf16 v[96:99], v[48:51], v[40:43], v[96:99]
    ds_read_b128 v[132:135], v2 offset:33024
    v_mfma_f32_16x16x32_bf16 v[112:115], v[48:51], v[44:47], v[112:115]
    ds_read_b128 v[136:139], v2 offset:33280
    v_mfma_f32_16x16x32_bf16 v[68:71], v[52:55], v[32:35], v[68:71]
    s_add_u32 m0, s31, 0x400
    s_mov_b32 s28, 0x900400
    buffer_load_dwordx4 v9, s[8:11], s28 offen lds
    v_mfma_f32_16x16x32_bf16 v[84:87], v[52:55], v[36:39], v[84:87]
    ds_read_b128 v[140:143], v2 offset:33536
    v_mfma_f32_16x16x32_bf16 v[100:103], v[52:55], v[40:43], v[100:103]
    ds_read_b64_tr_b16 v[144:145], v4 offset:32768
    v_mfma_f32_16x16x32_bf16 v[116:119], v[52:55], v[44:47], v[116:119]
    ds_read_b64_tr_b16 v[146:147], v4 offset:33280
    v_mfma_f32_16x16x32_bf16 v[72:75], v[56:59], v[32:35], v[72:75]
    s_add_u32 m0, s30, 0x4000
    s_mov_b32 s28, 0x280000
    buffer_load_dwordx4 v10, s[12:15], s28 offen lds
    v_mfma_f32_16x16x32_bf16 v[88:91], v[56:59], v[36:39], v[88:91]
    ds_read_b64_tr_b16 v[148:149], v5 offset:32768
    v_mfma_f32_16x16x32_bf16 v[104:107], v[56:59], v[40:43], v[104:107]
    ds_read_b64_tr_b16 v[150:151], v5 offset:33280
    v_mfma_f32_16x16x32_bf16 v[120:123], v[56:59], v[44:47], v[120:123]
    ds_read_b64_tr_b16 v[152:153], v6 offset:32768
    v_mfma_f32_16x16x32_bf16 v[76:79], v[60:63], v[32:35], v[76:79]
    s_add_u32 m0, s30, 0x6000
    s_mov_b32 s28, 0x280080
    buffer_load_dwordx4 v10, s[12:15], s28 offen lds
    v_mfma_f32_16x16x32_bf16 v[92:95], v[60:63], v[36:39], v[92:95]
    ds_read_b64_tr_b16 v[154:155], v6 offset:33280
    v_mfma_f32_16x16x32_bf16 v[108:111], v[60:63], v[40:43], v[108:111]
    ds_read_b64_tr_b16 v[156:157], v7 offset:32768
    v_mfma_f32_16x16x32_bf16 v[124:127], v[60:63], v[44:47], v[124:127]
    ds_read_b64_tr_b16 v[158:159], v7 offset:33280
    s_waitcnt lgkmcnt(0)
    s_waitcnt vmcnt(8)
    s_barrier
    v_mfma_f32_16x16x32_bf16 v[64:67], v[144:147], v[128:131], v[64:67]
    s_add_u32 m0, s31, 0x8000
    s_mov_b32 s28, 0x940000
    buffer_load_dwordx4 v9, s[8:11], s28 offen lds
    v_mfma_f32_16x16x32_bf16 v[80:83], v[144:147], v[132:135], v[80:83]
    ds_read_b128 v[32:35], v3 offset:0
    v_mfma_f32_16x16x32_bf16 v[96:99], v[144:147], v[136:139], v[96:99]
    ds_read_b128 v[36:39], v3 offset:256
    v_mfma_f32_16x16x32_bf16 v[112:115], v[144:147], v[140:143], v[112:115]
    ds_read_b128 v[40:43], v3 offset:512
    v_mfma_f32_16x16x32_bf16 v[68:71], v[148:151], v[128:131], v[68:71]
    s_add_u32 m0, s31, 0x8400
    s_mov_b32 s28, 0x940400
    buffer_load_dwordx4 v9, s[8:11], s28 offen lds
    v_mfma_f32_16x16x32_bf16 v[84:87], v[148:151], v[132:135], v[84:87]
    ds_read_b128 v[44:47], v3 offset:768
    v_mfma_f32_16x16x32_bf16 v[100:103], v[148:151], v[136:139], v[100:103]
    ds_read_b64_tr_b16 v[48:49], v240 offset:0
    v_mfma_f32_16x16x32_bf16 v[116:119], v[148:151], v[140:143], v[116:119]
    ds_read_b64_tr_b16 v[50:51], v240 offset:512
    v_mfma_f32_16x16x32_bf16 v[72:75], v[152:155], v[128:131], v[72:75]
    s_add_u32 m0, s30, 0xc000
    s_mov_b32 s28, 0x2a0000
    buffer_load_dwordx4 v10, s[12:15], s28 offen lds
    v_mfma_f32_16x16x32_bf16 v[88:91], v[152:155], v[132:135], v[88:91]
    ds_read_b64_tr_b16 v[52:53], v241 offset:0
    v_mfma_f32_16x16x32_bf16 v[104:107], v[152:155], v[136:139], v[104:107]
    ds_read_b64_tr_b16 v[54:55], v241 offset:512
    v_mfma_f32_16x16x32_bf16 v[120:123], v[152:155], v[140:143], v[120:123]
    ds_read_b64_tr_b16 v[56:57], v242 offset:0
    v_mfma_f32_16x16x32_bf16 v[76:79], v[156:159], v[128:131], v[76:79]
    s_add_u32 m0, s30, 0xe000
    s_mov_b32 s28, 0x2a0080
    buffer_load_dwordx4 v10, s[12:15], s28 offen lds
    v_mfma_f32_16x16x32_bf16 v[92:95], v[156:159], v[132:135], v[92:95]
    ds_read_b64_tr_b16 v[58:59], v242 offset:512
    v_mfma_f32_16x16x32_bf16 v[108:111], v[156:159], v[136:139], v[108:111]
    ds_read_b64_tr_b16 v[60:61], v243 offset:0
    v_mfma_f32_16x16x32_bf16 v[124:127], v[156:159], v[140:143], v[124:127]
    ds_read_b64_tr_b16 v[62:63], v243 offset:512
    s_waitcnt lgkmcnt(0)
    s_waitcnt vmcnt(8)
    s_barrier
    v_mfma_f32_16x16x32_bf16 v[64:67], v[48:51], v[32:35], v[64:67]
    s_add_u32 m0, s31, 0x10000
    s_mov_b32 s28, 0x980000
    buffer_load_dwordx4 v9, s[8:11], s28 offen lds
    v_mfma_f32_16x16x32_bf16 v[80:83], v[48:51], v[36:39], v[80:83]
    ds_read_b128 v[128:131], v3 offset:32768
    v_mfma_f32_16x16x32_bf16 v[96:99], v[48:51], v[40:43], v[96:99]
    ds_read_b128 v[132:135], v3 offset:33024
    v_mfma_f32_16x16x32_bf16 v[112:115], v[48:51], v[44:47], v[112:115]
    ds_read_b128 v[136:139], v3 offset:33280
    v_mfma_f32_16x16x32_bf16 v[68:71], v[52:55], v[32:35], v[68:71]
    s_add_u32 m0, s31, 0x10400
    s_mov_b32 s28, 0x980400
    buffer_load_dwordx4 v9, s[8:11], s28 offen lds
    v_mfma_f32_16x16x32_bf16 v[84:87], v[52:55], v[36:39], v[84:87]
    ds_read_b128 v[140:143], v3 offset:33536
    v_mfma_f32_16x16x32_bf16 v[100:103], v[52:55], v[40:43], v[100:103]
    ds_read_b64_tr_b16 v[144:145], v240 offset:32768
    v_mfma_f32_16x16x32_bf16 v[116:119], v[52:55], v[44:47], v[116:119]
    ds_read_b64_tr_b16 v[146:147], v240 offset:33280
    v_mfma_f32_16x16x32_bf16 v[72:75], v[56:59], v[32:35], v[72:75]
    s_add_u32 m0, s30, 0x14000
    s_mov_b32 s28, 0x2c0000
    buffer_load_dwordx4 v10, s[12:15], s28 offen lds
    v_mfma_f32_16x16x32_bf16 v[88:91], v[56:59], v[36:39], v[88:91]
    ds_read_b64_tr_b16 v[148:149], v241 offset:32768
    v_mfma_f32_16x16x32_bf16 v[104:107], v[56:59], v[40:43], v[104:107]
    ds_read_b64_tr_b16 v[150:151], v241 offset:33280
    v_mfma_f32_16x16x32_bf16 v[120:123], v[56:59], v[44:47], v[120:123]
    ds_read_b64_tr_b16 v[152:153], v242 offset:32768
    v_mfma_f32_16x16x32_bf16 v[76:79], v[60:63], v[32:35], v[76:79]
    s_add_u32 m0, s30, 0x16000
    s_mov_b32 s28, 0x2c0080
    buffer_load_dwordx4 v10, s[12:15], s28 offen lds
    v_mfma_f32_16x16x32_bf16 v[92:95], v[60:63], v[36:39], v[92:95]
    ds_read_b64_tr_b16 v[154:155], v242 offset:33280
    v_mfma_f32_16x16x32_bf16 v[108:111], v[60:63], v[40:43], v[108:111]
    ds_read_b64_tr_b16 v[156:157], v243 offset:32768
    v_mfma_f32_16x16x32_bf16 v[124:127], v[60:63], v[44:47], v[124:127]
    ds_read_b64_tr_b16 v[158:159], v243 offset:33280
    s_waitcnt lgkmcnt(0)
    s_waitcnt vmcnt(8)
    s_barrier
    v_mfma_f32_16x16x32_bf16 v[64:67], v[144:147], v[128:131], v[64:67]
    s_add_u32 m0, s31, 0x18000
    s_mov_b32 s28, 0x9c0000
    buffer_load_dwordx4 v9, s[8:11], s28 offen lds
    v_mfma_f32_16x16x32_bf16 v[80:83], v[144:147], v[132:135], v[80:83]
    ds_read_b128 v[32:35], v2 offset:0
    v_mfma_f32_16x16x32_bf16 v[96:99], v[144:147], v[136:139], v[96:99]
    ds_read_b128 v[36:39], v2 offset:256
    v_mfma_f32_16x16x32_bf16 v[112:115], v[144:147], v[140:143], v[112:115]
    ds_read_b128 v[40:43], v2 offset:512
    v_mfma_f32_16x16x32_bf16 v[68:71], v[148:151], v[128:131], v[68:71]
    s_add_u32 m0, s31, 0x18400
    s_mov_b32 s28, 0x9c0400
    buffer_load_dwordx4 v9, s[8:11], s28 offen lds
    v_mfma_f32_16x16x32_bf16 v[84:87], v[148:151], v[132:135], v[84:87]
    ds_read_b128 v[44:47], v2 offset:768
    v_mfma_f32_16x16x32_bf16 v[100:103], v[148:151], v[136:139], v[100:103]
    ds_read_b64_tr_b16 v[48:49], v4 offset:0
    v_mfma_f32_16x16x32_bf16 v[116:119], v[148:151], v[140:143], v[116:119]
    ds_read_b64_tr_b16 v[50:51], v4 offset:512
    v_mfma_f32_16x16x32_bf16 v[72:75], v[152:155], v[128:131], v[72:75]
    s_add_u32 m0, s30, 0x1c000
    s_mov_b32 s28, 0x2e0000
    buffer_load_dwordx4 v10, s[12:15], s28 offen lds
    v_mfma_f32_16x16x32_bf16 v[88:91], v[152:155], v[132:135], v[88:91]
    ds_read_b64_tr_b16 v[52:53], v5 offset:0
    v_mfma_f32_16x16x32_bf16 v[104:107], v[152:155], v[136:139], v[104:107]
    ds_read_b64_tr_b16 v[54:55], v5 offset:512
    v_mfma_f32_16x16x32_bf16 v[120:123], v[152:155], v[140:143], v[120:123]
    ds_read_b64_tr_b16 v[56:57], v6 offset:0
    v_mfma_f32_16x16x32_bf16 v[76:79], v[156:159], v[128:131], v[76:79]
    s_add_u32 m0, s30, 0x1e000
    s_mov_b32 s28, 0x2e0080
    buffer_load_dwordx4 v10, s[12:15], s28 offen lds
    v_mfma_f32_16x16x32_bf16 v[92:95], v[156:159], v[132:135], v[92:95]
    ds_read_b64_tr_b16 v[58:59], v6 offset:512
    v_mfma_f32_16x16x32_bf16 v[108:111], v[156:159], v[136:139], v[108:111]
    ds_read_b64_tr_b16 v[60:61], v7 offset:0
    v_mfma_f32_16x16x32_bf16 v[124:127], v[156:159], v[140:143], v[124:127]
    ds_read_b64_tr_b16 v[62:63], v7 offset:512
    s_waitcnt lgkmcnt(0)
    s_waitcnt vmcnt(8)
    s_barrier
    v_mfma_f32_16x16x32_bf16 v[64:67], v[48:51], v[32:35], v[64:67]
    s_add_u32 m0, s31, 0x0
    s_mov_b32 s28, 0xa00000
    buffer_load_dwordx4 v9, s[8:11], s28 offen lds
    v_mfma_f32_16x16x32_bf16 v[80:83], v[48:51], v[36:39], v[80:83]
    ds_read_b128 v[128:131], v2 offset:32768
    v_mfma_f32_16x16x32_bf16 v[96:99], v[48:51], v[40:43], v[96:99]
    ds_read_b128 v[132:135], v2 offset:33024
    v_mfma_f32_16x16x32_bf16 v[112:115], v[48:51], v[44:47], v[112:115]
    ds_read_b128 v[136:139], v2 offset:33280
    v_mfma_f32_16x16x32_bf16 v[68:71], v[52:55], v[32:35], v[68:71]
    s_add_u32 m0, s31, 0x400
    s_mov_b32 s28, 0xa00400
    buffer_load_dwordx4 v9, s[8:11], s28 offen lds
    v_mfma_f32_16x16x32_bf16 v[84:87], v[52:55], v[36:39], v[84:87]
    ds_read_b128 v[140:143], v2 offset:33536
    v_mfma_f32_16x16x32_bf16 v[100:103], v[52:55], v[40:43], v[100:103]
    ds_read_b64_tr_b16 v[144:145], v4 offset:32768
    v_mfma_f32_16x16x32_bf16 v[116:119], v[52:55], v[44:47], v[116:119]
    ds_read_b64_tr_b16 v[146:147], v4 offset:33280
    v_mfma_f32_16x16x32_bf16 v[72:75], v[56:59], v[32:35], v[72:75]
    s_add_u32 m0, s30, 0x4000
    s_mov_b32 s28, 0x300000
    buffer_load_dwordx4 v10, s[12:15], s28 offen lds
    v_mfma_f32_16x16x32_bf16 v[88:91], v[56:59], v[36:39], v[88:91]
    ds_read_b64_tr_b16 v[148:149], v5 offset:32768
    v_mfma_f32_16x16x32_bf16 v[104:107], v[56:59], v[40:43], v[104:107]
    ds_read_b64_tr_b16 v[150:151], v5 offset:33280
    v_mfma_f32_16x16x32_bf16 v[120:123], v[56:59], v[44:47], v[120:123]
    ds_read_b64_tr_b16 v[152:153], v6 offset:32768
    v_mfma_f32_16x16x32_bf16 v[76:79], v[60:63], v[32:35], v[76:79]
    s_add_u32 m0, s30, 0x6000
    s_mov_b32 s28, 0x300080
    buffer_load_dwordx4 v10, s[12:15], s28 offen lds
    v_mfma_f32_16x16x32_bf16 v[92:95], v[60:63], v[36:39], v[92:95]
    ds_read_b64_tr_b16 v[154:155], v6 offset:33280
    v_mfma_f32_16x16x32_bf16 v[108:111], v[60:63], v[40:43], v[108:111]
    ds_read_b64_tr_b16 v[156:157], v7 offset:32768
    v_mfma_f32_16x16x32_bf16 v[124:127], v[60:63], v[44:47], v[124:127]
    ds_read_b64_tr_b16 v[158:159], v7 offset:33280
    s_waitcnt lgkmcnt(0)
    s_waitcnt vmcnt(8)
    s_barrier
    v_mfma_f32_16x16x32_bf16 v[64:67], v[144:147], v[128:131], v[64:67]
    s_add_u32 m0, s31, 0x8000
    s_mov_b32 s28, 0xa40000
    buffer_load_dwordx4 v9, s[8:11], s28 offen lds
    v_mfma_f32_16x16x32_bf16 v[80:83], v[144:147], v[132:135], v[80:83]
    ds_read_b128 v[32:35], v3 offset:0
    v_mfma_f32_16x16x32_bf16 v[96:99], v[144:147], v[136:139], v[96:99]
    ds_read_b128 v[36:39], v3 offset:256
    v_mfma_f32_16x16x32_bf16 v[112:115], v[144:147], v[140:143], v[112:115]
    ds_read_b128 v[40:43], v3 offset:512
    v_mfma_f32_16x16x32_bf16 v[68:71], v[148:151], v[128:131], v[68:71]
    s_add_u32 m0, s31, 0x8400
    s_mov_b32 s28, 0xa40400
    buffer_load_dwordx4 v9, s[8:11], s28 offen lds
    v_mfma_f32_16x16x32_bf16 v[84:87], v[148:151], v[132:135], v[84:87]
    ds_read_b128 v[44:47], v3 offset:768
    v_mfma_f32_16x16x32_bf16 v[100:103], v[148:151], v[136:139], v[100:103]
    ds_read_b64_tr_b16 v[48:49], v240 offset:0
    v_mfma_f32_16x16x32_bf16 v[116:119], v[148:151], v[140:143], v[116:119]
    ds_read_b64_tr_b16 v[50:51], v240 offset:512
    v_mfma_f32_16x16x32_bf16 v[72:75], v[152:155], v[128:131], v[72:75]
    s_add_u32 m0, s30, 0xc000
    s_mov_b32 s28, 0x320000
    buffer_load_dwordx4 v10, s[12:15], s28 offen lds
    v_mfma_f32_16x16x32_bf16 v[88:91], v[152:155], v[132:135], v[88:91]
    ds_read_b64_tr_b16 v[52:53], v241 offset:0
    v_mfma_f32_16x16x32_bf16 v[104:107], v[152:155], v[136:139], v[104:107]
    ds_read_b64_tr_b16 v[54:55], v241 offset:512
    v_mfma_f32_16x16x32_bf16 v[120:123], v[152:155], v[140:143], v[120:123]
    ds_read_b64_tr_b16 v[56:57], v242 offset:0
    v_mfma_f32_16x16x32_bf16 v[76:79], v[156:159], v[128:131], v[76:79]
    s_add_u32 m0, s30, 0xe000
    s_mov_b32 s28, 0x320080
    buffer_load_dwordx4 v10, s[12:15], s28 offen lds
    v_mfma_f32_16x16x32_bf16 v[92:95], v[156:159], v[132:135], v[92:95]
    ds_read_b64_tr_b16 v[58:59], v242 offset:512
    v_mfma_f32_16x16x32_bf16 v[108:111], v[156:159], v[136:139], v[108:111]
    ds_read_b64_tr_b16 v[60:61], v243 offset:0
    v_mfma_f32_16x16x32_bf16 v[124:127], v[156:159], v[140:143], v[124:127]
    ds_read_b64_tr_b16 v[62:63], v243 offset:512
    s_waitcnt lgkmcnt(0)
    s_waitcnt vmcnt(8)
    s_barrier
    v_mfma_f32_16x16x32_bf16 v[64:67], v[48:51], v[32:35], v[64:67]
    s_add_u32 m0, s31, 0x10000
    s_mov_b32 s28, 0xa80000
    buffer_load_dwordx4 v9, s[8:11], s28 offen lds
    v_mfma_f32_16x16x32_bf16 v[80:83], v[48:51], v[36:39], v[80:83]
    ds_read_b128 v[128:131], v3 offset:32768
    v_mfma_f32_16x16x32_bf16 v[96:99], v[48:51], v[40:43], v[96:99]
    ds_read_b128 v[132:135], v3 offset:33024
    v_mfma_f32_16x16x32_bf16 v[112:115], v[48:51], v[44:47], v[112:115]
    ds_read_b128 v[136:139], v3 offset:33280
    v_mfma_f32_16x16x32_bf16 v[68:71], v[52:55], v[32:35], v[68:71]
    s_add_u32 m0, s31, 0x10400
    s_mov_b32 s28, 0xa80400
    buffer_load_dwordx4 v9, s[8:11], s28 offen lds
    v_mfma_f32_16x16x32_bf16 v[84:87], v[52:55], v[36:39], v[84:87]
    ds_read_b128 v[140:143], v3 offset:33536
    v_mfma_f32_16x16x32_bf16 v[100:103], v[52:55], v[40:43], v[100:103]
    ds_read_b64_tr_b16 v[144:145], v240 offset:32768
    v_mfma_f32_16x16x32_bf16 v[116:119], v[52:55], v[44:47], v[116:119]
    ds_read_b64_tr_b16 v[146:147], v240 offset:33280
    v_mfma_f32_16x16x32_bf16 v[72:75], v[56:59], v[32:35], v[72:75]
    s_add_u32 m0, s30, 0x14000
    s_mov_b32 s28, 0x340000
    buffer_load_dwordx4 v10, s[12:15], s28 offen lds
    v_mfma_f32_16x16x32_bf16 v[88:91], v[56:59], v[36:39], v[88:91]
    ds_read_b64_tr_b16 v[148:149], v241 offset:32768
    v_mfma_f32_16x16x32_bf16 v[104:107], v[56:59], v[40:43], v[104:107]
    ds_read_b64_tr_b16 v[150:151], v241 offset:33280
    v_mfma_f32_16x16x32_bf16 v[120:123], v[56:59], v[44:47], v[120:123]
    ds_read_b64_tr_b16 v[152:153], v242 offset:32768
    v_mfma_f32_16x16x32_bf16 v[76:79], v[60:63], v[32:35], v[76:79]
    s_add_u32 m0, s30, 0x16000
    s_mov_b32 s28, 0x340080
    buffer_load_dwordx4 v10, s[12:15], s28 offen lds
    v_mfma_f32_16x16x32_bf16 v[92:95], v[60:63], v[36:39], v[92:95]
    ds_read_b64_tr_b16 v[154:155], v242 offset:33280
    v_mfma_f32_16x16x32_bf16 v[108:111], v[60:63], v[40:43], v[108:111]
    ds_read_b64_tr_b16 v[156:157], v243 offset:32768
    v_mfma_f32_16x16x32_bf16 v[124:127], v[60:63], v[44:47], v[124:127]
    ds_read_b64_tr_b16 v[158:159], v243 offset:33280
    s_waitcnt lgkmcnt(0)
    s_waitcnt vmcnt(8)
    s_barrier
    v_mfma_f32_16x16x32_bf16 v[64:67], v[144:147], v[128:131], v[64:67]
    s_add_u32 m0, s31, 0x18000
    s_mov_b32 s28, 0xac0000
    buffer_load_dwordx4 v9, s[8:11], s28 offen lds
    v_mfma_f32_16x16x32_bf16 v[80:83], v[144:147], v[132:135], v[80:83]
    ds_read_b128 v[32:35], v2 offset:0
    v_mfma_f32_16x16x32_bf16 v[96:99], v[144:147], v[136:139], v[96:99]
    ds_read_b128 v[36:39], v2 offset:256
    v_mfma_f32_16x16x32_bf16 v[112:115], v[144:147], v[140:143], v[112:115]
    ds_read_b128 v[40:43], v2 offset:512
    v_mfma_f32_16x16x32_bf16 v[68:71], v[148:151], v[128:131], v[68:71]
    s_add_u32 m0, s31, 0x18400
    s_mov_b32 s28, 0xac0400
    buffer_load_dwordx4 v9, s[8:11], s28 offen lds
    v_mfma_f32_16x16x32_bf16 v[84:87], v[148:151], v[132:135], v[84:87]
    ds_read_b128 v[44:47], v2 offset:768
    v_mfma_f32_16x16x32_bf16 v[100:103], v[148:151], v[136:139], v[100:103]
    ds_read_b64_tr_b16 v[48:49], v4 offset:0
    v_mfma_f32_16x16x32_bf16 v[116:119], v[148:151], v[140:143], v[116:119]
    ds_read_b64_tr_b16 v[50:51], v4 offset:512
    v_mfma_f32_16x16x32_bf16 v[72:75], v[152:155], v[128:131], v[72:75]
    s_add_u32 m0, s30, 0x1c000
    s_mov_b32 s28, 0x360000
    buffer_load_dwordx4 v10, s[12:15], s28 offen lds
    v_mfma_f32_16x16x32_bf16 v[88:91], v[152:155], v[132:135], v[88:91]
    ds_read_b64_tr_b16 v[52:53], v5 offset:0
    v_mfma_f32_16x16x32_bf16 v[104:107], v[152:155], v[136:139], v[104:107]
    ds_read_b64_tr_b16 v[54:55], v5 offset:512
    v_mfma_f32_16x16x32_bf16 v[120:123], v[152:155], v[140:143], v[120:123]
    ds_read_b64_tr_b16 v[56:57], v6 offset:0
    v_mfma_f32_16x16x32_bf16 v[76:79], v[156:159], v[128:131], v[76:79]
    s_add_u32 m0, s30, 0x1e000
    s_mov_b32 s28, 0x360080
    buffer_load_dwordx4 v10, s[12:15], s28 offen lds
    v_mfma_f32_16x16x32_bf16 v[92:95], v[156:159], v[132:135], v[92:95]
    ds_read_b64_tr_b16 v[58:59], v6 offset:512
    v_mfma_f32_16x16x32_bf16 v[108:111], v[156:159], v[136:139], v[108:111]
    ds_read_b64_tr_b16 v[60:61], v7 offset:0
    v_mfma_f32_16x16x32_bf16 v[124:127], v[156:159], v[140:143], v[124:127]
    ds_read_b64_tr_b16 v[62:63], v7 offset:512
    s_waitcnt lgkmcnt(0)
    s_waitcnt vmcnt(8)
    s_barrier
    v_mfma_f32_16x16x32_bf16 v[64:67], v[48:51], v[32:35], v[64:67]
    s_add_u32 m0, s31, 0x0
    s_mov_b32 s28, 0xb00000
    buffer_load_dwordx4 v9, s[8:11], s28 offen lds
    v_mfma_f32_16x16x32_bf16 v[80:83], v[48:51], v[36:39], v[80:83]
    ds_read_b128 v[128:131], v2 offset:32768
    v_mfma_f32_16x16x32_bf16 v[96:99], v[48:51], v[40:43], v[96:99]
    ds_read_b128 v[132:135], v2 offset:33024
    v_mfma_f32_16x16x32_bf16 v[112:115], v[48:51], v[44:47], v[112:115]
    ds_read_b128 v[136:139], v2 offset:33280
    v_mfma_f32_16x16x32_bf16 v[68:71], v[52:55], v[32:35], v[68:71]
    s_add_u32 m0, s31, 0x400
    s_mov_b32 s28, 0xb00400
    buffer_load_dwordx4 v9, s[8:11], s28 offen lds
    v_mfma_f32_16x16x32_bf16 v[84:87], v[52:55], v[36:39], v[84:87]
    ds_read_b128 v[140:143], v2 offset:33536
    v_mfma_f32_16x16x32_bf16 v[100:103], v[52:55], v[40:43], v[100:103]
    ds_read_b64_tr_b16 v[144:145], v4 offset:32768
    v_mfma_f32_16x16x32_bf16 v[116:119], v[52:55], v[44:47], v[116:119]
    ds_read_b64_tr_b16 v[146:147], v4 offset:33280
    v_mfma_f32_16x16x32_bf16 v[72:75], v[56:59], v[32:35], v[72:75]
    s_add_u32 m0, s30, 0x4000
    s_mov_b32 s28, 0x380000
    buffer_load_dwordx4 v10, s[12:15], s28 offen lds
    v_mfma_f32_16x16x32_bf16 v[88:91], v[56:59], v[36:39], v[88:91]
    ds_read_b64_tr_b16 v[148:149], v5 offset:32768
    v_mfma_f32_16x16x32_bf16 v[104:107], v[56:59], v[40:43], v[104:107]
    ds_read_b64_tr_b16 v[150:151], v5 offset:33280
    v_mfma_f32_16x16x32_bf16 v[120:123], v[56:59], v[44:47], v[120:123]
    ds_read_b64_tr_b16 v[152:153], v6 offset:32768
    v_mfma_f32_16x16x32_bf16 v[76:79], v[60:63], v[32:35], v[76:79]
    s_add_u32 m0, s30, 0x6000
    s_mov_b32 s28, 0x380080
    buffer_load_dwordx4 v10, s[12:15], s28 offen lds
    v_mfma_f32_16x16x32_bf16 v[92:95], v[60:63], v[36:39], v[92:95]
    ds_read_b64_tr_b16 v[154:155], v6 offset:33280
    v_mfma_f32_16x16x32_bf16 v[108:111], v[60:63], v[40:43], v[108:111]
    ds_read_b64_tr_b16 v[156:157], v7 offset:32768
    v_mfma_f32_16x16x32_bf16 v[124:127], v[60:63], v[44:47], v[124:127]
    ds_read_b64_tr_b16 v[158:159], v7 offset:33280
    s_waitcnt lgkmcnt(0)
    s_waitcnt vmcnt(8)
    s_barrier
    v_mfma_f32_16x16x32_bf16 v[64:67], v[144:147], v[128:131], v[64:67]
    s_add_u32 m0, s31, 0x8000
    s_mov_b32 s28, 0xb40000
    buffer_load_dwordx4 v9, s[8:11], s28 offen lds
    v_mfma_f32_16x16x32_bf16 v[80:83], v[144:147], v[132:135], v[80:83]
    ds_read_b128 v[32:35], v3 offset:0
    v_mfma_f32_16x16x32_bf16 v[96:99], v[144:147], v[136:139], v[96:99]
    ds_read_b128 v[36:39], v3 offset:256
    v_mfma_f32_16x16x32_bf16 v[112:115], v[144:147], v[140:143], v[112:115]
    ds_read_b128 v[40:43], v3 offset:512
    v_mfma_f32_16x16x32_bf16 v[68:71], v[148:151], v[128:131], v[68:71]
    s_add_u32 m0, s31, 0x8400
    s_mov_b32 s28, 0xb40400
    buffer_load_dwordx4 v9, s[8:11], s28 offen lds
    v_mfma_f32_16x16x32_bf16 v[84:87], v[148:151], v[132:135], v[84:87]
    ds_read_b128 v[44:47], v3 offset:768
    v_mfma_f32_16x16x32_bf16 v[100:103], v[148:151], v[136:139], v[100:103]
    ds_read_b64_tr_b16 v[48:49], v240 offset:0
    v_mfma_f32_16x16x32_bf16 v[116:119], v[148:151], v[140:143], v[116:119]
    ds_read_b64_tr_b16 v[50:51], v240 offset:512
    v_mfma_f32_16x16x32_bf16 v[72:75], v[152:155], v[128:131], v[72:75]
    s_add_u32 m0, s30, 0xc000
    s_mov_b32 s28, 0x3a0000
    buffer_load_dwordx4 v10, s[12:15], s28 offen lds
    v_mfma_f32_16x16x32_bf16 v[88:91], v[152:155], v[132:135], v[88:91]
    ds_read_b64_tr_b16 v[52:53], v241 offset:0
    v_mfma_f32_16x16x32_bf16 v[104:107], v[152:155], v[136:139], v[104:107]
    ds_read_b64_tr_b16 v[54:55], v241 offset:512
    v_mfma_f32_16x16x32_bf16 v[120:123], v[152:155], v[140:143], v[120:123]
    ds_read_b64_tr_b16 v[56:57], v242 offset:0
    v_mfma_f32_16x16x32_bf16 v[76:79], v[156:159], v[128:131], v[76:79]
    s_add_u32 m0, s30, 0xe000
    s_mov_b32 s28, 0x3a0080
    buffer_load_dwordx4 v10, s[12:15], s28 offen lds
    v_mfma_f32_16x16x32_bf16 v[92:95], v[156:159], v[132:135], v[92:95]
    ds_read_b64_tr_b16 v[58:59], v242 offset:512
    v_mfma_f32_16x16x32_bf16 v[108:111], v[156:159], v[136:139], v[108:111]
    ds_read_b64_tr_b16 v[60:61], v243 offset:0
    v_mfma_f32_16x16x32_bf16 v[124:127], v[156:159], v[140:143], v[124:127]
    ds_read_b64_tr_b16 v[62:63], v243 offset:512
    s_waitcnt lgkmcnt(0)
    s_waitcnt vmcnt(8)
    s_barrier
    v_mfma_f32_16x16x32_bf16 v[64:67], v[48:51], v[32:35], v[64:67]
    s_add_u32 m0, s31, 0x10000
    s_mov_b32 s28, 0xb80000
    buffer_load_dwordx4 v9, s[8:11], s28 offen lds
    v_mfma_f32_16x16x32_bf16 v[80:83], v[48:51], v[36:39], v[80:83]
    ds_read_b128 v[128:131], v3 offset:32768
    v_mfma_f32_16x16x32_bf16 v[96:99], v[48:51], v[40:43], v[96:99]
    ds_read_b128 v[132:135], v3 offset:33024
    v_mfma_f32_16x16x32_bf16 v[112:115], v[48:51], v[44:47], v[112:115]
    ds_read_b128 v[136:139], v3 offset:33280
    v_mfma_f32_16x16x32_bf16 v[68:71], v[52:55], v[32:35], v[68:71]
    s_add_u32 m0, s31, 0x10400
    s_mov_b32 s28, 0xb80400
    buffer_load_dwordx4 v9, s[8:11], s28 offen lds
    v_mfma_f32_16x16x32_bf16 v[84:87], v[52:55], v[36:39], v[84:87]
    ds_read_b128 v[140:143], v3 offset:33536
    v_mfma_f32_16x16x32_bf16 v[100:103], v[52:55], v[40:43], v[100:103]
    ds_read_b64_tr_b16 v[144:145], v240 offset:32768
    v_mfma_f32_16x16x32_bf16 v[116:119], v[52:55], v[44:47], v[116:119]
    ds_read_b64_tr_b16 v[146:147], v240 offset:33280
    v_mfma_f32_16x16x32_bf16 v[72:75], v[56:59], v[32:35], v[72:75]
    s_add_u32 m0, s30, 0x14000
    s_mov_b32 s28, 0x3c0000
    buffer_load_dwordx4 v10, s[12:15], s28 offen lds
    v_mfma_f32_16x16x32_bf16 v[88:91], v[56:59], v[36:39], v[88:91]
    ds_read_b64_tr_b16 v[148:149], v241 offset:32768
    v_mfma_f32_16x16x32_bf16 v[104:107], v[56:59], v[40:43], v[104:107]
    ds_read_b64_tr_b16 v[150:151], v241 offset:33280
    v_mfma_f32_16x16x32_bf16 v[120:123], v[56:59], v[44:47], v[120:123]
    ds_read_b64_tr_b16 v[152:153], v242 offset:32768
    v_mfma_f32_16x16x32_bf16 v[76:79], v[60:63], v[32:35], v[76:79]
    s_add_u32 m0, s30, 0x16000
    s_mov_b32 s28, 0x3c0080
    buffer_load_dwordx4 v10, s[12:15], s28 offen lds
    v_mfma_f32_16x16x32_bf16 v[92:95], v[60:63], v[36:39], v[92:95]
    ds_read_b64_tr_b16 v[154:155], v242 offset:33280
    v_mfma_f32_16x16x32_bf16 v[108:111], v[60:63], v[40:43], v[108:111]
    ds_read_b64_tr_b16 v[156:157], v243 offset:32768
    v_mfma_f32_16x16x32_bf16 v[124:127], v[60:63], v[44:47], v[124:127]
    ds_read_b64_tr_b16 v[158:159], v243 offset:33280
    s_waitcnt lgkmcnt(0)
    s_waitcnt vmcnt(8)
    s_barrier
    v_mfma_f32_16x16x32_bf16 v[64:67], v[144:147], v[128:131], v[64:67]
    s_add_u32 m0, s31, 0x18000
    s_mov_b32 s28, 0xbc0000
    buffer_load_dwordx4 v9, s[8:11], s28 offen lds
    v_mfma_f32_16x16x32_bf16 v[80:83], v[144:147], v[132:135], v[80:83]
    ds_read_b128 v[32:35], v2 offset:0
    v_mfma_f32_16x16x32_bf16 v[96:99], v[144:147], v[136:139], v[96:99]
    ds_read_b128 v[36:39], v2 offset:256
    v_mfma_f32_16x16x32_bf16 v[112:115], v[144:147], v[140:143], v[112:115]
    ds_read_b128 v[40:43], v2 offset:512
    v_mfma_f32_16x16x32_bf16 v[68:71], v[148:151], v[128:131], v[68:71]
    s_add_u32 m0, s31, 0x18400
    s_mov_b32 s28, 0xbc0400
    buffer_load_dwordx4 v9, s[8:11], s28 offen lds
    v_mfma_f32_16x16x32_bf16 v[84:87], v[148:151], v[132:135], v[84:87]
    ds_read_b128 v[44:47], v2 offset:768
    v_mfma_f32_16x16x32_bf16 v[100:103], v[148:151], v[136:139], v[100:103]
    ds_read_b64_tr_b16 v[48:49], v4 offset:0
    v_mfma_f32_16x16x32_bf16 v[116:119], v[148:151], v[140:143], v[116:119]
    ds_read_b64_tr_b16 v[50:51], v4 offset:512
    v_mfma_f32_16x16x32_bf16 v[72:75], v[152:155], v[128:131], v[72:75]
    s_add_u32 m0, s30, 0x1c000
    s_mov_b32 s28, 0x3e0000
    buffer_load_dwordx4 v10, s[12:15], s28 offen lds
    v_mfma_f32_16x16x32_bf16 v[88:91], v[152:155], v[132:135], v[88:91]
    ds_read_b64_tr_b16 v[52:53], v5 offset:0
    v_mfma_f32_16x16x32_bf16 v[104:107], v[152:155], v[136:139], v[104:107]
    ds_read_b64_tr_b16 v[54:55], v5 offset:512
    v_mfma_f32_16x16x32_bf16 v[120:123], v[152:155], v[140:143], v[120:123]
    ds_read_b64_tr_b16 v[56:57], v6 offset:0
    v_mfma_f32_16x16x32_bf16 v[76:79], v[156:159], v[128:131], v[76:79]
    s_add_u32 m0, s30, 0x1e000
    s_mov_b32 s28, 0x3e0080
    buffer_load_dwordx4 v10, s[12:15], s28 offen lds
    v_mfma_f32_16x16x32_bf16 v[92:95], v[156:159], v[132:135], v[92:95]
    ds_read_b64_tr_b16 v[58:59], v6 offset:512
    v_mfma_f32_16x16x32_bf16 v[108:111], v[156:159], v[136:139], v[108:111]
    ds_read_b64_tr_b16 v[60:61], v7 offset:0
    v_mfma_f32_16x16x32_bf16 v[124:127], v[156:159], v[140:143], v[124:127]
    ds_read_b64_tr_b16 v[62:63], v7 offset:512
    s_waitcnt lgkmcnt(0)
    s_waitcnt vmcnt(8)
    s_barrier
    v_mfma_f32_16x16x32_bf16 v[64:67], v[48:51], v[32:35], v[64:67]
    s_add_u32 m0, s31, 0x0
    s_mov_b32 s28, 0xc00000
    buffer_load_dwordx4 v9, s[8:11], s28 offen lds
    v_mfma_f32_16x16x32_bf16 v[80:83], v[48:51], v[36:39], v[80:83]
    ds_read_b128 v[128:131], v2 offset:32768
    v_mfma_f32_16x16x32_bf16 v[96:99], v[48:51], v[40:43], v[96:99]
    ds_read_b128 v[132:135], v2 offset:33024
    v_mfma_f32_16x16x32_bf16 v[112:115], v[48:51], v[44:47], v[112:115]
    ds_read_b128 v[136:139], v2 offset:33280
    v_mfma_f32_16x16x32_bf16 v[68:71], v[52:55], v[32:35], v[68:71]
    s_add_u32 m0, s31, 0x400
    s_mov_b32 s28, 0xc00400
    buffer_load_dwordx4 v9, s[8:11], s28 offen lds
    v_mfma_f32_16x16x32_bf16 v[84:87], v[52:55], v[36:39], v[84:87]
    ds_read_b128 v[140:143], v2 offset:33536
    v_mfma_f32_16x16x32_bf16 v[100:103], v[52:55], v[40:43], v[100:103]
    ds_read_b64_tr_b16 v[144:145], v4 offset:32768
    v_mfma_f32_16x16x32_bf16 v[116:119], v[52:55], v[44:47], v[116:119]
    ds_read_b64_tr_b16 v[146:147], v4 offset:33280
    v_mfma_f32_16x16x32_bf16 v[72:75], v[56:59], v[32:35], v[72:75]
    s_add_u32 m0, s30, 0x4000
    s_mov_b32 s28, 0x400000
    buffer_load_dwordx4 v10, s[12:15], s28 offen lds
    v_mfma_f32_16x16x32_bf16 v[88:91], v[56:59], v[36:39], v[88:91]
    ds_read_b64_tr_b16 v[148:149], v5 offset:32768
    v_mfma_f32_16x16x32_bf16 v[104:107], v[56:59], v[40:43], v[104:107]
    ds_read_b64_tr_b16 v[150:151], v5 offset:33280
    v_mfma_f32_16x16x32_bf16 v[120:123], v[56:59], v[44:47], v[120:123]
    ds_read_b64_tr_b16 v[152:153], v6 offset:32768
    v_mfma_f32_16x16x32_bf16 v[76:79], v[60:63], v[32:35], v[76:79]
    s_add_u32 m0, s30, 0x6000
    s_mov_b32 s28, 0x400080
    buffer_load_dwordx4 v10, s[12:15], s28 offen lds
    v_mfma_f32_16x16x32_bf16 v[92:95], v[60:63], v[36:39], v[92:95]
    ds_read_b64_tr_b16 v[154:155], v6 offset:33280
    v_mfma_f32_16x16x32_bf16 v[108:111], v[60:63], v[40:43], v[108:111]
    ds_read_b64_tr_b16 v[156:157], v7 offset:32768
    v_mfma_f32_16x16x32_bf16 v[124:127], v[60:63], v[44:47], v[124:127]
    ds_read_b64_tr_b16 v[158:159], v7 offset:33280
    s_waitcnt lgkmcnt(0)
    s_waitcnt vmcnt(8)
    s_barrier
    v_mfma_f32_16x16x32_bf16 v[64:67], v[144:147], v[128:131], v[64:67]
    s_add_u32 m0, s31, 0x8000
    s_mov_b32 s28, 0xc40000
    buffer_load_dwordx4 v9, s[8:11], s28 offen lds
    v_mfma_f32_16x16x32_bf16 v[80:83], v[144:147], v[132:135], v[80:83]
    ds_read_b128 v[32:35], v3 offset:0
    v_mfma_f32_16x16x32_bf16 v[96:99], v[144:147], v[136:139], v[96:99]
    ds_read_b128 v[36:39], v3 offset:256
    v_mfma_f32_16x16x32_bf16 v[112:115], v[144:147], v[140:143], v[112:115]
    ds_read_b128 v[40:43], v3 offset:512
    v_mfma_f32_16x16x32_bf16 v[68:71], v[148:151], v[128:131], v[68:71]
    s_add_u32 m0, s31, 0x8400
    s_mov_b32 s28, 0xc40400
    buffer_load_dwordx4 v9, s[8:11], s28 offen lds
    v_mfma_f32_16x16x32_bf16 v[84:87], v[148:151], v[132:135], v[84:87]
    ds_read_b128 v[44:47], v3 offset:768
    v_mfma_f32_16x16x32_bf16 v[100:103], v[148:151], v[136:139], v[100:103]
    ds_read_b64_tr_b16 v[48:49], v240 offset:0
    v_mfma_f32_16x16x32_bf16 v[116:119], v[148:151], v[140:143], v[116:119]
    ds_read_b64_tr_b16 v[50:51], v240 offset:512
    v_mfma_f32_16x16x32_bf16 v[72:75], v[152:155], v[128:131], v[72:75]
    s_add_u32 m0, s30, 0xc000
    s_mov_b32 s28, 0x420000
    buffer_load_dwordx4 v10, s[12:15], s28 offen lds
    v_mfma_f32_16x16x32_bf16 v[88:91], v[152:155], v[132:135], v[88:91]
    ds_read_b64_tr_b16 v[52:53], v241 offset:0
    v_mfma_f32_16x16x32_bf16 v[104:107], v[152:155], v[136:139], v[104:107]
    ds_read_b64_tr_b16 v[54:55], v241 offset:512
    v_mfma_f32_16x16x32_bf16 v[120:123], v[152:155], v[140:143], v[120:123]
    ds_read_b64_tr_b16 v[56:57], v242 offset:0
    v_mfma_f32_16x16x32_bf16 v[76:79], v[156:159], v[128:131], v[76:79]
    s_add_u32 m0, s30, 0xe000
    s_mov_b32 s28, 0x420080
    buffer_load_dwordx4 v10, s[12:15], s28 offen lds
    v_mfma_f32_16x16x32_bf16 v[92:95], v[156:159], v[132:135], v[92:95]
    ds_read_b64_tr_b16 v[58:59], v242 offset:512
    v_mfma_f32_16x16x32_bf16 v[108:111], v[156:159], v[136:139], v[108:111]
    ds_read_b64_tr_b16 v[60:61], v243 offset:0
    v_mfma_f32_16x16x32_bf16 v[124:127], v[156:159], v[140:143], v[124:127]
    ds_read_b64_tr_b16 v[62:63], v243 offset:512
    s_waitcnt lgkmcnt(0)
    s_waitcnt vmcnt(8)
    s_barrier
    v_mfma_f32_16x16x32_bf16 v[64:67], v[48:51], v[32:35], v[64:67]
    s_add_u32 m0, s31, 0x10000
    s_mov_b32 s28, 0xc80000
    buffer_load_dwordx4 v9, s[8:11], s28 offen lds
    v_mfma_f32_16x16x32_bf16 v[80:83], v[48:51], v[36:39], v[80:83]
    ds_read_b128 v[128:131], v3 offset:32768
    v_mfma_f32_16x16x32_bf16 v[96:99], v[48:51], v[40:43], v[96:99]
    ds_read_b128 v[132:135], v3 offset:33024
    v_mfma_f32_16x16x32_bf16 v[112:115], v[48:51], v[44:47], v[112:115]
    ds_read_b128 v[136:139], v3 offset:33280
    v_mfma_f32_16x16x32_bf16 v[68:71], v[52:55], v[32:35], v[68:71]
    s_add_u32 m0, s31, 0x10400
    s_mov_b32 s28, 0xc80400
    buffer_load_dwordx4 v9, s[8:11], s28 offen lds
    v_mfma_f32_16x16x32_bf16 v[84:87], v[52:55], v[36:39], v[84:87]
    ds_read_b128 v[140:143], v3 offset:33536
    v_mfma_f32_16x16x32_bf16 v[100:103], v[52:55], v[40:43], v[100:103]
    ds_read_b64_tr_b16 v[144:145], v240 offset:32768
    v_mfma_f32_16x16x32_bf16 v[116:119], v[52:55], v[44:47], v[116:119]
    ds_read_b64_tr_b16 v[146:147], v240 offset:33280
    v_mfma_f32_16x16x32_bf16 v[72:75], v[56:59], v[32:35], v[72:75]
    s_add_u32 m0, s30, 0x14000
    s_mov_b32 s28, 0x440000
    buffer_load_dwordx4 v10, s[12:15], s28 offen lds
    v_mfma_f32_16x16x32_bf16 v[88:91], v[56:59], v[36:39], v[88:91]
    ds_read_b64_tr_b16 v[148:149], v241 offset:32768
    v_mfma_f32_16x16x32_bf16 v[104:107], v[56:59], v[40:43], v[104:107]
    ds_read_b64_tr_b16 v[150:151], v241 offset:33280
    v_mfma_f32_16x16x32_bf16 v[120:123], v[56:59], v[44:47], v[120:123]
    ds_read_b64_tr_b16 v[152:153], v242 offset:32768
    v_mfma_f32_16x16x32_bf16 v[76:79], v[60:63], v[32:35], v[76:79]
    s_add_u32 m0, s30, 0x16000
    s_mov_b32 s28, 0x440080
    buffer_load_dwordx4 v10, s[12:15], s28 offen lds
    v_mfma_f32_16x16x32_bf16 v[92:95], v[60:63], v[36:39], v[92:95]
    ds_read_b64_tr_b16 v[154:155], v242 offset:33280
    v_mfma_f32_16x16x32_bf16 v[108:111], v[60:63], v[40:43], v[108:111]
    ds_read_b64_tr_b16 v[156:157], v243 offset:32768
    v_mfma_f32_16x16x32_bf16 v[124:127], v[60:63], v[44:47], v[124:127]
    ds_read_b64_tr_b16 v[158:159], v243 offset:33280
    s_waitcnt lgkmcnt(0)
    s_waitcnt vmcnt(8)
    s_barrier
    v_mfma_f32_16x16x32_bf16 v[64:67], v[144:147], v[128:131], v[64:67]
    s_add_u32 m0, s31, 0x18000
    s_mov_b32 s28, 0xcc0000
    buffer_load_dwordx4 v9, s[8:11], s28 offen lds
    v_mfma_f32_16x16x32_bf16 v[80:83], v[144:147], v[132:135], v[80:83]
    ds_read_b128 v[32:35], v2 offset:0
    v_mfma_f32_16x16x32_bf16 v[96:99], v[144:147], v[136:139], v[96:99]
    ds_read_b128 v[36:39], v2 offset:256
    v_mfma_f32_16x16x32_bf16 v[112:115], v[144:147], v[140:143], v[112:115]
    ds_read_b128 v[40:43], v2 offset:512
    v_mfma_f32_16x16x32_bf16 v[68:71], v[148:151], v[128:131], v[68:71]
    s_add_u32 m0, s31, 0x18400
    s_mov_b32 s28, 0xcc0400
    buffer_load_dwordx4 v9, s[8:11], s28 offen lds
    v_mfma_f32_16x16x32_bf16 v[84:87], v[148:151], v[132:135], v[84:87]
    ds_read_b128 v[44:47], v2 offset:768
    v_mfma_f32_16x16x32_bf16 v[100:103], v[148:151], v[136:139], v[100:103]
    ds_read_b64_tr_b16 v[48:49], v4 offset:0
    v_mfma_f32_16x16x32_bf16 v[116:119], v[148:151], v[140:143], v[116:119]
    ds_read_b64_tr_b16 v[50:51], v4 offset:512
    v_mfma_f32_16x16x32_bf16 v[72:75], v[152:155], v[128:131], v[72:75]
    s_add_u32 m0, s30, 0x1c000
    s_mov_b32 s28, 0x460000
    buffer_load_dwordx4 v10, s[12:15], s28 offen lds
    v_mfma_f32_16x16x32_bf16 v[88:91], v[152:155], v[132:135], v[88:91]
    ds_read_b64_tr_b16 v[52:53], v5 offset:0
    v_mfma_f32_16x16x32_bf16 v[104:107], v[152:155], v[136:139], v[104:107]
    ds_read_b64_tr_b16 v[54:55], v5 offset:512
    v_mfma_f32_16x16x32_bf16 v[120:123], v[152:155], v[140:143], v[120:123]
    ds_read_b64_tr_b16 v[56:57], v6 offset:0
    v_mfma_f32_16x16x32_bf16 v[76:79], v[156:159], v[128:131], v[76:79]
    s_add_u32 m0, s30, 0x1e000
    s_mov_b32 s28, 0x460080
    buffer_load_dwordx4 v10, s[12:15], s28 offen lds
    v_mfma_f32_16x16x32_bf16 v[92:95], v[156:159], v[132:135], v[92:95]
    ds_read_b64_tr_b16 v[58:59], v6 offset:512
    v_mfma_f32_16x16x32_bf16 v[108:111], v[156:159], v[136:139], v[108:111]
    ds_read_b64_tr_b16 v[60:61], v7 offset:0
    v_mfma_f32_16x16x32_bf16 v[124:127], v[156:159], v[140:143], v[124:127]
    ds_read_b64_tr_b16 v[62:63], v7 offset:512
    s_waitcnt lgkmcnt(0)
    s_waitcnt vmcnt(8)
    s_barrier
    v_mfma_f32_16x16x32_bf16 v[64:67], v[48:51], v[32:35], v[64:67]
    s_add_u32 m0, s31, 0x0
    s_mov_b32 s28, 0xd00000
    buffer_load_dwordx4 v9, s[8:11], s28 offen lds
    v_mfma_f32_16x16x32_bf16 v[80:83], v[48:51], v[36:39], v[80:83]
    ds_read_b128 v[128:131], v2 offset:32768
    v_mfma_f32_16x16x32_bf16 v[96:99], v[48:51], v[40:43], v[96:99]
    ds_read_b128 v[132:135], v2 offset:33024
    v_mfma_f32_16x16x32_bf16 v[112:115], v[48:51], v[44:47], v[112:115]
    ds_read_b128 v[136:139], v2 offset:33280
    v_mfma_f32_16x16x32_bf16 v[68:71], v[52:55], v[32:35], v[68:71]
    s_add_u32 m0, s31, 0x400
    s_mov_b32 s28, 0xd00400
    buffer_load_dwordx4 v9, s[8:11], s28 offen lds
    v_mfma_f32_16x16x32_bf16 v[84:87], v[52:55], v[36:39], v[84:87]
    ds_read_b128 v[140:143], v2 offset:33536
    v_mfma_f32_16x16x32_bf16 v[100:103], v[52:55], v[40:43], v[100:103]
    ds_read_b64_tr_b16 v[144:145], v4 offset:32768
    v_mfma_f32_16x16x32_bf16 v[116:119], v[52:55], v[44:47], v[116:119]
    ds_read_b64_tr_b16 v[146:147], v4 offset:33280
    v_mfma_f32_16x16x32_bf16 v[72:75], v[56:59], v[32:35], v[72:75]
    s_add_u32 m0, s30, 0x4000
    s_mov_b32 s28, 0x480000
    buffer_load_dwordx4 v10, s[12:15], s28 offen lds
    v_mfma_f32_16x16x32_bf16 v[88:91], v[56:59], v[36:39], v[88:91]
    ds_read_b64_tr_b16 v[148:149], v5 offset:32768
    v_mfma_f32_16x16x32_bf16 v[104:107], v[56:59], v[40:43], v[104:107]
    ds_read_b64_tr_b16 v[150:151], v5 offset:33280
    v_mfma_f32_16x16x32_bf16 v[120:123], v[56:59], v[44:47], v[120:123]
    ds_read_b64_tr_b16 v[152:153], v6 offset:32768
    v_mfma_f32_16x16x32_bf16 v[76:79], v[60:63], v[32:35], v[76:79]
    s_add_u32 m0, s30, 0x6000
    s_mov_b32 s28, 0x480080
    buffer_load_dwordx4 v10, s[12:15], s28 offen lds
    v_mfma_f32_16x16x32_bf16 v[92:95], v[60:63], v[36:39], v[92:95]
    ds_read_b64_tr_b16 v[154:155], v6 offset:33280
    v_mfma_f32_16x16x32_bf16 v[108:111], v[60:63], v[40:43], v[108:111]
    ds_read_b64_tr_b16 v[156:157], v7 offset:32768
    v_mfma_f32_16x16x32_bf16 v[124:127], v[60:63], v[44:47], v[124:127]
    ds_read_b64_tr_b16 v[158:159], v7 offset:33280
    s_waitcnt lgkmcnt(0)
    s_waitcnt vmcnt(8)
    s_barrier
    v_mfma_f32_16x16x32_bf16 v[64:67], v[144:147], v[128:131], v[64:67]
    s_add_u32 m0, s31, 0x8000
    s_mov_b32 s28, 0xd40000
    buffer_load_dwordx4 v9, s[8:11], s28 offen lds
    v_mfma_f32_16x16x32_bf16 v[80:83], v[144:147], v[132:135], v[80:83]
    ds_read_b128 v[32:35], v3 offset:0
    v_mfma_f32_16x16x32_bf16 v[96:99], v[144:147], v[136:139], v[96:99]
    ds_read_b128 v[36:39], v3 offset:256
    v_mfma_f32_16x16x32_bf16 v[112:115], v[144:147], v[140:143], v[112:115]
    ds_read_b128 v[40:43], v3 offset:512
    v_mfma_f32_16x16x32_bf16 v[68:71], v[148:151], v[128:131], v[68:71]
    s_add_u32 m0, s31, 0x8400
    s_mov_b32 s28, 0xd40400
    buffer_load_dwordx4 v9, s[8:11], s28 offen lds
    v_mfma_f32_16x16x32_bf16 v[84:87], v[148:151], v[132:135], v[84:87]
    ds_read_b128 v[44:47], v3 offset:768
    v_mfma_f32_16x16x32_bf16 v[100:103], v[148:151], v[136:139], v[100:103]
    ds_read_b64_tr_b16 v[48:49], v240 offset:0
    v_mfma_f32_16x16x32_bf16 v[116:119], v[148:151], v[140:143], v[116:119]
    ds_read_b64_tr_b16 v[50:51], v240 offset:512
    v_mfma_f32_16x16x32_bf16 v[72:75], v[152:155], v[128:131], v[72:75]
    s_add_u32 m0, s30, 0xc000
    s_mov_b32 s28, 0x4a0000
    buffer_load_dwordx4 v10, s[12:15], s28 offen lds
    v_mfma_f32_16x16x32_bf16 v[88:91], v[152:155], v[132:135], v[88:91]
    ds_read_b64_tr_b16 v[52:53], v241 offset:0
    v_mfma_f32_16x16x32_bf16 v[104:107], v[152:155], v[136:139], v[104:107]
    ds_read_b64_tr_b16 v[54:55], v241 offset:512
    v_mfma_f32_16x16x32_bf16 v[120:123], v[152:155], v[140:143], v[120:123]
    ds_read_b64_tr_b16 v[56:57], v242 offset:0
    v_mfma_f32_16x16x32_bf16 v[76:79], v[156:159], v[128:131], v[76:79]
    s_add_u32 m0, s30, 0xe000
    s_mov_b32 s28, 0x4a0080
    buffer_load_dwordx4 v10, s[12:15], s28 offen lds
    v_mfma_f32_16x16x32_bf16 v[92:95], v[156:159], v[132:135], v[92:95]
    ds_read_b64_tr_b16 v[58:59], v242 offset:512
    v_mfma_f32_16x16x32_bf16 v[108:111], v[156:159], v[136:139], v[108:111]
    ds_read_b64_tr_b16 v[60:61], v243 offset:0
    v_mfma_f32_16x16x32_bf16 v[124:127], v[156:159], v[140:143], v[124:127]
    ds_read_b64_tr_b16 v[62:63], v243 offset:512
    s_waitcnt lgkmcnt(0)
    s_waitcnt vmcnt(8)
    s_barrier
    v_mfma_f32_16x16x32_bf16 v[64:67], v[48:51], v[32:35], v[64:67]
    s_add_u32 m0, s31, 0x10000
    s_mov_b32 s28, 0xd80000
    buffer_load_dwordx4 v9, s[8:11], s28 offen lds
    v_mfma_f32_16x16x32_bf16 v[80:83], v[48:51], v[36:39], v[80:83]
    ds_read_b128 v[128:131], v3 offset:32768
    v_mfma_f32_16x16x32_bf16 v[96:99], v[48:51], v[40:43], v[96:99]
    ds_read_b128 v[132:135], v3 offset:33024
    v_mfma_f32_16x16x32_bf16 v[112:115], v[48:51], v[44:47], v[112:115]
    ds_read_b128 v[136:139], v3 offset:33280
    v_mfma_f32_16x16x32_bf16 v[68:71], v[52:55], v[32:35], v[68:71]
    s_add_u32 m0, s31, 0x10400
    s_mov_b32 s28, 0xd80400
    buffer_load_dwordx4 v9, s[8:11], s28 offen lds
    v_mfma_f32_16x16x32_bf16 v[84:87], v[52:55], v[36:39], v[84:87]
    ds_read_b128 v[140:143], v3 offset:33536
    v_mfma_f32_16x16x32_bf16 v[100:103], v[52:55], v[40:43], v[100:103]
    ds_read_b64_tr_b16 v[144:145], v240 offset:32768
    v_mfma_f32_16x16x32_bf16 v[116:119], v[52:55], v[44:47], v[116:119]
    ds_read_b64_tr_b16 v[146:147], v240 offset:33280
    v_mfma_f32_16x16x32_bf16 v[72:75], v[56:59], v[32:35], v[72:75]
    s_add_u32 m0, s30, 0x14000
    s_mov_b32 s28, 0x4c0000
    buffer_load_dwordx4 v10, s[12:15], s28 offen lds
    v_mfma_f32_16x16x32_bf16 v[88:91], v[56:59], v[36:39], v[88:91]
    ds_read_b64_tr_b16 v[148:149], v241 offset:32768
    v_mfma_f32_16x16x32_bf16 v[104:107], v[56:59], v[40:43], v[104:107]
    ds_read_b64_tr_b16 v[150:151], v241 offset:33280
    v_mfma_f32_16x16x32_bf16 v[120:123], v[56:59], v[44:47], v[120:123]
    ds_read_b64_tr_b16 v[152:153], v242 offset:32768
    v_mfma_f32_16x16x32_bf16 v[76:79], v[60:63], v[32:35], v[76:79]
    s_add_u32 m0, s30, 0x16000
    s_mov_b32 s28, 0x4c0080
    buffer_load_dwordx4 v10, s[12:15], s28 offen lds
    v_mfma_f32_16x16x32_bf16 v[92:95], v[60:63], v[36:39], v[92:95]
    ds_read_b64_tr_b16 v[154:155], v242 offset:33280
    v_mfma_f32_16x16x32_bf16 v[108:111], v[60:63], v[40:43], v[108:111]
    ds_read_b64_tr_b16 v[156:157], v243 offset:32768
    v_mfma_f32_16x16x32_bf16 v[124:127], v[60:63], v[44:47], v[124:127]
    ds_read_b64_tr_b16 v[158:159], v243 offset:33280
    s_waitcnt lgkmcnt(0)
    s_waitcnt vmcnt(8)
    s_barrier
    v_mfma_f32_16x16x32_bf16 v[64:67], v[144:147], v[128:131], v[64:67]
    s_add_u32 m0, s31, 0x18000
    s_mov_b32 s28, 0xdc0000
    buffer_load_dwordx4 v9, s[8:11], s28 offen lds
    v_mfma_f32_16x16x32_bf16 v[80:83], v[144:147], v[132:135], v[80:83]
    ds_read_b128 v[32:35], v2 offset:0
    v_mfma_f32_16x16x32_bf16 v[96:99], v[144:147], v[136:139], v[96:99]
    ds_read_b128 v[36:39], v2 offset:256
    v_mfma_f32_16x16x32_bf16 v[112:115], v[144:147], v[140:143], v[112:115]
    ds_read_b128 v[40:43], v2 offset:512
    v_mfma_f32_16x16x32_bf16 v[68:71], v[148:151], v[128:131], v[68:71]
    s_add_u32 m0, s31, 0x18400
    s_mov_b32 s28, 0xdc0400
    buffer_load_dwordx4 v9, s[8:11], s28 offen lds
    v_mfma_f32_16x16x32_bf16 v[84:87], v[148:151], v[132:135], v[84:87]
    ds_read_b128 v[44:47], v2 offset:768
    v_mfma_f32_16x16x32_bf16 v[100:103], v[148:151], v[136:139], v[100:103]
    ds_read_b64_tr_b16 v[48:49], v4 offset:0
    v_mfma_f32_16x16x32_bf16 v[116:119], v[148:151], v[140:143], v[116:119]
    ds_read_b64_tr_b16 v[50:51], v4 offset:512
    v_mfma_f32_16x16x32_bf16 v[72:75], v[152:155], v[128:131], v[72:75]
    s_add_u32 m0, s30, 0x1c000
    s_mov_b32 s28, 0x4e0000
    buffer_load_dwordx4 v10, s[12:15], s28 offen lds
    v_mfma_f32_16x16x32_bf16 v[88:91], v[152:155], v[132:135], v[88:91]
    ds_read_b64_tr_b16 v[52:53], v5 offset:0
    v_mfma_f32_16x16x32_bf16 v[104:107], v[152:155], v[136:139], v[104:107]
    ds_read_b64_tr_b16 v[54:55], v5 offset:512
    v_mfma_f32_16x16x32_bf16 v[120:123], v[152:155], v[140:143], v[120:123]
    ds_read_b64_tr_b16 v[56:57], v6 offset:0
    v_mfma_f32_16x16x32_bf16 v[76:79], v[156:159], v[128:131], v[76:79]
    s_add_u32 m0, s30, 0x1e000
    s_mov_b32 s28, 0x4e0080
    buffer_load_dwordx4 v10, s[12:15], s28 offen lds
    v_mfma_f32_16x16x32_bf16 v[92:95], v[156:159], v[132:135], v[92:95]
    ds_read_b64_tr_b16 v[58:59], v6 offset:512
    v_mfma_f32_16x16x32_bf16 v[108:111], v[156:159], v[136:139], v[108:111]
    ds_read_b64_tr_b16 v[60:61], v7 offset:0
    v_mfma_f32_16x16x32_bf16 v[124:127], v[156:159], v[140:143], v[124:127]
    ds_read_b64_tr_b16 v[62:63], v7 offset:512
    s_waitcnt lgkmcnt(0)
    s_waitcnt vmcnt(8)
    s_barrier
    v_mfma_f32_16x16x32_bf16 v[64:67], v[48:51], v[32:35], v[64:67]
    s_add_u32 m0, s31, 0x0
    s_mov_b32 s28, 0xe00000
    buffer_load_dwordx4 v9, s[8:11], s28 offen lds
    v_mfma_f32_16x16x32_bf16 v[80:83], v[48:51], v[36:39], v[80:83]
    ds_read_b128 v[128:131], v2 offset:32768
    v_mfma_f32_16x16x32_bf16 v[96:99], v[48:51], v[40:43], v[96:99]
    ds_read_b128 v[132:135], v2 offset:33024
    v_mfma_f32_16x16x32_bf16 v[112:115], v[48:51], v[44:47], v[112:115]
    ds_read_b128 v[136:139], v2 offset:33280
    v_mfma_f32_16x16x32_bf16 v[68:71], v[52:55], v[32:35], v[68:71]
    s_add_u32 m0, s31, 0x400
    s_mov_b32 s28, 0xe00400
    buffer_load_dwordx4 v9, s[8:11], s28 offen lds
    v_mfma_f32_16x16x32_bf16 v[84:87], v[52:55], v[36:39], v[84:87]
    ds_read_b128 v[140:143], v2 offset:33536
    v_mfma_f32_16x16x32_bf16 v[100:103], v[52:55], v[40:43], v[100:103]
    ds_read_b64_tr_b16 v[144:145], v4 offset:32768
    v_mfma_f32_16x16x32_bf16 v[116:119], v[52:55], v[44:47], v[116:119]
    ds_read_b64_tr_b16 v[146:147], v4 offset:33280
    v_mfma_f32_16x16x32_bf16 v[72:75], v[56:59], v[32:35], v[72:75]
    s_add_u32 m0, s30, 0x4000
    s_mov_b32 s28, 0x500000
    buffer_load_dwordx4 v10, s[12:15], s28 offen lds
    v_mfma_f32_16x16x32_bf16 v[88:91], v[56:59], v[36:39], v[88:91]
    ds_read_b64_tr_b16 v[148:149], v5 offset:32768
    v_mfma_f32_16x16x32_bf16 v[104:107], v[56:59], v[40:43], v[104:107]
    ds_read_b64_tr_b16 v[150:151], v5 offset:33280
    v_mfma_f32_16x16x32_bf16 v[120:123], v[56:59], v[44:47], v[120:123]
    ds_read_b64_tr_b16 v[152:153], v6 offset:32768
    v_mfma_f32_16x16x32_bf16 v[76:79], v[60:63], v[32:35], v[76:79]
    s_add_u32 m0, s30, 0x6000
    s_mov_b32 s28, 0x500080
    buffer_load_dwordx4 v10, s[12:15], s28 offen lds
    v_mfma_f32_16x16x32_bf16 v[92:95], v[60:63], v[36:39], v[92:95]
    ds_read_b64_tr_b16 v[154:155], v6 offset:33280
    v_mfma_f32_16x16x32_bf16 v[108:111], v[60:63], v[40:43], v[108:111]
    ds_read_b64_tr_b16 v[156:157], v7 offset:32768
    v_mfma_f32_16x16x32_bf16 v[124:127], v[60:63], v[44:47], v[124:127]
    ds_read_b64_tr_b16 v[158:159], v7 offset:33280
    s_waitcnt lgkmcnt(0)
    s_waitcnt vmcnt(8)
    s_barrier
    v_mfma_f32_16x16x32_bf16 v[64:67], v[144:147], v[128:131], v[64:67]
    ds_read_b128 v[32:35], v3 offset:0
    v_mfma_f32_16x16x32_bf16 v[80:83], v[144:147], v[132:135], v[80:83]
    ds_read_b128 v[36:39], v3 offset:256
    v_mfma_f32_16x16x32_bf16 v[96:99], v[144:147], v[136:139], v[96:99]
    ds_read_b128 v[40:43], v3 offset:512
    v_mfma_f32_16x16x32_bf16 v[112:115], v[144:147], v[140:143], v[112:115]
    ds_read_b128 v[44:47], v3 offset:768
    v_mfma_f32_16x16x32_bf16 v[68:71], v[148:151], v[128:131], v[68:71]
    ds_read_b64_tr_b16 v[48:49], v240 offset:0
    v_mfma_f32_16x16x32_bf16 v[84:87], v[148:151], v[132:135], v[84:87]
    ds_read_b64_tr_b16 v[50:51], v240 offset:512
    v_mfma_f32_16x16x32_bf16 v[100:103], v[148:151], v[136:139], v[100:103]
    ds_read_b64_tr_b16 v[52:53], v241 offset:0
    v_mfma_f32_16x16x32_bf16 v[116:119], v[148:151], v[140:143], v[116:119]
    ds_read_b64_tr_b16 v[54:55], v241 offset:512
    v_mfma_f32_16x16x32_bf16 v[72:75], v[152:155], v[128:131], v[72:75]
    ds_read_b64_tr_b16 v[56:57], v242 offset:0
    v_mfma_f32_16x16x32_bf16 v[88:91], v[152:155], v[132:135], v[88:91]
    ds_read_b64_tr_b16 v[58:59], v242 offset:512
    v_mfma_f32_16x16x32_bf16 v[104:107], v[152:155], v[136:139], v[104:107]
    ds_read_b64_tr_b16 v[60:61], v243 offset:0
    v_mfma_f32_16x16x32_bf16 v[120:123], v[152:155], v[140:143], v[120:123]
    ds_read_b64_tr_b16 v[62:63], v243 offset:512
    v_mfma_f32_16x16x32_bf16 v[76:79], v[156:159], v[128:131], v[76:79]
    v_mfma_f32_16x16x32_bf16 v[92:95], v[156:159], v[132:135], v[92:95]
    v_mfma_f32_16x16x32_bf16 v[108:111], v[156:159], v[136:139], v[108:111]
    v_mfma_f32_16x16x32_bf16 v[124:127], v[156:159], v[140:143], v[124:127]
    s_waitcnt lgkmcnt(0)
    s_waitcnt vmcnt(4)
    s_barrier
    v_mfma_f32_16x16x32_bf16 v[64:67], v[48:51], v[32:35], v[64:67]
    ds_read_b128 v[128:131], v3 offset:32768
    v_mfma_f32_16x16x32_bf16 v[80:83], v[48:51], v[36:39], v[80:83]
    ds_read_b128 v[132:135], v3 offset:33024
    v_mfma_f32_16x16x32_bf16 v[96:99], v[48:51], v[40:43], v[96:99]
    ds_read_b128 v[136:139], v3 offset:33280
    v_mfma_f32_16x16x32_bf16 v[112:115], v[48:51], v[44:47], v[112:115]
    ds_read_b128 v[140:143], v3 offset:33536
    v_mfma_f32_16x16x32_bf16 v[68:71], v[52:55], v[32:35], v[68:71]
    ds_read_b64_tr_b16 v[144:145], v240 offset:32768
    v_mfma_f32_16x16x32_bf16 v[84:87], v[52:55], v[36:39], v[84:87]
    ds_read_b64_tr_b16 v[146:147], v240 offset:33280
    v_mfma_f32_16x16x32_bf16 v[100:103], v[52:55], v[40:43], v[100:103]
    ds_read_b64_tr_b16 v[148:149], v241 offset:32768
    v_mfma_f32_16x16x32_bf16 v[116:119], v[52:55], v[44:47], v[116:119]
    ds_read_b64_tr_b16 v[150:151], v241 offset:33280
    v_mfma_f32_16x16x32_bf16 v[72:75], v[56:59], v[32:35], v[72:75]
    ds_read_b64_tr_b16 v[152:153], v242 offset:32768
    v_mfma_f32_16x16x32_bf16 v[88:91], v[56:59], v[36:39], v[88:91]
    ds_read_b64_tr_b16 v[154:155], v242 offset:33280
    v_mfma_f32_16x16x32_bf16 v[104:107], v[56:59], v[40:43], v[104:107]
    ds_read_b64_tr_b16 v[156:157], v243 offset:32768
    v_mfma_f32_16x16x32_bf16 v[120:123], v[56:59], v[44:47], v[120:123]
    ds_read_b64_tr_b16 v[158:159], v243 offset:33280
    v_mfma_f32_16x16x32_bf16 v[76:79], v[60:63], v[32:35], v[76:79]
    v_mfma_f32_16x16x32_bf16 v[92:95], v[60:63], v[36:39], v[92:95]
    v_mfma_f32_16x16x32_bf16 v[108:111], v[60:63], v[40:43], v[108:111]
    v_mfma_f32_16x16x32_bf16 v[124:127], v[60:63], v[44:47], v[124:127]
    s_waitcnt lgkmcnt(0)
    s_waitcnt vmcnt(0)
    s_barrier
    v_mfma_f32_16x16x32_bf16 v[64:67], v[144:147], v[128:131], v[64:67]
    ds_read_b128 v[32:35], v2 offset:0
    v_mfma_f32_16x16x32_bf16 v[80:83], v[144:147], v[132:135], v[80:83]
    ds_read_b128 v[36:39], v2 offset:256
    v_mfma_f32_16x16x32_bf16 v[96:99], v[144:147], v[136:139], v[96:99]
    ds_read_b128 v[40:43], v2 offset:512
    v_mfma_f32_16x16x32_bf16 v[112:115], v[144:147], v[140:143], v[112:115]
    ds_read_b128 v[44:47], v2 offset:768
    v_mfma_f32_16x16x32_bf16 v[68:71], v[148:151], v[128:131], v[68:71]
    ds_read_b64_tr_b16 v[48:49], v4 offset:0
    v_mfma_f32_16x16x32_bf16 v[84:87], v[148:151], v[132:135], v[84:87]
    ds_read_b64_tr_b16 v[50:51], v4 offset:512
    v_mfma_f32_16x16x32_bf16 v[100:103], v[148:151], v[136:139], v[100:103]
    ds_read_b64_tr_b16 v[52:53], v5 offset:0
    v_mfma_f32_16x16x32_bf16 v[116:119], v[148:151], v[140:143], v[116:119]
    ds_read_b64_tr_b16 v[54:55], v5 offset:512
    v_mfma_f32_16x16x32_bf16 v[72:75], v[152:155], v[128:131], v[72:75]
    ds_read_b64_tr_b16 v[56:57], v6 offset:0
    v_mfma_f32_16x16x32_bf16 v[88:91], v[152:155], v[132:135], v[88:91]
    ds_read_b64_tr_b16 v[58:59], v6 offset:512
    v_mfma_f32_16x16x32_bf16 v[104:107], v[152:155], v[136:139], v[104:107]
    ds_read_b64_tr_b16 v[60:61], v7 offset:0
    v_mfma_f32_16x16x32_bf16 v[120:123], v[152:155], v[140:143], v[120:123]
    ds_read_b64_tr_b16 v[62:63], v7 offset:512
    v_mfma_f32_16x16x32_bf16 v[76:79], v[156:159], v[128:131], v[76:79]
    v_mfma_f32_16x16x32_bf16 v[92:95], v[156:159], v[132:135], v[92:95]
    v_mfma_f32_16x16x32_bf16 v[108:111], v[156:159], v[136:139], v[108:111]
    v_mfma_f32_16x16x32_bf16 v[124:127], v[156:159], v[140:143], v[124:127]
    s_waitcnt lgkmcnt(0)
    s_barrier
    v_mfma_f32_16x16x32_bf16 v[64:67], v[48:51], v[32:35], v[64:67]
    v_mfma_f32_16x16x32_bf16 v[80:83], v[48:51], v[36:39], v[80:83]
    v_mfma_f32_16x16x32_bf16 v[96:99], v[48:51], v[40:43], v[96:99]
    v_mfma_f32_16x16x32_bf16 v[112:115], v[48:51], v[44:47], v[112:115]
    v_mfma_f32_16x16x32_bf16 v[68:71], v[52:55], v[32:35], v[68:71]
    v_mfma_f32_16x16x32_bf16 v[84:87], v[52:55], v[36:39], v[84:87]
    v_mfma_f32_16x16x32_bf16 v[100:103], v[52:55], v[40:43], v[100:103]
    v_mfma_f32_16x16x32_bf16 v[116:119], v[52:55], v[44:47], v[116:119]
    v_mfma_f32_16x16x32_bf16 v[72:75], v[56:59], v[32:35], v[72:75]
    v_mfma_f32_16x16x32_bf16 v[88:91], v[56:59], v[36:39], v[88:91]
    v_mfma_f32_16x16x32_bf16 v[104:107], v[56:59], v[40:43], v[104:107]
    v_mfma_f32_16x16x32_bf16 v[120:123], v[56:59], v[44:47], v[120:123]
    v_mfma_f32_16x16x32_bf16 v[76:79], v[60:63], v[32:35], v[76:79]
    v_mfma_f32_16x16x32_bf16 v[92:95], v[60:63], v[36:39], v[92:95]
    v_mfma_f32_16x16x32_bf16 v[108:111], v[60:63], v[40:43], v[108:111]
    v_mfma_f32_16x16x32_bf16 v[124:127], v[60:63], v[44:47], v[124:127]
    s_waitcnt lgkmcnt(0)
g2_tail:
    v_lshlrev_b32 v17, 4, v14
    s_and_b32 s28, s20, 3
    s_lshl_b32 s28, s28, 14
    s_xor_b32 s29, s22, 1
    s_lshl_b32 s29, s29, 13
    s_add_u32 s29, s29, s28
    v_add_u32 v18, s29, v17
    s_lshl_b32 s29, s22, 13
    s_add_u32 s29, s29, s28
    v_add_u32 v19, s29, v17
    s_cmp_eq_u32 s22, 0
    s_cbranch_scc0 g2_ks1
    ds_write_b128 v18, v[96:99] offset:0
    ds_write_b128 v18, v[100:103] offset:1024
    ds_write_b128 v18, v[104:107] offset:2048
    ds_write_b128 v18, v[108:111] offset:3072
    ds_write_b128 v18, v[112:115] offset:4096
    ds_write_b128 v18, v[116:119] offset:5120
    ds_write_b128 v18, v[120:123] offset:6144
    ds_write_b128 v18, v[124:127] offset:7168
    s_branch g2_ksd
g2_ks1:
    ds_write_b128 v18, v[64:67] offset:0
    ds_write_b128 v18, v[68:71] offset:1024
    ds_write_b128 v18, v[72:75] offset:2048
    ds_write_b128 v18, v[76:79] offset:3072
    ds_write_b128 v18, v[80:83] offset:4096
    ds_write_b128 v18, v[84:87] offset:5120
    ds_write_b128 v18, v[88:91] offset:6144
    ds_write_b128 v18, v[92:95] offset:7168
    v_mov_b32 v64, v96
    v_mov_b32 v65, v97
    v_mov_b32 v66, v98
    v_mov_b32 v67, v99
    v_mov_b32 v68, v100
    v_mov_b32 v69, v101
    v_mov_b32 v70, v102
    v_mov_b32 v71, v103
    v_mov_b32 v72, v104
    v_mov_b32 v73, v105
    v_mov_b32 v74, v106
    v_mov_b32 v75, v107
    v_mov_b32 v76, v108
    v_mov_b32 v77, v109
    v_mov_b32 v78, v110
    v_mov_b32 v79, v111
    v_mov_b32 v80, v112
    v_mov_b32 v81, v113
    v_mov_b32 v82, v114
    v_mov_b32 v83, v115
    v_mov_b32 v84, v116
    v_mov_b32 v85, v117
    v_mov_b32 v86, v118
    v_mov_b32 v87, v119
    v_mov_b32 v88, v120
    v_mov_b32 v89, v121
    v_mov_b32 v90, v122
    v_mov_b32 v91, v123
    v_mov_b32 v92, v124
    v_mov_b32 v93, v125
    v_mov_b32 v94, v126
    v_mov_b32 v95, v127
g2_ksd:
    s_waitcnt lgkmcnt(0)
    s_barrier
    ds_read_b128 v[128:131], v19 offset:0
    ds_read_b128 v[132:135], v19 offset:1024
    ds_read_b128 v[136:139], v19 offset:2048
    ds_read_b128 v[140:143], v19 offset:3072
    ds_read_b128 v[144:147], v19 offset:4096
    ds_read_b128 v[148:151], v19 offset:5120
    ds_read_b128 v[152:155], v19 offset:6144
    ds_read_b128 v[156:159], v19 offset:7168
    s_waitcnt lgkmcnt(0)
    v_add_f32 v64, v64, v128
    v_add_f32 v65, v65, v129
    v_add_f32 v66, v66, v130
    v_add_f32 v67, v67, v131
    v_add_f32 v68, v68, v132
    v_add_f32 v69, v69, v133
    v_add_f32 v70, v70, v134
    v_add_f32 v71, v71, v135
    v_add_f32 v72, v72, v136
    v_add_f32 v73, v73, v137
    v_add_f32 v74, v74, v138
    v_add_f32 v75, v75, v139
    v_add_f32 v76, v76, v140
    v_add_f32 v77, v77, v141
    v_add_f32 v78, v78, v142
    v_add_f32 v79, v79, v143
    v_add_f32 v80, v80, v144
    v_add_f32 v81, v81, v145
    v_add_f32 v82, v82, v146
    v_add_f32 v83, v83, v147
    v_add_f32 v84, v84, v148
    v_add_f32 v85, v85, v149
    v_add_f32 v86, v86, v150
    v_add_f32 v87, v87, v151
    v_add_f32 v88, v88, v152
    v_add_f32 v89, v89, v153
    v_add_f32 v90, v90, v154
    v_add_f32 v91, v91, v155
    v_add_f32 v92, v92, v156
    v_add_f32 v93, v93, v157
    v_add_f32 v94, v94, v158
    v_add_f32 v95, v95, v159
    s_lshl_b32 s28, s21, 1
    s_add_u32 s28, s28, s22
    s_lshl_b32 s67, s28, 7
    s_lshl_b32 s28, s28, 13
    v_add_u32 v18, s28, v17
    s_cmp_eq_u32 s23, s33
    s_cbranch_scc1 g2_recv
    s_lshl_b32 s28, s2, 15
    buffer_store_dwordx4 v[64:67], v18, s[48:51], s28 offen offset:0 sc1
    buffer_store_dwordx4 v[68:71], v18, s[48:51], s28 offen offset:1024 sc1
    buffer_store_dwordx4 v[72:75], v18, s[48:51], s28 offen offset:2048 sc1
    buffer_store_dwordx4 v[76:79], v18, s[48:51], s28 offen offset:3072 sc1
    s_add_u32 s29, s28, 4096
    buffer_store_dwordx4 v[80:83], v18, s[48:51], s29 offen offset:0 sc1
    buffer_store_dwordx4 v[84:87], v18, s[48:51], s29 offen offset:1024 sc1
    buffer_store_dwordx4 v[88:91], v18, s[48:51], s29 offen offset:2048 sc1
    buffer_store_dwordx4 v[92:95], v18, s[48:51], s29 offen offset:3072 sc1
    s_waitcnt vmcnt(0)
    s_lshl_b32 s28, s2, 9
    s_add_u32 s28, s28, s67
    v_mov_b32 v1, 1
    v_mov_b32 v2, s28
    s_mov_b64 exec, 1
    buffer_store_dword v1, v2, s[52:55], 0 offen sc1
    s_branch g2_fin
g2_recv:
    v_lshrrev_b32 v19, 3, v14
    v_and_b32 v20, 7, v14
    s_lshl_b32 s28, s24, 7
    s_lshl_b32 s29, s21, 6
    s_add_u32 s28, s28, s29
    s_lshl_b32 s29, s22, 5
    s_add_u32 s28, s28, s29
    v_add_u32 v21, s28, v19
    v_lshlrev_b32 v21, 11, v21
    s_lshl_b32 s29, s23, 7
    s_add_u32 s29, s29, s32
    v_lshl_add_u32 v22, v20, 4, s29
    v_add_u32 v21, v21, v22
    s_mov_b32 s34, 0
    buffer_load_dwordx4 v[32:35], v21, s[40:43], s34 offen
    s_mov_b32 s34, 16384
    buffer_load_dwordx4 v[36:39], v21, s[40:43], s34 offen
    s_mov_b32 s34, 32768
    buffer_load_dwordx4 v[40:43], v21, s[40:43], s34 offen
    s_mov_b32 s34, 49152
    buffer_load_dwordx4 v[44:47], v21, s[40:43], s34 offen
    buffer_load_dwordx4 v[48:51], v22, s[36:39], 0 offen
    s_mul_i32 s28, s20, 8704
    s_add_u32 s28, s28, 65536
    v_mul_u32_u24 v23, 272, v16
    v_lshl_add_u32 v23, v15, 4, v23
    v_add_u32 v23, s28, v23
    v_mul_u32_u24 v19, 272, v19
    v_lshl_add_u32 v19, v20, 5, v19
    v_add_u32 v19, s28, v19
    s_xor_b32 s35, s2, 128
    s_lshl_b32 s28, s35, 9
    s_add_u32 s28, s28, s67
    v_mov_b32 v2, s28
g2_poll:
    buffer_load_dword v1, v2, s[52:55], 0 offen sc1
    s_waitcnt vmcnt(0)
    v_readfirstlane_b32 s28, v1
    s_nop 1
    s_nop 3
    s_cmp_eq_u32 s28, 1
    s_cbranch_scc1 g2_ready
    s_sleep 1
    s_branch g2_poll
g2_ready:
    s_lshl_b32 s28, s35, 15
    s_add_u32 s29, s28, 4096
    buffer_load_dwordx4 v[128:131], v18, s[48:51], s28 offen offset:0 sc1
    buffer_load_dwordx4 v[132:135], v18, s[48:51], s28 offen offset:1024 sc1
    buffer_load_dwordx4 v[136:139], v18, s[48:51], s28 offen offset:2048 sc1
    buffer_load_dwordx4 v[140:143], v18, s[48:51], s28 offen offset:3072 sc1
    buffer_load_dwordx4 v[144:147], v18, s[48:51], s29 offen offset:0 sc1
    buffer_load_dwordx4 v[148:151], v18, s[48:51], s29 offen offset:1024 sc1
    buffer_load_dwordx4 v[152:155], v18, s[48:51], s29 offen offset:2048 sc1
    buffer_load_dwordx4 v[156:159], v18, s[48:51], s29 offen offset:3072 sc1
    s_mov_b32 s66, 0xffff0000
    s_waitcnt vmcnt(0)
    v_add_f32 v64, v64, v128
    v_add_f32 v65, v65, v129
    v_add_f32 v66, v66, v130
    v_add_f32 v67, v67, v131
    v_add_f32 v68, v68, v132
    v_add_f32 v69, v69, v133
    v_add_f32 v70, v70, v134
    v_add_f32 v71, v71, v135
    v_add_f32 v72, v72, v136
    v_add_f32 v73, v73, v137
    v_add_f32 v74, v74, v138
    v_add_f32 v75, v75, v139
    v_add_f32 v76, v76, v140
    v_add_f32 v77, v77, v141
    v_add_f32 v78, v78, v142
    v_add_f32 v79, v79, v143
    v_add_f32 v80, v80, v144
    v_add_f32 v81, v81, v145
    v_add_f32 v82, v82, v146
    v_add_f32 v83, v83, v147
    v_add_f32 v84, v84, v148
    v_add_f32 v85, v85, v149
    v_add_f32 v86, v86, v150
    v_add_f32 v87, v87, v151
    v_add_f32 v88, v88, v152
    v_add_f32 v89, v89, v153
    v_add_f32 v90, v90, v154
    v_add_f32 v91, v91, v155
    v_add_f32 v92, v92, v156
    v_add_f32 v93, v93, v157
    v_add_f32 v94, v94, v158
    v_add_f32 v95, v95, v159
    ds_write_b128 v23, v[64:67] offset:0
    ds_write_b128 v23, v[68:71] offset:64
    ds_write_b128 v23, v[72:75] offset:128
    ds_write_b128 v23, v[76:79] offset:192
    ds_write_b128 v23, v[80:83] offset:4352
    ds_write_b128 v23, v[84:87] offset:4416
    ds_write_b128 v23, v[88:91] offset:4480
    ds_write_b128 v23, v[92:95] offset:4544
    v_lshlrev_b32 v52, 16, v48
    v_and_b32 v53, s66, v48
    v_lshlrev_b32 v54, 16, v49
    v_and_b32 v55, s66, v49
    v_lshlrev_b32 v56, 16, v50
    v_and_b32 v57, s66, v50
    v_lshlrev_b32 v58, 16, v51
    v_and_b32 v59, s66, v51
    s_waitcnt lgkmcnt(0)
    ds_read_b128 v[128:131], v19 offset:0
    ds_read_b128 v[132:135], v19 offset:16
    ds_read_b128 v[136:139], v19 offset:2176
    ds_read_b128 v[140:143], v19 offset:2192
    ds_read_b128 v[144:147], v19 offset:4352
    ds_read_b128 v[148:151], v19 offset:4368
    ds_read_b128 v[152:155], v19 offset:6528
    ds_read_b128 v[156:159], v19 offset:6544
    s_waitcnt lgkmcnt(6)
    v_lshlrev_b32 v60, 16, v32
    v_and_b32 v61, s66, v32
    v_add_f32 v128, v128, v52
    v_add_f32 v129, v129, v53
    v_add_f32 v128, v128, v60
    v_add_f32 v129, v129, v61
    v_cvt_pk_bf16_f32 v160, v128, v129
    v_lshlrev_b32 v60, 16, v33
    v_and_b32 v61, s66, v33
    v_add_f32 v130, v130, v54
    v_add_f32 v131, v131, v55
    v_add_f32 v130, v130, v60
    v_add_f32 v131, v131, v61
    v_cvt_pk_bf16_f32 v161, v130, v131
    v_lshlrev_b32 v60, 16, v34
    v_and_b32 v61, s66, v34
    v_add_f32 v132, v132, v56
    v_add_f32 v133, v133, v57
    v_add_f32 v132, v132, v60
    v_add_f32 v133, v133, v61
    v_cvt_pk_bf16_f32 v162, v132, v133
    v_lshlrev_b32 v60, 16, v35
    v_and_b32 v61, s66, v35
    v_add_f32 v134, v134, v58
    v_add_f32 v135, v135, v59
    v_add_f32 v134, v134, v60
    v_add_f32 v135, v135, v61
    v_cvt_pk_bf16_f32 v163, v134, v135
    s_mov_b32 s34, 0
    buffer_store_dwordx4 v[160:163], v21, s[44:47], s34 offen
    s_waitcnt lgkmcnt(4)
    v_lshlrev_b32 v60, 16, v36
    v_and_b32 v61, s66, v36
    v_add_f32 v136, v136, v52
    v_add_f32 v137, v137, v53
    v_add_f32 v136, v136, v60
    v_add_f32 v137, v137, v61
    v_cvt_pk_bf16_f32 v164, v136, v137
    v_lshlrev_b32 v60, 16, v37
    v_and_b32 v61, s66, v37
    v_add_f32 v138, v138, v54
    v_add_f32 v139, v139, v55
    v_add_f32 v138, v138, v60
    v_add_f32 v139, v139, v61
    v_cvt_pk_bf16_f32 v165, v138, v139
    v_lshlrev_b32 v60, 16, v38
    v_and_b32 v61, s66, v38
    v_add_f32 v140, v140, v56
    v_add_f32 v141, v141, v57
    v_add_f32 v140, v140, v60
    v_add_f32 v141, v141, v61
    v_cvt_pk_bf16_f32 v166, v140, v141
    v_lshlrev_b32 v60, 16, v39
    v_and_b32 v61, s66, v39
    v_add_f32 v142, v142, v58
    v_add_f32 v143, v143, v59
    v_add_f32 v142, v142, v60
    v_add_f32 v143, v143, v61
    v_cvt_pk_bf16_f32 v167, v142, v143
    s_mov_b32 s34, 16384
    buffer_store_dwordx4 v[164:167], v21, s[44:47], s34 offen
    s_waitcnt lgkmcnt(2)
    v_lshlrev_b32 v60, 16, v40
    v_and_b32 v61, s66, v40
    v_add_f32 v144, v144, v52
    v_add_f32 v145, v145, v53
    v_add_f32 v144, v144, v60
    v_add_f32 v145, v145, v61
    v_cvt_pk_bf16_f32 v168, v144, v145
    v_lshlrev_b32 v60, 16, v41
    v_and_b32 v61, s66, v41
    v_add_f32 v146, v146, v54
    v_add_f32 v147, v147, v55
    v_add_f32 v146, v146, v60
    v_add_f32 v147, v147, v61
    v_cvt_pk_bf16_f32 v169, v146, v147
    v_lshlrev_b32 v60, 16, v42
    v_and_b32 v61, s66, v42
    v_add_f32 v148, v148, v56
    v_add_f32 v149, v149, v57
    v_add_f32 v148, v148, v60
    v_add_f32 v149, v149, v61
    v_cvt_pk_bf16_f32 v170, v148, v149
    v_lshlrev_b32 v60, 16, v43
    v_and_b32 v61, s66, v43
    v_add_f32 v150, v150, v58
    v_add_f32 v151, v151, v59
    v_add_f32 v150, v150, v60
    v_add_f32 v151, v151, v61
    v_cvt_pk_bf16_f32 v171, v150, v151
    s_mov_b32 s34, 32768
    buffer_store_dwordx4 v[168:171], v21, s[44:47], s34 offen
    s_waitcnt lgkmcnt(0)
    v_lshlrev_b32 v60, 16, v44
    v_and_b32 v61, s66, v44
    v_add_f32 v152, v152, v52
    v_add_f32 v153, v153, v53
    v_add_f32 v152, v152, v60
    v_add_f32 v153, v153, v61
    v_cvt_pk_bf16_f32 v172, v152, v153
    v_lshlrev_b32 v60, 16, v45
    v_and_b32 v61, s66, v45
    v_add_f32 v154, v154, v54
    v_add_f32 v155, v155, v55
    v_add_f32 v154, v154, v60
    v_add_f32 v155, v155, v61
    v_cvt_pk_bf16_f32 v173, v154, v155
    v_lshlrev_b32 v60, 16, v46
    v_and_b32 v61, s66, v46
    v_add_f32 v156, v156, v56
    v_add_f32 v157, v157, v57
    v_add_f32 v156, v156, v60
    v_add_f32 v157, v157, v61
    v_cvt_pk_bf16_f32 v174, v156, v157
    v_lshlrev_b32 v60, 16, v47
    v_and_b32 v61, s66, v47
    v_add_f32 v158, v158, v58
    v_add_f32 v159, v159, v59
    v_add_f32 v158, v158, v60
    v_add_f32 v159, v159, v61
    v_cvt_pk_bf16_f32 v175, v158, v159
    s_mov_b32 s34, 49152
    buffer_store_dwordx4 v[172:175], v21, s[44:47], s34 offen
g2_fin:
g2_exit:
    s_endpgm
.section .rodata,"a"
.p2align 6
.amdhsa_kernel ln_kernel
  .amdhsa_next_free_vgpr 72
  .amdhsa_next_free_sgpr 40
  .amdhsa_accum_offset 72
  .amdhsa_group_segment_fixed_size 0
  .amdhsa_kernarg_size 96
  .amdhsa_user_sgpr_count 2
  .amdhsa_user_sgpr_kernarg_segment_ptr 1
  .amdhsa_system_sgpr_workgroup_id_x 1
.end_amdhsa_kernel
.p2align 6
.amdhsa_kernel gemm1_kernel
  .amdhsa_next_free_vgpr 256
  .amdhsa_next_free_sgpr 102
  .amdhsa_accum_offset 256
  .amdhsa_group_segment_fixed_size 0
  .amdhsa_kernarg_size 96
  .amdhsa_user_sgpr_count 2
  .amdhsa_user_sgpr_kernarg_segment_ptr 1
  .amdhsa_system_sgpr_workgroup_id_x 1
.end_amdhsa_kernel
```
